```python
import torch

def _softmax(x, axis=-1):
    return torch.softmax(x, dim=axis)
def _gelu(x):
    return torch.nn.functional.gelu(x, approximate="tanh")
def _silu(x):
    return torch.nn.functional.silu(x)
def _sigmoid(x):
    return torch.sigmoid(x)
def _layernorm(x, axis=-1, eps=1e-5):
    m = x.mean(dim=axis, keepdim=True)
    v = x.var(dim=axis, keepdim=True, unbiased=False)
    return (x - m) / torch.sqrt(v + eps)
def _scatter_add(tgt, idx, src, axis=0):
    return tgt.clone().index_add_(axis, idx, src)
def _segment_sum(src, seg, n):
    out = torch.zeros((n,) + src.shape[1:], dtype=src.dtype)
    return out.index_add_(0, seg, src)
def _pad(x, pw):
    flat = tuple(v for pair in reversed(pw) for v in pair)
    return torch.nn.functional.pad(x, flat)

kernel_name = 'recurrent_scan__mha_block_cached__mixer_channel_mlp__prompt'

def setup_inputs():

    _w = (lambda a: (lambda t: t.to(torch.bfloat16) if t.is_floating_point() else t)(torch.as_tensor(a)))
    def _A_setup():
        B, Sq, D = 1, 2048, 512
        H, Sk, Dh = 32, 2048, 128
        return {
            "x": _w((lambda *s: torch.randn(*s, dtype=torch.bfloat16) * 0.05)(B, Sq, D)),
            "k_cache": _w((lambda *s: torch.randn(*s, dtype=torch.bfloat16) * 1.6)(B, H, Sk, Dh)),
            "v_cache": _w((lambda *s: torch.randn(*s, dtype=torch.bfloat16) * 0.8)(B, H, Sk, Dh)),
            "wq": _w((lambda *s: torch.randn(*s, dtype=torch.bfloat16) * 1.6)(D, H * Dh) * (D ** -0.5)),
            "wo": _w((lambda *s: torch.randn(*s, dtype=torch.bfloat16) * 0.8)(H * Dh, D) * ((H * Dh) ** -0.5)),
        }
    _A_in = _A_setup()

    def _B_setup():
        B, S, D, F = 1, 2048, 512, 1376
        return {
            "x": _w((lambda *s: torch.randn(*s, dtype=torch.bfloat16) * 0.05)(B, S, D)),
            "w1": _w((lambda *s: torch.randn(*s, dtype=torch.bfloat16) * 1.6)(D, F) * (D ** -0.5)),
            "b1": _w((lambda *s: torch.randn(*s, dtype=torch.bfloat16) * 0.8)(F)),
            "w2": _w((lambda *s: torch.randn(*s, dtype=torch.bfloat16) * 0.2)(F, D) * (F ** -0.5)),
            "b2": _w((lambda *s: torch.randn(*s, dtype=torch.bfloat16) * 0.2)(D)),
        }
    _B_in = _B_setup()

    return {
        "A_x": _A_in["x"],
        "A_k_cache": _A_in["k_cache"],
        "A_v_cache": _A_in["v_cache"],
        "A_wq": _A_in["wq"],
        "A_wo": _A_in["wo"],
        "B_x": _B_in["x"],
        "B_w1": _B_in["w1"],
        "B_b1": _B_in["b1"],
        "B_w2": _B_in["w2"],
        "B_b2": _B_in["b2"],
    }

def reference(A_x, A_k_cache, A_v_cache, A_wq, A_wo, B_x, B_w1, B_b1, B_w2, B_b2):
    def _A_ref(x, k_cache, v_cache, wq, wo):
        B, Sq, D = x.shape
        H, Dh = 32, 128
        q = (lambda x, *d: x.permute(*d))((x @ wq).reshape(B, Sq, H, Dh), 0, 2, 1, 3)
        scores = torch.einsum("bhqd,bhkd->bhqk", q, k_cache) * (Dh ** -0.5)
        p = _softmax(scores, axis=-1)
        o = torch.einsum("bhqk,bhkd->bhqd", p, v_cache)
        return (lambda x, *d: x.permute(*d))(o, 0, 2, 1, 3).reshape(B, Sq, H * Dh) @ wo

    def _B_ref(x, w1, b1, w2, b2):
        y = _layernorm(x, axis=-1)
        h = _gelu(torch.einsum("bsd,df->bsf", y, w1) + b1)
        return torch.einsum("bsf,fd->bsd", h, w2) + b2

    x = A_x
    xn = _layernorm(x, axis=-1)
    s = _A_ref(xn, A_k_cache, A_v_cache, A_wq, A_wo)
    g = _silu(_B_ref(xn, B_w1, B_b1, B_w2, B_b2))
    return x + s * g
```

```asm
; @launch grid=(256,1,1) block=(256,1,1) lds=163840
.amdgcn_target "amdgcn-amd-amdhsa--gfx950"
.text
.globl recurrent_scan__mha_block_cached__mixer_channel_mlp__prompt_kernel
.p2align 8
.type recurrent_scan__mha_block_cached__mixer_channel_mlp__prompt_kernel,@function
recurrent_scan__mha_block_cached__mixer_channel_mlp__prompt_kernel:
    s_cmp_ge_u32 s2, 256
    s_cbranch_scc1 L_k2_end
    s_load_dwordx8 s[32:39], s[0:1], 0
    s_load_dwordx4 s[68:71], s[0:1], 48
    s_load_dwordx2 s[72:73], s[0:1], 96
    v_lshrrev_b32 v104, 6, v0
    s_and_b32 s26, s2, 7
    s_lshl_b32 s26, s26, 2
    s_bfe_u32 s27, s2, 0x20003
    v_readfirstlane_b32 s20, v104
    s_add_u32 s21, s26, s27
    s_lshr_b32 s22, s2, 5
    s_bfe_u32 s30, s2, 0x20001
    s_lshl_b32 s30, s30, 2
    s_lshr_b32 s30, 12576, s30
    s_and_b32 s30, s30, 3
    s_lshl_b32 s30, s30, 2
    s_add_u32 s30, s30, s27
    s_and_b32 s65, s30, 1
    s_lshl_b32 s65, s65, 5
    s_lshr_b32 s25, s30, 1
    s_sub_u32 s31, s30, 5
    s_cmp_ge_u32 s30, 10
    s_cselect_b32 s25, s31, s25
    s_cselect_b32 s65, 0, s65
    s_bitcmp1_b32 s2, 0
    s_cselect_b32 s25, 0x40000, s25
    s_cselect_b32 s65, 0, s65
    s_add_u32 s25, s25, 32
    s_lshl_b32 s24, s20, 12
    s_lshl_b32 s64, s20, 11
    s_lshl_b32 s60, s20, 13
    s_lshl_b32 s61, s22, 18
    s_lshl_b32 s26, s20, 16
    s_add_u32 s61, s61, s26
    s_lshl_b32 s26, s65, 10
    s_add_u32 s61, s61, s26
    s_xor_b32 s28, s27, s22
    s_and_b32 s28, s28, 1
    s_lshl_b32 s28, s28, 2
    s_lshl_b32 s62, s20, 17
    s_lshl_b32 s26, s21, 8
    s_add_u32 s62, s62, s26
    s_mul_i32 s63, s20, 44032
    s_mov_b32 s23, s24
    v_and_b32 v102, 63, v0
    s_getpc_b64 s[56:57]
L_code0:
    s_mov_b32 s58, L_attn_exact-L_code0
    s_mov_b32 s59, 0x20000
    s_lshr_b32 s26, s2, 3
    s_lshl_b32 s26, s26, 2
    s_add_u32 s26, s26, s20
    s_mul_i32 s26, s26, 768
    v_mul_u32_u24 v72, 12, v102
    buffer_load_dwordx3 v[74:76], v72, s[56:59], s26 offen
    v_lshrrev_b32 v64, 3, v102
    v_lshrrev_b32 v65, 4, v102
    v_and_b32 v66, 7, v102
    v_add_u32 v67, 0, v65
    v_xor_b32 v67, v67, v66
    v_lshlrev_b32 v67, 4, v67
    v_lshl_add_u32 v0, v64, 10, v67
    v_add_u32 v67, 4, v65
    v_xor_b32 v67, v67, v66
    v_lshlrev_b32 v67, 4, v67
    v_lshl_add_u32 v1, v64, 10, v67
    v_add_u32 v1, 7168, v1
    v_add_u32 v2, 14336, v0
    v_add_u32 v3, 14336, v1
    v_and_b32 v66, 15, v102
    v_lshlrev_b32 v67, 2, v65
    v_xor_b32 v67, v67, v66
    v_lshlrev_b32 v67, 4, v67
    v_lshl_add_u32 v8, v65, 13, v67
    v_add_u32 v9, 31744, v8
    v_add_u32 v10, 63488, v8
    v_add_u32 v11, 95232, v8
    s_lshl_b32 s30, s21, 6
    s_lshl_b32 s31, s25, 6
    s_movk_i32 s29, 2752
    v_mov_b32 v69, s31
    v_and_b32 v66, 7, v102
    v_and_b32 v67, 1, v65
    v_lshlrev_b32 v67, 1, v67
    v_xor_b32 v66, v66, v67
    v_and_b32 v67, 3, v66
    v_lshlrev_b32 v67, 4, v67
    v_mov_b32 v68, s30
    v_cmp_gt_u32 vcc, 4, v66
    s_nop 1
    v_cndmask_b32 v68, v69, v68, vcc
    v_add_u32 v67, v67, v68
    v_mad_u32_u24 v12, v64, s29, v67
    v_and_b32 v66, 7, v102
    v_and_b32 v67, 1, v65
    v_lshlrev_b32 v67, 1, v67
    v_xor_b32 v66, v66, v67
    v_xor_b32 v66, 4, v66
    v_and_b32 v67, 3, v66
    v_lshlrev_b32 v67, 4, v67
    v_mov_b32 v68, s30
    v_cmp_gt_u32 vcc, 4, v66
    s_nop 1
    v_cndmask_b32 v68, v69, v68, vcc
    v_add_u32 v67, v67, v68
    v_mad_u32_u24 v13, v64, s29, v67
    v_add_u32 v13, 20992, v13
    s_waitcnt lgkmcnt(0)
    s_mov_b32 s16, s32
    s_mov_b32 s17, s33
    s_mov_b32 s18, 2097152
    s_mov_b32 s19, 0x20000
    s_mov_b32 s40, s38
    s_mov_b32 s41, s39
    s_mov_b32 s42, 4194304
    s_mov_b32 s43, 0x20000
    s_mov_b32 s44, s68
    s_mov_b32 s45, s69
    s_mov_b32 s46, 1409024
    s_mov_b32 s47, 0x20000
    s_add_u32 s78, s28, 0
    s_and_b32 s78, s78, 7
    s_lshl_b32 s79, s78, 19
    s_add_u32 s76, s62, s79
    s_mul_i32 s79, s78, 176128
    s_add_u32 s77, s63, s79
    s_add_u32 m0, s24, 65536
    s_nop 0
    buffer_load_dwordx4 v8, s[40:43], s76 offen offset:0 lds
    buffer_load_dwordx4 v9, s[40:43], s76 offen offset:1024 lds
    buffer_load_dwordx4 v10, s[40:43], s76 offen offset:2048 lds
    buffer_load_dwordx4 v11, s[40:43], s76 offen offset:3072 lds
    s_add_u32 m0, s64, 81920
    s_nop 0
    buffer_load_dwordx4 v12, s[44:47], s77 offen offset:0 lds
    buffer_load_dwordx4 v13, s[44:47], s77 offen offset:1024 lds
    s_add_u32 s78, s28, 0
    s_and_b32 s78, s78, 7
    s_lshl_b32 s78, s78, 7
    s_add_u32 s74, s61, s78
    s_xor_b32 s75, s74, 0x8000
    s_add_u32 m0, s60, 0
    s_nop 0
    buffer_load_dwordx4 v0, s[16:19], s74 offen offset:0 lds
    buffer_load_dwordx4 v1, s[16:19], s74 offen offset:1024 lds
    buffer_load_dwordx4 v2, s[16:19], s74 offen offset:2048 lds
    buffer_load_dwordx4 v3, s[16:19], s74 offen offset:3072 lds
    s_add_u32 m0, s60, 4096
    s_nop 0
    buffer_load_dwordx4 v0, s[16:19], s75 offen offset:0 lds
    buffer_load_dwordx4 v1, s[16:19], s75 offen offset:1024 lds
    buffer_load_dwordx4 v2, s[16:19], s75 offen offset:2048 lds
    buffer_load_dwordx4 v3, s[16:19], s75 offen offset:3072 lds
    s_add_u32 s78, s28, 1
    s_and_b32 s78, s78, 7
    s_lshl_b32 s78, s78, 7
    s_add_u32 s74, s61, s78
    s_xor_b32 s75, s74, 0x8000
    s_add_u32 m0, s60, 32768
    s_nop 0
    buffer_load_dwordx4 v0, s[16:19], s74 offen offset:0 lds
    buffer_load_dwordx4 v1, s[16:19], s74 offen offset:1024 lds
    buffer_load_dwordx4 v2, s[16:19], s74 offen offset:2048 lds
    buffer_load_dwordx4 v3, s[16:19], s74 offen offset:3072 lds
    s_add_u32 m0, s60, 36864
    s_nop 0
    buffer_load_dwordx4 v0, s[16:19], s75 offen offset:0 lds
    buffer_load_dwordx4 v1, s[16:19], s75 offen offset:1024 lds
    buffer_load_dwordx4 v2, s[16:19], s75 offen offset:2048 lds
    buffer_load_dwordx4 v3, s[16:19], s75 offen offset:3072 lds
    s_add_u32 s78, s28, 1
    s_and_b32 s78, s78, 7
    s_lshl_b32 s79, s78, 19
    s_add_u32 s76, s62, s79
    s_mul_i32 s79, s78, 176128
    s_add_u32 s77, s63, s79
    s_add_u32 m0, s24, 90112
    s_nop 0
    buffer_load_dwordx4 v8, s[40:43], s76 offen offset:0 lds
    buffer_load_dwordx4 v9, s[40:43], s76 offen offset:1024 lds
    buffer_load_dwordx4 v10, s[40:43], s76 offen offset:2048 lds
    buffer_load_dwordx4 v11, s[40:43], s76 offen offset:3072 lds
    s_add_u32 m0, s64, 106496
    s_nop 0
    buffer_load_dwordx4 v12, s[44:47], s77 offen offset:0 lds
    buffer_load_dwordx4 v13, s[44:47], s77 offen offset:1024 lds
    v_lshrrev_b32 v65, 4, v102
    v_and_b32 v66, 15, v102
    v_lshrrev_b32 v67, 1, v66
    v_lshlrev_b32 v66, 7, v66
    v_add_u32 v66, s60, v66
    v_add_u32 v64, 0, v65
    v_xor_b32 v64, v64, v67
    v_lshl_add_u32 v14, v64, 4, v66
    v_add_u32 v64, 4, v65
    v_xor_b32 v64, v64, v67
    v_lshl_add_u32 v15, v64, 4, v66
    v_bfe_u32 v66, v102, 2, 2
    v_lshl_add_u32 v64, v65, 3, v66
    v_and_b32 v68, 1, v65
    v_and_b32 v65, 3, v102
    v_lshlrev_b32 v69, 4, v65
    v_lshl_add_u32 v69, v64, 8, v69
    v_add_u32 v69, 65536, v69
    s_xor_b32 s29, s20, 0
    v_xor_b32 v67, s29, v66
    v_lshl_add_u32 v16, v67, 6, v69
    s_xor_b32 s29, s20, 1
    v_xor_b32 v67, s29, v66
    v_lshl_add_u32 v17, v67, 6, v69
    s_xor_b32 s29, s20, 2
    v_xor_b32 v67, s29, v66
    v_lshl_add_u32 v18, v67, 6, v69
    s_xor_b32 s29, s20, 3
    v_xor_b32 v67, s29, v66
    v_lshl_add_u32 v19, v67, 6, v69
    v_lshrrev_b32 v66, 1, v66
    v_lshl_add_u32 v66, v68, 1, v66
    v_lshlrev_b32 v65, 3, v65
    v_lshl_add_u32 v65, v64, 7, v65
    v_add_u32 v65, 81920, v65
    v_xor_b32 v67, 0, v66
    v_lshl_add_u32 v20, v67, 5, v65
    v_xor_b32 v67, 1, v66
    v_lshl_add_u32 v21, v67, 5, v65
    v_xor_b32 v67, 2, v66
    v_lshl_add_u32 v22, v67, 5, v65
    v_xor_b32 v67, 3, v66
    v_lshl_add_u32 v23, v67, 5, v65
    v_xor_b32 v67, s20, v66
    v_lshl_add_u32 v4, v67, 5, v65
    v_mov_b32 v64, 0x3f803f80
    v_accvgpr_write_b32 a96, v64
    v_accvgpr_write_b32 a97, v64
    v_accvgpr_write_b32 a98, v64
    v_accvgpr_write_b32 a99, v64
    s_cmp_lt_u32 s25, 43
    s_cbranch_scc0 L_light
    s_cmp_lt_u32 s25, 37
    s_cbranch_scc1 L_medium
    s_waitcnt vmcnt(14)
    s_barrier
    ds_read_b128 a[0:3], v14 offset:0
    ds_read_b128 a[4:7], v14 offset:2048
    ds_read_b128 a[8:11], v14 offset:4096
    ds_read_b128 a[12:15], v14 offset:6144
    ds_read_b128 a[16:19], v15 offset:0
    ds_read_b128 a[20:23], v15 offset:2048
    ds_read_b128 a[24:27], v15 offset:4096
    ds_read_b128 a[28:31], v15 offset:6144
    ds_read_b64_tr_b16 a[64:65], v16 offset:0
    ds_read_b64_tr_b16 a[66:67], v16 offset:1024
    ds_read_b64_tr_b16 a[68:69], v16 offset:8192
    ds_read_b64_tr_b16 a[70:71], v16 offset:9216
    ds_read_b64_tr_b16 a[72:73], v16 offset:8
    ds_read_b64_tr_b16 a[74:75], v16 offset:1032
    ds_read_b64_tr_b16 a[76:77], v16 offset:8200
    ds_read_b64_tr_b16 a[78:79], v16 offset:9224
    s_waitcnt lgkmcnt(4)
    v_mfma_f32_16x16x32_bf16 v[128:131], a[64:67], a[0:3], 0
    ds_read_b64_tr_b16 a[80:81], v17 offset:0
    v_mfma_f32_16x16x32_bf16 v[128:131], a[68:71], a[16:19], v[128:131]
    ds_read_b64_tr_b16 a[82:83], v17 offset:1024
    v_mfma_f32_16x16x32_bf16 v[160:163], a[64:67], a[4:7], 0
    ds_read_b64_tr_b16 a[84:85], v17 offset:8192
    v_mfma_f32_16x16x32_bf16 v[160:163], a[68:71], a[20:23], v[160:163]
    ds_read_b64_tr_b16 a[86:87], v17 offset:9216
    s_add_u32 s78, s28, 2
    s_and_b32 s78, s78, 7
    s_lshl_b32 s78, s78, 7
    s_add_u32 s74, s61, s78
    s_xor_b32 s75, s74, 0x8000
    s_add_u32 m0, s60, 0
    v_mfma_f32_16x16x32_bf16 v[192:195], a[64:67], a[8:11], 0
    buffer_load_dwordx4 v0, s[16:19], s74 offen offset:0 lds
    v_mfma_f32_16x16x32_bf16 v[192:195], a[68:71], a[24:27], v[192:195]
    buffer_load_dwordx4 v1, s[16:19], s74 offen offset:1024 lds
    v_mfma_f32_16x16x32_bf16 v[224:227], a[64:67], a[12:15], 0
    buffer_load_dwordx4 v2, s[16:19], s74 offen offset:2048 lds
    v_mfma_f32_16x16x32_bf16 v[224:227], a[68:71], a[28:31], v[224:227]
    buffer_load_dwordx4 v3, s[16:19], s74 offen offset:3072 lds
    v_mfma_f32_16x16x32_bf16 a[224:227], a[64:67], a[96:99], 0
    v_mfma_f32_16x16x32_bf16 a[224:227], a[68:71], a[96:99], a[224:227]
    s_waitcnt lgkmcnt(4)
    v_mfma_f32_16x16x32_bf16 v[132:135], a[72:75], a[0:3], 0
    ds_read_b64_tr_b16 a[88:89], v17 offset:8
    v_mfma_f32_16x16x32_bf16 v[132:135], a[76:79], a[16:19], v[132:135]
    ds_read_b64_tr_b16 a[90:91], v17 offset:1032
    v_mfma_f32_16x16x32_bf16 v[164:167], a[72:75], a[4:7], 0
    ds_read_b64_tr_b16 a[92:93], v17 offset:8200
    v_mfma_f32_16x16x32_bf16 v[164:167], a[76:79], a[20:23], v[164:167]
    ds_read_b64_tr_b16 a[94:95], v17 offset:9224
    s_add_u32 m0, s60, 4096
    v_mfma_f32_16x16x32_bf16 v[196:199], a[72:75], a[8:11], 0
    buffer_load_dwordx4 v0, s[16:19], s75 offen offset:0 lds
    v_mfma_f32_16x16x32_bf16 v[196:199], a[76:79], a[24:27], v[196:199]
    buffer_load_dwordx4 v1, s[16:19], s75 offen offset:1024 lds
    v_mfma_f32_16x16x32_bf16 v[228:231], a[72:75], a[12:15], 0
    buffer_load_dwordx4 v2, s[16:19], s75 offen offset:2048 lds
    v_mfma_f32_16x16x32_bf16 v[228:231], a[76:79], a[28:31], v[228:231]
    buffer_load_dwordx4 v3, s[16:19], s75 offen offset:3072 lds
    v_mfma_f32_16x16x32_bf16 a[228:231], a[72:75], a[96:99], 0
    v_mfma_f32_16x16x32_bf16 a[228:231], a[76:79], a[96:99], a[228:231]
    s_waitcnt lgkmcnt(4)
    v_mfma_f32_16x16x32_bf16 v[136:139], a[80:83], a[0:3], 0
    ds_read_b64_tr_b16 a[64:65], v18 offset:0
    v_mfma_f32_16x16x32_bf16 v[136:139], a[84:87], a[16:19], v[136:139]
    ds_read_b64_tr_b16 a[66:67], v18 offset:1024
    v_mfma_f32_16x16x32_bf16 v[168:171], a[80:83], a[4:7], 0
    ds_read_b64_tr_b16 a[68:69], v18 offset:8192
    v_mfma_f32_16x16x32_bf16 v[168:171], a[84:87], a[20:23], v[168:171]
    ds_read_b64_tr_b16 a[70:71], v18 offset:9216
    s_add_u32 s78, s28, 2
    s_and_b32 s78, s78, 7
    s_lshl_b32 s79, s78, 19
    s_add_u32 s76, s62, s79
    s_mul_i32 s79, s78, 176128
    s_add_u32 s77, s63, s79
    s_add_u32 m0, s24, 114688
    v_mfma_f32_16x16x32_bf16 v[200:203], a[80:83], a[8:11], 0
    buffer_load_dwordx4 v8, s[40:43], s76 offen offset:0 lds
    v_mfma_f32_16x16x32_bf16 v[200:203], a[84:87], a[24:27], v[200:203]
    buffer_load_dwordx4 v9, s[40:43], s76 offen offset:1024 lds
    v_mfma_f32_16x16x32_bf16 v[232:235], a[80:83], a[12:15], 0
    buffer_load_dwordx4 v10, s[40:43], s76 offen offset:2048 lds
    v_mfma_f32_16x16x32_bf16 v[232:235], a[84:87], a[28:31], v[232:235]
    s_waitcnt lgkmcnt(4)
    v_mfma_f32_16x16x32_bf16 v[140:143], a[88:91], a[0:3], 0
    ds_read_b64_tr_b16 a[72:73], v18 offset:8
    v_mfma_f32_16x16x32_bf16 v[140:143], a[92:95], a[16:19], v[140:143]
    ds_read_b64_tr_b16 a[74:75], v18 offset:1032
    v_mfma_f32_16x16x32_bf16 v[172:175], a[88:91], a[4:7], 0
    ds_read_b64_tr_b16 a[76:77], v18 offset:8200
    v_mfma_f32_16x16x32_bf16 v[172:175], a[92:95], a[20:23], v[172:175]
    ds_read_b64_tr_b16 a[78:79], v18 offset:9224
    v_mfma_f32_16x16x32_bf16 v[204:207], a[88:91], a[8:11], 0
    buffer_load_dwordx4 v11, s[40:43], s76 offen offset:3072 lds
    s_add_u32 m0, s64, 131072
    v_mfma_f32_16x16x32_bf16 v[204:207], a[92:95], a[24:27], v[204:207]
    buffer_load_dwordx4 v12, s[44:47], s77 offen offset:0 lds
    v_mfma_f32_16x16x32_bf16 v[236:239], a[88:91], a[12:15], 0
    buffer_load_dwordx4 v13, s[44:47], s77 offen offset:1024 lds
    v_mfma_f32_16x16x32_bf16 v[236:239], a[92:95], a[28:31], v[236:239]
    s_waitcnt lgkmcnt(4)
    v_mfma_f32_16x16x32_bf16 v[144:147], a[64:67], a[0:3], 0
    ds_read_b64_tr_b16 a[80:81], v19 offset:0
    v_mfma_f32_16x16x32_bf16 v[144:147], a[68:71], a[16:19], v[144:147]
    ds_read_b64_tr_b16 a[82:83], v19 offset:1024
    v_mfma_f32_16x16x32_bf16 v[176:179], a[64:67], a[4:7], 0
    ds_read_b64_tr_b16 a[84:85], v19 offset:8192
    v_mfma_f32_16x16x32_bf16 v[176:179], a[68:71], a[20:23], v[176:179]
    ds_read_b64_tr_b16 a[86:87], v19 offset:9216
    v_mfma_f32_16x16x32_bf16 v[208:211], a[64:67], a[8:11], 0
    v_mfma_f32_16x16x32_bf16 v[208:211], a[68:71], a[24:27], v[208:211]
    v_mfma_f32_16x16x32_bf16 v[240:243], a[64:67], a[12:15], 0
    v_mfma_f32_16x16x32_bf16 v[240:243], a[68:71], a[28:31], v[240:243]
    s_waitcnt lgkmcnt(4)
    v_mfma_f32_16x16x32_bf16 v[148:151], a[72:75], a[0:3], 0
    ds_read_b64_tr_b16 a[88:89], v19 offset:8
    v_mfma_f32_16x16x32_bf16 v[148:151], a[76:79], a[16:19], v[148:151]
    ds_read_b64_tr_b16 a[90:91], v19 offset:1032
    v_mfma_f32_16x16x32_bf16 v[180:183], a[72:75], a[4:7], 0
    ds_read_b64_tr_b16 a[92:93], v19 offset:8200
    v_mfma_f32_16x16x32_bf16 v[180:183], a[76:79], a[20:23], v[180:183]
    ds_read_b64_tr_b16 a[94:95], v19 offset:9224
    v_mfma_f32_16x16x32_bf16 v[212:215], a[72:75], a[8:11], 0
    v_mfma_f32_16x16x32_bf16 v[212:215], a[76:79], a[24:27], v[212:215]
    v_mfma_f32_16x16x32_bf16 v[244:247], a[72:75], a[12:15], 0
    v_mfma_f32_16x16x32_bf16 v[244:247], a[76:79], a[28:31], v[244:247]
    s_waitcnt lgkmcnt(4)
    v_mfma_f32_16x16x32_bf16 v[152:155], a[80:83], a[0:3], 0
    ds_read_b64_tr_b16 a[64:65], v20 offset:0
    v_mfma_f32_16x16x32_bf16 v[152:155], a[84:87], a[16:19], v[152:155]
    ds_read_b64_tr_b16 a[66:67], v20 offset:512
    v_mfma_f32_16x16x32_bf16 v[184:187], a[80:83], a[4:7], 0
    ds_read_b64_tr_b16 a[68:69], v20 offset:4096
    v_mfma_f32_16x16x32_bf16 v[184:187], a[84:87], a[20:23], v[184:187]
    ds_read_b64_tr_b16 a[70:71], v20 offset:4608
    v_mfma_f32_16x16x32_bf16 v[216:219], a[80:83], a[8:11], 0
    v_mfma_f32_16x16x32_bf16 v[216:219], a[84:87], a[24:27], v[216:219]
    v_mfma_f32_16x16x32_bf16 v[248:251], a[80:83], a[12:15], 0
    v_mfma_f32_16x16x32_bf16 v[248:251], a[84:87], a[28:31], v[248:251]
    s_waitcnt lgkmcnt(4)
    v_mfma_f32_16x16x32_bf16 v[156:159], a[88:91], a[0:3], 0
    ds_read_b64_tr_b16 a[72:73], v21 offset:0
    v_mfma_f32_16x16x32_bf16 v[156:159], a[92:95], a[16:19], v[156:159]
    ds_read_b64_tr_b16 a[74:75], v21 offset:512
    v_mfma_f32_16x16x32_bf16 v[188:191], a[88:91], a[4:7], 0
    ds_read_b64_tr_b16 a[76:77], v21 offset:4096
    v_mfma_f32_16x16x32_bf16 v[188:191], a[92:95], a[20:23], v[188:191]
    ds_read_b64_tr_b16 a[78:79], v21 offset:4608
    v_mfma_f32_16x16x32_bf16 v[220:223], a[88:91], a[8:11], 0
    v_mfma_f32_16x16x32_bf16 v[220:223], a[92:95], a[24:27], v[220:223]
    v_mfma_f32_16x16x32_bf16 v[252:255], a[88:91], a[12:15], 0
    v_mfma_f32_16x16x32_bf16 v[252:255], a[92:95], a[28:31], v[252:255]
    s_waitcnt lgkmcnt(4)
    v_mfma_f32_16x16x32_bf16 a[128:131], a[64:67], a[0:3], 0
    ds_read_b64_tr_b16 a[80:81], v22 offset:0
    v_mfma_f32_16x16x32_bf16 a[128:131], a[68:71], a[16:19], a[128:131]
    ds_read_b64_tr_b16 a[82:83], v22 offset:512
    v_mfma_f32_16x16x32_bf16 a[132:135], a[64:67], a[4:7], 0
    ds_read_b64_tr_b16 a[84:85], v22 offset:4096
    v_mfma_f32_16x16x32_bf16 a[132:135], a[68:71], a[20:23], a[132:135]
    ds_read_b64_tr_b16 a[86:87], v22 offset:4608
    v_mfma_f32_16x16x32_bf16 a[136:139], a[64:67], a[8:11], 0
    ds_read_b64_tr_b16 a[100:101], v4 offset:0
    v_mfma_f32_16x16x32_bf16 a[136:139], a[68:71], a[24:27], a[136:139]
    ds_read_b64_tr_b16 a[102:103], v4 offset:512
    v_mfma_f32_16x16x32_bf16 a[140:143], a[64:67], a[12:15], 0
    v_lshrrev_b32 v104, 4, v102
    v_and_b32 v105, 15, v102
    v_mfma_f32_16x16x32_bf16 a[140:143], a[68:71], a[28:31], a[140:143]
    v_add_u32 v106, 0, v104
    v_xor_b32 v106, v106, v105
    s_waitcnt lgkmcnt(6)
    v_mfma_f32_16x16x32_bf16 a[144:147], a[72:75], a[0:3], 0
    ds_read_b64_tr_b16 a[88:89], v23 offset:0
    v_mfma_f32_16x16x32_bf16 a[144:147], a[76:79], a[16:19], a[144:147]
    ds_read_b64_tr_b16 a[90:91], v23 offset:512
    v_mfma_f32_16x16x32_bf16 a[148:151], a[72:75], a[4:7], 0
    ds_read_b64_tr_b16 a[92:93], v23 offset:4096
    v_mfma_f32_16x16x32_bf16 a[148:151], a[76:79], a[20:23], a[148:151]
    ds_read_b64_tr_b16 a[94:95], v23 offset:4608
    v_mfma_f32_16x16x32_bf16 a[152:155], a[72:75], a[8:11], 0
    ds_read_b64_tr_b16 a[104:105], v4 offset:4096
    v_mfma_f32_16x16x32_bf16 a[152:155], a[76:79], a[24:27], a[152:155]
    ds_read_b64_tr_b16 a[106:107], v4 offset:4608
    v_mfma_f32_16x16x32_bf16 a[156:159], a[72:75], a[12:15], 0
    v_lshlrev_b32 v106, 4, v106
    v_lshl_add_u32 v92, v104, 8, v106
    v_mfma_f32_16x16x32_bf16 a[156:159], a[76:79], a[28:31], a[156:159]
    s_xor_b32 s29, s20, 0
    s_lshl_b32 s29, s29, 2
    s_waitcnt lgkmcnt(6)
    v_mfma_f32_16x16x32_bf16 a[160:163], a[80:83], a[0:3], 0
    s_waitcnt vmcnt(20)
    v_mfma_f32_16x16x32_bf16 a[160:163], a[84:87], a[16:19], a[160:163]
    ds_read_b128 a[32:35], v14 offset:32768
    v_mfma_f32_16x16x32_bf16 a[164:167], a[80:83], a[4:7], 0
    ds_read_b128 a[36:39], v14 offset:34816
    v_mfma_f32_16x16x32_bf16 a[164:167], a[84:87], a[20:23], a[164:167]
    ds_read_b128 a[40:43], v14 offset:36864
    v_mfma_f32_16x16x32_bf16 a[168:171], a[80:83], a[8:11], 0
    ds_read_b128 a[44:47], v14 offset:38912
    v_mfma_f32_16x16x32_bf16 a[168:171], a[84:87], a[24:27], a[168:171]
    v_add_u32 v106, s29, v104
    v_xor_b32 v106, v106, v105
    v_mfma_f32_16x16x32_bf16 a[172:175], a[80:83], a[12:15], 0
    v_lshlrev_b32 v106, 4, v106
    v_lshl_add_u32 v80, v105, 8, v106
    v_mfma_f32_16x16x32_bf16 a[172:175], a[84:87], a[28:31], a[172:175]
    v_add_u32 v106, 4, v104
    v_xor_b32 v106, v106, v105
    s_waitcnt lgkmcnt(4)
    v_mfma_f32_16x16x32_bf16 a[176:179], a[88:91], a[0:3], 0
    ds_read_b128 a[48:51], v15 offset:32768
    v_mfma_f32_16x16x32_bf16 a[176:179], a[92:95], a[16:19], a[176:179]
    ds_read_b128 a[52:55], v15 offset:34816
    v_mfma_f32_16x16x32_bf16 a[180:183], a[88:91], a[4:7], 0
    ds_read_b128 a[56:59], v15 offset:36864
    v_mfma_f32_16x16x32_bf16 a[180:183], a[92:95], a[20:23], a[180:183]
    ds_read_b128 a[60:63], v15 offset:38912
    v_mfma_f32_16x16x32_bf16 a[184:187], a[88:91], a[8:11], 0
    v_lshlrev_b32 v106, 4, v106
    v_lshl_add_u32 v93, v104, 8, v106
    v_mfma_f32_16x16x32_bf16 a[184:187], a[92:95], a[24:27], a[184:187]
    s_xor_b32 s29, s20, 1
    s_lshl_b32 s29, s29, 2
    v_mfma_f32_16x16x32_bf16 a[188:191], a[88:91], a[12:15], 0
    v_add_u32 v106, s29, v104
    v_xor_b32 v106, v106, v105
    v_mfma_f32_16x16x32_bf16 a[188:191], a[92:95], a[28:31], a[188:191]
    v_lshlrev_b32 v106, 4, v106
    v_lshl_add_u32 v81, v105, 8, v106
    v_mfma_f32_16x16x32_bf16 a[232:235], a[100:103], a[96:99], 0
    v_add_u32 v106, 8, v104
    v_xor_b32 v106, v106, v105
    v_mfma_f32_16x16x32_bf16 a[232:235], a[104:107], a[96:99], a[232:235]
    v_lshlrev_b32 v106, 4, v106
    v_lshl_add_u32 v94, v104, 8, v106
    v_mfma_f32_16x16x32_bf16 a[192:195], a[96:99], a[0:3], 0
    s_waitcnt vmcnt(14)
    v_mfma_f32_16x16x32_bf16 a[192:195], a[96:99], a[16:19], a[192:195]
    s_barrier
    v_mfma_f32_16x16x32_bf16 a[208:211], a[0:3], a[0:3], 0
    ds_read_b64_tr_b16 a[64:65], v16 offset:24576
    v_mfma_f32_16x16x32_bf16 a[208:211], a[16:19], a[16:19], a[208:211]
    ds_read_b64_tr_b16 a[66:67], v16 offset:25600
    v_mfma_f32_16x16x32_bf16 a[196:199], a[96:99], a[4:7], 0
    ds_read_b64_tr_b16 a[68:69], v16 offset:32768
    v_mfma_f32_16x16x32_bf16 a[196:199], a[96:99], a[20:23], a[196:199]
    ds_read_b64_tr_b16 a[70:71], v16 offset:33792
    s_add_u32 s78, s28, 3
    s_and_b32 s78, s78, 7
    s_lshl_b32 s79, s78, 19
    s_add_u32 s76, s62, s79
    s_mul_i32 s79, s78, 176128
    s_add_u32 s77, s63, s79
    s_add_u32 m0, s24, 65536
    v_mfma_f32_16x16x32_bf16 a[212:215], a[4:7], a[4:7], 0
    buffer_load_dwordx4 v8, s[40:43], s76 offen offset:0 lds
    v_mfma_f32_16x16x32_bf16 a[212:215], a[20:23], a[20:23], a[212:215]
    buffer_load_dwordx4 v9, s[40:43], s76 offen offset:1024 lds
    v_mfma_f32_16x16x32_bf16 a[200:203], a[96:99], a[8:11], 0
    ds_read_b64_tr_b16 a[72:73], v16 offset:24584
    v_mfma_f32_16x16x32_bf16 a[200:203], a[96:99], a[24:27], a[200:203]
    ds_read_b64_tr_b16 a[74:75], v16 offset:25608
    v_mfma_f32_16x16x32_bf16 a[216:219], a[8:11], a[8:11], 0
    ds_read_b64_tr_b16 a[76:77], v16 offset:32776
    v_mfma_f32_16x16x32_bf16 a[216:219], a[24:27], a[24:27], a[216:219]
    ds_read_b64_tr_b16 a[78:79], v16 offset:33800
    v_mfma_f32_16x16x32_bf16 a[204:207], a[96:99], a[12:15], 0
    buffer_load_dwordx4 v10, s[40:43], s76 offen offset:2048 lds
    v_mfma_f32_16x16x32_bf16 a[204:207], a[96:99], a[28:31], a[204:207]
    buffer_load_dwordx4 v11, s[40:43], s76 offen offset:3072 lds
    s_add_u32 m0, s64, 81920
    v_mfma_f32_16x16x32_bf16 a[220:223], a[12:15], a[12:15], 0
    buffer_load_dwordx4 v12, s[44:47], s77 offen offset:0 lds
    v_mfma_f32_16x16x32_bf16 a[220:223], a[28:31], a[28:31], a[220:223]
    buffer_load_dwordx4 v13, s[44:47], s77 offen offset:1024 lds
    s_waitcnt lgkmcnt(4)
    v_mfma_f32_16x16x32_bf16 v[128:131], a[64:67], a[32:35], v[128:131]
    ds_read_b64_tr_b16 a[80:81], v17 offset:24576
    v_mfma_f32_16x16x32_bf16 v[128:131], a[68:71], a[48:51], v[128:131]
    ds_read_b64_tr_b16 a[82:83], v17 offset:25600
    v_mfma_f32_16x16x32_bf16 v[160:163], a[64:67], a[36:39], v[160:163]
    ds_read_b64_tr_b16 a[84:85], v17 offset:32768
    v_mfma_f32_16x16x32_bf16 v[160:163], a[68:71], a[52:55], v[160:163]
    ds_read_b64_tr_b16 a[86:87], v17 offset:33792
    s_add_u32 s78, s28, 3
    s_and_b32 s78, s78, 7
    s_lshl_b32 s78, s78, 7
    s_add_u32 s74, s61, s78
    s_xor_b32 s75, s74, 0x8000
    s_add_u32 m0, s60, 32768
    v_mfma_f32_16x16x32_bf16 v[192:195], a[64:67], a[40:43], v[192:195]
    buffer_load_dwordx4 v0, s[16:19], s74 offen offset:0 lds
    v_mfma_f32_16x16x32_bf16 v[192:195], a[68:71], a[56:59], v[192:195]
    buffer_load_dwordx4 v1, s[16:19], s74 offen offset:1024 lds
    v_mfma_f32_16x16x32_bf16 v[224:227], a[64:67], a[44:47], v[224:227]
    s_xor_b32 s29, s20, 2
    s_lshl_b32 s29, s29, 2
    v_mfma_f32_16x16x32_bf16 v[224:227], a[68:71], a[60:63], v[224:227]
    v_add_u32 v106, s29, v104
    v_xor_b32 v106, v106, v105
    v_mfma_f32_16x16x32_bf16 a[224:227], a[64:67], a[96:99], a[224:227]
    v_lshlrev_b32 v106, 4, v106
    v_lshl_add_u32 v82, v105, 8, v106
    v_mfma_f32_16x16x32_bf16 a[224:227], a[68:71], a[96:99], a[224:227]
    v_add_u32 v106, 12, v104
    v_xor_b32 v106, v106, v105
    s_waitcnt lgkmcnt(4)
    v_mfma_f32_16x16x32_bf16 v[132:135], a[72:75], a[32:35], v[132:135]
    ds_read_b64_tr_b16 a[88:89], v17 offset:24584
    v_mfma_f32_16x16x32_bf16 v[132:135], a[76:79], a[48:51], v[132:135]
    ds_read_b64_tr_b16 a[90:91], v17 offset:25608
    v_mfma_f32_16x16x32_bf16 v[164:167], a[72:75], a[36:39], v[164:167]
    ds_read_b64_tr_b16 a[92:93], v17 offset:32776
    v_mfma_f32_16x16x32_bf16 v[164:167], a[76:79], a[52:55], v[164:167]
    ds_read_b64_tr_b16 a[94:95], v17 offset:33800
    v_mfma_f32_16x16x32_bf16 v[196:199], a[72:75], a[40:43], v[196:199]
    buffer_load_dwordx4 v2, s[16:19], s74 offen offset:2048 lds
    v_mfma_f32_16x16x32_bf16 v[196:199], a[76:79], a[56:59], v[196:199]
    buffer_load_dwordx4 v3, s[16:19], s74 offen offset:3072 lds
    v_mfma_f32_16x16x32_bf16 v[228:231], a[72:75], a[44:47], v[228:231]
    v_lshlrev_b32 v106, 4, v106
    v_lshl_add_u32 v95, v104, 8, v106
    v_mfma_f32_16x16x32_bf16 v[228:231], a[76:79], a[60:63], v[228:231]
    s_xor_b32 s29, s20, 3
    s_lshl_b32 s29, s29, 2
    v_mfma_f32_16x16x32_bf16 a[228:231], a[72:75], a[96:99], a[228:231]
    v_add_u32 v106, s29, v104
    v_xor_b32 v106, v106, v105
    v_mfma_f32_16x16x32_bf16 a[228:231], a[76:79], a[96:99], a[228:231]
    v_lshlrev_b32 v106, 4, v106
    v_lshl_add_u32 v83, v105, 8, v106
    s_waitcnt lgkmcnt(4)
    v_mfma_f32_16x16x32_bf16 v[136:139], a[80:83], a[32:35], v[136:139]
    ds_read_b64_tr_b16 a[64:65], v18 offset:24576
    v_mfma_f32_16x16x32_bf16 v[136:139], a[84:87], a[48:51], v[136:139]
    ds_read_b64_tr_b16 a[66:67], v18 offset:25600
    v_mfma_f32_16x16x32_bf16 v[168:171], a[80:83], a[36:39], v[168:171]
    ds_read_b64_tr_b16 a[68:69], v18 offset:32768
    v_mfma_f32_16x16x32_bf16 v[168:171], a[84:87], a[52:55], v[168:171]
    ds_read_b64_tr_b16 a[70:71], v18 offset:33792
    s_add_u32 m0, s60, 36864
    v_mfma_f32_16x16x32_bf16 v[200:203], a[80:83], a[40:43], v[200:203]
    buffer_load_dwordx4 v0, s[16:19], s75 offen offset:0 lds
    v_mfma_f32_16x16x32_bf16 v[200:203], a[84:87], a[56:59], v[200:203]
    buffer_load_dwordx4 v1, s[16:19], s75 offen offset:1024 lds
    v_mfma_f32_16x16x32_bf16 v[232:235], a[80:83], a[44:47], v[232:235]
    v_add_u32 v106, 0, v104
    v_lshlrev_b32 v106, 1, v106
    v_mfma_f32_16x16x32_bf16 v[232:235], a[84:87], a[60:63], v[232:235]
    v_xor_b32 v106, v106, v105
    v_lshlrev_b32 v106, 4, v106
    s_waitcnt lgkmcnt(4)
    v_mfma_f32_16x16x32_bf16 v[140:143], a[88:91], a[32:35], v[140:143]
    ds_read_b64_tr_b16 a[72:73], v18 offset:24584
    v_mfma_f32_16x16x32_bf16 v[140:143], a[92:95], a[48:51], v[140:143]
    ds_read_b64_tr_b16 a[74:75], v18 offset:25608
    v_mfma_f32_16x16x32_bf16 v[172:175], a[88:91], a[36:39], v[172:175]
    ds_read_b64_tr_b16 a[76:77], v18 offset:32776
    v_mfma_f32_16x16x32_bf16 v[172:175], a[92:95], a[52:55], v[172:175]
    ds_read_b64_tr_b16 a[78:79], v18 offset:33800
    v_mfma_f32_16x16x32_bf16 v[204:207], a[88:91], a[40:43], v[204:207]
    buffer_load_dwordx4 v2, s[16:19], s75 offen offset:2048 lds
    v_mfma_f32_16x16x32_bf16 v[204:207], a[92:95], a[56:59], v[204:207]
    buffer_load_dwordx4 v3, s[16:19], s75 offen offset:3072 lds
    v_mfma_f32_16x16x32_bf16 v[236:239], a[88:91], a[44:47], v[236:239]
    v_lshl_add_u32 v96, v104, 8, v106
    v_add_u32 v106, 4, v104
    v_mfma_f32_16x16x32_bf16 v[236:239], a[92:95], a[60:63], v[236:239]
    v_lshlrev_b32 v106, 1, v106
    v_xor_b32 v106, v106, v105
    s_waitcnt lgkmcnt(4)
    v_mfma_f32_16x16x32_bf16 v[144:147], a[64:67], a[32:35], v[144:147]
    ds_read_b64_tr_b16 a[80:81], v19 offset:24576
    v_mfma_f32_16x16x32_bf16 v[144:147], a[68:71], a[48:51], v[144:147]
    ds_read_b64_tr_b16 a[82:83], v19 offset:25600
    v_mfma_f32_16x16x32_bf16 v[176:179], a[64:67], a[36:39], v[176:179]
    ds_read_b64_tr_b16 a[84:85], v19 offset:32768
    v_mfma_f32_16x16x32_bf16 v[176:179], a[68:71], a[52:55], v[176:179]
    ds_read_b64_tr_b16 a[86:87], v19 offset:33792
    v_mfma_f32_16x16x32_bf16 v[208:211], a[64:67], a[40:43], v[208:211]
    v_lshlrev_b32 v106, 4, v106
    v_lshl_add_u32 v97, v104, 8, v106
    v_mfma_f32_16x16x32_bf16 v[208:211], a[68:71], a[56:59], v[208:211]
    v_lshrrev_b32 v108, 2, v102
    v_and_b32 v106, 3, v102
    v_mfma_f32_16x16x32_bf16 v[240:243], a[64:67], a[44:47], v[240:243]
    v_lshlrev_b32 v106, 3, v106
    v_lshl_add_u32 v109, v108, 8, v106
    v_mfma_f32_16x16x32_bf16 v[240:243], a[68:71], a[60:63], v[240:243]
    v_add_u32 v109, 0x10000, v109
    v_and_b32 v110, 7, v108
    s_waitcnt lgkmcnt(4)
    v_mfma_f32_16x16x32_bf16 v[148:151], a[72:75], a[32:35], v[148:151]
    ds_read_b64_tr_b16 a[88:89], v19 offset:24584
    v_mfma_f32_16x16x32_bf16 v[148:151], a[76:79], a[48:51], v[148:151]
    ds_read_b64_tr_b16 a[90:91], v19 offset:25608
    v_mfma_f32_16x16x32_bf16 v[180:183], a[72:75], a[36:39], v[180:183]
    ds_read_b64_tr_b16 a[92:93], v19 offset:32776
    v_mfma_f32_16x16x32_bf16 v[180:183], a[76:79], a[52:55], v[180:183]
    ds_read_b64_tr_b16 a[94:95], v19 offset:33800
    v_mfma_f32_16x16x32_bf16 v[212:215], a[72:75], a[40:43], v[212:215]
    v_xor_b32 v106, 0, v110
    v_lshl_add_u32 v84, v106, 5, v109
    v_mfma_f32_16x16x32_bf16 v[212:215], a[76:79], a[56:59], v[212:215]
    v_xor_b32 v106, 1, v110
    v_lshl_add_u32 v85, v106, 5, v109
    v_mfma_f32_16x16x32_bf16 v[244:247], a[72:75], a[44:47], v[244:247]
    v_xor_b32 v106, 2, v110
    v_lshl_add_u32 v86, v106, 5, v109
    v_mfma_f32_16x16x32_bf16 v[244:247], a[76:79], a[60:63], v[244:247]
    v_xor_b32 v106, 3, v110
    v_lshl_add_u32 v87, v106, 5, v109
    s_waitcnt lgkmcnt(4)
    v_mfma_f32_16x16x32_bf16 v[152:155], a[80:83], a[32:35], v[152:155]
    ds_read_b64_tr_b16 a[64:65], v20 offset:24576
    v_mfma_f32_16x16x32_bf16 v[152:155], a[84:87], a[48:51], v[152:155]
    ds_read_b64_tr_b16 a[66:67], v20 offset:25088
    v_mfma_f32_16x16x32_bf16 v[184:187], a[80:83], a[36:39], v[184:187]
    ds_read_b64_tr_b16 a[68:69], v20 offset:28672
    v_mfma_f32_16x16x32_bf16 v[184:187], a[84:87], a[52:55], v[184:187]
    ds_read_b64_tr_b16 a[70:71], v20 offset:29184
    v_mfma_f32_16x16x32_bf16 v[216:219], a[80:83], a[40:43], v[216:219]
    v_xor_b32 v106, 4, v110
    v_lshl_add_u32 v88, v106, 5, v109
    v_mfma_f32_16x16x32_bf16 v[216:219], a[84:87], a[56:59], v[216:219]
    v_xor_b32 v106, 5, v110
    v_lshl_add_u32 v89, v106, 5, v109
    v_mfma_f32_16x16x32_bf16 v[248:251], a[80:83], a[44:47], v[248:251]
    v_xor_b32 v106, 6, v110
    v_lshl_add_u32 v90, v106, 5, v109
    v_mfma_f32_16x16x32_bf16 v[248:251], a[84:87], a[60:63], v[248:251]
    v_xor_b32 v106, 7, v110
    v_lshl_add_u32 v91, v106, 5, v109
    s_waitcnt lgkmcnt(4)
    v_mfma_f32_16x16x32_bf16 v[156:159], a[88:91], a[32:35], v[156:159]
    ds_read_b64_tr_b16 a[72:73], v21 offset:24576
    v_mfma_f32_16x16x32_bf16 v[156:159], a[92:95], a[48:51], v[156:159]
    ds_read_b64_tr_b16 a[74:75], v21 offset:25088
    v_mfma_f32_16x16x32_bf16 v[188:191], a[88:91], a[36:39], v[188:191]
    ds_read_b64_tr_b16 a[76:77], v21 offset:28672
    v_mfma_f32_16x16x32_bf16 v[188:191], a[92:95], a[52:55], v[188:191]
    ds_read_b64_tr_b16 a[78:79], v21 offset:29184
    v_mfma_f32_16x16x32_bf16 v[220:223], a[88:91], a[40:43], v[220:223]
    s_lshl_b32 s26, s21, 19
    s_add_u32 s27, s26, 16384
    v_mfma_f32_16x16x32_bf16 v[220:223], a[92:95], a[56:59], v[220:223]
    s_add_u32 s4, s34, s27
    s_addc_u32 s5, s35, 0
    s_mov_b32 s6, 507904
    v_mfma_f32_16x16x32_bf16 v[252:255], a[88:91], a[44:47], v[252:255]
    s_mov_b32 s7, 0x20000
    s_add_u32 s48, s34, s26
    s_addc_u32 s49, s35, 0
    v_mfma_f32_16x16x32_bf16 v[252:255], a[92:95], a[60:63], v[252:255]
    s_mov_b32 s50, 16384
    s_mov_b32 s51, 0x20000
    s_waitcnt lgkmcnt(4)
    v_mfma_f32_16x16x32_bf16 a[128:131], a[64:67], a[32:35], a[128:131]
    ds_read_b64_tr_b16 a[80:81], v22 offset:24576
    v_mfma_f32_16x16x32_bf16 a[128:131], a[68:71], a[48:51], a[128:131]
    ds_read_b64_tr_b16 a[82:83], v22 offset:25088
    v_mfma_f32_16x16x32_bf16 a[132:135], a[64:67], a[36:39], a[132:135]
    ds_read_b64_tr_b16 a[84:85], v22 offset:28672
    v_mfma_f32_16x16x32_bf16 a[132:135], a[68:71], a[52:55], a[132:135]
    ds_read_b64_tr_b16 a[86:87], v22 offset:29184
    v_mfma_f32_16x16x32_bf16 a[136:139], a[64:67], a[40:43], a[136:139]
    ds_read_b64_tr_b16 a[100:101], v4 offset:24576
    v_mfma_f32_16x16x32_bf16 a[136:139], a[68:71], a[56:59], a[136:139]
    ds_read_b64_tr_b16 a[102:103], v4 offset:25088
    v_mfma_f32_16x16x32_bf16 a[140:143], a[64:67], a[44:47], a[140:143]
    s_add_u32 s8, s36, s26
    s_addc_u32 s9, s37, 0
    s_mov_b32 s10, 524288
    v_mfma_f32_16x16x32_bf16 a[140:143], a[68:71], a[60:63], a[140:143]
    s_mov_b32 s11, 0x20000
    s_mov_b32 s12, s72
    s_waitcnt lgkmcnt(6)
    v_mfma_f32_16x16x32_bf16 a[144:147], a[72:75], a[32:35], a[144:147]
    ds_read_b64_tr_b16 a[88:89], v23 offset:24576
    v_mfma_f32_16x16x32_bf16 a[144:147], a[76:79], a[48:51], a[144:147]
    ds_read_b64_tr_b16 a[90:91], v23 offset:25088
    v_mfma_f32_16x16x32_bf16 a[148:151], a[72:75], a[36:39], a[148:151]
    ds_read_b64_tr_b16 a[92:93], v23 offset:28672
    v_mfma_f32_16x16x32_bf16 a[148:151], a[76:79], a[52:55], a[148:151]
    ds_read_b64_tr_b16 a[94:95], v23 offset:29184
    v_mfma_f32_16x16x32_bf16 a[152:155], a[72:75], a[40:43], a[152:155]
    ds_read_b64_tr_b16 a[104:105], v4 offset:28672
    v_mfma_f32_16x16x32_bf16 a[152:155], a[76:79], a[56:59], a[152:155]
    ds_read_b64_tr_b16 a[106:107], v4 offset:29184
    v_mfma_f32_16x16x32_bf16 a[156:159], a[72:75], a[44:47], a[156:159]
    s_mov_b32 s13, s73
    s_mov_b32 s14, 16777216
    v_mfma_f32_16x16x32_bf16 a[156:159], a[76:79], a[60:63], a[156:159]
    s_mov_b32 s15, 0x20000
    s_add_u32 s52, s72, 16777216
    s_addc_u32 s53, s73, 0
    s_waitcnt lgkmcnt(6)
    v_mfma_f32_16x16x32_bf16 a[160:163], a[80:83], a[32:35], a[160:163]
    s_waitcnt vmcnt(20)
    v_mfma_f32_16x16x32_bf16 a[160:163], a[84:87], a[48:51], a[160:163]
    ds_read_b128 a[0:3], v14 offset:0
    v_mfma_f32_16x16x32_bf16 a[164:167], a[80:83], a[36:39], a[164:167]
    ds_read_b128 a[4:7], v14 offset:2048
    v_mfma_f32_16x16x32_bf16 a[164:167], a[84:87], a[52:55], a[164:167]
    ds_read_b128 a[8:11], v14 offset:4096
    v_mfma_f32_16x16x32_bf16 a[168:171], a[80:83], a[40:43], a[168:171]
    ds_read_b128 a[12:15], v14 offset:6144
    v_mfma_f32_16x16x32_bf16 a[168:171], a[84:87], a[56:59], a[168:171]
    s_mov_b32 s54, 5636096
    s_mov_b32 s55, 0x20000
    v_mfma_f32_16x16x32_bf16 a[172:175], a[80:83], a[44:47], a[172:175]
    s_mov_b32 s56, s70
    s_mov_b32 s57, s71
    v_mfma_f32_16x16x32_bf16 a[172:175], a[84:87], a[60:63], a[172:175]
    s_mov_b32 s58, 2752
    s_mov_b32 s59, 0x20000
    s_waitcnt lgkmcnt(4)
    v_mfma_f32_16x16x32_bf16 a[176:179], a[88:91], a[32:35], a[176:179]
    ds_read_b128 a[16:19], v15 offset:0
    v_mfma_f32_16x16x32_bf16 a[176:179], a[92:95], a[48:51], a[176:179]
    ds_read_b128 a[20:23], v15 offset:2048
    v_mfma_f32_16x16x32_bf16 a[180:183], a[88:91], a[36:39], a[180:183]
    ds_read_b128 a[24:27], v15 offset:4096
    v_mfma_f32_16x16x32_bf16 a[180:183], a[92:95], a[52:55], a[180:183]
    ds_read_b128 a[28:31], v15 offset:6144
    v_mfma_f32_16x16x32_bf16 a[184:187], a[88:91], a[40:43], a[184:187]
    v_lshrrev_b32 v64, 4, v102
    v_lshlrev_b32 v64, 3, v64
    v_mfma_f32_16x16x32_bf16 a[184:187], a[92:95], a[56:59], a[184:187]
    s_lshl_b32 s26, s21, 6
    s_lshl_b32 s27, s25, 6
    v_mfma_f32_16x16x32_bf16 a[188:191], a[88:91], a[44:47], a[188:191]
    buffer_load_dwordx2 v[24:25], v64, s[56:59], s26 offen offset:0
    v_mfma_f32_16x16x32_bf16 a[188:191], a[92:95], a[60:63], a[188:191]
    buffer_load_dwordx2 v[26:27], v64, s[56:59], s26 offen offset:32
    v_mfma_f32_16x16x32_bf16 a[232:235], a[100:103], a[96:99], a[232:235]
    buffer_load_dwordx2 v[28:29], v64, s[56:59], s27 offen offset:0
    v_mfma_f32_16x16x32_bf16 a[232:235], a[104:107], a[96:99], a[232:235]
    buffer_load_dwordx2 v[30:31], v64, s[56:59], s27 offen offset:32
    v_mfma_f32_16x16x32_bf16 a[192:195], a[96:99], a[32:35], a[192:195]
    s_waitcnt vmcnt(18)
    v_mfma_f32_16x16x32_bf16 a[192:195], a[96:99], a[48:51], a[192:195]
    s_barrier
    v_mfma_f32_16x16x32_bf16 a[208:211], a[32:35], a[32:35], a[208:211]
    ds_read_b64_tr_b16 a[64:65], v16 offset:49152
    v_mfma_f32_16x16x32_bf16 a[208:211], a[48:51], a[48:51], a[208:211]
    ds_read_b64_tr_b16 a[66:67], v16 offset:50176
    v_mfma_f32_16x16x32_bf16 a[196:199], a[96:99], a[36:39], a[196:199]
    ds_read_b64_tr_b16 a[68:69], v16 offset:57344
    v_mfma_f32_16x16x32_bf16 a[196:199], a[96:99], a[52:55], a[196:199]
    ds_read_b64_tr_b16 a[70:71], v16 offset:58368
    s_add_u32 s78, s28, 4
    s_and_b32 s78, s78, 7
    s_lshl_b32 s79, s78, 19
    s_add_u32 s76, s62, s79
    s_mul_i32 s79, s78, 176128
    s_add_u32 s77, s63, s79
    s_add_u32 m0, s24, 90112
    v_mfma_f32_16x16x32_bf16 a[212:215], a[36:39], a[36:39], a[212:215]
    buffer_load_dwordx4 v8, s[40:43], s76 offen offset:0 lds
    v_mfma_f32_16x16x32_bf16 a[212:215], a[52:55], a[52:55], a[212:215]
    buffer_load_dwordx4 v9, s[40:43], s76 offen offset:1024 lds
    v_mfma_f32_16x16x32_bf16 a[200:203], a[96:99], a[40:43], a[200:203]
    ds_read_b64_tr_b16 a[72:73], v16 offset:49160
    v_mfma_f32_16x16x32_bf16 a[200:203], a[96:99], a[56:59], a[200:203]
    ds_read_b64_tr_b16 a[74:75], v16 offset:50184
    v_mfma_f32_16x16x32_bf16 a[216:219], a[40:43], a[40:43], a[216:219]
    ds_read_b64_tr_b16 a[76:77], v16 offset:57352
    v_mfma_f32_16x16x32_bf16 a[216:219], a[56:59], a[56:59], a[216:219]
    ds_read_b64_tr_b16 a[78:79], v16 offset:58376
    v_mfma_f32_16x16x32_bf16 a[204:207], a[96:99], a[44:47], a[204:207]
    buffer_load_dwordx4 v10, s[40:43], s76 offen offset:2048 lds
    v_mfma_f32_16x16x32_bf16 a[204:207], a[96:99], a[60:63], a[204:207]
    buffer_load_dwordx4 v11, s[40:43], s76 offen offset:3072 lds
    s_add_u32 m0, s64, 106496
    v_mfma_f32_16x16x32_bf16 a[220:223], a[44:47], a[44:47], a[220:223]
    buffer_load_dwordx4 v12, s[44:47], s77 offen offset:0 lds
    v_mfma_f32_16x16x32_bf16 a[220:223], a[60:63], a[60:63], a[220:223]
    buffer_load_dwordx4 v13, s[44:47], s77 offen offset:1024 lds
    s_waitcnt lgkmcnt(4)
    v_mfma_f32_16x16x32_bf16 v[128:131], a[64:67], a[0:3], v[128:131]
    ds_read_b64_tr_b16 a[80:81], v17 offset:49152
    v_mfma_f32_16x16x32_bf16 v[128:131], a[68:71], a[16:19], v[128:131]
    ds_read_b64_tr_b16 a[82:83], v17 offset:50176
    v_mfma_f32_16x16x32_bf16 v[160:163], a[64:67], a[4:7], v[160:163]
    ds_read_b64_tr_b16 a[84:85], v17 offset:57344
    v_mfma_f32_16x16x32_bf16 v[160:163], a[68:71], a[20:23], v[160:163]
    ds_read_b64_tr_b16 a[86:87], v17 offset:58368
    s_add_u32 s78, s28, 4
    s_and_b32 s78, s78, 7
    s_lshl_b32 s78, s78, 7
    s_add_u32 s74, s61, s78
    s_xor_b32 s75, s74, 0x8000
    s_add_u32 m0, s60, 0
    v_mfma_f32_16x16x32_bf16 v[192:195], a[64:67], a[8:11], v[192:195]
    buffer_load_dwordx4 v0, s[16:19], s74 offen offset:0 lds
    v_mfma_f32_16x16x32_bf16 v[192:195], a[68:71], a[24:27], v[192:195]
    buffer_load_dwordx4 v1, s[16:19], s74 offen offset:1024 lds
    v_mfma_f32_16x16x32_bf16 v[224:227], a[64:67], a[12:15], v[224:227]
    v_mfma_f32_16x16x32_bf16 v[224:227], a[68:71], a[28:31], v[224:227]
    v_mfma_f32_16x16x32_bf16 a[224:227], a[64:67], a[96:99], a[224:227]
    v_mfma_f32_16x16x32_bf16 a[224:227], a[68:71], a[96:99], a[224:227]
    s_waitcnt lgkmcnt(4)
    v_mfma_f32_16x16x32_bf16 v[132:135], a[72:75], a[0:3], v[132:135]
    ds_read_b64_tr_b16 a[88:89], v17 offset:49160
    v_mfma_f32_16x16x32_bf16 v[132:135], a[76:79], a[16:19], v[132:135]
    ds_read_b64_tr_b16 a[90:91], v17 offset:50184
    v_mfma_f32_16x16x32_bf16 v[164:167], a[72:75], a[4:7], v[164:167]
    ds_read_b64_tr_b16 a[92:93], v17 offset:57352
    v_mfma_f32_16x16x32_bf16 v[164:167], a[76:79], a[20:23], v[164:167]
    ds_read_b64_tr_b16 a[94:95], v17 offset:58376
    v_mfma_f32_16x16x32_bf16 v[196:199], a[72:75], a[8:11], v[196:199]
    buffer_load_dwordx4 v2, s[16:19], s74 offen offset:2048 lds
    v_mfma_f32_16x16x32_bf16 v[196:199], a[76:79], a[24:27], v[196:199]
    buffer_load_dwordx4 v3, s[16:19], s74 offen offset:3072 lds
    v_mfma_f32_16x16x32_bf16 v[228:231], a[72:75], a[12:15], v[228:231]
    v_mfma_f32_16x16x32_bf16 v[228:231], a[76:79], a[28:31], v[228:231]
    v_mfma_f32_16x16x32_bf16 a[228:231], a[72:75], a[96:99], a[228:231]
    v_mfma_f32_16x16x32_bf16 a[228:231], a[76:79], a[96:99], a[228:231]
    s_waitcnt lgkmcnt(4)
    v_mfma_f32_16x16x32_bf16 v[136:139], a[80:83], a[0:3], v[136:139]
    ds_read_b64_tr_b16 a[64:65], v18 offset:49152
    v_mfma_f32_16x16x32_bf16 v[136:139], a[84:87], a[16:19], v[136:139]
    ds_read_b64_tr_b16 a[66:67], v18 offset:50176
    v_mfma_f32_16x16x32_bf16 v[168:171], a[80:83], a[4:7], v[168:171]
    ds_read_b64_tr_b16 a[68:69], v18 offset:57344
    v_mfma_f32_16x16x32_bf16 v[168:171], a[84:87], a[20:23], v[168:171]
    ds_read_b64_tr_b16 a[70:71], v18 offset:58368
    s_add_u32 m0, s60, 4096
    v_mfma_f32_16x16x32_bf16 v[200:203], a[80:83], a[8:11], v[200:203]
    buffer_load_dwordx4 v0, s[16:19], s75 offen offset:0 lds
    v_mfma_f32_16x16x32_bf16 v[200:203], a[84:87], a[24:27], v[200:203]
    buffer_load_dwordx4 v1, s[16:19], s75 offen offset:1024 lds
    v_mfma_f32_16x16x32_bf16 v[232:235], a[80:83], a[12:15], v[232:235]
    v_mfma_f32_16x16x32_bf16 v[232:235], a[84:87], a[28:31], v[232:235]
    s_waitcnt lgkmcnt(4)
    v_mfma_f32_16x16x32_bf16 v[140:143], a[88:91], a[0:3], v[140:143]
    ds_read_b64_tr_b16 a[72:73], v18 offset:49160
    v_mfma_f32_16x16x32_bf16 v[140:143], a[92:95], a[16:19], v[140:143]
    ds_read_b64_tr_b16 a[74:75], v18 offset:50184
    v_mfma_f32_16x16x32_bf16 v[172:175], a[88:91], a[4:7], v[172:175]
    ds_read_b64_tr_b16 a[76:77], v18 offset:57352
    v_mfma_f32_16x16x32_bf16 v[172:175], a[92:95], a[20:23], v[172:175]
    ds_read_b64_tr_b16 a[78:79], v18 offset:58376
    v_mfma_f32_16x16x32_bf16 v[204:207], a[88:91], a[8:11], v[204:207]
    buffer_load_dwordx4 v2, s[16:19], s75 offen offset:2048 lds
    v_mfma_f32_16x16x32_bf16 v[204:207], a[92:95], a[24:27], v[204:207]
    buffer_load_dwordx4 v3, s[16:19], s75 offen offset:3072 lds
    v_mfma_f32_16x16x32_bf16 v[236:239], a[88:91], a[12:15], v[236:239]
    v_mfma_f32_16x16x32_bf16 v[236:239], a[92:95], a[28:31], v[236:239]
    s_waitcnt lgkmcnt(4)
    v_mfma_f32_16x16x32_bf16 v[144:147], a[64:67], a[0:3], v[144:147]
    ds_read_b64_tr_b16 a[80:81], v19 offset:49152
    v_mfma_f32_16x16x32_bf16 v[144:147], a[68:71], a[16:19], v[144:147]
    ds_read_b64_tr_b16 a[82:83], v19 offset:50176
    v_mfma_f32_16x16x32_bf16 v[176:179], a[64:67], a[4:7], v[176:179]
    ds_read_b64_tr_b16 a[84:85], v19 offset:57344
    v_mfma_f32_16x16x32_bf16 v[176:179], a[68:71], a[20:23], v[176:179]
    ds_read_b64_tr_b16 a[86:87], v19 offset:58368
    v_mfma_f32_16x16x32_bf16 v[208:211], a[64:67], a[8:11], v[208:211]
    v_mfma_f32_16x16x32_bf16 v[208:211], a[68:71], a[24:27], v[208:211]
    v_mfma_f32_16x16x32_bf16 v[240:243], a[64:67], a[12:15], v[240:243]
    v_mfma_f32_16x16x32_bf16 v[240:243], a[68:71], a[28:31], v[240:243]
    s_waitcnt lgkmcnt(4)
    v_mfma_f32_16x16x32_bf16 v[148:151], a[72:75], a[0:3], v[148:151]
    ds_read_b64_tr_b16 a[88:89], v19 offset:49160
    v_mfma_f32_16x16x32_bf16 v[148:151], a[76:79], a[16:19], v[148:151]
    ds_read_b64_tr_b16 a[90:91], v19 offset:50184
    v_mfma_f32_16x16x32_bf16 v[180:183], a[72:75], a[4:7], v[180:183]
    ds_read_b64_tr_b16 a[92:93], v19 offset:57352
    v_mfma_f32_16x16x32_bf16 v[180:183], a[76:79], a[20:23], v[180:183]
    ds_read_b64_tr_b16 a[94:95], v19 offset:58376
    v_mfma_f32_16x16x32_bf16 v[212:215], a[72:75], a[8:11], v[212:215]
    v_mfma_f32_16x16x32_bf16 v[212:215], a[76:79], a[24:27], v[212:215]
    v_mfma_f32_16x16x32_bf16 v[244:247], a[72:75], a[12:15], v[244:247]
    v_mfma_f32_16x16x32_bf16 v[244:247], a[76:79], a[28:31], v[244:247]
    s_waitcnt lgkmcnt(4)
    v_mfma_f32_16x16x32_bf16 v[152:155], a[80:83], a[0:3], v[152:155]
    ds_read_b64_tr_b16 a[64:65], v20 offset:49152
    v_mfma_f32_16x16x32_bf16 v[152:155], a[84:87], a[16:19], v[152:155]
    ds_read_b64_tr_b16 a[66:67], v20 offset:49664
    v_mfma_f32_16x16x32_bf16 v[184:187], a[80:83], a[4:7], v[184:187]
    ds_read_b64_tr_b16 a[68:69], v20 offset:53248
    v_mfma_f32_16x16x32_bf16 v[184:187], a[84:87], a[20:23], v[184:187]
    ds_read_b64_tr_b16 a[70:71], v20 offset:53760
    v_mfma_f32_16x16x32_bf16 v[216:219], a[80:83], a[8:11], v[216:219]
    v_mfma_f32_16x16x32_bf16 v[216:219], a[84:87], a[24:27], v[216:219]
    v_mfma_f32_16x16x32_bf16 v[248:251], a[80:83], a[12:15], v[248:251]
    v_mfma_f32_16x16x32_bf16 v[248:251], a[84:87], a[28:31], v[248:251]
    s_waitcnt lgkmcnt(4)
    v_mfma_f32_16x16x32_bf16 v[156:159], a[88:91], a[0:3], v[156:159]
    ds_read_b64_tr_b16 a[72:73], v21 offset:49152
    v_mfma_f32_16x16x32_bf16 v[156:159], a[92:95], a[16:19], v[156:159]
    ds_read_b64_tr_b16 a[74:75], v21 offset:49664
    v_mfma_f32_16x16x32_bf16 v[188:191], a[88:91], a[4:7], v[188:191]
    ds_read_b64_tr_b16 a[76:77], v21 offset:53248
    v_mfma_f32_16x16x32_bf16 v[188:191], a[92:95], a[20:23], v[188:191]
    ds_read_b64_tr_b16 a[78:79], v21 offset:53760
    v_mfma_f32_16x16x32_bf16 v[220:223], a[88:91], a[8:11], v[220:223]
    v_mfma_f32_16x16x32_bf16 v[220:223], a[92:95], a[24:27], v[220:223]
    v_mfma_f32_16x16x32_bf16 v[252:255], a[88:91], a[12:15], v[252:255]
    v_mfma_f32_16x16x32_bf16 v[252:255], a[92:95], a[28:31], v[252:255]
    s_waitcnt lgkmcnt(4)
    v_mfma_f32_16x16x32_bf16 a[128:131], a[64:67], a[0:3], a[128:131]
    ds_read_b64_tr_b16 a[80:81], v22 offset:49152
    v_mfma_f32_16x16x32_bf16 a[128:131], a[68:71], a[16:19], a[128:131]
    ds_read_b64_tr_b16 a[82:83], v22 offset:49664
    v_mfma_f32_16x16x32_bf16 a[132:135], a[64:67], a[4:7], a[132:135]
    ds_read_b64_tr_b16 a[84:85], v22 offset:53248
    v_mfma_f32_16x16x32_bf16 a[132:135], a[68:71], a[20:23], a[132:135]
    ds_read_b64_tr_b16 a[86:87], v22 offset:53760
    v_mfma_f32_16x16x32_bf16 a[136:139], a[64:67], a[8:11], a[136:139]
    ds_read_b64_tr_b16 a[100:101], v4 offset:49152
    v_mfma_f32_16x16x32_bf16 a[136:139], a[68:71], a[24:27], a[136:139]
    ds_read_b64_tr_b16 a[102:103], v4 offset:49664
    v_mfma_f32_16x16x32_bf16 a[140:143], a[64:67], a[12:15], a[140:143]
    v_mfma_f32_16x16x32_bf16 a[140:143], a[68:71], a[28:31], a[140:143]
    s_waitcnt lgkmcnt(6)
    v_mfma_f32_16x16x32_bf16 a[144:147], a[72:75], a[0:3], a[144:147]
    ds_read_b64_tr_b16 a[88:89], v23 offset:49152
    v_mfma_f32_16x16x32_bf16 a[144:147], a[76:79], a[16:19], a[144:147]
    ds_read_b64_tr_b16 a[90:91], v23 offset:49664
    v_mfma_f32_16x16x32_bf16 a[148:151], a[72:75], a[4:7], a[148:151]
    ds_read_b64_tr_b16 a[92:93], v23 offset:53248
    v_mfma_f32_16x16x32_bf16 a[148:151], a[76:79], a[20:23], a[148:151]
    ds_read_b64_tr_b16 a[94:95], v23 offset:53760
    v_mfma_f32_16x16x32_bf16 a[152:155], a[72:75], a[8:11], a[152:155]
    ds_read_b64_tr_b16 a[104:105], v4 offset:53248
    v_mfma_f32_16x16x32_bf16 a[152:155], a[76:79], a[24:27], a[152:155]
    ds_read_b64_tr_b16 a[106:107], v4 offset:53760
    v_mfma_f32_16x16x32_bf16 a[156:159], a[72:75], a[12:15], a[156:159]
    v_mfma_f32_16x16x32_bf16 a[156:159], a[76:79], a[28:31], a[156:159]
    s_waitcnt lgkmcnt(6)
    v_mfma_f32_16x16x32_bf16 a[160:163], a[80:83], a[0:3], a[160:163]
    s_waitcnt vmcnt(18)
    v_mfma_f32_16x16x32_bf16 a[160:163], a[84:87], a[16:19], a[160:163]
    ds_read_b128 a[32:35], v14 offset:32768
    v_mfma_f32_16x16x32_bf16 a[164:167], a[80:83], a[4:7], a[164:167]
    ds_read_b128 a[36:39], v14 offset:34816
    v_mfma_f32_16x16x32_bf16 a[164:167], a[84:87], a[20:23], a[164:167]
    ds_read_b128 a[40:43], v14 offset:36864
    v_mfma_f32_16x16x32_bf16 a[168:171], a[80:83], a[8:11], a[168:171]
    ds_read_b128 a[44:47], v14 offset:38912
    v_mfma_f32_16x16x32_bf16 a[168:171], a[84:87], a[24:27], a[168:171]
    v_mfma_f32_16x16x32_bf16 a[172:175], a[80:83], a[12:15], a[172:175]
    v_mfma_f32_16x16x32_bf16 a[172:175], a[84:87], a[28:31], a[172:175]
    s_waitcnt lgkmcnt(4)
    v_mfma_f32_16x16x32_bf16 a[176:179], a[88:91], a[0:3], a[176:179]
    ds_read_b128 a[48:51], v15 offset:32768
    v_mfma_f32_16x16x32_bf16 a[176:179], a[92:95], a[16:19], a[176:179]
    ds_read_b128 a[52:55], v15 offset:34816
    v_mfma_f32_16x16x32_bf16 a[180:183], a[88:91], a[4:7], a[180:183]
    ds_read_b128 a[56:59], v15 offset:36864
    v_mfma_f32_16x16x32_bf16 a[180:183], a[92:95], a[20:23], a[180:183]
    ds_read_b128 a[60:63], v15 offset:38912
    v_mfma_f32_16x16x32_bf16 a[184:187], a[88:91], a[8:11], a[184:187]
    v_mfma_f32_16x16x32_bf16 a[184:187], a[92:95], a[24:27], a[184:187]
    v_mfma_f32_16x16x32_bf16 a[188:191], a[88:91], a[12:15], a[188:191]
    v_mfma_f32_16x16x32_bf16 a[188:191], a[92:95], a[28:31], a[188:191]
    v_mfma_f32_16x16x32_bf16 a[232:235], a[100:103], a[96:99], a[232:235]
    v_mfma_f32_16x16x32_bf16 a[232:235], a[104:107], a[96:99], a[232:235]
    v_mfma_f32_16x16x32_bf16 a[192:195], a[96:99], a[0:3], a[192:195]
    s_waitcnt vmcnt(26)
    v_mfma_f32_16x16x32_bf16 a[192:195], a[96:99], a[16:19], a[192:195]
    s_barrier
    v_mfma_f32_16x16x32_bf16 a[208:211], a[0:3], a[0:3], a[208:211]
    ds_read_b64_tr_b16 a[64:65], v16 offset:0
    v_mfma_f32_16x16x32_bf16 a[208:211], a[16:19], a[16:19], a[208:211]
    ds_read_b64_tr_b16 a[66:67], v16 offset:1024
    v_mfma_f32_16x16x32_bf16 a[196:199], a[96:99], a[4:7], a[196:199]
    ds_read_b64_tr_b16 a[68:69], v16 offset:8192
    v_mfma_f32_16x16x32_bf16 a[196:199], a[96:99], a[20:23], a[196:199]
    ds_read_b64_tr_b16 a[70:71], v16 offset:9216
    s_add_u32 s78, s28, 5
    s_and_b32 s78, s78, 7
    s_lshl_b32 s79, s78, 19
    s_add_u32 s76, s62, s79
    s_mul_i32 s79, s78, 176128
    s_add_u32 s77, s63, s79
    s_add_u32 m0, s24, 114688
    v_mfma_f32_16x16x32_bf16 a[212:215], a[4:7], a[4:7], a[212:215]
    buffer_load_dwordx4 v8, s[40:43], s76 offen offset:0 lds
    v_mfma_f32_16x16x32_bf16 a[212:215], a[20:23], a[20:23], a[212:215]
    buffer_load_dwordx4 v9, s[40:43], s76 offen offset:1024 lds
    v_mfma_f32_16x16x32_bf16 a[200:203], a[96:99], a[8:11], a[200:203]
    ds_read_b64_tr_b16 a[72:73], v16 offset:8
    v_mfma_f32_16x16x32_bf16 a[200:203], a[96:99], a[24:27], a[200:203]
    ds_read_b64_tr_b16 a[74:75], v16 offset:1032
    v_mfma_f32_16x16x32_bf16 a[216:219], a[8:11], a[8:11], a[216:219]
    ds_read_b64_tr_b16 a[76:77], v16 offset:8200
    v_mfma_f32_16x16x32_bf16 a[216:219], a[24:27], a[24:27], a[216:219]
    ds_read_b64_tr_b16 a[78:79], v16 offset:9224
    v_mfma_f32_16x16x32_bf16 a[204:207], a[96:99], a[12:15], a[204:207]
    buffer_load_dwordx4 v10, s[40:43], s76 offen offset:2048 lds
    v_mfma_f32_16x16x32_bf16 a[204:207], a[96:99], a[28:31], a[204:207]
    buffer_load_dwordx4 v11, s[40:43], s76 offen offset:3072 lds
    s_add_u32 m0, s64, 131072
    v_mfma_f32_16x16x32_bf16 a[220:223], a[12:15], a[12:15], a[220:223]
    buffer_load_dwordx4 v12, s[44:47], s77 offen offset:0 lds
    v_mfma_f32_16x16x32_bf16 a[220:223], a[28:31], a[28:31], a[220:223]
    buffer_load_dwordx4 v13, s[44:47], s77 offen offset:1024 lds
    s_waitcnt lgkmcnt(4)
    v_mfma_f32_16x16x32_bf16 v[128:131], a[64:67], a[32:35], v[128:131]
    ds_read_b64_tr_b16 a[80:81], v17 offset:0
    v_mfma_f32_16x16x32_bf16 v[128:131], a[68:71], a[48:51], v[128:131]
    ds_read_b64_tr_b16 a[82:83], v17 offset:1024
    v_mfma_f32_16x16x32_bf16 v[160:163], a[64:67], a[36:39], v[160:163]
    ds_read_b64_tr_b16 a[84:85], v17 offset:8192
    v_mfma_f32_16x16x32_bf16 v[160:163], a[68:71], a[52:55], v[160:163]
    ds_read_b64_tr_b16 a[86:87], v17 offset:9216
    s_add_u32 s78, s28, 5
    s_and_b32 s78, s78, 7
    s_lshl_b32 s78, s78, 7
    s_add_u32 s74, s61, s78
    s_xor_b32 s75, s74, 0x8000
    s_add_u32 m0, s60, 32768
    v_mfma_f32_16x16x32_bf16 v[192:195], a[64:67], a[40:43], v[192:195]
    buffer_load_dwordx4 v0, s[16:19], s74 offen offset:0 lds
    v_mfma_f32_16x16x32_bf16 v[192:195], a[68:71], a[56:59], v[192:195]
    buffer_load_dwordx4 v1, s[16:19], s74 offen offset:1024 lds
    v_mfma_f32_16x16x32_bf16 v[224:227], a[64:67], a[44:47], v[224:227]
    v_mfma_f32_16x16x32_bf16 v[224:227], a[68:71], a[60:63], v[224:227]
    v_mfma_f32_16x16x32_bf16 a[224:227], a[64:67], a[96:99], a[224:227]
    v_mfma_f32_16x16x32_bf16 a[224:227], a[68:71], a[96:99], a[224:227]
    s_waitcnt lgkmcnt(4)
    v_mfma_f32_16x16x32_bf16 v[132:135], a[72:75], a[32:35], v[132:135]
    ds_read_b64_tr_b16 a[88:89], v17 offset:8
    v_mfma_f32_16x16x32_bf16 v[132:135], a[76:79], a[48:51], v[132:135]
    ds_read_b64_tr_b16 a[90:91], v17 offset:1032
    v_mfma_f32_16x16x32_bf16 v[164:167], a[72:75], a[36:39], v[164:167]
    ds_read_b64_tr_b16 a[92:93], v17 offset:8200
    v_mfma_f32_16x16x32_bf16 v[164:167], a[76:79], a[52:55], v[164:167]
    ds_read_b64_tr_b16 a[94:95], v17 offset:9224
    v_mfma_f32_16x16x32_bf16 v[196:199], a[72:75], a[40:43], v[196:199]
    buffer_load_dwordx4 v2, s[16:19], s74 offen offset:2048 lds
    v_mfma_f32_16x16x32_bf16 v[196:199], a[76:79], a[56:59], v[196:199]
    buffer_load_dwordx4 v3, s[16:19], s74 offen offset:3072 lds
    v_mfma_f32_16x16x32_bf16 v[228:231], a[72:75], a[44:47], v[228:231]
    v_mfma_f32_16x16x32_bf16 v[228:231], a[76:79], a[60:63], v[228:231]
    v_mfma_f32_16x16x32_bf16 a[228:231], a[72:75], a[96:99], a[228:231]
    v_mfma_f32_16x16x32_bf16 a[228:231], a[76:79], a[96:99], a[228:231]
    s_waitcnt lgkmcnt(4)
    v_mfma_f32_16x16x32_bf16 v[136:139], a[80:83], a[32:35], v[136:139]
    ds_read_b64_tr_b16 a[64:65], v18 offset:0
    v_mfma_f32_16x16x32_bf16 v[136:139], a[84:87], a[48:51], v[136:139]
    ds_read_b64_tr_b16 a[66:67], v18 offset:1024
    v_mfma_f32_16x16x32_bf16 v[168:171], a[80:83], a[36:39], v[168:171]
    ds_read_b64_tr_b16 a[68:69], v18 offset:8192
    v_mfma_f32_16x16x32_bf16 v[168:171], a[84:87], a[52:55], v[168:171]
    ds_read_b64_tr_b16 a[70:71], v18 offset:9216
    s_add_u32 m0, s60, 36864
    v_mfma_f32_16x16x32_bf16 v[200:203], a[80:83], a[40:43], v[200:203]
    buffer_load_dwordx4 v0, s[16:19], s75 offen offset:0 lds
    v_mfma_f32_16x16x32_bf16 v[200:203], a[84:87], a[56:59], v[200:203]
    buffer_load_dwordx4 v1, s[16:19], s75 offen offset:1024 lds
    v_mfma_f32_16x16x32_bf16 v[232:235], a[80:83], a[44:47], v[232:235]
    v_mfma_f32_16x16x32_bf16 v[232:235], a[84:87], a[60:63], v[232:235]
    s_waitcnt lgkmcnt(4)
    v_mfma_f32_16x16x32_bf16 v[140:143], a[88:91], a[32:35], v[140:143]
    ds_read_b64_tr_b16 a[72:73], v18 offset:8
    v_mfma_f32_16x16x32_bf16 v[140:143], a[92:95], a[48:51], v[140:143]
    ds_read_b64_tr_b16 a[74:75], v18 offset:1032
    v_mfma_f32_16x16x32_bf16 v[172:175], a[88:91], a[36:39], v[172:175]
    ds_read_b64_tr_b16 a[76:77], v18 offset:8200
    v_mfma_f32_16x16x32_bf16 v[172:175], a[92:95], a[52:55], v[172:175]
    ds_read_b64_tr_b16 a[78:79], v18 offset:9224
    v_mfma_f32_16x16x32_bf16 v[204:207], a[88:91], a[40:43], v[204:207]
    buffer_load_dwordx4 v2, s[16:19], s75 offen offset:2048 lds
    v_mfma_f32_16x16x32_bf16 v[204:207], a[92:95], a[56:59], v[204:207]
    buffer_load_dwordx4 v3, s[16:19], s75 offen offset:3072 lds
    v_mfma_f32_16x16x32_bf16 v[236:239], a[88:91], a[44:47], v[236:239]
    v_mfma_f32_16x16x32_bf16 v[236:239], a[92:95], a[60:63], v[236:239]
    s_waitcnt lgkmcnt(4)
    v_mfma_f32_16x16x32_bf16 v[144:147], a[64:67], a[32:35], v[144:147]
    ds_read_b64_tr_b16 a[80:81], v19 offset:0
    v_mfma_f32_16x16x32_bf16 v[144:147], a[68:71], a[48:51], v[144:147]
    ds_read_b64_tr_b16 a[82:83], v19 offset:1024
    v_mfma_f32_16x16x32_bf16 v[176:179], a[64:67], a[36:39], v[176:179]
    ds_read_b64_tr_b16 a[84:85], v19 offset:8192
    v_mfma_f32_16x16x32_bf16 v[176:179], a[68:71], a[52:55], v[176:179]
    ds_read_b64_tr_b16 a[86:87], v19 offset:9216
    v_mfma_f32_16x16x32_bf16 v[208:211], a[64:67], a[40:43], v[208:211]
    v_mfma_f32_16x16x32_bf16 v[208:211], a[68:71], a[56:59], v[208:211]
    v_mfma_f32_16x16x32_bf16 v[240:243], a[64:67], a[44:47], v[240:243]
    v_mfma_f32_16x16x32_bf16 v[240:243], a[68:71], a[60:63], v[240:243]
    s_waitcnt lgkmcnt(4)
    v_mfma_f32_16x16x32_bf16 v[148:151], a[72:75], a[32:35], v[148:151]
    ds_read_b64_tr_b16 a[88:89], v19 offset:8
    v_mfma_f32_16x16x32_bf16 v[148:151], a[76:79], a[48:51], v[148:151]
    ds_read_b64_tr_b16 a[90:91], v19 offset:1032
    v_mfma_f32_16x16x32_bf16 v[180:183], a[72:75], a[36:39], v[180:183]
    ds_read_b64_tr_b16 a[92:93], v19 offset:8200
    v_mfma_f32_16x16x32_bf16 v[180:183], a[76:79], a[52:55], v[180:183]
    ds_read_b64_tr_b16 a[94:95], v19 offset:9224
    v_mfma_f32_16x16x32_bf16 v[212:215], a[72:75], a[40:43], v[212:215]
    v_mfma_f32_16x16x32_bf16 v[212:215], a[76:79], a[56:59], v[212:215]
    v_mfma_f32_16x16x32_bf16 v[244:247], a[72:75], a[44:47], v[244:247]
    v_mfma_f32_16x16x32_bf16 v[244:247], a[76:79], a[60:63], v[244:247]
    s_waitcnt lgkmcnt(4)
    v_mfma_f32_16x16x32_bf16 v[152:155], a[80:83], a[32:35], v[152:155]
    ds_read_b64_tr_b16 a[64:65], v20 offset:0
    v_mfma_f32_16x16x32_bf16 v[152:155], a[84:87], a[48:51], v[152:155]
    ds_read_b64_tr_b16 a[66:67], v20 offset:512
    v_mfma_f32_16x16x32_bf16 v[184:187], a[80:83], a[36:39], v[184:187]
    ds_read_b64_tr_b16 a[68:69], v20 offset:4096
    v_mfma_f32_16x16x32_bf16 v[184:187], a[84:87], a[52:55], v[184:187]
    ds_read_b64_tr_b16 a[70:71], v20 offset:4608
    v_mfma_f32_16x16x32_bf16 v[216:219], a[80:83], a[40:43], v[216:219]
    v_mfma_f32_16x16x32_bf16 v[216:219], a[84:87], a[56:59], v[216:219]
    v_mfma_f32_16x16x32_bf16 v[248:251], a[80:83], a[44:47], v[248:251]
    v_mfma_f32_16x16x32_bf16 v[248:251], a[84:87], a[60:63], v[248:251]
    s_waitcnt lgkmcnt(4)
    v_mfma_f32_16x16x32_bf16 v[156:159], a[88:91], a[32:35], v[156:159]
    ds_read_b64_tr_b16 a[72:73], v21 offset:0
    v_mfma_f32_16x16x32_bf16 v[156:159], a[92:95], a[48:51], v[156:159]
    ds_read_b64_tr_b16 a[74:75], v21 offset:512
    v_mfma_f32_16x16x32_bf16 v[188:191], a[88:91], a[36:39], v[188:191]
    ds_read_b64_tr_b16 a[76:77], v21 offset:4096
    v_mfma_f32_16x16x32_bf16 v[188:191], a[92:95], a[52:55], v[188:191]
    ds_read_b64_tr_b16 a[78:79], v21 offset:4608
    v_mfma_f32_16x16x32_bf16 v[220:223], a[88:91], a[40:43], v[220:223]
    v_mfma_f32_16x16x32_bf16 v[220:223], a[92:95], a[56:59], v[220:223]
    v_mfma_f32_16x16x32_bf16 v[252:255], a[88:91], a[44:47], v[252:255]
    v_mfma_f32_16x16x32_bf16 v[252:255], a[92:95], a[60:63], v[252:255]
    s_waitcnt lgkmcnt(4)
    v_mfma_f32_16x16x32_bf16 a[128:131], a[64:67], a[32:35], a[128:131]
    ds_read_b64_tr_b16 a[80:81], v22 offset:0
    v_mfma_f32_16x16x32_bf16 a[128:131], a[68:71], a[48:51], a[128:131]
    ds_read_b64_tr_b16 a[82:83], v22 offset:512
    v_mfma_f32_16x16x32_bf16 a[132:135], a[64:67], a[36:39], a[132:135]
    ds_read_b64_tr_b16 a[84:85], v22 offset:4096
    v_mfma_f32_16x16x32_bf16 a[132:135], a[68:71], a[52:55], a[132:135]
    ds_read_b64_tr_b16 a[86:87], v22 offset:4608
    v_mfma_f32_16x16x32_bf16 a[136:139], a[64:67], a[40:43], a[136:139]
    ds_read_b64_tr_b16 a[100:101], v4 offset:0
    v_mfma_f32_16x16x32_bf16 a[136:139], a[68:71], a[56:59], a[136:139]
    ds_read_b64_tr_b16 a[102:103], v4 offset:512
    v_mfma_f32_16x16x32_bf16 a[140:143], a[64:67], a[44:47], a[140:143]
    v_mfma_f32_16x16x32_bf16 a[140:143], a[68:71], a[60:63], a[140:143]
    s_waitcnt lgkmcnt(6)
    v_mfma_f32_16x16x32_bf16 a[144:147], a[72:75], a[32:35], a[144:147]
    ds_read_b64_tr_b16 a[88:89], v23 offset:0
    v_mfma_f32_16x16x32_bf16 a[144:147], a[76:79], a[48:51], a[144:147]
    ds_read_b64_tr_b16 a[90:91], v23 offset:512
    v_mfma_f32_16x16x32_bf16 a[148:151], a[72:75], a[36:39], a[148:151]
    ds_read_b64_tr_b16 a[92:93], v23 offset:4096
    v_mfma_f32_16x16x32_bf16 a[148:151], a[76:79], a[52:55], a[148:151]
    ds_read_b64_tr_b16 a[94:95], v23 offset:4608
    v_mfma_f32_16x16x32_bf16 a[152:155], a[72:75], a[40:43], a[152:155]
    ds_read_b64_tr_b16 a[104:105], v4 offset:4096
    v_mfma_f32_16x16x32_bf16 a[152:155], a[76:79], a[56:59], a[152:155]
    ds_read_b64_tr_b16 a[106:107], v4 offset:4608
    v_mfma_f32_16x16x32_bf16 a[156:159], a[72:75], a[44:47], a[156:159]
    v_mfma_f32_16x16x32_bf16 a[156:159], a[76:79], a[60:63], a[156:159]
    s_waitcnt lgkmcnt(6)
    v_mfma_f32_16x16x32_bf16 a[160:163], a[80:83], a[32:35], a[160:163]
    s_waitcnt vmcnt(14)
    v_mfma_f32_16x16x32_bf16 a[160:163], a[84:87], a[48:51], a[160:163]
    ds_read_b128 a[0:3], v14 offset:0
    v_mfma_f32_16x16x32_bf16 a[164:167], a[80:83], a[36:39], a[164:167]
    ds_read_b128 a[4:7], v14 offset:2048
    v_mfma_f32_16x16x32_bf16 a[164:167], a[84:87], a[52:55], a[164:167]
    ds_read_b128 a[8:11], v14 offset:4096
    v_mfma_f32_16x16x32_bf16 a[168:171], a[80:83], a[40:43], a[168:171]
    ds_read_b128 a[12:15], v14 offset:6144
    v_mfma_f32_16x16x32_bf16 a[168:171], a[84:87], a[56:59], a[168:171]
    v_mfma_f32_16x16x32_bf16 a[172:175], a[80:83], a[44:47], a[172:175]
    v_mfma_f32_16x16x32_bf16 a[172:175], a[84:87], a[60:63], a[172:175]
    s_waitcnt lgkmcnt(4)
    v_mfma_f32_16x16x32_bf16 a[176:179], a[88:91], a[32:35], a[176:179]
    ds_read_b128 a[16:19], v15 offset:0
    v_mfma_f32_16x16x32_bf16 a[176:179], a[92:95], a[48:51], a[176:179]
    ds_read_b128 a[20:23], v15 offset:2048
    v_mfma_f32_16x16x32_bf16 a[180:183], a[88:91], a[36:39], a[180:183]
    ds_read_b128 a[24:27], v15 offset:4096
    v_mfma_f32_16x16x32_bf16 a[180:183], a[92:95], a[52:55], a[180:183]
    ds_read_b128 a[28:31], v15 offset:6144
    v_mfma_f32_16x16x32_bf16 a[184:187], a[88:91], a[40:43], a[184:187]
    v_mfma_f32_16x16x32_bf16 a[184:187], a[92:95], a[56:59], a[184:187]
    v_mfma_f32_16x16x32_bf16 a[188:191], a[88:91], a[44:47], a[188:191]
    v_mfma_f32_16x16x32_bf16 a[188:191], a[92:95], a[60:63], a[188:191]
    v_mfma_f32_16x16x32_bf16 a[232:235], a[100:103], a[96:99], a[232:235]
    v_mfma_f32_16x16x32_bf16 a[232:235], a[104:107], a[96:99], a[232:235]
    v_mfma_f32_16x16x32_bf16 a[192:195], a[96:99], a[32:35], a[192:195]
    s_waitcnt vmcnt(22)
    v_mfma_f32_16x16x32_bf16 a[192:195], a[96:99], a[48:51], a[192:195]
    s_barrier
    v_mfma_f32_16x16x32_bf16 a[208:211], a[32:35], a[32:35], a[208:211]
    ds_read_b64_tr_b16 a[64:65], v16 offset:24576
    v_mfma_f32_16x16x32_bf16 a[208:211], a[48:51], a[48:51], a[208:211]
    ds_read_b64_tr_b16 a[66:67], v16 offset:25600
    v_mfma_f32_16x16x32_bf16 a[196:199], a[96:99], a[36:39], a[196:199]
    ds_read_b64_tr_b16 a[68:69], v16 offset:32768
    v_mfma_f32_16x16x32_bf16 a[196:199], a[96:99], a[52:55], a[196:199]
    ds_read_b64_tr_b16 a[70:71], v16 offset:33792
    s_add_u32 s78, s28, 6
    s_and_b32 s78, s78, 7
    s_lshl_b32 s79, s78, 19
    s_add_u32 s76, s62, s79
    s_mul_i32 s79, s78, 176128
    s_add_u32 s77, s63, s79
    s_add_u32 m0, s24, 65536
    v_mfma_f32_16x16x32_bf16 a[212:215], a[36:39], a[36:39], a[212:215]
    buffer_load_dwordx4 v8, s[40:43], s76 offen offset:0 lds
    v_mfma_f32_16x16x32_bf16 a[212:215], a[52:55], a[52:55], a[212:215]
    buffer_load_dwordx4 v9, s[40:43], s76 offen offset:1024 lds
    v_mfma_f32_16x16x32_bf16 a[200:203], a[96:99], a[40:43], a[200:203]
    ds_read_b64_tr_b16 a[72:73], v16 offset:24584
    v_mfma_f32_16x16x32_bf16 a[200:203], a[96:99], a[56:59], a[200:203]
    ds_read_b64_tr_b16 a[74:75], v16 offset:25608
    v_mfma_f32_16x16x32_bf16 a[216:219], a[40:43], a[40:43], a[216:219]
    ds_read_b64_tr_b16 a[76:77], v16 offset:32776
    v_mfma_f32_16x16x32_bf16 a[216:219], a[56:59], a[56:59], a[216:219]
    ds_read_b64_tr_b16 a[78:79], v16 offset:33800
    v_mfma_f32_16x16x32_bf16 a[204:207], a[96:99], a[44:47], a[204:207]
    buffer_load_dwordx4 v10, s[40:43], s76 offen offset:2048 lds
    v_mfma_f32_16x16x32_bf16 a[204:207], a[96:99], a[60:63], a[204:207]
    buffer_load_dwordx4 v11, s[40:43], s76 offen offset:3072 lds
    s_add_u32 m0, s64, 81920
    v_mfma_f32_16x16x32_bf16 a[220:223], a[44:47], a[44:47], a[220:223]
    buffer_load_dwordx4 v12, s[44:47], s77 offen offset:0 lds
    v_mfma_f32_16x16x32_bf16 a[220:223], a[60:63], a[60:63], a[220:223]
    buffer_load_dwordx4 v13, s[44:47], s77 offen offset:1024 lds
    s_waitcnt lgkmcnt(4)
    v_mfma_f32_16x16x32_bf16 v[128:131], a[64:67], a[0:3], v[128:131]
    ds_read_b64_tr_b16 a[80:81], v17 offset:24576
    v_mfma_f32_16x16x32_bf16 v[128:131], a[68:71], a[16:19], v[128:131]
    ds_read_b64_tr_b16 a[82:83], v17 offset:25600
    v_mfma_f32_16x16x32_bf16 v[160:163], a[64:67], a[4:7], v[160:163]
    ds_read_b64_tr_b16 a[84:85], v17 offset:32768
    v_mfma_f32_16x16x32_bf16 v[160:163], a[68:71], a[20:23], v[160:163]
    ds_read_b64_tr_b16 a[86:87], v17 offset:33792
    s_add_u32 s78, s28, 6
    s_and_b32 s78, s78, 7
    s_lshl_b32 s78, s78, 7
    s_add_u32 s74, s61, s78
    s_xor_b32 s75, s74, 0x8000
    s_add_u32 m0, s60, 0
    v_mfma_f32_16x16x32_bf16 v[192:195], a[64:67], a[8:11], v[192:195]
    buffer_load_dwordx4 v0, s[16:19], s74 offen offset:0 lds
    v_mfma_f32_16x16x32_bf16 v[192:195], a[68:71], a[24:27], v[192:195]
    buffer_load_dwordx4 v1, s[16:19], s74 offen offset:1024 lds
    v_mfma_f32_16x16x32_bf16 v[224:227], a[64:67], a[12:15], v[224:227]
    v_mfma_f32_16x16x32_bf16 v[224:227], a[68:71], a[28:31], v[224:227]
    v_mfma_f32_16x16x32_bf16 a[224:227], a[64:67], a[96:99], a[224:227]
    v_mfma_f32_16x16x32_bf16 a[224:227], a[68:71], a[96:99], a[224:227]
    s_waitcnt lgkmcnt(4)
    v_mfma_f32_16x16x32_bf16 v[132:135], a[72:75], a[0:3], v[132:135]
    ds_read_b64_tr_b16 a[88:89], v17 offset:24584
    v_mfma_f32_16x16x32_bf16 v[132:135], a[76:79], a[16:19], v[132:135]
    ds_read_b64_tr_b16 a[90:91], v17 offset:25608
    v_mfma_f32_16x16x32_bf16 v[164:167], a[72:75], a[4:7], v[164:167]
    ds_read_b64_tr_b16 a[92:93], v17 offset:32776
    v_mfma_f32_16x16x32_bf16 v[164:167], a[76:79], a[20:23], v[164:167]
    ds_read_b64_tr_b16 a[94:95], v17 offset:33800
    v_mfma_f32_16x16x32_bf16 v[196:199], a[72:75], a[8:11], v[196:199]
    buffer_load_dwordx4 v2, s[16:19], s74 offen offset:2048 lds
    v_mfma_f32_16x16x32_bf16 v[196:199], a[76:79], a[24:27], v[196:199]
    buffer_load_dwordx4 v3, s[16:19], s74 offen offset:3072 lds
    v_mfma_f32_16x16x32_bf16 v[228:231], a[72:75], a[12:15], v[228:231]
    v_mfma_f32_16x16x32_bf16 v[228:231], a[76:79], a[28:31], v[228:231]
    v_mfma_f32_16x16x32_bf16 a[228:231], a[72:75], a[96:99], a[228:231]
    v_mfma_f32_16x16x32_bf16 a[228:231], a[76:79], a[96:99], a[228:231]
    s_waitcnt lgkmcnt(4)
    v_mfma_f32_16x16x32_bf16 v[136:139], a[80:83], a[0:3], v[136:139]
    ds_read_b64_tr_b16 a[64:65], v18 offset:24576
    v_mfma_f32_16x16x32_bf16 v[136:139], a[84:87], a[16:19], v[136:139]
    ds_read_b64_tr_b16 a[66:67], v18 offset:25600
    v_mfma_f32_16x16x32_bf16 v[168:171], a[80:83], a[4:7], v[168:171]
    ds_read_b64_tr_b16 a[68:69], v18 offset:32768
    v_mfma_f32_16x16x32_bf16 v[168:171], a[84:87], a[20:23], v[168:171]
    ds_read_b64_tr_b16 a[70:71], v18 offset:33792
    s_add_u32 m0, s60, 4096
    v_mfma_f32_16x16x32_bf16 v[200:203], a[80:83], a[8:11], v[200:203]
    buffer_load_dwordx4 v0, s[16:19], s75 offen offset:0 lds
    v_mfma_f32_16x16x32_bf16 v[200:203], a[84:87], a[24:27], v[200:203]
    buffer_load_dwordx4 v1, s[16:19], s75 offen offset:1024 lds
    v_mfma_f32_16x16x32_bf16 v[232:235], a[80:83], a[12:15], v[232:235]
    v_mfma_f32_16x16x32_bf16 v[232:235], a[84:87], a[28:31], v[232:235]
    s_waitcnt lgkmcnt(4)
    v_mfma_f32_16x16x32_bf16 v[140:143], a[88:91], a[0:3], v[140:143]
    ds_read_b64_tr_b16 a[72:73], v18 offset:24584
    v_mfma_f32_16x16x32_bf16 v[140:143], a[92:95], a[16:19], v[140:143]
    ds_read_b64_tr_b16 a[74:75], v18 offset:25608
    v_mfma_f32_16x16x32_bf16 v[172:175], a[88:91], a[4:7], v[172:175]
    ds_read_b64_tr_b16 a[76:77], v18 offset:32776
    v_mfma_f32_16x16x32_bf16 v[172:175], a[92:95], a[20:23], v[172:175]
    ds_read_b64_tr_b16 a[78:79], v18 offset:33800
    v_mfma_f32_16x16x32_bf16 v[204:207], a[88:91], a[8:11], v[204:207]
    buffer_load_dwordx4 v2, s[16:19], s75 offen offset:2048 lds
    v_mfma_f32_16x16x32_bf16 v[204:207], a[92:95], a[24:27], v[204:207]
    buffer_load_dwordx4 v3, s[16:19], s75 offen offset:3072 lds
    v_mfma_f32_16x16x32_bf16 v[236:239], a[88:91], a[12:15], v[236:239]
    v_mfma_f32_16x16x32_bf16 v[236:239], a[92:95], a[28:31], v[236:239]
    s_waitcnt lgkmcnt(4)
    v_mfma_f32_16x16x32_bf16 v[144:147], a[64:67], a[0:3], v[144:147]
    ds_read_b64_tr_b16 a[80:81], v19 offset:24576
    v_mfma_f32_16x16x32_bf16 v[144:147], a[68:71], a[16:19], v[144:147]
    ds_read_b64_tr_b16 a[82:83], v19 offset:25600
    v_mfma_f32_16x16x32_bf16 v[176:179], a[64:67], a[4:7], v[176:179]
    ds_read_b64_tr_b16 a[84:85], v19 offset:32768
    v_mfma_f32_16x16x32_bf16 v[176:179], a[68:71], a[20:23], v[176:179]
    ds_read_b64_tr_b16 a[86:87], v19 offset:33792
    v_mfma_f32_16x16x32_bf16 v[208:211], a[64:67], a[8:11], v[208:211]
    v_mfma_f32_16x16x32_bf16 v[208:211], a[68:71], a[24:27], v[208:211]
    v_mfma_f32_16x16x32_bf16 v[240:243], a[64:67], a[12:15], v[240:243]
    v_mfma_f32_16x16x32_bf16 v[240:243], a[68:71], a[28:31], v[240:243]
    s_waitcnt lgkmcnt(4)
    v_mfma_f32_16x16x32_bf16 v[148:151], a[72:75], a[0:3], v[148:151]
    ds_read_b64_tr_b16 a[88:89], v19 offset:24584
    v_mfma_f32_16x16x32_bf16 v[148:151], a[76:79], a[16:19], v[148:151]
    ds_read_b64_tr_b16 a[90:91], v19 offset:25608
    v_mfma_f32_16x16x32_bf16 v[180:183], a[72:75], a[4:7], v[180:183]
    ds_read_b64_tr_b16 a[92:93], v19 offset:32776
    v_mfma_f32_16x16x32_bf16 v[180:183], a[76:79], a[20:23], v[180:183]
    ds_read_b64_tr_b16 a[94:95], v19 offset:33800
    v_mfma_f32_16x16x32_bf16 v[212:215], a[72:75], a[8:11], v[212:215]
    v_mfma_f32_16x16x32_bf16 v[212:215], a[76:79], a[24:27], v[212:215]
    v_mfma_f32_16x16x32_bf16 v[244:247], a[72:75], a[12:15], v[244:247]
    v_mfma_f32_16x16x32_bf16 v[244:247], a[76:79], a[28:31], v[244:247]
    s_waitcnt lgkmcnt(4)
    v_mfma_f32_16x16x32_bf16 v[152:155], a[80:83], a[0:3], v[152:155]
    ds_read_b64_tr_b16 a[64:65], v20 offset:24576
    v_mfma_f32_16x16x32_bf16 v[152:155], a[84:87], a[16:19], v[152:155]
    ds_read_b64_tr_b16 a[66:67], v20 offset:25088
    v_mfma_f32_16x16x32_bf16 v[184:187], a[80:83], a[4:7], v[184:187]
    ds_read_b64_tr_b16 a[68:69], v20 offset:28672
    v_mfma_f32_16x16x32_bf16 v[184:187], a[84:87], a[20:23], v[184:187]
    ds_read_b64_tr_b16 a[70:71], v20 offset:29184
    v_mfma_f32_16x16x32_bf16 v[216:219], a[80:83], a[8:11], v[216:219]
    v_mfma_f32_16x16x32_bf16 v[216:219], a[84:87], a[24:27], v[216:219]
    v_mfma_f32_16x16x32_bf16 v[248:251], a[80:83], a[12:15], v[248:251]
    v_mfma_f32_16x16x32_bf16 v[248:251], a[84:87], a[28:31], v[248:251]
    s_waitcnt lgkmcnt(4)
    v_mfma_f32_16x16x32_bf16 v[156:159], a[88:91], a[0:3], v[156:159]
    ds_read_b64_tr_b16 a[72:73], v21 offset:24576
    v_mfma_f32_16x16x32_bf16 v[156:159], a[92:95], a[16:19], v[156:159]
    ds_read_b64_tr_b16 a[74:75], v21 offset:25088
    v_mfma_f32_16x16x32_bf16 v[188:191], a[88:91], a[4:7], v[188:191]
    ds_read_b64_tr_b16 a[76:77], v21 offset:28672
    v_mfma_f32_16x16x32_bf16 v[188:191], a[92:95], a[20:23], v[188:191]
    ds_read_b64_tr_b16 a[78:79], v21 offset:29184
    v_mfma_f32_16x16x32_bf16 v[220:223], a[88:91], a[8:11], v[220:223]
    v_mfma_f32_16x16x32_bf16 v[220:223], a[92:95], a[24:27], v[220:223]
    v_mfma_f32_16x16x32_bf16 v[252:255], a[88:91], a[12:15], v[252:255]
    v_mfma_f32_16x16x32_bf16 v[252:255], a[92:95], a[28:31], v[252:255]
    s_waitcnt lgkmcnt(4)
    v_mfma_f32_16x16x32_bf16 a[128:131], a[64:67], a[0:3], a[128:131]
    ds_read_b64_tr_b16 a[80:81], v22 offset:24576
    v_mfma_f32_16x16x32_bf16 a[128:131], a[68:71], a[16:19], a[128:131]
    ds_read_b64_tr_b16 a[82:83], v22 offset:25088
    v_mfma_f32_16x16x32_bf16 a[132:135], a[64:67], a[4:7], a[132:135]
    ds_read_b64_tr_b16 a[84:85], v22 offset:28672
    v_mfma_f32_16x16x32_bf16 a[132:135], a[68:71], a[20:23], a[132:135]
    ds_read_b64_tr_b16 a[86:87], v22 offset:29184
    v_mfma_f32_16x16x32_bf16 a[136:139], a[64:67], a[8:11], a[136:139]
    ds_read_b64_tr_b16 a[100:101], v4 offset:24576
    v_mfma_f32_16x16x32_bf16 a[136:139], a[68:71], a[24:27], a[136:139]
    ds_read_b64_tr_b16 a[102:103], v4 offset:25088
    v_mfma_f32_16x16x32_bf16 a[140:143], a[64:67], a[12:15], a[140:143]
    v_mfma_f32_16x16x32_bf16 a[140:143], a[68:71], a[28:31], a[140:143]
    s_waitcnt lgkmcnt(6)
    v_mfma_f32_16x16x32_bf16 a[144:147], a[72:75], a[0:3], a[144:147]
    ds_read_b64_tr_b16 a[88:89], v23 offset:24576
    v_mfma_f32_16x16x32_bf16 a[144:147], a[76:79], a[16:19], a[144:147]
    ds_read_b64_tr_b16 a[90:91], v23 offset:25088
    v_mfma_f32_16x16x32_bf16 a[148:151], a[72:75], a[4:7], a[148:151]
    ds_read_b64_tr_b16 a[92:93], v23 offset:28672
    v_mfma_f32_16x16x32_bf16 a[148:151], a[76:79], a[20:23], a[148:151]
    ds_read_b64_tr_b16 a[94:95], v23 offset:29184
    v_mfma_f32_16x16x32_bf16 a[152:155], a[72:75], a[8:11], a[152:155]
    ds_read_b64_tr_b16 a[104:105], v4 offset:28672
    v_mfma_f32_16x16x32_bf16 a[152:155], a[76:79], a[24:27], a[152:155]
    ds_read_b64_tr_b16 a[106:107], v4 offset:29184
    v_mfma_f32_16x16x32_bf16 a[156:159], a[72:75], a[12:15], a[156:159]
    v_mfma_f32_16x16x32_bf16 a[156:159], a[76:79], a[28:31], a[156:159]
    s_waitcnt lgkmcnt(6)
    v_mfma_f32_16x16x32_bf16 a[160:163], a[80:83], a[0:3], a[160:163]
    s_waitcnt vmcnt(14)
    v_mfma_f32_16x16x32_bf16 a[160:163], a[84:87], a[16:19], a[160:163]
    ds_read_b128 a[32:35], v14 offset:32768
    v_mfma_f32_16x16x32_bf16 a[164:167], a[80:83], a[4:7], a[164:167]
    ds_read_b128 a[36:39], v14 offset:34816
    v_mfma_f32_16x16x32_bf16 a[164:167], a[84:87], a[20:23], a[164:167]
    ds_read_b128 a[40:43], v14 offset:36864
    v_mfma_f32_16x16x32_bf16 a[168:171], a[80:83], a[8:11], a[168:171]
    ds_read_b128 a[44:47], v14 offset:38912
    v_mfma_f32_16x16x32_bf16 a[168:171], a[84:87], a[24:27], a[168:171]
    v_mfma_f32_16x16x32_bf16 a[172:175], a[80:83], a[12:15], a[172:175]
    v_mfma_f32_16x16x32_bf16 a[172:175], a[84:87], a[28:31], a[172:175]
    s_waitcnt lgkmcnt(4)
    v_mfma_f32_16x16x32_bf16 a[176:179], a[88:91], a[0:3], a[176:179]
    ds_read_b128 a[48:51], v15 offset:32768
    v_mfma_f32_16x16x32_bf16 a[176:179], a[92:95], a[16:19], a[176:179]
    ds_read_b128 a[52:55], v15 offset:34816
    v_mfma_f32_16x16x32_bf16 a[180:183], a[88:91], a[4:7], a[180:183]
    ds_read_b128 a[56:59], v15 offset:36864
    v_mfma_f32_16x16x32_bf16 a[180:183], a[92:95], a[20:23], a[180:183]
    ds_read_b128 a[60:63], v15 offset:38912
    v_mfma_f32_16x16x32_bf16 a[184:187], a[88:91], a[8:11], a[184:187]
    v_mfma_f32_16x16x32_bf16 a[184:187], a[92:95], a[24:27], a[184:187]
    v_mfma_f32_16x16x32_bf16 a[188:191], a[88:91], a[12:15], a[188:191]
    v_mfma_f32_16x16x32_bf16 a[188:191], a[92:95], a[28:31], a[188:191]
    v_mfma_f32_16x16x32_bf16 a[232:235], a[100:103], a[96:99], a[232:235]
    v_mfma_f32_16x16x32_bf16 a[232:235], a[104:107], a[96:99], a[232:235]
    v_mfma_f32_16x16x32_bf16 a[192:195], a[96:99], a[0:3], a[192:195]
    s_waitcnt vmcnt(22)
    v_mfma_f32_16x16x32_bf16 a[192:195], a[96:99], a[16:19], a[192:195]
    s_barrier
    v_mfma_f32_16x16x32_bf16 a[208:211], a[0:3], a[0:3], a[208:211]
    ds_read_b64_tr_b16 a[64:65], v16 offset:49152
    v_mfma_f32_16x16x32_bf16 a[208:211], a[16:19], a[16:19], a[208:211]
    ds_read_b64_tr_b16 a[66:67], v16 offset:50176
    v_mfma_f32_16x16x32_bf16 a[196:199], a[96:99], a[4:7], a[196:199]
    ds_read_b64_tr_b16 a[68:69], v16 offset:57344
    v_mfma_f32_16x16x32_bf16 a[196:199], a[96:99], a[20:23], a[196:199]
    ds_read_b64_tr_b16 a[70:71], v16 offset:58368
    s_add_u32 s78, s28, 7
    s_and_b32 s78, s78, 7
    s_lshl_b32 s79, s78, 19
    s_add_u32 s76, s62, s79
    s_mul_i32 s79, s78, 176128
    s_add_u32 s77, s63, s79
    s_add_u32 m0, s24, 90112
    v_mfma_f32_16x16x32_bf16 a[212:215], a[4:7], a[4:7], a[212:215]
    buffer_load_dwordx4 v8, s[40:43], s76 offen offset:0 lds
    v_mfma_f32_16x16x32_bf16 a[212:215], a[20:23], a[20:23], a[212:215]
    buffer_load_dwordx4 v9, s[40:43], s76 offen offset:1024 lds
    v_mfma_f32_16x16x32_bf16 a[200:203], a[96:99], a[8:11], a[200:203]
    ds_read_b64_tr_b16 a[72:73], v16 offset:49160
    v_mfma_f32_16x16x32_bf16 a[200:203], a[96:99], a[24:27], a[200:203]
    ds_read_b64_tr_b16 a[74:75], v16 offset:50184
    v_mfma_f32_16x16x32_bf16 a[216:219], a[8:11], a[8:11], a[216:219]
    ds_read_b64_tr_b16 a[76:77], v16 offset:57352
    v_mfma_f32_16x16x32_bf16 a[216:219], a[24:27], a[24:27], a[216:219]
    ds_read_b64_tr_b16 a[78:79], v16 offset:58376
    v_mfma_f32_16x16x32_bf16 a[204:207], a[96:99], a[12:15], a[204:207]
    buffer_load_dwordx4 v10, s[40:43], s76 offen offset:2048 lds
    v_mfma_f32_16x16x32_bf16 a[204:207], a[96:99], a[28:31], a[204:207]
    buffer_load_dwordx4 v11, s[40:43], s76 offen offset:3072 lds
    s_add_u32 m0, s64, 106496
    v_mfma_f32_16x16x32_bf16 a[220:223], a[12:15], a[12:15], a[220:223]
    buffer_load_dwordx4 v12, s[44:47], s77 offen offset:0 lds
    v_mfma_f32_16x16x32_bf16 a[220:223], a[28:31], a[28:31], a[220:223]
    buffer_load_dwordx4 v13, s[44:47], s77 offen offset:1024 lds
    s_waitcnt lgkmcnt(4)
    v_mfma_f32_16x16x32_bf16 v[128:131], a[64:67], a[32:35], v[128:131]
    ds_read_b64_tr_b16 a[80:81], v17 offset:49152
    v_mfma_f32_16x16x32_bf16 v[128:131], a[68:71], a[48:51], v[128:131]
    ds_read_b64_tr_b16 a[82:83], v17 offset:50176
    v_mfma_f32_16x16x32_bf16 v[160:163], a[64:67], a[36:39], v[160:163]
    ds_read_b64_tr_b16 a[84:85], v17 offset:57344
    v_mfma_f32_16x16x32_bf16 v[160:163], a[68:71], a[52:55], v[160:163]
    ds_read_b64_tr_b16 a[86:87], v17 offset:58368
    s_add_u32 s78, s28, 7
    s_and_b32 s78, s78, 7
    s_lshl_b32 s78, s78, 7
    s_add_u32 s74, s61, s78
    s_xor_b32 s75, s74, 0x8000
    s_add_u32 m0, s60, 32768
    v_mfma_f32_16x16x32_bf16 v[192:195], a[64:67], a[40:43], v[192:195]
    buffer_load_dwordx4 v0, s[16:19], s74 offen offset:0 lds
    v_mfma_f32_16x16x32_bf16 v[192:195], a[68:71], a[56:59], v[192:195]
    buffer_load_dwordx4 v1, s[16:19], s74 offen offset:1024 lds
    v_mfma_f32_16x16x32_bf16 v[224:227], a[64:67], a[44:47], v[224:227]
    v_mfma_f32_16x16x32_bf16 v[224:227], a[68:71], a[60:63], v[224:227]
    v_mfma_f32_16x16x32_bf16 a[224:227], a[64:67], a[96:99], a[224:227]
    v_mfma_f32_16x16x32_bf16 a[224:227], a[68:71], a[96:99], a[224:227]
    s_waitcnt lgkmcnt(4)
    v_mfma_f32_16x16x32_bf16 v[132:135], a[72:75], a[32:35], v[132:135]
    ds_read_b64_tr_b16 a[88:89], v17 offset:49160
    v_mfma_f32_16x16x32_bf16 v[132:135], a[76:79], a[48:51], v[132:135]
    ds_read_b64_tr_b16 a[90:91], v17 offset:50184
    v_mfma_f32_16x16x32_bf16 v[164:167], a[72:75], a[36:39], v[164:167]
    ds_read_b64_tr_b16 a[92:93], v17 offset:57352
    v_mfma_f32_16x16x32_bf16 v[164:167], a[76:79], a[52:55], v[164:167]
    ds_read_b64_tr_b16 a[94:95], v17 offset:58376
    v_mfma_f32_16x16x32_bf16 v[196:199], a[72:75], a[40:43], v[196:199]
    buffer_load_dwordx4 v2, s[16:19], s74 offen offset:2048 lds
    v_mfma_f32_16x16x32_bf16 v[196:199], a[76:79], a[56:59], v[196:199]
    buffer_load_dwordx4 v3, s[16:19], s74 offen offset:3072 lds
    v_mfma_f32_16x16x32_bf16 v[228:231], a[72:75], a[44:47], v[228:231]
    v_mfma_f32_16x16x32_bf16 v[228:231], a[76:79], a[60:63], v[228:231]
    v_mfma_f32_16x16x32_bf16 a[228:231], a[72:75], a[96:99], a[228:231]
    v_mfma_f32_16x16x32_bf16 a[228:231], a[76:79], a[96:99], a[228:231]
    s_waitcnt lgkmcnt(4)
    v_mfma_f32_16x16x32_bf16 v[136:139], a[80:83], a[32:35], v[136:139]
    ds_read_b64_tr_b16 a[64:65], v18 offset:49152
    v_mfma_f32_16x16x32_bf16 v[136:139], a[84:87], a[48:51], v[136:139]
    ds_read_b64_tr_b16 a[66:67], v18 offset:50176
    v_mfma_f32_16x16x32_bf16 v[168:171], a[80:83], a[36:39], v[168:171]
    ds_read_b64_tr_b16 a[68:69], v18 offset:57344
    v_mfma_f32_16x16x32_bf16 v[168:171], a[84:87], a[52:55], v[168:171]
    ds_read_b64_tr_b16 a[70:71], v18 offset:58368
    s_add_u32 m0, s60, 36864
    v_mfma_f32_16x16x32_bf16 v[200:203], a[80:83], a[40:43], v[200:203]
    buffer_load_dwordx4 v0, s[16:19], s75 offen offset:0 lds
    v_mfma_f32_16x16x32_bf16 v[200:203], a[84:87], a[56:59], v[200:203]
    buffer_load_dwordx4 v1, s[16:19], s75 offen offset:1024 lds
    v_mfma_f32_16x16x32_bf16 v[232:235], a[80:83], a[44:47], v[232:235]
    v_mfma_f32_16x16x32_bf16 v[232:235], a[84:87], a[60:63], v[232:235]
    s_waitcnt lgkmcnt(4)
    v_mfma_f32_16x16x32_bf16 v[140:143], a[88:91], a[32:35], v[140:143]
    ds_read_b64_tr_b16 a[72:73], v18 offset:49160
    v_mfma_f32_16x16x32_bf16 v[140:143], a[92:95], a[48:51], v[140:143]
    ds_read_b64_tr_b16 a[74:75], v18 offset:50184
    v_mfma_f32_16x16x32_bf16 v[172:175], a[88:91], a[36:39], v[172:175]
    ds_read_b64_tr_b16 a[76:77], v18 offset:57352
    v_mfma_f32_16x16x32_bf16 v[172:175], a[92:95], a[52:55], v[172:175]
    ds_read_b64_tr_b16 a[78:79], v18 offset:58376
    v_mfma_f32_16x16x32_bf16 v[204:207], a[88:91], a[40:43], v[204:207]
    buffer_load_dwordx4 v2, s[16:19], s75 offen offset:2048 lds
    v_mfma_f32_16x16x32_bf16 v[204:207], a[92:95], a[56:59], v[204:207]
    buffer_load_dwordx4 v3, s[16:19], s75 offen offset:3072 lds
    v_mfma_f32_16x16x32_bf16 v[236:239], a[88:91], a[44:47], v[236:239]
    v_mfma_f32_16x16x32_bf16 v[236:239], a[92:95], a[60:63], v[236:239]
    s_waitcnt lgkmcnt(4)
    v_mfma_f32_16x16x32_bf16 v[144:147], a[64:67], a[32:35], v[144:147]
    ds_read_b64_tr_b16 a[80:81], v19 offset:49152
    v_mfma_f32_16x16x32_bf16 v[144:147], a[68:71], a[48:51], v[144:147]
    ds_read_b64_tr_b16 a[82:83], v19 offset:50176
    v_mfma_f32_16x16x32_bf16 v[176:179], a[64:67], a[36:39], v[176:179]
    ds_read_b64_tr_b16 a[84:85], v19 offset:57344
    v_mfma_f32_16x16x32_bf16 v[176:179], a[68:71], a[52:55], v[176:179]
    ds_read_b64_tr_b16 a[86:87], v19 offset:58368
    v_mfma_f32_16x16x32_bf16 v[208:211], a[64:67], a[40:43], v[208:211]
    v_mfma_f32_16x16x32_bf16 v[208:211], a[68:71], a[56:59], v[208:211]
    v_mfma_f32_16x16x32_bf16 v[240:243], a[64:67], a[44:47], v[240:243]
    v_mfma_f32_16x16x32_bf16 v[240:243], a[68:71], a[60:63], v[240:243]
    s_waitcnt lgkmcnt(4)
    v_mfma_f32_16x16x32_bf16 v[148:151], a[72:75], a[32:35], v[148:151]
    ds_read_b64_tr_b16 a[88:89], v19 offset:49160
    v_mfma_f32_16x16x32_bf16 v[148:151], a[76:79], a[48:51], v[148:151]
    ds_read_b64_tr_b16 a[90:91], v19 offset:50184
    v_mfma_f32_16x16x32_bf16 v[180:183], a[72:75], a[36:39], v[180:183]
    ds_read_b64_tr_b16 a[92:93], v19 offset:57352
    v_mfma_f32_16x16x32_bf16 v[180:183], a[76:79], a[52:55], v[180:183]
    ds_read_b64_tr_b16 a[94:95], v19 offset:58376
    v_mfma_f32_16x16x32_bf16 v[212:215], a[72:75], a[40:43], v[212:215]
    v_mfma_f32_16x16x32_bf16 v[212:215], a[76:79], a[56:59], v[212:215]
    v_mfma_f32_16x16x32_bf16 v[244:247], a[72:75], a[44:47], v[244:247]
    v_mfma_f32_16x16x32_bf16 v[244:247], a[76:79], a[60:63], v[244:247]
    s_waitcnt lgkmcnt(4)
    v_mfma_f32_16x16x32_bf16 v[152:155], a[80:83], a[32:35], v[152:155]
    ds_read_b64_tr_b16 a[64:65], v20 offset:49152
    v_mfma_f32_16x16x32_bf16 v[152:155], a[84:87], a[48:51], v[152:155]
    ds_read_b64_tr_b16 a[66:67], v20 offset:49664
    v_mfma_f32_16x16x32_bf16 v[184:187], a[80:83], a[36:39], v[184:187]
    ds_read_b64_tr_b16 a[68:69], v20 offset:53248
    v_mfma_f32_16x16x32_bf16 v[184:187], a[84:87], a[52:55], v[184:187]
    ds_read_b64_tr_b16 a[70:71], v20 offset:53760
    v_mfma_f32_16x16x32_bf16 v[216:219], a[80:83], a[40:43], v[216:219]
    v_mfma_f32_16x16x32_bf16 v[216:219], a[84:87], a[56:59], v[216:219]
    v_mfma_f32_16x16x32_bf16 v[248:251], a[80:83], a[44:47], v[248:251]
    v_mfma_f32_16x16x32_bf16 v[248:251], a[84:87], a[60:63], v[248:251]
    s_waitcnt lgkmcnt(4)
    v_mfma_f32_16x16x32_bf16 v[156:159], a[88:91], a[32:35], v[156:159]
    ds_read_b64_tr_b16 a[72:73], v21 offset:49152
    v_mfma_f32_16x16x32_bf16 v[156:159], a[92:95], a[48:51], v[156:159]
    ds_read_b64_tr_b16 a[74:75], v21 offset:49664
    v_mfma_f32_16x16x32_bf16 v[188:191], a[88:91], a[36:39], v[188:191]
    ds_read_b64_tr_b16 a[76:77], v21 offset:53248
    v_mfma_f32_16x16x32_bf16 v[188:191], a[92:95], a[52:55], v[188:191]
    ds_read_b64_tr_b16 a[78:79], v21 offset:53760
    v_mfma_f32_16x16x32_bf16 v[220:223], a[88:91], a[40:43], v[220:223]
    v_mfma_f32_16x16x32_bf16 v[220:223], a[92:95], a[56:59], v[220:223]
    v_mfma_f32_16x16x32_bf16 v[252:255], a[88:91], a[44:47], v[252:255]
    v_mfma_f32_16x16x32_bf16 v[252:255], a[92:95], a[60:63], v[252:255]
    s_waitcnt lgkmcnt(4)
    v_mfma_f32_16x16x32_bf16 a[128:131], a[64:67], a[32:35], a[128:131]
    ds_read_b64_tr_b16 a[80:81], v22 offset:49152
    v_mfma_f32_16x16x32_bf16 a[128:131], a[68:71], a[48:51], a[128:131]
    ds_read_b64_tr_b16 a[82:83], v22 offset:49664
    v_mfma_f32_16x16x32_bf16 a[132:135], a[64:67], a[36:39], a[132:135]
    ds_read_b64_tr_b16 a[84:85], v22 offset:53248
    v_mfma_f32_16x16x32_bf16 a[132:135], a[68:71], a[52:55], a[132:135]
    ds_read_b64_tr_b16 a[86:87], v22 offset:53760
    v_mfma_f32_16x16x32_bf16 a[136:139], a[64:67], a[40:43], a[136:139]
    ds_read_b64_tr_b16 a[100:101], v4 offset:49152
    v_mfma_f32_16x16x32_bf16 a[136:139], a[68:71], a[56:59], a[136:139]
    ds_read_b64_tr_b16 a[102:103], v4 offset:49664
    v_mfma_f32_16x16x32_bf16 a[140:143], a[64:67], a[44:47], a[140:143]
    v_mfma_f32_16x16x32_bf16 a[140:143], a[68:71], a[60:63], a[140:143]
    s_waitcnt lgkmcnt(6)
    v_mfma_f32_16x16x32_bf16 a[144:147], a[72:75], a[32:35], a[144:147]
    ds_read_b64_tr_b16 a[88:89], v23 offset:49152
    v_mfma_f32_16x16x32_bf16 a[144:147], a[76:79], a[48:51], a[144:147]
    ds_read_b64_tr_b16 a[90:91], v23 offset:49664
    v_mfma_f32_16x16x32_bf16 a[148:151], a[72:75], a[36:39], a[148:151]
    ds_read_b64_tr_b16 a[92:93], v23 offset:53248
    v_mfma_f32_16x16x32_bf16 a[148:151], a[76:79], a[52:55], a[148:151]
    ds_read_b64_tr_b16 a[94:95], v23 offset:53760
    v_mfma_f32_16x16x32_bf16 a[152:155], a[72:75], a[40:43], a[152:155]
    ds_read_b64_tr_b16 a[104:105], v4 offset:53248
    v_mfma_f32_16x16x32_bf16 a[152:155], a[76:79], a[56:59], a[152:155]
    ds_read_b64_tr_b16 a[106:107], v4 offset:53760
    v_mfma_f32_16x16x32_bf16 a[156:159], a[72:75], a[44:47], a[156:159]
    v_mfma_f32_16x16x32_bf16 a[156:159], a[76:79], a[60:63], a[156:159]
    s_waitcnt lgkmcnt(6)
    v_mfma_f32_16x16x32_bf16 a[160:163], a[80:83], a[32:35], a[160:163]
    s_waitcnt vmcnt(14)
    v_mfma_f32_16x16x32_bf16 a[160:163], a[84:87], a[48:51], a[160:163]
    ds_read_b128 a[0:3], v14 offset:0
    v_mfma_f32_16x16x32_bf16 a[164:167], a[80:83], a[36:39], a[164:167]
    ds_read_b128 a[4:7], v14 offset:2048
    v_mfma_f32_16x16x32_bf16 a[164:167], a[84:87], a[52:55], a[164:167]
    ds_read_b128 a[8:11], v14 offset:4096
    v_mfma_f32_16x16x32_bf16 a[168:171], a[80:83], a[40:43], a[168:171]
    ds_read_b128 a[12:15], v14 offset:6144
    v_mfma_f32_16x16x32_bf16 a[168:171], a[84:87], a[56:59], a[168:171]
    v_mfma_f32_16x16x32_bf16 a[172:175], a[80:83], a[44:47], a[172:175]
    v_mfma_f32_16x16x32_bf16 a[172:175], a[84:87], a[60:63], a[172:175]
    s_waitcnt lgkmcnt(4)
    v_mfma_f32_16x16x32_bf16 a[176:179], a[88:91], a[32:35], a[176:179]
    ds_read_b128 a[16:19], v15 offset:0
    v_mfma_f32_16x16x32_bf16 a[176:179], a[92:95], a[48:51], a[176:179]
    ds_read_b128 a[20:23], v15 offset:2048
    v_mfma_f32_16x16x32_bf16 a[180:183], a[88:91], a[36:39], a[180:183]
    ds_read_b128 a[24:27], v15 offset:4096
    v_mfma_f32_16x16x32_bf16 a[180:183], a[92:95], a[52:55], a[180:183]
    ds_read_b128 a[28:31], v15 offset:6144
    v_mfma_f32_16x16x32_bf16 a[184:187], a[88:91], a[40:43], a[184:187]
    v_mfma_f32_16x16x32_bf16 a[184:187], a[92:95], a[56:59], a[184:187]
    v_mfma_f32_16x16x32_bf16 a[188:191], a[88:91], a[44:47], a[188:191]
    v_mfma_f32_16x16x32_bf16 a[188:191], a[92:95], a[60:63], a[188:191]
    v_mfma_f32_16x16x32_bf16 a[232:235], a[100:103], a[96:99], a[232:235]
    v_mfma_f32_16x16x32_bf16 a[232:235], a[104:107], a[96:99], a[232:235]
    v_mfma_f32_16x16x32_bf16 a[192:195], a[96:99], a[32:35], a[192:195]
    s_waitcnt vmcnt(22)
    v_mfma_f32_16x16x32_bf16 a[192:195], a[96:99], a[48:51], a[192:195]
    s_barrier
    v_mfma_f32_16x16x32_bf16 a[208:211], a[32:35], a[32:35], a[208:211]
    ds_read_b64_tr_b16 a[64:65], v16 offset:0
    v_mfma_f32_16x16x32_bf16 a[208:211], a[48:51], a[48:51], a[208:211]
    ds_read_b64_tr_b16 a[66:67], v16 offset:1024
    v_mfma_f32_16x16x32_bf16 a[196:199], a[96:99], a[36:39], a[196:199]
    ds_read_b64_tr_b16 a[68:69], v16 offset:8192
    v_mfma_f32_16x16x32_bf16 a[196:199], a[96:99], a[52:55], a[196:199]
    ds_read_b64_tr_b16 a[70:71], v16 offset:9216
    v_mfma_f32_16x16x32_bf16 a[212:215], a[36:39], a[36:39], a[212:215]
    v_mfma_f32_16x16x32_bf16 a[212:215], a[52:55], a[52:55], a[212:215]
    v_mfma_f32_16x16x32_bf16 a[200:203], a[96:99], a[40:43], a[200:203]
    ds_read_b64_tr_b16 a[72:73], v16 offset:8
    v_mfma_f32_16x16x32_bf16 a[200:203], a[96:99], a[56:59], a[200:203]
    ds_read_b64_tr_b16 a[74:75], v16 offset:1032
    v_mfma_f32_16x16x32_bf16 a[216:219], a[40:43], a[40:43], a[216:219]
    ds_read_b64_tr_b16 a[76:77], v16 offset:8200
    v_mfma_f32_16x16x32_bf16 a[216:219], a[56:59], a[56:59], a[216:219]
    ds_read_b64_tr_b16 a[78:79], v16 offset:9224
    v_mfma_f32_16x16x32_bf16 a[204:207], a[96:99], a[44:47], a[204:207]
    v_mfma_f32_16x16x32_bf16 a[204:207], a[96:99], a[60:63], a[204:207]
    v_mfma_f32_16x16x32_bf16 a[220:223], a[44:47], a[44:47], a[220:223]
    v_mfma_f32_16x16x32_bf16 a[220:223], a[60:63], a[60:63], a[220:223]
    s_waitcnt lgkmcnt(4)
    v_mfma_f32_16x16x32_bf16 v[128:131], a[64:67], a[0:3], v[128:131]
    ds_read_b64_tr_b16 a[80:81], v17 offset:0
    v_mfma_f32_16x16x32_bf16 v[128:131], a[68:71], a[16:19], v[128:131]
    ds_read_b64_tr_b16 a[82:83], v17 offset:1024
    v_mfma_f32_16x16x32_bf16 v[160:163], a[64:67], a[4:7], v[160:163]
    ds_read_b64_tr_b16 a[84:85], v17 offset:8192
    v_mfma_f32_16x16x32_bf16 v[160:163], a[68:71], a[20:23], v[160:163]
    ds_read_b64_tr_b16 a[86:87], v17 offset:9216
    v_mfma_f32_16x16x32_bf16 v[192:195], a[64:67], a[8:11], v[192:195]
    v_mfma_f32_16x16x32_bf16 v[192:195], a[68:71], a[24:27], v[192:195]
    v_mfma_f32_16x16x32_bf16 v[224:227], a[64:67], a[12:15], v[224:227]
    v_mfma_f32_16x16x32_bf16 v[224:227], a[68:71], a[28:31], v[224:227]
    v_mfma_f32_16x16x32_bf16 a[224:227], a[64:67], a[96:99], a[224:227]
    v_mfma_f32_16x16x32_bf16 a[224:227], a[68:71], a[96:99], a[224:227]
    s_waitcnt lgkmcnt(4)
    v_mfma_f32_16x16x32_bf16 v[132:135], a[72:75], a[0:3], v[132:135]
    ds_read_b64_tr_b16 a[88:89], v17 offset:8
    v_mfma_f32_16x16x32_bf16 v[132:135], a[76:79], a[16:19], v[132:135]
    ds_read_b64_tr_b16 a[90:91], v17 offset:1032
    v_mfma_f32_16x16x32_bf16 v[164:167], a[72:75], a[4:7], v[164:167]
    ds_read_b64_tr_b16 a[92:93], v17 offset:8200
    v_mfma_f32_16x16x32_bf16 v[164:167], a[76:79], a[20:23], v[164:167]
    ds_read_b64_tr_b16 a[94:95], v17 offset:9224
    v_mfma_f32_16x16x32_bf16 v[196:199], a[72:75], a[8:11], v[196:199]
    v_mfma_f32_16x16x32_bf16 v[196:199], a[76:79], a[24:27], v[196:199]
    v_mfma_f32_16x16x32_bf16 v[228:231], a[72:75], a[12:15], v[228:231]
    v_mfma_f32_16x16x32_bf16 v[228:231], a[76:79], a[28:31], v[228:231]
    v_mfma_f32_16x16x32_bf16 a[228:231], a[72:75], a[96:99], a[228:231]
    v_mfma_f32_16x16x32_bf16 a[228:231], a[76:79], a[96:99], a[228:231]
    s_waitcnt lgkmcnt(4)
    v_mfma_f32_16x16x32_bf16 v[136:139], a[80:83], a[0:3], v[136:139]
    ds_read_b64_tr_b16 a[64:65], v18 offset:0
    v_mfma_f32_16x16x32_bf16 v[136:139], a[84:87], a[16:19], v[136:139]
    ds_read_b64_tr_b16 a[66:67], v18 offset:1024
    v_mfma_f32_16x16x32_bf16 v[168:171], a[80:83], a[4:7], v[168:171]
    ds_read_b64_tr_b16 a[68:69], v18 offset:8192
    v_mfma_f32_16x16x32_bf16 v[168:171], a[84:87], a[20:23], v[168:171]
    ds_read_b64_tr_b16 a[70:71], v18 offset:9216
    v_mfma_f32_16x16x32_bf16 v[200:203], a[80:83], a[8:11], v[200:203]
    v_mfma_f32_16x16x32_bf16 v[200:203], a[84:87], a[24:27], v[200:203]
    v_mfma_f32_16x16x32_bf16 v[232:235], a[80:83], a[12:15], v[232:235]
    v_mfma_f32_16x16x32_bf16 v[232:235], a[84:87], a[28:31], v[232:235]
    s_waitcnt lgkmcnt(4)
    v_mfma_f32_16x16x32_bf16 v[140:143], a[88:91], a[0:3], v[140:143]
    ds_read_b64_tr_b16 a[72:73], v18 offset:8
    v_mfma_f32_16x16x32_bf16 v[140:143], a[92:95], a[16:19], v[140:143]
    ds_read_b64_tr_b16 a[74:75], v18 offset:1032
    v_mfma_f32_16x16x32_bf16 v[172:175], a[88:91], a[4:7], v[172:175]
    ds_read_b64_tr_b16 a[76:77], v18 offset:8200
    v_mfma_f32_16x16x32_bf16 v[172:175], a[92:95], a[20:23], v[172:175]
    ds_read_b64_tr_b16 a[78:79], v18 offset:9224
    v_mfma_f32_16x16x32_bf16 v[204:207], a[88:91], a[8:11], v[204:207]
    v_mfma_f32_16x16x32_bf16 v[204:207], a[92:95], a[24:27], v[204:207]
    v_mfma_f32_16x16x32_bf16 v[236:239], a[88:91], a[12:15], v[236:239]
    v_mfma_f32_16x16x32_bf16 v[236:239], a[92:95], a[28:31], v[236:239]
    s_waitcnt lgkmcnt(4)
    v_mfma_f32_16x16x32_bf16 v[144:147], a[64:67], a[0:3], v[144:147]
    ds_read_b64_tr_b16 a[80:81], v19 offset:0
    v_mfma_f32_16x16x32_bf16 v[144:147], a[68:71], a[16:19], v[144:147]
    ds_read_b64_tr_b16 a[82:83], v19 offset:1024
    v_mfma_f32_16x16x32_bf16 v[176:179], a[64:67], a[4:7], v[176:179]
    ds_read_b64_tr_b16 a[84:85], v19 offset:8192
    v_mfma_f32_16x16x32_bf16 v[176:179], a[68:71], a[20:23], v[176:179]
    ds_read_b64_tr_b16 a[86:87], v19 offset:9216
    s_add_u32 m0, s24, 139264
    v_mfma_f32_16x16x32_bf16 v[208:211], a[64:67], a[8:11], v[208:211]
    buffer_load_dwordx4 v92, s[48:51], s23 offen offset:0 lds
    v_mfma_f32_16x16x32_bf16 v[208:211], a[68:71], a[24:27], v[208:211]
    buffer_load_dwordx4 v93, s[48:51], s23 offen offset:1024 lds
    v_mfma_f32_16x16x32_bf16 v[240:243], a[64:67], a[12:15], v[240:243]
    buffer_load_dwordx4 v94, s[48:51], s23 offen offset:2048 lds
    v_mfma_f32_16x16x32_bf16 v[240:243], a[68:71], a[28:31], v[240:243]
    buffer_load_dwordx4 v95, s[48:51], s23 offen offset:3072 lds
    s_waitcnt lgkmcnt(4)
    v_mfma_f32_16x16x32_bf16 v[148:151], a[72:75], a[0:3], v[148:151]
    ds_read_b64_tr_b16 a[88:89], v19 offset:8
    v_mfma_f32_16x16x32_bf16 v[148:151], a[76:79], a[16:19], v[148:151]
    ds_read_b64_tr_b16 a[90:91], v19 offset:1032
    v_mfma_f32_16x16x32_bf16 v[180:183], a[72:75], a[4:7], v[180:183]
    ds_read_b64_tr_b16 a[92:93], v19 offset:8200
    v_mfma_f32_16x16x32_bf16 v[180:183], a[76:79], a[20:23], v[180:183]
    ds_read_b64_tr_b16 a[94:95], v19 offset:9224
    v_mfma_f32_16x16x32_bf16 v[212:215], a[72:75], a[8:11], v[212:215]
    v_mfma_f32_16x16x32_bf16 v[212:215], a[76:79], a[24:27], v[212:215]
    v_mfma_f32_16x16x32_bf16 v[244:247], a[72:75], a[12:15], v[244:247]
    v_mfma_f32_16x16x32_bf16 v[244:247], a[76:79], a[28:31], v[244:247]
    s_waitcnt lgkmcnt(4)
    v_mfma_f32_16x16x32_bf16 v[152:155], a[80:83], a[0:3], v[152:155]
    ds_read_b64_tr_b16 a[64:65], v20 offset:0
    v_mfma_f32_16x16x32_bf16 v[152:155], a[84:87], a[16:19], v[152:155]
    ds_read_b64_tr_b16 a[66:67], v20 offset:512
    v_mfma_f32_16x16x32_bf16 v[184:187], a[80:83], a[4:7], v[184:187]
    ds_read_b64_tr_b16 a[68:69], v20 offset:4096
    v_mfma_f32_16x16x32_bf16 v[184:187], a[84:87], a[20:23], v[184:187]
    ds_read_b64_tr_b16 a[70:71], v20 offset:4608
    v_mfma_f32_16x16x32_bf16 v[216:219], a[80:83], a[8:11], v[216:219]
    v_mfma_f32_16x16x32_bf16 v[216:219], a[84:87], a[24:27], v[216:219]
    v_mfma_f32_16x16x32_bf16 v[248:251], a[80:83], a[12:15], v[248:251]
    v_mfma_f32_16x16x32_bf16 v[248:251], a[84:87], a[28:31], v[248:251]
    s_waitcnt lgkmcnt(4)
    v_mfma_f32_16x16x32_bf16 v[156:159], a[88:91], a[0:3], v[156:159]
    ds_read_b64_tr_b16 a[72:73], v21 offset:0
    v_mfma_f32_16x16x32_bf16 v[156:159], a[92:95], a[16:19], v[156:159]
    ds_read_b64_tr_b16 a[74:75], v21 offset:512
    v_mfma_f32_16x16x32_bf16 v[188:191], a[88:91], a[4:7], v[188:191]
    ds_read_b64_tr_b16 a[76:77], v21 offset:4096
    v_mfma_f32_16x16x32_bf16 v[188:191], a[92:95], a[20:23], v[188:191]
    ds_read_b64_tr_b16 a[78:79], v21 offset:4608
    v_mfma_f32_16x16x32_bf16 v[220:223], a[88:91], a[8:11], v[220:223]
    v_mfma_f32_16x16x32_bf16 v[220:223], a[92:95], a[24:27], v[220:223]
    v_mfma_f32_16x16x32_bf16 v[252:255], a[88:91], a[12:15], v[252:255]
    v_mfma_f32_16x16x32_bf16 v[252:255], a[92:95], a[28:31], v[252:255]
    s_waitcnt lgkmcnt(4)
    v_mfma_f32_16x16x32_bf16 a[128:131], a[64:67], a[0:3], a[128:131]
    ds_read_b64_tr_b16 a[80:81], v22 offset:0
    v_mfma_f32_16x16x32_bf16 a[128:131], a[68:71], a[16:19], a[128:131]
    ds_read_b64_tr_b16 a[82:83], v22 offset:512
    v_mfma_f32_16x16x32_bf16 a[132:135], a[64:67], a[4:7], a[132:135]
    ds_read_b64_tr_b16 a[84:85], v22 offset:4096
    v_mfma_f32_16x16x32_bf16 a[132:135], a[68:71], a[20:23], a[132:135]
    ds_read_b64_tr_b16 a[86:87], v22 offset:4608
    v_mfma_f32_16x16x32_bf16 a[136:139], a[64:67], a[8:11], a[136:139]
    ds_read_b64_tr_b16 a[100:101], v4 offset:0
    v_mfma_f32_16x16x32_bf16 a[136:139], a[68:71], a[24:27], a[136:139]
    ds_read_b64_tr_b16 a[102:103], v4 offset:512
    v_mfma_f32_16x16x32_bf16 a[140:143], a[64:67], a[12:15], a[140:143]
    v_mfma_f32_16x16x32_bf16 a[140:143], a[68:71], a[28:31], a[140:143]
    s_waitcnt lgkmcnt(6)
    v_mfma_f32_16x16x32_bf16 a[144:147], a[72:75], a[0:3], a[144:147]
    ds_read_b64_tr_b16 a[88:89], v23 offset:0
    v_mfma_f32_16x16x32_bf16 a[144:147], a[76:79], a[16:19], a[144:147]
    ds_read_b64_tr_b16 a[90:91], v23 offset:512
    v_mfma_f32_16x16x32_bf16 a[148:151], a[72:75], a[4:7], a[148:151]
    ds_read_b64_tr_b16 a[92:93], v23 offset:4096
    v_mfma_f32_16x16x32_bf16 a[148:151], a[76:79], a[20:23], a[148:151]
    ds_read_b64_tr_b16 a[94:95], v23 offset:4608
    v_mfma_f32_16x16x32_bf16 a[152:155], a[72:75], a[8:11], a[152:155]
    ds_read_b64_tr_b16 a[104:105], v4 offset:4096
    v_mfma_f32_16x16x32_bf16 a[152:155], a[76:79], a[24:27], a[152:155]
    ds_read_b64_tr_b16 a[106:107], v4 offset:4608
    v_mfma_f32_16x16x32_bf16 a[156:159], a[72:75], a[12:15], a[156:159]
    v_mfma_f32_16x16x32_bf16 a[156:159], a[76:79], a[28:31], a[156:159]
    s_waitcnt lgkmcnt(6)
    v_mfma_f32_16x16x32_bf16 a[160:163], a[80:83], a[0:3], a[160:163]
    s_waitcnt vmcnt(4)
    v_mfma_f32_16x16x32_bf16 a[160:163], a[84:87], a[16:19], a[160:163]
    ds_read_b128 a[32:35], v14 offset:32768
    v_mfma_f32_16x16x32_bf16 a[164:167], a[80:83], a[4:7], a[164:167]
    ds_read_b128 a[36:39], v14 offset:34816
    v_mfma_f32_16x16x32_bf16 a[164:167], a[84:87], a[20:23], a[164:167]
    ds_read_b128 a[40:43], v14 offset:36864
    v_mfma_f32_16x16x32_bf16 a[168:171], a[80:83], a[8:11], a[168:171]
    ds_read_b128 a[44:47], v14 offset:38912
    v_mfma_f32_16x16x32_bf16 a[168:171], a[84:87], a[24:27], a[168:171]
    v_mfma_f32_16x16x32_bf16 a[172:175], a[80:83], a[12:15], a[172:175]
    v_mfma_f32_16x16x32_bf16 a[172:175], a[84:87], a[28:31], a[172:175]
    s_waitcnt lgkmcnt(4)
    v_mfma_f32_16x16x32_bf16 a[176:179], a[88:91], a[0:3], a[176:179]
    ds_read_b128 a[48:51], v15 offset:32768
    v_mfma_f32_16x16x32_bf16 a[176:179], a[92:95], a[16:19], a[176:179]
    ds_read_b128 a[52:55], v15 offset:34816
    v_mfma_f32_16x16x32_bf16 a[180:183], a[88:91], a[4:7], a[180:183]
    ds_read_b128 a[56:59], v15 offset:36864
    v_mfma_f32_16x16x32_bf16 a[180:183], a[92:95], a[20:23], a[180:183]
    ds_read_b128 a[60:63], v15 offset:38912
    v_mfma_f32_16x16x32_bf16 a[184:187], a[88:91], a[8:11], a[184:187]
    v_mfma_f32_16x16x32_bf16 a[184:187], a[92:95], a[24:27], a[184:187]
    v_mfma_f32_16x16x32_bf16 a[188:191], a[88:91], a[12:15], a[188:191]
    v_mfma_f32_16x16x32_bf16 a[188:191], a[92:95], a[28:31], a[188:191]
    v_mfma_f32_16x16x32_bf16 a[232:235], a[100:103], a[96:99], a[232:235]
    v_mfma_f32_16x16x32_bf16 a[232:235], a[104:107], a[96:99], a[232:235]
    v_mfma_f32_16x16x32_bf16 a[192:195], a[96:99], a[0:3], a[192:195]
    s_waitcnt vmcnt(12)
    v_mfma_f32_16x16x32_bf16 a[192:195], a[96:99], a[16:19], a[192:195]
    s_barrier
    v_mfma_f32_16x16x32_bf16 a[208:211], a[0:3], a[0:3], a[208:211]
    ds_read_b64_tr_b16 a[64:65], v20 offset:24576
    v_mfma_f32_16x16x32_bf16 a[208:211], a[16:19], a[16:19], a[208:211]
    ds_read_b64_tr_b16 a[66:67], v20 offset:25088
    v_mfma_f32_16x16x32_bf16 a[196:199], a[96:99], a[4:7], a[196:199]
    ds_read_b64_tr_b16 a[68:69], v20 offset:28672
    v_mfma_f32_16x16x32_bf16 a[196:199], a[96:99], a[20:23], a[196:199]
    ds_read_b64_tr_b16 a[70:71], v20 offset:29184
    v_mfma_f32_16x16x32_bf16 a[212:215], a[4:7], a[4:7], a[212:215]
    v_mfma_f32_16x16x32_bf16 a[212:215], a[20:23], a[20:23], a[212:215]
    v_mfma_f32_16x16x32_bf16 a[200:203], a[96:99], a[8:11], a[200:203]
    ds_read_b64_tr_b16 a[72:73], v21 offset:24576
    v_mfma_f32_16x16x32_bf16 a[200:203], a[96:99], a[24:27], a[200:203]
    ds_read_b64_tr_b16 a[74:75], v21 offset:25088
    v_mfma_f32_16x16x32_bf16 a[216:219], a[8:11], a[8:11], a[216:219]
    ds_read_b64_tr_b16 a[76:77], v21 offset:28672
    v_mfma_f32_16x16x32_bf16 a[216:219], a[24:27], a[24:27], a[216:219]
    ds_read_b64_tr_b16 a[78:79], v21 offset:29184
    v_mfma_f32_16x16x32_bf16 a[204:207], a[96:99], a[12:15], a[204:207]
    v_mfma_f32_16x16x32_bf16 a[204:207], a[96:99], a[28:31], a[204:207]
    v_mfma_f32_16x16x32_bf16 a[220:223], a[12:15], a[12:15], a[220:223]
    v_mfma_f32_16x16x32_bf16 a[220:223], a[28:31], a[28:31], a[220:223]
    v_mfma_f32_16x16x32_bf16 a[192:195], a[96:99], a[32:35], a[192:195]
    ds_read_b64_tr_b16 a[80:81], v22 offset:24576
    v_mfma_f32_16x16x32_bf16 a[192:195], a[96:99], a[48:51], a[192:195]
    ds_read_b64_tr_b16 a[82:83], v22 offset:25088
    v_mfma_f32_16x16x32_bf16 a[208:211], a[32:35], a[32:35], a[208:211]
    ds_read_b64_tr_b16 a[84:85], v22 offset:28672
    v_mfma_f32_16x16x32_bf16 a[208:211], a[48:51], a[48:51], a[208:211]
    ds_read_b64_tr_b16 a[86:87], v22 offset:29184
    v_mfma_f32_16x16x32_bf16 a[196:199], a[96:99], a[36:39], a[196:199]
    ds_read_b64_tr_b16 a[100:101], v4 offset:24576
    v_mfma_f32_16x16x32_bf16 a[196:199], a[96:99], a[52:55], a[196:199]
    ds_read_b64_tr_b16 a[102:103], v4 offset:25088
    s_add_u32 m0, s24, 0
    v_mfma_f32_16x16x32_bf16 a[212:215], a[36:39], a[36:39], a[212:215]
    buffer_load_dwordx4 v92, s[4:7], s23 offen offset:0 lds
    v_mfma_f32_16x16x32_bf16 a[212:215], a[52:55], a[52:55], a[212:215]
    buffer_load_dwordx4 v93, s[4:7], s23 offen offset:1024 lds
    buffer_load_dwordx4 v94, s[4:7], s23 offen offset:2048 lds
    buffer_load_dwordx4 v95, s[4:7], s23 offen offset:3072 lds
    v_mfma_f32_16x16x32_bf16 a[200:203], a[96:99], a[40:43], a[200:203]
    ds_read_b64_tr_b16 a[88:89], v23 offset:24576
    v_mfma_f32_16x16x32_bf16 a[200:203], a[96:99], a[56:59], a[200:203]
    ds_read_b64_tr_b16 a[90:91], v23 offset:25088
    v_mfma_f32_16x16x32_bf16 a[216:219], a[40:43], a[40:43], a[216:219]
    ds_read_b64_tr_b16 a[92:93], v23 offset:28672
    v_mfma_f32_16x16x32_bf16 a[216:219], a[56:59], a[56:59], a[216:219]
    ds_read_b64_tr_b16 a[94:95], v23 offset:29184
    v_mfma_f32_16x16x32_bf16 a[204:207], a[96:99], a[44:47], a[204:207]
    ds_read_b64_tr_b16 a[104:105], v4 offset:28672
    v_mfma_f32_16x16x32_bf16 a[204:207], a[96:99], a[60:63], a[204:207]
    ds_read_b64_tr_b16 a[106:107], v4 offset:29184
    s_add_u32 m0, s24, 65536
    v_mfma_f32_16x16x32_bf16 a[220:223], a[44:47], a[44:47], a[220:223]
    buffer_load_dwordx4 v96, s[8:11], s23 offen offset:0 lds
    v_mfma_f32_16x16x32_bf16 a[220:223], a[60:63], a[60:63], a[220:223]
    buffer_load_dwordx4 v97, s[8:11], s23 offen offset:1024 lds
    buffer_load_dwordx4 v96, s[8:11], s23 offen offset:2048 lds
    buffer_load_dwordx4 v97, s[8:11], s23 offen offset:3072 lds
    s_add_u32 s23, s23, 16384
    s_waitcnt lgkmcnt(15)
    v_mfma_f32_16x16x32_bf16 a[128:131], a[64:67], a[32:35], a[128:131]
    s_add_u32 m0, s24, 16384
    v_mfma_f32_16x16x32_bf16 a[128:131], a[68:71], a[48:51], a[128:131]
    buffer_load_dwordx4 v92, s[4:7], s23 offen offset:0 lds
    v_mfma_f32_16x16x32_bf16 a[132:135], a[64:67], a[36:39], a[132:135]
    buffer_load_dwordx4 v93, s[4:7], s23 offen offset:1024 lds
    v_mfma_f32_16x16x32_bf16 a[132:135], a[68:71], a[52:55], a[132:135]
    buffer_load_dwordx4 v94, s[4:7], s23 offen offset:2048 lds
    v_mfma_f32_16x16x32_bf16 a[136:139], a[64:67], a[40:43], a[136:139]
    buffer_load_dwordx4 v95, s[4:7], s23 offen offset:3072 lds
    v_mfma_f32_16x16x32_bf16 a[136:139], a[68:71], a[56:59], a[136:139]
    v_mfma_f32_16x16x32_bf16 a[140:143], a[64:67], a[44:47], a[140:143]
    v_mfma_f32_16x16x32_bf16 a[140:143], a[68:71], a[60:63], a[140:143]
    s_waitcnt lgkmcnt(12)
    v_mfma_f32_16x16x32_bf16 a[144:147], a[72:75], a[32:35], a[144:147]
    ds_read_b64_tr_b16 a[64:65], v16 offset:24576
    v_and_b32 v66, 3, v102
    v_mfma_f32_16x16x32_bf16 a[144:147], a[76:79], a[48:51], a[144:147]
    ds_read_b64_tr_b16 a[66:67], v16 offset:25600
    v_cmp_eq_u32 s[68:69], 1, v66
    v_mfma_f32_16x16x32_bf16 a[148:151], a[72:75], a[36:39], a[148:151]
    ds_read_b64_tr_b16 a[68:69], v16 offset:32768
    v_cmp_eq_u32 s[70:71], 2, v66
    v_mfma_f32_16x16x32_bf16 a[148:151], a[76:79], a[52:55], a[148:151]
    ds_read_b64_tr_b16 a[70:71], v16 offset:33792
    v_cmp_eq_u32 s[72:73], 3, v66
    v_mfma_f32_16x16x32_bf16 a[152:155], a[72:75], a[40:43], a[152:155]
    v_bfe_u32 v66, v102, 2, 2
    v_lshrrev_b32 v67, 4, v102
    v_mfma_f32_16x16x32_bf16 a[152:155], a[76:79], a[56:59], a[152:155]
    v_cmp_eq_u32 s[74:75], v66, v67
    s_mov_b32 s76, 0x3b000000
    v_mfma_f32_16x16x32_bf16 a[156:159], a[72:75], a[44:47], a[156:159]
    s_mov_b32 s77, 0x3727c5ac
    s_mov_b32 s78, 0x3e0293ee
    v_mfma_f32_16x16x32_bf16 a[156:159], a[76:79], a[60:63], a[156:159]
    v_lshlrev_b32 v117, 4, v102
    v_accvgpr_read_b32 v72, a208
    s_waitcnt lgkmcnt(10)
    v_mfma_f32_16x16x32_bf16 a[160:163], a[80:83], a[32:35], a[160:163]
    ds_read_b64_tr_b16 a[72:73], v16 offset:24584
    v_accvgpr_read_b32 v73, a209
    v_mfma_f32_16x16x32_bf16 a[160:163], a[84:87], a[48:51], a[160:163]
    ds_read_b64_tr_b16 a[74:75], v16 offset:25608
    v_accvgpr_read_b32 v74, a210
    v_mfma_f32_16x16x32_bf16 a[164:167], a[80:83], a[36:39], a[164:167]
    ds_read_b64_tr_b16 a[76:77], v16 offset:32776
    v_accvgpr_read_b32 v75, a211
    v_mfma_f32_16x16x32_bf16 a[164:167], a[84:87], a[52:55], a[164:167]
    ds_read_b64_tr_b16 a[78:79], v16 offset:33800
    v_accvgpr_read_b32 v66, a192
    v_mfma_f32_16x16x32_bf16 a[168:171], a[80:83], a[40:43], a[168:171]
    v_cndmask_b32 v72, v72, v73, s[68:69]
    v_cndmask_b32 v72, v72, v74, s[70:71]
    v_mfma_f32_16x16x32_bf16 a[168:171], a[84:87], a[56:59], a[168:171]
    v_cndmask_b32 v72, v72, v75, s[72:73]
    v_cndmask_b32 v72, 0, v72, s[74:75]
    v_mfma_f32_16x16x32_bf16 a[172:175], a[80:83], a[44:47], a[172:175]
    v_mov_b32 v73, v72
    s_nop 1
    v_permlane32_swap_b32 v72, v73
    v_mfma_f32_16x16x32_bf16 a[172:175], a[84:87], a[60:63], a[172:175]
    v_add_f32 v72, v72, v73
    v_mov_b32 v73, v72
    s_waitcnt lgkmcnt(8)
    v_mfma_f32_16x16x32_bf16 a[176:179], a[88:91], a[32:35], a[176:179]
    ds_read_b64_tr_b16 a[80:81], v17 offset:24576
    v_permlane16_swap_b32 v72, v73
    v_mfma_f32_16x16x32_bf16 a[176:179], a[92:95], a[48:51], a[176:179]
    ds_read_b64_tr_b16 a[82:83], v17 offset:25600
    v_add_f32 v72, v72, v73
    v_mfma_f32_16x16x32_bf16 a[180:183], a[88:91], a[36:39], a[180:183]
    ds_read_b64_tr_b16 a[84:85], v17 offset:32768
    v_mul_f32 v66, s76, v66
    v_mfma_f32_16x16x32_bf16 a[180:183], a[92:95], a[52:55], a[180:183]
    ds_read_b64_tr_b16 a[86:87], v17 offset:33792
    v_mul_f32 v72, s76, v72
    v_mfma_f32_16x16x32_bf16 a[184:187], a[88:91], a[40:43], a[184:187]
    v_fma_f32 v72, -v66, v66, v72
    v_max_f32 v72, 0, v72
    v_mfma_f32_16x16x32_bf16 a[184:187], a[92:95], a[56:59], a[184:187]
    v_add_f32 v67, s77, v72
    v_rsq_f32 v67, v67
    v_mfma_f32_16x16x32_bf16 a[188:191], a[88:91], a[44:47], a[188:191]
    v_sub_f32 v104, 0, v66
    v_mul_f32 v72, v72, v67
    v_mfma_f32_16x16x32_bf16 a[188:191], a[92:95], a[60:63], a[188:191]
    v_fma_f32 v72, v72, v67, s77
    v_rsq_f32 v72, v72
    v_mfma_f32_16x16x32_bf16 a[232:235], a[100:103], a[96:99], a[232:235]
    v_mul_f32 v108, s78, v67
    v_mul_f32 v112, v72, v67
    v_mfma_f32_16x16x32_bf16 a[232:235], a[104:107], a[96:99], a[232:235]
    v_accvgpr_read_b32 v72, a212
    v_accvgpr_read_b32 v73, a213
    s_waitcnt lgkmcnt(8)
    v_mfma_f32_16x16x32_bf16 v[128:131], a[64:67], a[32:35], v[128:131]
    ds_read_b64_tr_b16 a[88:89], v17 offset:24584
    v_accvgpr_read_b32 v74, a214
    v_mfma_f32_16x16x32_bf16 v[128:131], a[68:71], a[48:51], v[128:131]
    ds_read_b64_tr_b16 a[90:91], v17 offset:25608
    v_accvgpr_read_b32 v75, a215
    v_mfma_f32_16x16x32_bf16 v[160:163], a[64:67], a[36:39], v[160:163]
    ds_read_b64_tr_b16 a[92:93], v17 offset:32776
    v_accvgpr_read_b32 v66, a196
    v_mfma_f32_16x16x32_bf16 v[160:163], a[68:71], a[52:55], v[160:163]
    ds_read_b64_tr_b16 a[94:95], v17 offset:33800
    v_cndmask_b32 v72, v72, v73, s[68:69]
    v_mfma_f32_16x16x32_bf16 v[192:195], a[64:67], a[40:43], v[192:195]
    v_cndmask_b32 v72, v72, v74, s[70:71]
    v_cndmask_b32 v72, v72, v75, s[72:73]
    v_mfma_f32_16x16x32_bf16 v[192:195], a[68:71], a[56:59], v[192:195]
    v_cndmask_b32 v72, 0, v72, s[74:75]
    v_mov_b32 v73, v72
    v_mfma_f32_16x16x32_bf16 v[224:227], a[64:67], a[44:47], v[224:227]
    s_nop 0
    v_permlane32_swap_b32 v72, v73
    v_add_f32 v72, v72, v73
    v_mfma_f32_16x16x32_bf16 v[224:227], a[68:71], a[60:63], v[224:227]
    v_mov_b32 v73, v72
    s_nop 1
    v_permlane16_swap_b32 v72, v73
    v_mfma_f32_16x16x32_bf16 a[224:227], a[64:67], a[96:99], a[224:227]
    v_add_f32 v72, v72, v73
    v_mul_f32 v66, s76, v66
    v_mfma_f32_16x16x32_bf16 a[224:227], a[68:71], a[96:99], a[224:227]
    v_mul_f32 v72, s76, v72
    v_fma_f32 v72, -v66, v66, v72
    s_waitcnt lgkmcnt(8)
    v_mfma_f32_16x16x32_bf16 v[132:135], a[72:75], a[32:35], v[132:135]
    ds_read_b64_tr_b16 a[64:65], v18 offset:24576
    v_max_f32 v72, 0, v72
    v_mfma_f32_16x16x32_bf16 v[132:135], a[76:79], a[48:51], v[132:135]
    ds_read_b64_tr_b16 a[66:67], v18 offset:25600
    v_add_f32 v67, s77, v72
    v_mfma_f32_16x16x32_bf16 v[164:167], a[72:75], a[36:39], v[164:167]
    ds_read_b64_tr_b16 a[68:69], v18 offset:32768
    v_rsq_f32 v67, v67
    v_mfma_f32_16x16x32_bf16 v[164:167], a[76:79], a[52:55], v[164:167]
    ds_read_b64_tr_b16 a[70:71], v18 offset:33792
    v_sub_f32 v105, 0, v66
    v_mfma_f32_16x16x32_bf16 v[196:199], a[72:75], a[40:43], v[196:199]
    v_mul_f32 v72, v72, v67
    v_fma_f32 v72, v72, v67, s77
    v_mfma_f32_16x16x32_bf16 v[196:199], a[76:79], a[56:59], v[196:199]
    v_rsq_f32 v72, v72
    v_mul_f32 v109, s78, v67
    v_mfma_f32_16x16x32_bf16 v[228:231], a[72:75], a[44:47], v[228:231]
    v_mul_f32 v113, v72, v67
    v_accvgpr_read_b32 v72, a216
    v_mfma_f32_16x16x32_bf16 v[228:231], a[76:79], a[60:63], v[228:231]
    v_accvgpr_read_b32 v73, a217
    v_accvgpr_read_b32 v74, a218
    v_mfma_f32_16x16x32_bf16 a[228:231], a[72:75], a[96:99], a[228:231]
    v_accvgpr_read_b32 v75, a219
    v_accvgpr_read_b32 v66, a200
    v_mfma_f32_16x16x32_bf16 a[228:231], a[76:79], a[96:99], a[228:231]
    v_cndmask_b32 v72, v72, v73, s[68:69]
    v_cndmask_b32 v72, v72, v74, s[70:71]
    s_waitcnt lgkmcnt(8)
    v_mfma_f32_16x16x32_bf16 v[136:139], a[80:83], a[32:35], v[136:139]
    ds_read_b64_tr_b16 a[72:73], v18 offset:24584
    v_cndmask_b32 v72, v72, v75, s[72:73]
    v_mfma_f32_16x16x32_bf16 v[136:139], a[84:87], a[48:51], v[136:139]
    ds_read_b64_tr_b16 a[74:75], v18 offset:25608
    v_cndmask_b32 v72, 0, v72, s[74:75]
    v_mfma_f32_16x16x32_bf16 v[168:171], a[80:83], a[36:39], v[168:171]
    ds_read_b64_tr_b16 a[76:77], v18 offset:32776
    v_mov_b32 v73, v72
    v_mfma_f32_16x16x32_bf16 v[168:171], a[84:87], a[52:55], v[168:171]
    ds_read_b64_tr_b16 a[78:79], v18 offset:33800
    v_permlane32_swap_b32 v72, v73
    v_mfma_f32_16x16x32_bf16 v[200:203], a[80:83], a[40:43], v[200:203]
    v_add_f32 v72, v72, v73
    v_mov_b32 v73, v72
    v_mfma_f32_16x16x32_bf16 v[200:203], a[84:87], a[56:59], v[200:203]
    s_nop 0
    v_permlane16_swap_b32 v72, v73
    v_add_f32 v72, v72, v73
    v_mfma_f32_16x16x32_bf16 v[232:235], a[80:83], a[44:47], v[232:235]
    v_mul_f32 v66, s76, v66
    v_mul_f32 v72, s76, v72
    v_mfma_f32_16x16x32_bf16 v[232:235], a[84:87], a[60:63], v[232:235]
    v_fma_f32 v72, -v66, v66, v72
    v_max_f32 v72, 0, v72
    s_waitcnt lgkmcnt(8)
    v_mfma_f32_16x16x32_bf16 v[140:143], a[88:91], a[32:35], v[140:143]
    ds_read_b64_tr_b16 a[80:81], v19 offset:24576
    v_add_f32 v67, s77, v72
    v_mfma_f32_16x16x32_bf16 v[140:143], a[92:95], a[48:51], v[140:143]
    ds_read_b64_tr_b16 a[82:83], v19 offset:25600
    v_rsq_f32 v67, v67
    v_mfma_f32_16x16x32_bf16 v[172:175], a[88:91], a[36:39], v[172:175]
    ds_read_b64_tr_b16 a[84:85], v19 offset:32768
    v_sub_f32 v106, 0, v66
    v_mfma_f32_16x16x32_bf16 v[172:175], a[92:95], a[52:55], v[172:175]
    ds_read_b64_tr_b16 a[86:87], v19 offset:33792
    v_mul_f32 v72, v72, v67
    v_mfma_f32_16x16x32_bf16 v[204:207], a[88:91], a[40:43], v[204:207]
    v_fma_f32 v72, v72, v67, s77
    v_rsq_f32 v72, v72
    v_mfma_f32_16x16x32_bf16 v[204:207], a[92:95], a[56:59], v[204:207]
    s_lshl_b32 s29, s20, 8
    s_add_u32 s29, s29, 155648
    v_and_b32 v118, 0x30, v102
    v_add_u32 v118, s29, v118
    ds_write_b128 v118, a[224:227] offset:0
    ds_write_b128 v118, a[228:231] offset:64
    ds_write_b128 v118, a[232:235] offset:128
    v_mul_f32 v110, s78, v67
    v_mfma_f32_16x16x32_bf16 v[236:239], a[88:91], a[44:47], v[236:239]
    v_mul_f32 v114, v72, v67
    v_accvgpr_read_b32 v72, a220
    v_mfma_f32_16x16x32_bf16 v[236:239], a[92:95], a[60:63], v[236:239]
    v_accvgpr_read_b32 v73, a221
    v_accvgpr_read_b32 v74, a222
    s_waitcnt lgkmcnt(8)
    v_mfma_f32_16x16x32_bf16 v[144:147], a[64:67], a[32:35], v[144:147]
    ds_read_b64_tr_b16 a[88:89], v19 offset:24584
    v_accvgpr_read_b32 v75, a223
    v_mfma_f32_16x16x32_bf16 v[144:147], a[68:71], a[48:51], v[144:147]
    ds_read_b64_tr_b16 a[90:91], v19 offset:25608
    v_accvgpr_read_b32 v66, a204
    v_mfma_f32_16x16x32_bf16 v[176:179], a[64:67], a[36:39], v[176:179]
    ds_read_b64_tr_b16 a[92:93], v19 offset:32776
    v_cndmask_b32 v72, v72, v73, s[68:69]
    v_mfma_f32_16x16x32_bf16 v[176:179], a[68:71], a[52:55], v[176:179]
    ds_read_b64_tr_b16 a[94:95], v19 offset:33800
    v_cndmask_b32 v72, v72, v74, s[70:71]
    v_mfma_f32_16x16x32_bf16 v[208:211], a[64:67], a[40:43], v[208:211]
    v_cndmask_b32 v72, v72, v75, s[72:73]
    v_cndmask_b32 v72, 0, v72, s[74:75]
    v_mfma_f32_16x16x32_bf16 v[208:211], a[68:71], a[56:59], v[208:211]
    v_mov_b32 v73, v72
    s_nop 1
    v_permlane32_swap_b32 v72, v73
    v_mfma_f32_16x16x32_bf16 v[240:243], a[64:67], a[44:47], v[240:243]
    v_add_f32 v72, v72, v73
    v_mov_b32 v73, v72
    v_mfma_f32_16x16x32_bf16 v[240:243], a[68:71], a[60:63], v[240:243]
    s_nop 0
    v_permlane16_swap_b32 v72, v73
    v_add_f32 v72, v72, v73
    s_waitcnt lgkmcnt(8)
    v_mfma_f32_16x16x32_bf16 v[148:151], a[72:75], a[32:35], v[148:151]
    v_mul_f32 v66, s76, v66
    v_mul_f32 v72, s76, v72
    v_mfma_f32_16x16x32_bf16 v[148:151], a[76:79], a[48:51], v[148:151]
    v_fma_f32 v72, -v66, v66, v72
    v_max_f32 v72, 0, v72
    v_mfma_f32_16x16x32_bf16 v[180:183], a[72:75], a[36:39], v[180:183]
    v_add_f32 v67, s77, v72
    v_rsq_f32 v67, v67
    v_mfma_f32_16x16x32_bf16 v[180:183], a[76:79], a[52:55], v[180:183]
    v_sub_f32 v107, 0, v66
    v_mul_f32 v72, v72, v67
    v_mfma_f32_16x16x32_bf16 v[212:215], a[72:75], a[40:43], v[212:215]
    v_fma_f32 v72, v72, v67, s77
    v_rsq_f32 v72, v72
    v_mfma_f32_16x16x32_bf16 v[212:215], a[76:79], a[56:59], v[212:215]
    v_mul_f32 v111, s78, v67
    v_mul_f32 v115, v72, v67
    v_mfma_f32_16x16x32_bf16 v[244:247], a[72:75], a[44:47], v[244:247]
    v_mfma_f32_16x16x32_bf16 v[244:247], a[76:79], a[60:63], v[244:247]
    v_mfma_f32_16x16x32_bf16 v[152:155], a[80:83], a[32:35], v[152:155]
    s_waitcnt vmcnt(12) lgkmcnt(0)
    s_barrier
    s_add_u32 m0, s24, 81920
    v_mfma_f32_16x16x32_bf16 v[152:155], a[84:87], a[48:51], v[152:155]
    buffer_load_dwordx4 v96, s[8:11], s23 offen offset:0 lds
    v_lshlrev_b32 v64, 16, v24
    v_mfma_f32_16x16x32_bf16 v[184:187], a[80:83], a[36:39], v[184:187]
    buffer_load_dwordx4 v97, s[8:11], s23 offen offset:1024 lds
    v_and_b32 v65, 0xffff0000, v24
    v_mfma_f32_16x16x32_bf16 v[184:187], a[84:87], a[52:55], v[184:187]
    buffer_load_dwordx4 v96, s[8:11], s23 offen offset:2048 lds
    v_lshlrev_b32 v66, 16, v25
    v_mfma_f32_16x16x32_bf16 v[216:219], a[80:83], a[40:43], v[216:219]
    buffer_load_dwordx4 v97, s[8:11], s23 offen offset:3072 lds
    v_and_b32 v67, 0xffff0000, v25
    v_mfma_f32_16x16x32_bf16 v[216:219], a[84:87], a[56:59], v[216:219]
    v_lshlrev_b32 v68, 16, v26
    v_and_b32 v69, 0xffff0000, v26
    v_mfma_f32_16x16x32_bf16 v[248:251], a[80:83], a[44:47], v[248:251]
    v_lshlrev_b32 v70, 16, v27
    v_and_b32 v71, 0xffff0000, v27
    v_mfma_f32_16x16x32_bf16 v[248:251], a[84:87], a[60:63], v[248:251]
    s_add_u32 s23, s23, 16384
    v_lshlrev_b32 v72, 16, v28
    v_mfma_f32_16x16x32_bf16 v[156:159], a[88:91], a[32:35], v[156:159]
    v_xor_b32 v119, 0, v118
    ds_read_b128 v[32:35], v119 offset:0
    v_and_b32 v73, 0xffff0000, v28
    v_mfma_f32_16x16x32_bf16 v[156:159], a[92:95], a[48:51], v[156:159]
    ds_read_b128 v[36:39], v119 offset:64
    v_lshlrev_b32 v74, 16, v29
    v_mfma_f32_16x16x32_bf16 v[188:191], a[88:91], a[36:39], v[188:191]
    v_xor_b32 v119, 256, v118
    ds_read_b128 v[40:43], v119 offset:0
    v_and_b32 v75, 0xffff0000, v29
    v_mfma_f32_16x16x32_bf16 v[188:191], a[92:95], a[52:55], v[188:191]
    ds_read_b128 v[44:47], v119 offset:64
    v_lshlrev_b32 v76, 16, v30
    v_mfma_f32_16x16x32_bf16 v[220:223], a[88:91], a[40:43], v[220:223]
    v_xor_b32 v119, 512, v118
    ds_read_b128 v[48:51], v119 offset:0
    v_and_b32 v77, 0xffff0000, v30
    v_mfma_f32_16x16x32_bf16 v[220:223], a[92:95], a[56:59], v[220:223]
    ds_read_b128 v[52:55], v119 offset:64
    v_lshlrev_b32 v78, 16, v31
    v_mfma_f32_16x16x32_bf16 v[252:255], a[88:91], a[44:47], v[252:255]
    v_xor_b32 v119, 768, v118
    ds_read_b128 v[56:59], v119 offset:0
    v_and_b32 v79, 0xffff0000, v31
    v_mfma_f32_16x16x32_bf16 v[252:255], a[92:95], a[60:63], v[252:255]
    ds_read_b128 v[60:63], v119 offset:64
    v_and_b32 v119, 0x30, v102
    v_add_u32 v119, 155648, v119
    ds_read_b128 v[0:3], v119 offset:128
    ds_read_b128 v[4:7], v119 offset:384
    ds_read_b128 v[8:11], v119 offset:640
    ds_read_b128 v[12:15], v119 offset:896
    s_mov_b32 s67, 0xbdd2d3e8
    v_mov_b32 v116, 0xc0135761
    s_lshl_b32 s26, s22, 4
    s_lshl_b32 s30, s20, 2
    s_add_u32 s26, s26, s30
    s_lshl_b32 s26, s26, 10
    s_lshl_b32 s30, s65, 6
    s_lshl_b32 s31, s21, 17
    s_add_u32 s31, s31, s26
    s_add_u32 s68, s31, s30
    s_xor_b32 s69, s68, 2048
    s_lshl_b32 s31, s25, 17
    s_add_u32 s31, s31, s26
    s_add_u32 s70, s31, s30
    s_xor_b32 s71, s70, 2048
    s_waitcnt lgkmcnt(0)
    v_pk_fma_f32 v[128:129], v[104:105], v[32:33], v[128:129] op_sel:[0,0,0] op_sel_hi:[0,1,1]
    v_pk_fma_f32 v[130:131], v[104:105], v[34:35], v[130:131] op_sel:[0,0,0] op_sel_hi:[0,1,1]
    v_pk_fma_f32 v[132:133], v[104:105], v[36:37], v[132:133] op_sel:[0,0,0] op_sel_hi:[0,1,1]
    v_pk_fma_f32 v[134:135], v[104:105], v[38:39], v[134:135] op_sel:[0,0,0] op_sel_hi:[0,1,1]
    v_pk_mul_f32 v[128:129], v[108:109], v[128:129] op_sel:[0,0] op_sel_hi:[0,1]
    v_pk_mul_f32 v[130:131], v[108:109], v[130:131] op_sel:[0,0] op_sel_hi:[0,1]
    v_pk_mul_f32 v[132:133], v[108:109], v[132:133] op_sel:[0,0] op_sel_hi:[0,1]
    v_pk_mul_f32 v[134:135], v[108:109], v[134:135] op_sel:[0,0] op_sel_hi:[0,1]
    v_cvt_pk_bf16_f32 v128, v128, v129
    v_cvt_pk_bf16_f32 v129, v130, v131
    v_cvt_pk_bf16_f32 v130, v132, v133
    v_cvt_pk_bf16_f32 v131, v134, v135
    v_accvgpr_write_b32 a0, v128
    v_accvgpr_write_b32 a1, v129
    v_accvgpr_write_b32 a2, v130
    v_accvgpr_write_b32 a3, v131
    v_pk_fma_f32 v[136:137], v[104:105], v[40:41], v[136:137] op_sel:[0,0,0] op_sel_hi:[0,1,1]
    v_pk_fma_f32 v[138:139], v[104:105], v[42:43], v[138:139] op_sel:[0,0,0] op_sel_hi:[0,1,1]
    v_pk_fma_f32 v[140:141], v[104:105], v[44:45], v[140:141] op_sel:[0,0,0] op_sel_hi:[0,1,1]
    v_pk_fma_f32 v[142:143], v[104:105], v[46:47], v[142:143] op_sel:[0,0,0] op_sel_hi:[0,1,1]
    v_pk_mul_f32 v[136:137], v[108:109], v[136:137] op_sel:[0,0] op_sel_hi:[0,1]
    v_pk_mul_f32 v[138:139], v[108:109], v[138:139] op_sel:[0,0] op_sel_hi:[0,1]
    v_pk_mul_f32 v[140:141], v[108:109], v[140:141] op_sel:[0,0] op_sel_hi:[0,1]
    v_pk_mul_f32 v[142:143], v[108:109], v[142:143] op_sel:[0,0] op_sel_hi:[0,1]
    v_cvt_pk_bf16_f32 v136, v136, v137
    v_cvt_pk_bf16_f32 v137, v138, v139
    v_cvt_pk_bf16_f32 v138, v140, v141
    v_cvt_pk_bf16_f32 v139, v142, v143
    v_accvgpr_write_b32 a4, v136
    v_accvgpr_write_b32 a5, v137
    v_accvgpr_write_b32 a6, v138
    v_accvgpr_write_b32 a7, v139
    v_pk_fma_f32 v[144:145], v[104:105], v[48:49], v[144:145] op_sel:[0,0,0] op_sel_hi:[0,1,1]
    v_pk_fma_f32 v[146:147], v[104:105], v[50:51], v[146:147] op_sel:[0,0,0] op_sel_hi:[0,1,1]
    v_pk_fma_f32 v[148:149], v[104:105], v[52:53], v[148:149] op_sel:[0,0,0] op_sel_hi:[0,1,1]
    v_pk_fma_f32 v[150:151], v[104:105], v[54:55], v[150:151] op_sel:[0,0,0] op_sel_hi:[0,1,1]
    v_pk_mul_f32 v[144:145], v[108:109], v[144:145] op_sel:[0,0] op_sel_hi:[0,1]
    v_pk_mul_f32 v[146:147], v[108:109], v[146:147] op_sel:[0,0] op_sel_hi:[0,1]
    v_pk_mul_f32 v[148:149], v[108:109], v[148:149] op_sel:[0,0] op_sel_hi:[0,1]
    v_pk_mul_f32 v[150:151], v[108:109], v[150:151] op_sel:[0,0] op_sel_hi:[0,1]
    v_cvt_pk_bf16_f32 v144, v144, v145
    v_cvt_pk_bf16_f32 v145, v146, v147
    v_cvt_pk_bf16_f32 v146, v148, v149
    v_cvt_pk_bf16_f32 v147, v150, v151
    v_accvgpr_write_b32 a8, v144
    v_accvgpr_write_b32 a9, v145
    v_accvgpr_write_b32 a10, v146
    v_accvgpr_write_b32 a11, v147
    v_pk_fma_f32 v[152:153], v[104:105], v[56:57], v[152:153] op_sel:[0,0,0] op_sel_hi:[0,1,1]
    v_pk_fma_f32 v[154:155], v[104:105], v[58:59], v[154:155] op_sel:[0,0,0] op_sel_hi:[0,1,1]
    v_pk_fma_f32 v[156:157], v[104:105], v[60:61], v[156:157] op_sel:[0,0,0] op_sel_hi:[0,1,1]
    v_pk_fma_f32 v[158:159], v[104:105], v[62:63], v[158:159] op_sel:[0,0,0] op_sel_hi:[0,1,1]
    v_pk_mul_f32 v[152:153], v[108:109], v[152:153] op_sel:[0,0] op_sel_hi:[0,1]
    v_pk_mul_f32 v[154:155], v[108:109], v[154:155] op_sel:[0,0] op_sel_hi:[0,1]
    v_pk_mul_f32 v[156:157], v[108:109], v[156:157] op_sel:[0,0] op_sel_hi:[0,1]
    v_pk_mul_f32 v[158:159], v[108:109], v[158:159] op_sel:[0,0] op_sel_hi:[0,1]
    v_cvt_pk_bf16_f32 v152, v152, v153
    v_cvt_pk_bf16_f32 v153, v154, v155
    v_cvt_pk_bf16_f32 v154, v156, v157
    v_cvt_pk_bf16_f32 v155, v158, v159
    v_accvgpr_write_b32 a12, v152
    v_accvgpr_write_b32 a13, v153
    v_accvgpr_write_b32 a14, v154
    v_accvgpr_write_b32 a15, v155
    v_pk_fma_f32 v[160:161], v[104:105], v[32:33], v[160:161] op_sel:[1,0,0] op_sel_hi:[1,1,1]
    v_pk_fma_f32 v[162:163], v[104:105], v[34:35], v[162:163] op_sel:[1,0,0] op_sel_hi:[1,1,1]
    v_pk_fma_f32 v[164:165], v[104:105], v[36:37], v[164:165] op_sel:[1,0,0] op_sel_hi:[1,1,1]
    v_pk_fma_f32 v[166:167], v[104:105], v[38:39], v[166:167] op_sel:[1,0,0] op_sel_hi:[1,1,1]
    v_pk_mul_f32 v[160:161], v[108:109], v[160:161] op_sel:[1,0] op_sel_hi:[1,1]
    v_pk_mul_f32 v[162:163], v[108:109], v[162:163] op_sel:[1,0] op_sel_hi:[1,1]
    v_pk_mul_f32 v[164:165], v[108:109], v[164:165] op_sel:[1,0] op_sel_hi:[1,1]
    v_pk_mul_f32 v[166:167], v[108:109], v[166:167] op_sel:[1,0] op_sel_hi:[1,1]
    v_cvt_pk_bf16_f32 v160, v160, v161
    v_cvt_pk_bf16_f32 v161, v162, v163
    v_cvt_pk_bf16_f32 v162, v164, v165
    v_cvt_pk_bf16_f32 v163, v166, v167
    v_accvgpr_write_b32 a16, v160
    v_accvgpr_write_b32 a17, v161
    v_accvgpr_write_b32 a18, v162
    v_accvgpr_write_b32 a19, v163
    v_pk_fma_f32 v[168:169], v[104:105], v[40:41], v[168:169] op_sel:[1,0,0] op_sel_hi:[1,1,1]
    v_pk_fma_f32 v[170:171], v[104:105], v[42:43], v[170:171] op_sel:[1,0,0] op_sel_hi:[1,1,1]
    v_pk_fma_f32 v[172:173], v[104:105], v[44:45], v[172:173] op_sel:[1,0,0] op_sel_hi:[1,1,1]
    v_pk_fma_f32 v[174:175], v[104:105], v[46:47], v[174:175] op_sel:[1,0,0] op_sel_hi:[1,1,1]
    v_pk_mul_f32 v[168:169], v[108:109], v[168:169] op_sel:[1,0] op_sel_hi:[1,1]
    v_pk_mul_f32 v[170:171], v[108:109], v[170:171] op_sel:[1,0] op_sel_hi:[1,1]
    v_pk_mul_f32 v[172:173], v[108:109], v[172:173] op_sel:[1,0] op_sel_hi:[1,1]
    v_pk_mul_f32 v[174:175], v[108:109], v[174:175] op_sel:[1,0] op_sel_hi:[1,1]
    v_cvt_pk_bf16_f32 v168, v168, v169
    v_cvt_pk_bf16_f32 v169, v170, v171
    v_cvt_pk_bf16_f32 v170, v172, v173
    v_cvt_pk_bf16_f32 v171, v174, v175
    v_accvgpr_write_b32 a20, v168
    v_accvgpr_write_b32 a21, v169
    v_accvgpr_write_b32 a22, v170
    v_accvgpr_write_b32 a23, v171
    v_pk_fma_f32 v[176:177], v[104:105], v[48:49], v[176:177] op_sel:[1,0,0] op_sel_hi:[1,1,1]
    v_pk_fma_f32 v[178:179], v[104:105], v[50:51], v[178:179] op_sel:[1,0,0] op_sel_hi:[1,1,1]
    v_pk_fma_f32 v[180:181], v[104:105], v[52:53], v[180:181] op_sel:[1,0,0] op_sel_hi:[1,1,1]
    v_pk_fma_f32 v[182:183], v[104:105], v[54:55], v[182:183] op_sel:[1,0,0] op_sel_hi:[1,1,1]
    v_pk_mul_f32 v[176:177], v[108:109], v[176:177] op_sel:[1,0] op_sel_hi:[1,1]
    v_pk_mul_f32 v[178:179], v[108:109], v[178:179] op_sel:[1,0] op_sel_hi:[1,1]
    v_pk_mul_f32 v[180:181], v[108:109], v[180:181] op_sel:[1,0] op_sel_hi:[1,1]
    v_pk_mul_f32 v[182:183], v[108:109], v[182:183] op_sel:[1,0] op_sel_hi:[1,1]
    v_cvt_pk_bf16_f32 v176, v176, v177
    v_cvt_pk_bf16_f32 v177, v178, v179
    v_cvt_pk_bf16_f32 v178, v180, v181
    v_cvt_pk_bf16_f32 v179, v182, v183
    v_accvgpr_write_b32 a24, v176
    v_accvgpr_write_b32 a25, v177
    v_accvgpr_write_b32 a26, v178
    v_accvgpr_write_b32 a27, v179
    v_pk_fma_f32 v[184:185], v[104:105], v[56:57], v[184:185] op_sel:[1,0,0] op_sel_hi:[1,1,1]
    v_pk_fma_f32 v[186:187], v[104:105], v[58:59], v[186:187] op_sel:[1,0,0] op_sel_hi:[1,1,1]
    v_pk_fma_f32 v[188:189], v[104:105], v[60:61], v[188:189] op_sel:[1,0,0] op_sel_hi:[1,1,1]
    v_pk_fma_f32 v[190:191], v[104:105], v[62:63], v[190:191] op_sel:[1,0,0] op_sel_hi:[1,1,1]
    v_pk_mul_f32 v[184:185], v[108:109], v[184:185] op_sel:[1,0] op_sel_hi:[1,1]
    v_pk_mul_f32 v[186:187], v[108:109], v[186:187] op_sel:[1,0] op_sel_hi:[1,1]
    v_pk_mul_f32 v[188:189], v[108:109], v[188:189] op_sel:[1,0] op_sel_hi:[1,1]
    v_pk_mul_f32 v[190:191], v[108:109], v[190:191] op_sel:[1,0] op_sel_hi:[1,1]
    v_cvt_pk_bf16_f32 v184, v184, v185
    v_cvt_pk_bf16_f32 v185, v186, v187
    v_cvt_pk_bf16_f32 v186, v188, v189
    v_cvt_pk_bf16_f32 v187, v190, v191
    v_accvgpr_write_b32 a28, v184
    v_accvgpr_write_b32 a29, v185
    v_accvgpr_write_b32 a30, v186
    v_accvgpr_write_b32 a31, v187
    v_pk_fma_f32 v[192:193], v[106:107], v[32:33], v[192:193] op_sel:[0,0,0] op_sel_hi:[0,1,1]
    v_pk_fma_f32 v[194:195], v[106:107], v[34:35], v[194:195] op_sel:[0,0,0] op_sel_hi:[0,1,1]
    v_pk_fma_f32 v[196:197], v[106:107], v[36:37], v[196:197] op_sel:[0,0,0] op_sel_hi:[0,1,1]
    v_pk_fma_f32 v[198:199], v[106:107], v[38:39], v[198:199] op_sel:[0,0,0] op_sel_hi:[0,1,1]
    v_pk_mul_f32 v[192:193], v[110:111], v[192:193] op_sel:[0,0] op_sel_hi:[0,1]
    v_pk_mul_f32 v[194:195], v[110:111], v[194:195] op_sel:[0,0] op_sel_hi:[0,1]
    v_pk_mul_f32 v[196:197], v[110:111], v[196:197] op_sel:[0,0] op_sel_hi:[0,1]
    v_pk_mul_f32 v[198:199], v[110:111], v[198:199] op_sel:[0,0] op_sel_hi:[0,1]
    v_cvt_pk_bf16_f32 v192, v192, v193
    v_cvt_pk_bf16_f32 v193, v194, v195
    v_cvt_pk_bf16_f32 v194, v196, v197
    v_cvt_pk_bf16_f32 v195, v198, v199
    v_accvgpr_write_b32 a32, v192
    v_accvgpr_write_b32 a33, v193
    v_accvgpr_write_b32 a34, v194
    v_accvgpr_write_b32 a35, v195
    v_pk_fma_f32 v[200:201], v[106:107], v[40:41], v[200:201] op_sel:[0,0,0] op_sel_hi:[0,1,1]
    v_pk_fma_f32 v[202:203], v[106:107], v[42:43], v[202:203] op_sel:[0,0,0] op_sel_hi:[0,1,1]
    v_pk_fma_f32 v[204:205], v[106:107], v[44:45], v[204:205] op_sel:[0,0,0] op_sel_hi:[0,1,1]
    v_pk_fma_f32 v[206:207], v[106:107], v[46:47], v[206:207] op_sel:[0,0,0] op_sel_hi:[0,1,1]
    v_pk_mul_f32 v[200:201], v[110:111], v[200:201] op_sel:[0,0] op_sel_hi:[0,1]
    v_pk_mul_f32 v[202:203], v[110:111], v[202:203] op_sel:[0,0] op_sel_hi:[0,1]
    v_pk_mul_f32 v[204:205], v[110:111], v[204:205] op_sel:[0,0] op_sel_hi:[0,1]
    v_pk_mul_f32 v[206:207], v[110:111], v[206:207] op_sel:[0,0] op_sel_hi:[0,1]
    v_cvt_pk_bf16_f32 v200, v200, v201
    v_cvt_pk_bf16_f32 v201, v202, v203
    v_cvt_pk_bf16_f32 v202, v204, v205
    v_cvt_pk_bf16_f32 v203, v206, v207
    v_accvgpr_write_b32 a36, v200
    v_accvgpr_write_b32 a37, v201
    v_accvgpr_write_b32 a38, v202
    v_accvgpr_write_b32 a39, v203
    v_pk_fma_f32 v[208:209], v[106:107], v[48:49], v[208:209] op_sel:[0,0,0] op_sel_hi:[0,1,1]
    v_pk_fma_f32 v[210:211], v[106:107], v[50:51], v[210:211] op_sel:[0,0,0] op_sel_hi:[0,1,1]
    v_pk_fma_f32 v[212:213], v[106:107], v[52:53], v[212:213] op_sel:[0,0,0] op_sel_hi:[0,1,1]
    v_pk_fma_f32 v[214:215], v[106:107], v[54:55], v[214:215] op_sel:[0,0,0] op_sel_hi:[0,1,1]
    v_pk_mul_f32 v[208:209], v[110:111], v[208:209] op_sel:[0,0] op_sel_hi:[0,1]
    v_pk_mul_f32 v[210:211], v[110:111], v[210:211] op_sel:[0,0] op_sel_hi:[0,1]
    v_pk_mul_f32 v[212:213], v[110:111], v[212:213] op_sel:[0,0] op_sel_hi:[0,1]
    v_pk_mul_f32 v[214:215], v[110:111], v[214:215] op_sel:[0,0] op_sel_hi:[0,1]
    v_cvt_pk_bf16_f32 v208, v208, v209
    v_cvt_pk_bf16_f32 v209, v210, v211
    v_cvt_pk_bf16_f32 v210, v212, v213
    v_cvt_pk_bf16_f32 v211, v214, v215
    v_accvgpr_write_b32 a40, v208
    v_accvgpr_write_b32 a41, v209
    v_accvgpr_write_b32 a42, v210
    v_accvgpr_write_b32 a43, v211
    v_pk_fma_f32 v[216:217], v[106:107], v[56:57], v[216:217] op_sel:[0,0,0] op_sel_hi:[0,1,1]
    v_pk_fma_f32 v[218:219], v[106:107], v[58:59], v[218:219] op_sel:[0,0,0] op_sel_hi:[0,1,1]
    v_pk_fma_f32 v[220:221], v[106:107], v[60:61], v[220:221] op_sel:[0,0,0] op_sel_hi:[0,1,1]
    v_pk_fma_f32 v[222:223], v[106:107], v[62:63], v[222:223] op_sel:[0,0,0] op_sel_hi:[0,1,1]
    v_pk_mul_f32 v[216:217], v[110:111], v[216:217] op_sel:[0,0] op_sel_hi:[0,1]
    v_pk_mul_f32 v[218:219], v[110:111], v[218:219] op_sel:[0,0] op_sel_hi:[0,1]
    v_pk_mul_f32 v[220:221], v[110:111], v[220:221] op_sel:[0,0] op_sel_hi:[0,1]
    v_pk_mul_f32 v[222:223], v[110:111], v[222:223] op_sel:[0,0] op_sel_hi:[0,1]
    v_cvt_pk_bf16_f32 v216, v216, v217
    v_cvt_pk_bf16_f32 v217, v218, v219
    v_cvt_pk_bf16_f32 v218, v220, v221
    v_cvt_pk_bf16_f32 v219, v222, v223
    v_accvgpr_write_b32 a44, v216
    v_accvgpr_write_b32 a45, v217
    v_accvgpr_write_b32 a46, v218
    v_accvgpr_write_b32 a47, v219
    v_pk_fma_f32 v[224:225], v[106:107], v[32:33], v[224:225] op_sel:[1,0,0] op_sel_hi:[1,1,1]
    v_pk_fma_f32 v[226:227], v[106:107], v[34:35], v[226:227] op_sel:[1,0,0] op_sel_hi:[1,1,1]
    v_pk_fma_f32 v[228:229], v[106:107], v[36:37], v[228:229] op_sel:[1,0,0] op_sel_hi:[1,1,1]
    v_pk_fma_f32 v[230:231], v[106:107], v[38:39], v[230:231] op_sel:[1,0,0] op_sel_hi:[1,1,1]
    v_pk_mul_f32 v[224:225], v[110:111], v[224:225] op_sel:[1,0] op_sel_hi:[1,1]
    v_pk_mul_f32 v[226:227], v[110:111], v[226:227] op_sel:[1,0] op_sel_hi:[1,1]
    v_pk_mul_f32 v[228:229], v[110:111], v[228:229] op_sel:[1,0] op_sel_hi:[1,1]
    v_pk_mul_f32 v[230:231], v[110:111], v[230:231] op_sel:[1,0] op_sel_hi:[1,1]
    v_cvt_pk_bf16_f32 v224, v224, v225
    v_cvt_pk_bf16_f32 v225, v226, v227
    v_cvt_pk_bf16_f32 v226, v228, v229
    v_cvt_pk_bf16_f32 v227, v230, v231
    v_accvgpr_write_b32 a48, v224
    v_accvgpr_write_b32 a49, v225
    v_accvgpr_write_b32 a50, v226
    v_accvgpr_write_b32 a51, v227
    v_pk_fma_f32 v[232:233], v[106:107], v[40:41], v[232:233] op_sel:[1,0,0] op_sel_hi:[1,1,1]
    v_pk_fma_f32 v[234:235], v[106:107], v[42:43], v[234:235] op_sel:[1,0,0] op_sel_hi:[1,1,1]
    v_pk_fma_f32 v[236:237], v[106:107], v[44:45], v[236:237] op_sel:[1,0,0] op_sel_hi:[1,1,1]
    v_pk_fma_f32 v[238:239], v[106:107], v[46:47], v[238:239] op_sel:[1,0,0] op_sel_hi:[1,1,1]
    v_pk_mul_f32 v[232:233], v[110:111], v[232:233] op_sel:[1,0] op_sel_hi:[1,1]
    v_pk_mul_f32 v[234:235], v[110:111], v[234:235] op_sel:[1,0] op_sel_hi:[1,1]
    v_pk_mul_f32 v[236:237], v[110:111], v[236:237] op_sel:[1,0] op_sel_hi:[1,1]
    v_pk_mul_f32 v[238:239], v[110:111], v[238:239] op_sel:[1,0] op_sel_hi:[1,1]
    v_cvt_pk_bf16_f32 v232, v232, v233
    v_cvt_pk_bf16_f32 v233, v234, v235
    v_cvt_pk_bf16_f32 v234, v236, v237
    v_cvt_pk_bf16_f32 v235, v238, v239
    v_accvgpr_write_b32 a52, v232
    v_accvgpr_write_b32 a53, v233
    v_accvgpr_write_b32 a54, v234
    v_accvgpr_write_b32 a55, v235
    v_pk_fma_f32 v[240:241], v[106:107], v[48:49], v[240:241] op_sel:[1,0,0] op_sel_hi:[1,1,1]
    v_pk_fma_f32 v[242:243], v[106:107], v[50:51], v[242:243] op_sel:[1,0,0] op_sel_hi:[1,1,1]
    v_pk_fma_f32 v[244:245], v[106:107], v[52:53], v[244:245] op_sel:[1,0,0] op_sel_hi:[1,1,1]
    v_pk_fma_f32 v[246:247], v[106:107], v[54:55], v[246:247] op_sel:[1,0,0] op_sel_hi:[1,1,1]
    v_pk_mul_f32 v[240:241], v[110:111], v[240:241] op_sel:[1,0] op_sel_hi:[1,1]
    v_pk_mul_f32 v[242:243], v[110:111], v[242:243] op_sel:[1,0] op_sel_hi:[1,1]
    v_pk_mul_f32 v[244:245], v[110:111], v[244:245] op_sel:[1,0] op_sel_hi:[1,1]
    v_pk_mul_f32 v[246:247], v[110:111], v[246:247] op_sel:[1,0] op_sel_hi:[1,1]
    v_cvt_pk_bf16_f32 v240, v240, v241
    v_cvt_pk_bf16_f32 v241, v242, v243
    v_cvt_pk_bf16_f32 v242, v244, v245
    v_cvt_pk_bf16_f32 v243, v246, v247
    v_accvgpr_write_b32 a56, v240
    v_accvgpr_write_b32 a57, v241
    v_accvgpr_write_b32 a58, v242
    v_accvgpr_write_b32 a59, v243
    v_pk_fma_f32 v[248:249], v[106:107], v[56:57], v[248:249] op_sel:[1,0,0] op_sel_hi:[1,1,1]
    v_pk_fma_f32 v[250:251], v[106:107], v[58:59], v[250:251] op_sel:[1,0,0] op_sel_hi:[1,1,1]
    v_pk_fma_f32 v[252:253], v[106:107], v[60:61], v[252:253] op_sel:[1,0,0] op_sel_hi:[1,1,1]
    v_pk_fma_f32 v[254:255], v[106:107], v[62:63], v[254:255] op_sel:[1,0,0] op_sel_hi:[1,1,1]
    v_pk_mul_f32 v[248:249], v[110:111], v[248:249] op_sel:[1,0] op_sel_hi:[1,1]
    v_pk_mul_f32 v[250:251], v[110:111], v[250:251] op_sel:[1,0] op_sel_hi:[1,1]
    v_pk_mul_f32 v[252:253], v[110:111], v[252:253] op_sel:[1,0] op_sel_hi:[1,1]
    v_pk_mul_f32 v[254:255], v[110:111], v[254:255] op_sel:[1,0] op_sel_hi:[1,1]
    v_cvt_pk_bf16_f32 v248, v248, v249
    v_cvt_pk_bf16_f32 v249, v250, v251
    v_cvt_pk_bf16_f32 v250, v252, v253
    v_cvt_pk_bf16_f32 v251, v254, v255
    v_accvgpr_write_b32 a60, v248
    v_accvgpr_write_b32 a61, v249
    v_accvgpr_write_b32 a62, v250
    v_accvgpr_write_b32 a63, v251
    v_accvgpr_read_b32 v128, a128
    v_accvgpr_read_b32 v129, a129
    v_accvgpr_read_b32 v130, a130
    v_accvgpr_read_b32 v131, a131
    v_accvgpr_read_b32 v132, a144
    v_accvgpr_read_b32 v133, a145
    v_accvgpr_read_b32 v134, a146
    v_accvgpr_read_b32 v135, a147
    v_pk_fma_f32 v[128:129], v[104:105], v[0:1], v[128:129] op_sel:[0,0,0] op_sel_hi:[0,1,1]
    v_pk_fma_f32 v[130:131], v[104:105], v[2:3], v[130:131] op_sel:[0,0,0] op_sel_hi:[0,1,1]
    v_pk_fma_f32 v[132:133], v[104:105], v[4:5], v[132:133] op_sel:[0,0,0] op_sel_hi:[0,1,1]
    v_pk_fma_f32 v[134:135], v[104:105], v[6:7], v[134:135] op_sel:[0,0,0] op_sel_hi:[0,1,1]
    v_pk_fma_f32 v[128:129], v[112:113], v[128:129], v[64:65] op_sel:[0,0,0] op_sel_hi:[0,1,1]
    v_pk_fma_f32 v[130:131], v[112:113], v[130:131], v[66:67] op_sel:[0,0,0] op_sel_hi:[0,1,1]
    v_pk_fma_f32 v[132:133], v[112:113], v[132:133], v[68:69] op_sel:[0,0,0] op_sel_hi:[0,1,1]
    v_pk_fma_f32 v[134:135], v[112:113], v[134:135], v[70:71] op_sel:[0,0,0] op_sel_hi:[0,1,1]
    v_pk_mul_f32 v[136:137], v[128:129], v[128:129] op_sel:[0,0] op_sel_hi:[1,1]
    v_pk_mul_f32 v[138:139], v[130:131], v[130:131] op_sel:[0,0] op_sel_hi:[1,1]
    v_pk_mul_f32 v[140:141], v[132:133], v[132:133] op_sel:[0,0] op_sel_hi:[1,1]
    v_pk_mul_f32 v[142:143], v[134:135], v[134:135] op_sel:[0,0] op_sel_hi:[1,1]
    v_pk_fma_f32 v[136:137], v[136:137], s[66:67], v[116:117] op_sel:[0,1,0] op_sel_hi:[1,1,0]
    v_pk_fma_f32 v[138:139], v[138:139], s[66:67], v[116:117] op_sel:[0,1,0] op_sel_hi:[1,1,0]
    v_pk_fma_f32 v[140:141], v[140:141], s[66:67], v[116:117] op_sel:[0,1,0] op_sel_hi:[1,1,0]
    v_pk_fma_f32 v[142:143], v[142:143], s[66:67], v[116:117] op_sel:[0,1,0] op_sel_hi:[1,1,0]
    v_pk_mul_f32 v[136:137], v[136:137], v[128:129] op_sel:[0,0] op_sel_hi:[1,1]
    v_pk_mul_f32 v[138:139], v[138:139], v[130:131] op_sel:[0,0] op_sel_hi:[1,1]
    v_pk_mul_f32 v[140:141], v[140:141], v[132:133] op_sel:[0,0] op_sel_hi:[1,1]
    v_pk_mul_f32 v[142:143], v[142:143], v[134:135] op_sel:[0,0] op_sel_hi:[1,1]
    v_exp_f32 v136, v136
    v_exp_f32 v137, v137
    v_exp_f32 v138, v138
    v_exp_f32 v139, v139
    v_exp_f32 v140, v140
    v_exp_f32 v141, v141
    v_exp_f32 v142, v142
    v_exp_f32 v143, v143
    v_pk_add_f32 v[136:137], v[136:137], 1.0 op_sel:[0,0] op_sel_hi:[1,0]
    v_pk_add_f32 v[138:139], v[138:139], 1.0 op_sel:[0,0] op_sel_hi:[1,0]
    v_pk_add_f32 v[140:141], v[140:141], 1.0 op_sel:[0,0] op_sel_hi:[1,0]
    v_pk_add_f32 v[142:143], v[142:143], 1.0 op_sel:[0,0] op_sel_hi:[1,0]
    v_rcp_f32 v136, v136
    v_rcp_f32 v137, v137
    v_rcp_f32 v138, v138
    v_rcp_f32 v139, v139
    v_rcp_f32 v140, v140
    v_rcp_f32 v141, v141
    v_rcp_f32 v142, v142
    v_rcp_f32 v143, v143
    v_pk_mul_f32 v[128:129], v[128:129], v[136:137] op_sel:[0,0] op_sel_hi:[1,1]
    v_pk_mul_f32 v[130:131], v[130:131], v[138:139] op_sel:[0,0] op_sel_hi:[1,1]
    v_pk_mul_f32 v[132:133], v[132:133], v[140:141] op_sel:[0,0] op_sel_hi:[1,1]
    v_pk_mul_f32 v[134:135], v[134:135], v[142:143] op_sel:[0,0] op_sel_hi:[1,1]
    v_cvt_pk_bf16_f32 v136, v128, v129
    v_cvt_pk_bf16_f32 v137, v130, v131
    v_cvt_pk_bf16_f32 v138, v132, v133
    v_cvt_pk_bf16_f32 v139, v134, v135
    buffer_store_dwordx4 v[136:139], v117, s[52:55], s68 offen offset:0 sc1
    v_accvgpr_read_b32 v144, a132
    v_accvgpr_read_b32 v145, a133
    v_accvgpr_read_b32 v146, a134
    v_accvgpr_read_b32 v147, a135
    v_accvgpr_read_b32 v148, a148
    v_accvgpr_read_b32 v149, a149
    v_accvgpr_read_b32 v150, a150
    v_accvgpr_read_b32 v151, a151
    v_pk_fma_f32 v[144:145], v[104:105], v[0:1], v[144:145] op_sel:[1,0,0] op_sel_hi:[1,1,1]
    v_pk_fma_f32 v[146:147], v[104:105], v[2:3], v[146:147] op_sel:[1,0,0] op_sel_hi:[1,1,1]
    v_pk_fma_f32 v[148:149], v[104:105], v[4:5], v[148:149] op_sel:[1,0,0] op_sel_hi:[1,1,1]
    v_pk_fma_f32 v[150:151], v[104:105], v[6:7], v[150:151] op_sel:[1,0,0] op_sel_hi:[1,1,1]
    v_pk_fma_f32 v[144:145], v[112:113], v[144:145], v[64:65] op_sel:[1,0,0] op_sel_hi:[1,1,1]
    v_pk_fma_f32 v[146:147], v[112:113], v[146:147], v[66:67] op_sel:[1,0,0] op_sel_hi:[1,1,1]
    v_pk_fma_f32 v[148:149], v[112:113], v[148:149], v[68:69] op_sel:[1,0,0] op_sel_hi:[1,1,1]
    v_pk_fma_f32 v[150:151], v[112:113], v[150:151], v[70:71] op_sel:[1,0,0] op_sel_hi:[1,1,1]
    v_pk_mul_f32 v[152:153], v[144:145], v[144:145] op_sel:[0,0] op_sel_hi:[1,1]
    v_pk_mul_f32 v[154:155], v[146:147], v[146:147] op_sel:[0,0] op_sel_hi:[1,1]
    v_pk_mul_f32 v[156:157], v[148:149], v[148:149] op_sel:[0,0] op_sel_hi:[1,1]
    v_pk_mul_f32 v[158:159], v[150:151], v[150:151] op_sel:[0,0] op_sel_hi:[1,1]
    v_pk_fma_f32 v[152:153], v[152:153], s[66:67], v[116:117] op_sel:[0,1,0] op_sel_hi:[1,1,0]
    v_pk_fma_f32 v[154:155], v[154:155], s[66:67], v[116:117] op_sel:[0,1,0] op_sel_hi:[1,1,0]
    v_pk_fma_f32 v[156:157], v[156:157], s[66:67], v[116:117] op_sel:[0,1,0] op_sel_hi:[1,1,0]
    v_pk_fma_f32 v[158:159], v[158:159], s[66:67], v[116:117] op_sel:[0,1,0] op_sel_hi:[1,1,0]
    v_pk_mul_f32 v[152:153], v[152:153], v[144:145] op_sel:[0,0] op_sel_hi:[1,1]
    v_pk_mul_f32 v[154:155], v[154:155], v[146:147] op_sel:[0,0] op_sel_hi:[1,1]
    v_pk_mul_f32 v[156:157], v[156:157], v[148:149] op_sel:[0,0] op_sel_hi:[1,1]
    v_pk_mul_f32 v[158:159], v[158:159], v[150:151] op_sel:[0,0] op_sel_hi:[1,1]
    v_exp_f32 v152, v152
    v_exp_f32 v153, v153
    v_exp_f32 v154, v154
    v_exp_f32 v155, v155
    v_exp_f32 v156, v156
    v_exp_f32 v157, v157
    v_exp_f32 v158, v158
    v_exp_f32 v159, v159
    v_pk_add_f32 v[152:153], v[152:153], 1.0 op_sel:[0,0] op_sel_hi:[1,0]
    v_pk_add_f32 v[154:155], v[154:155], 1.0 op_sel:[0,0] op_sel_hi:[1,0]
    v_pk_add_f32 v[156:157], v[156:157], 1.0 op_sel:[0,0] op_sel_hi:[1,0]
    v_pk_add_f32 v[158:159], v[158:159], 1.0 op_sel:[0,0] op_sel_hi:[1,0]
    v_rcp_f32 v152, v152
    v_rcp_f32 v153, v153
    v_rcp_f32 v154, v154
    v_rcp_f32 v155, v155
    v_rcp_f32 v156, v156
    v_rcp_f32 v157, v157
    v_rcp_f32 v158, v158
    v_rcp_f32 v159, v159
    v_pk_mul_f32 v[144:145], v[144:145], v[152:153] op_sel:[0,0] op_sel_hi:[1,1]
    v_pk_mul_f32 v[146:147], v[146:147], v[154:155] op_sel:[0,0] op_sel_hi:[1,1]
    v_pk_mul_f32 v[148:149], v[148:149], v[156:157] op_sel:[0,0] op_sel_hi:[1,1]
    v_pk_mul_f32 v[150:151], v[150:151], v[158:159] op_sel:[0,0] op_sel_hi:[1,1]
    v_cvt_pk_bf16_f32 v152, v144, v145
    v_cvt_pk_bf16_f32 v153, v146, v147
    v_cvt_pk_bf16_f32 v154, v148, v149
    v_cvt_pk_bf16_f32 v155, v150, v151
    buffer_store_dwordx4 v[152:155], v117, s[52:55], s68 offen offset:1024 sc1
    v_accvgpr_read_b32 v160, a136
    v_accvgpr_read_b32 v161, a137
    v_accvgpr_read_b32 v162, a138
    v_accvgpr_read_b32 v163, a139
    v_accvgpr_read_b32 v164, a152
    v_accvgpr_read_b32 v165, a153
    v_accvgpr_read_b32 v166, a154
    v_accvgpr_read_b32 v167, a155
    v_pk_fma_f32 v[160:161], v[106:107], v[0:1], v[160:161] op_sel:[0,0,0] op_sel_hi:[0,1,1]
    v_pk_fma_f32 v[162:163], v[106:107], v[2:3], v[162:163] op_sel:[0,0,0] op_sel_hi:[0,1,1]
    v_pk_fma_f32 v[164:165], v[106:107], v[4:5], v[164:165] op_sel:[0,0,0] op_sel_hi:[0,1,1]
    v_pk_fma_f32 v[166:167], v[106:107], v[6:7], v[166:167] op_sel:[0,0,0] op_sel_hi:[0,1,1]
    v_pk_fma_f32 v[160:161], v[114:115], v[160:161], v[64:65] op_sel:[0,0,0] op_sel_hi:[0,1,1]
    v_pk_fma_f32 v[162:163], v[114:115], v[162:163], v[66:67] op_sel:[0,0,0] op_sel_hi:[0,1,1]
    v_pk_fma_f32 v[164:165], v[114:115], v[164:165], v[68:69] op_sel:[0,0,0] op_sel_hi:[0,1,1]
    v_pk_fma_f32 v[166:167], v[114:115], v[166:167], v[70:71] op_sel:[0,0,0] op_sel_hi:[0,1,1]
    v_pk_mul_f32 v[168:169], v[160:161], v[160:161] op_sel:[0,0] op_sel_hi:[1,1]
    v_pk_mul_f32 v[170:171], v[162:163], v[162:163] op_sel:[0,0] op_sel_hi:[1,1]
    v_pk_mul_f32 v[172:173], v[164:165], v[164:165] op_sel:[0,0] op_sel_hi:[1,1]
    v_pk_mul_f32 v[174:175], v[166:167], v[166:167] op_sel:[0,0] op_sel_hi:[1,1]
    v_pk_fma_f32 v[168:169], v[168:169], s[66:67], v[116:117] op_sel:[0,1,0] op_sel_hi:[1,1,0]
    v_pk_fma_f32 v[170:171], v[170:171], s[66:67], v[116:117] op_sel:[0,1,0] op_sel_hi:[1,1,0]
    v_pk_fma_f32 v[172:173], v[172:173], s[66:67], v[116:117] op_sel:[0,1,0] op_sel_hi:[1,1,0]
    v_pk_fma_f32 v[174:175], v[174:175], s[66:67], v[116:117] op_sel:[0,1,0] op_sel_hi:[1,1,0]
    v_pk_mul_f32 v[168:169], v[168:169], v[160:161] op_sel:[0,0] op_sel_hi:[1,1]
    v_pk_mul_f32 v[170:171], v[170:171], v[162:163] op_sel:[0,0] op_sel_hi:[1,1]
    v_pk_mul_f32 v[172:173], v[172:173], v[164:165] op_sel:[0,0] op_sel_hi:[1,1]
    v_pk_mul_f32 v[174:175], v[174:175], v[166:167] op_sel:[0,0] op_sel_hi:[1,1]
    v_exp_f32 v168, v168
    v_exp_f32 v169, v169
    v_exp_f32 v170, v170
    v_exp_f32 v171, v171
    v_exp_f32 v172, v172
    v_exp_f32 v173, v173
    v_exp_f32 v174, v174
    v_exp_f32 v175, v175
    v_pk_add_f32 v[168:169], v[168:169], 1.0 op_sel:[0,0] op_sel_hi:[1,0]
    v_pk_add_f32 v[170:171], v[170:171], 1.0 op_sel:[0,0] op_sel_hi:[1,0]
    v_pk_add_f32 v[172:173], v[172:173], 1.0 op_sel:[0,0] op_sel_hi:[1,0]
    v_pk_add_f32 v[174:175], v[174:175], 1.0 op_sel:[0,0] op_sel_hi:[1,0]
    v_rcp_f32 v168, v168
    v_rcp_f32 v169, v169
    v_rcp_f32 v170, v170
    v_rcp_f32 v171, v171
    v_rcp_f32 v172, v172
    v_rcp_f32 v173, v173
    v_rcp_f32 v174, v174
    v_rcp_f32 v175, v175
    v_pk_mul_f32 v[160:161], v[160:161], v[168:169] op_sel:[0,0] op_sel_hi:[1,1]
    v_pk_mul_f32 v[162:163], v[162:163], v[170:171] op_sel:[0,0] op_sel_hi:[1,1]
    v_pk_mul_f32 v[164:165], v[164:165], v[172:173] op_sel:[0,0] op_sel_hi:[1,1]
    v_pk_mul_f32 v[166:167], v[166:167], v[174:175] op_sel:[0,0] op_sel_hi:[1,1]
    v_cvt_pk_bf16_f32 v168, v160, v161
    v_cvt_pk_bf16_f32 v169, v162, v163
    v_cvt_pk_bf16_f32 v170, v164, v165
    v_cvt_pk_bf16_f32 v171, v166, v167
    buffer_store_dwordx4 v[168:171], v117, s[52:55], s69 offen offset:0 sc1
    v_accvgpr_read_b32 v176, a140
    v_accvgpr_read_b32 v177, a141
    v_accvgpr_read_b32 v178, a142
    v_accvgpr_read_b32 v179, a143
    v_accvgpr_read_b32 v180, a156
    v_accvgpr_read_b32 v181, a157
    v_accvgpr_read_b32 v182, a158
    v_accvgpr_read_b32 v183, a159
    v_pk_fma_f32 v[176:177], v[106:107], v[0:1], v[176:177] op_sel:[1,0,0] op_sel_hi:[1,1,1]
    v_pk_fma_f32 v[178:179], v[106:107], v[2:3], v[178:179] op_sel:[1,0,0] op_sel_hi:[1,1,1]
    v_pk_fma_f32 v[180:181], v[106:107], v[4:5], v[180:181] op_sel:[1,0,0] op_sel_hi:[1,1,1]
    v_pk_fma_f32 v[182:183], v[106:107], v[6:7], v[182:183] op_sel:[1,0,0] op_sel_hi:[1,1,1]
    v_pk_fma_f32 v[176:177], v[114:115], v[176:177], v[64:65] op_sel:[1,0,0] op_sel_hi:[1,1,1]
    v_pk_fma_f32 v[178:179], v[114:115], v[178:179], v[66:67] op_sel:[1,0,0] op_sel_hi:[1,1,1]
    v_pk_fma_f32 v[180:181], v[114:115], v[180:181], v[68:69] op_sel:[1,0,0] op_sel_hi:[1,1,1]
    v_pk_fma_f32 v[182:183], v[114:115], v[182:183], v[70:71] op_sel:[1,0,0] op_sel_hi:[1,1,1]
    v_pk_mul_f32 v[184:185], v[176:177], v[176:177] op_sel:[0,0] op_sel_hi:[1,1]
    v_pk_mul_f32 v[186:187], v[178:179], v[178:179] op_sel:[0,0] op_sel_hi:[1,1]
    v_pk_mul_f32 v[188:189], v[180:181], v[180:181] op_sel:[0,0] op_sel_hi:[1,1]
    v_pk_mul_f32 v[190:191], v[182:183], v[182:183] op_sel:[0,0] op_sel_hi:[1,1]
    v_pk_fma_f32 v[184:185], v[184:185], s[66:67], v[116:117] op_sel:[0,1,0] op_sel_hi:[1,1,0]
    v_pk_fma_f32 v[186:187], v[186:187], s[66:67], v[116:117] op_sel:[0,1,0] op_sel_hi:[1,1,0]
    v_pk_fma_f32 v[188:189], v[188:189], s[66:67], v[116:117] op_sel:[0,1,0] op_sel_hi:[1,1,0]
    v_pk_fma_f32 v[190:191], v[190:191], s[66:67], v[116:117] op_sel:[0,1,0] op_sel_hi:[1,1,0]
    v_pk_mul_f32 v[184:185], v[184:185], v[176:177] op_sel:[0,0] op_sel_hi:[1,1]
    v_pk_mul_f32 v[186:187], v[186:187], v[178:179] op_sel:[0,0] op_sel_hi:[1,1]
    v_pk_mul_f32 v[188:189], v[188:189], v[180:181] op_sel:[0,0] op_sel_hi:[1,1]
    v_pk_mul_f32 v[190:191], v[190:191], v[182:183] op_sel:[0,0] op_sel_hi:[1,1]
    v_exp_f32 v184, v184
    v_exp_f32 v185, v185
    v_exp_f32 v186, v186
    v_exp_f32 v187, v187
    v_exp_f32 v188, v188
    v_exp_f32 v189, v189
    v_exp_f32 v190, v190
    v_exp_f32 v191, v191
    v_pk_add_f32 v[184:185], v[184:185], 1.0 op_sel:[0,0] op_sel_hi:[1,0]
    v_pk_add_f32 v[186:187], v[186:187], 1.0 op_sel:[0,0] op_sel_hi:[1,0]
    v_pk_add_f32 v[188:189], v[188:189], 1.0 op_sel:[0,0] op_sel_hi:[1,0]
    v_pk_add_f32 v[190:191], v[190:191], 1.0 op_sel:[0,0] op_sel_hi:[1,0]
    v_rcp_f32 v184, v184
    v_rcp_f32 v185, v185
    v_rcp_f32 v186, v186
    v_rcp_f32 v187, v187
    v_rcp_f32 v188, v188
    v_rcp_f32 v189, v189
    v_rcp_f32 v190, v190
    v_rcp_f32 v191, v191
    v_pk_mul_f32 v[176:177], v[176:177], v[184:185] op_sel:[0,0] op_sel_hi:[1,1]
    v_pk_mul_f32 v[178:179], v[178:179], v[186:187] op_sel:[0,0] op_sel_hi:[1,1]
    v_pk_mul_f32 v[180:181], v[180:181], v[188:189] op_sel:[0,0] op_sel_hi:[1,1]
    v_pk_mul_f32 v[182:183], v[182:183], v[190:191] op_sel:[0,0] op_sel_hi:[1,1]
    v_cvt_pk_bf16_f32 v184, v176, v177
    v_cvt_pk_bf16_f32 v185, v178, v179
    v_cvt_pk_bf16_f32 v186, v180, v181
    v_cvt_pk_bf16_f32 v187, v182, v183
    buffer_store_dwordx4 v[184:187], v117, s[52:55], s69 offen offset:1024 sc1
    v_accvgpr_read_b32 v128, a160
    v_accvgpr_read_b32 v129, a161
    v_accvgpr_read_b32 v130, a162
    v_accvgpr_read_b32 v131, a163
    v_accvgpr_read_b32 v132, a176
    v_accvgpr_read_b32 v133, a177
    v_accvgpr_read_b32 v134, a178
    v_accvgpr_read_b32 v135, a179
    v_pk_fma_f32 v[128:129], v[104:105], v[8:9], v[128:129] op_sel:[0,0,0] op_sel_hi:[0,1,1]
    v_pk_fma_f32 v[130:131], v[104:105], v[10:11], v[130:131] op_sel:[0,0,0] op_sel_hi:[0,1,1]
    v_pk_fma_f32 v[132:133], v[104:105], v[12:13], v[132:133] op_sel:[0,0,0] op_sel_hi:[0,1,1]
    v_pk_fma_f32 v[134:135], v[104:105], v[14:15], v[134:135] op_sel:[0,0,0] op_sel_hi:[0,1,1]
    v_pk_fma_f32 v[128:129], v[112:113], v[128:129], v[72:73] op_sel:[0,0,0] op_sel_hi:[0,1,1]
    v_pk_fma_f32 v[130:131], v[112:113], v[130:131], v[74:75] op_sel:[0,0,0] op_sel_hi:[0,1,1]
    v_pk_fma_f32 v[132:133], v[112:113], v[132:133], v[76:77] op_sel:[0,0,0] op_sel_hi:[0,1,1]
    v_pk_fma_f32 v[134:135], v[112:113], v[134:135], v[78:79] op_sel:[0,0,0] op_sel_hi:[0,1,1]
    v_pk_mul_f32 v[136:137], v[128:129], v[128:129] op_sel:[0,0] op_sel_hi:[1,1]
    v_pk_mul_f32 v[138:139], v[130:131], v[130:131] op_sel:[0,0] op_sel_hi:[1,1]
    v_pk_mul_f32 v[140:141], v[132:133], v[132:133] op_sel:[0,0] op_sel_hi:[1,1]
    v_pk_mul_f32 v[142:143], v[134:135], v[134:135] op_sel:[0,0] op_sel_hi:[1,1]
    v_pk_fma_f32 v[136:137], v[136:137], s[66:67], v[116:117] op_sel:[0,1,0] op_sel_hi:[1,1,0]
    v_pk_fma_f32 v[138:139], v[138:139], s[66:67], v[116:117] op_sel:[0,1,0] op_sel_hi:[1,1,0]
    v_pk_fma_f32 v[140:141], v[140:141], s[66:67], v[116:117] op_sel:[0,1,0] op_sel_hi:[1,1,0]
    v_pk_fma_f32 v[142:143], v[142:143], s[66:67], v[116:117] op_sel:[0,1,0] op_sel_hi:[1,1,0]
    v_pk_mul_f32 v[136:137], v[136:137], v[128:129] op_sel:[0,0] op_sel_hi:[1,1]
    v_pk_mul_f32 v[138:139], v[138:139], v[130:131] op_sel:[0,0] op_sel_hi:[1,1]
    v_pk_mul_f32 v[140:141], v[140:141], v[132:133] op_sel:[0,0] op_sel_hi:[1,1]
    v_pk_mul_f32 v[142:143], v[142:143], v[134:135] op_sel:[0,0] op_sel_hi:[1,1]
    v_exp_f32 v136, v136
    v_exp_f32 v137, v137
    v_exp_f32 v138, v138
    v_exp_f32 v139, v139
    v_exp_f32 v140, v140
    v_exp_f32 v141, v141
    v_exp_f32 v142, v142
    v_exp_f32 v143, v143
    v_pk_add_f32 v[136:137], v[136:137], 1.0 op_sel:[0,0] op_sel_hi:[1,0]
    v_pk_add_f32 v[138:139], v[138:139], 1.0 op_sel:[0,0] op_sel_hi:[1,0]
    v_pk_add_f32 v[140:141], v[140:141], 1.0 op_sel:[0,0] op_sel_hi:[1,0]
    v_pk_add_f32 v[142:143], v[142:143], 1.0 op_sel:[0,0] op_sel_hi:[1,0]
    v_rcp_f32 v136, v136
    v_rcp_f32 v137, v137
    v_rcp_f32 v138, v138
    v_rcp_f32 v139, v139
    v_rcp_f32 v140, v140
    v_rcp_f32 v141, v141
    v_rcp_f32 v142, v142
    v_rcp_f32 v143, v143
    v_pk_mul_f32 v[128:129], v[128:129], v[136:137] op_sel:[0,0] op_sel_hi:[1,1]
    v_pk_mul_f32 v[130:131], v[130:131], v[138:139] op_sel:[0,0] op_sel_hi:[1,1]
    v_pk_mul_f32 v[132:133], v[132:133], v[140:141] op_sel:[0,0] op_sel_hi:[1,1]
    v_pk_mul_f32 v[134:135], v[134:135], v[142:143] op_sel:[0,0] op_sel_hi:[1,1]
    v_cvt_pk_bf16_f32 v136, v128, v129
    v_cvt_pk_bf16_f32 v137, v130, v131
    v_cvt_pk_bf16_f32 v138, v132, v133
    v_cvt_pk_bf16_f32 v139, v134, v135
    buffer_store_dwordx4 v[136:139], v117, s[52:55], s70 offen offset:0 sc1
    v_accvgpr_read_b32 v144, a164
    v_accvgpr_read_b32 v145, a165
    v_accvgpr_read_b32 v146, a166
    v_accvgpr_read_b32 v147, a167
    v_accvgpr_read_b32 v148, a180
    v_accvgpr_read_b32 v149, a181
    v_accvgpr_read_b32 v150, a182
    v_accvgpr_read_b32 v151, a183
    v_pk_fma_f32 v[144:145], v[104:105], v[8:9], v[144:145] op_sel:[1,0,0] op_sel_hi:[1,1,1]
    v_pk_fma_f32 v[146:147], v[104:105], v[10:11], v[146:147] op_sel:[1,0,0] op_sel_hi:[1,1,1]
    v_pk_fma_f32 v[148:149], v[104:105], v[12:13], v[148:149] op_sel:[1,0,0] op_sel_hi:[1,1,1]
    v_pk_fma_f32 v[150:151], v[104:105], v[14:15], v[150:151] op_sel:[1,0,0] op_sel_hi:[1,1,1]
    v_pk_fma_f32 v[144:145], v[112:113], v[144:145], v[72:73] op_sel:[1,0,0] op_sel_hi:[1,1,1]
    v_pk_fma_f32 v[146:147], v[112:113], v[146:147], v[74:75] op_sel:[1,0,0] op_sel_hi:[1,1,1]
    v_pk_fma_f32 v[148:149], v[112:113], v[148:149], v[76:77] op_sel:[1,0,0] op_sel_hi:[1,1,1]
    v_pk_fma_f32 v[150:151], v[112:113], v[150:151], v[78:79] op_sel:[1,0,0] op_sel_hi:[1,1,1]
    v_pk_mul_f32 v[152:153], v[144:145], v[144:145] op_sel:[0,0] op_sel_hi:[1,1]
    v_pk_mul_f32 v[154:155], v[146:147], v[146:147] op_sel:[0,0] op_sel_hi:[1,1]
    v_pk_mul_f32 v[156:157], v[148:149], v[148:149] op_sel:[0,0] op_sel_hi:[1,1]
    v_pk_mul_f32 v[158:159], v[150:151], v[150:151] op_sel:[0,0] op_sel_hi:[1,1]
    v_pk_fma_f32 v[152:153], v[152:153], s[66:67], v[116:117] op_sel:[0,1,0] op_sel_hi:[1,1,0]
    v_pk_fma_f32 v[154:155], v[154:155], s[66:67], v[116:117] op_sel:[0,1,0] op_sel_hi:[1,1,0]
    v_pk_fma_f32 v[156:157], v[156:157], s[66:67], v[116:117] op_sel:[0,1,0] op_sel_hi:[1,1,0]
    v_pk_fma_f32 v[158:159], v[158:159], s[66:67], v[116:117] op_sel:[0,1,0] op_sel_hi:[1,1,0]
    v_pk_mul_f32 v[152:153], v[152:153], v[144:145] op_sel:[0,0] op_sel_hi:[1,1]
    v_pk_mul_f32 v[154:155], v[154:155], v[146:147] op_sel:[0,0] op_sel_hi:[1,1]
    v_pk_mul_f32 v[156:157], v[156:157], v[148:149] op_sel:[0,0] op_sel_hi:[1,1]
    v_pk_mul_f32 v[158:159], v[158:159], v[150:151] op_sel:[0,0] op_sel_hi:[1,1]
    v_exp_f32 v152, v152
    v_exp_f32 v153, v153
    v_exp_f32 v154, v154
    v_exp_f32 v155, v155
    v_exp_f32 v156, v156
    v_exp_f32 v157, v157
    v_exp_f32 v158, v158
    v_exp_f32 v159, v159
    v_pk_add_f32 v[152:153], v[152:153], 1.0 op_sel:[0,0] op_sel_hi:[1,0]
    v_pk_add_f32 v[154:155], v[154:155], 1.0 op_sel:[0,0] op_sel_hi:[1,0]
    v_pk_add_f32 v[156:157], v[156:157], 1.0 op_sel:[0,0] op_sel_hi:[1,0]
    v_pk_add_f32 v[158:159], v[158:159], 1.0 op_sel:[0,0] op_sel_hi:[1,0]
    v_rcp_f32 v152, v152
    v_rcp_f32 v153, v153
    v_rcp_f32 v154, v154
    v_rcp_f32 v155, v155
    v_rcp_f32 v156, v156
    v_rcp_f32 v157, v157
    v_rcp_f32 v158, v158
    v_rcp_f32 v159, v159
    v_pk_mul_f32 v[144:145], v[144:145], v[152:153] op_sel:[0,0] op_sel_hi:[1,1]
    v_pk_mul_f32 v[146:147], v[146:147], v[154:155] op_sel:[0,0] op_sel_hi:[1,1]
    v_pk_mul_f32 v[148:149], v[148:149], v[156:157] op_sel:[0,0] op_sel_hi:[1,1]
    v_pk_mul_f32 v[150:151], v[150:151], v[158:159] op_sel:[0,0] op_sel_hi:[1,1]
    v_cvt_pk_bf16_f32 v152, v144, v145
    v_cvt_pk_bf16_f32 v153, v146, v147
    v_cvt_pk_bf16_f32 v154, v148, v149
    v_cvt_pk_bf16_f32 v155, v150, v151
    buffer_store_dwordx4 v[152:155], v117, s[52:55], s70 offen offset:1024 sc1
    v_accvgpr_read_b32 v160, a168
    v_accvgpr_read_b32 v161, a169
    v_accvgpr_read_b32 v162, a170
    v_accvgpr_read_b32 v163, a171
    v_accvgpr_read_b32 v164, a184
    v_accvgpr_read_b32 v165, a185
    v_accvgpr_read_b32 v166, a186
    v_accvgpr_read_b32 v167, a187
    v_pk_fma_f32 v[160:161], v[106:107], v[8:9], v[160:161] op_sel:[0,0,0] op_sel_hi:[0,1,1]
    v_pk_fma_f32 v[162:163], v[106:107], v[10:11], v[162:163] op_sel:[0,0,0] op_sel_hi:[0,1,1]
    v_pk_fma_f32 v[164:165], v[106:107], v[12:13], v[164:165] op_sel:[0,0,0] op_sel_hi:[0,1,1]
    v_pk_fma_f32 v[166:167], v[106:107], v[14:15], v[166:167] op_sel:[0,0,0] op_sel_hi:[0,1,1]
    v_pk_fma_f32 v[160:161], v[114:115], v[160:161], v[72:73] op_sel:[0,0,0] op_sel_hi:[0,1,1]
    v_pk_fma_f32 v[162:163], v[114:115], v[162:163], v[74:75] op_sel:[0,0,0] op_sel_hi:[0,1,1]
    v_pk_fma_f32 v[164:165], v[114:115], v[164:165], v[76:77] op_sel:[0,0,0] op_sel_hi:[0,1,1]
    v_pk_fma_f32 v[166:167], v[114:115], v[166:167], v[78:79] op_sel:[0,0,0] op_sel_hi:[0,1,1]
    v_pk_mul_f32 v[168:169], v[160:161], v[160:161] op_sel:[0,0] op_sel_hi:[1,1]
    v_pk_mul_f32 v[170:171], v[162:163], v[162:163] op_sel:[0,0] op_sel_hi:[1,1]
    v_pk_mul_f32 v[172:173], v[164:165], v[164:165] op_sel:[0,0] op_sel_hi:[1,1]
    v_pk_mul_f32 v[174:175], v[166:167], v[166:167] op_sel:[0,0] op_sel_hi:[1,1]
    v_pk_fma_f32 v[168:169], v[168:169], s[66:67], v[116:117] op_sel:[0,1,0] op_sel_hi:[1,1,0]
    v_pk_fma_f32 v[170:171], v[170:171], s[66:67], v[116:117] op_sel:[0,1,0] op_sel_hi:[1,1,0]
    v_pk_fma_f32 v[172:173], v[172:173], s[66:67], v[116:117] op_sel:[0,1,0] op_sel_hi:[1,1,0]
    v_pk_fma_f32 v[174:175], v[174:175], s[66:67], v[116:117] op_sel:[0,1,0] op_sel_hi:[1,1,0]
    v_pk_mul_f32 v[168:169], v[168:169], v[160:161] op_sel:[0,0] op_sel_hi:[1,1]
    v_pk_mul_f32 v[170:171], v[170:171], v[162:163] op_sel:[0,0] op_sel_hi:[1,1]
    v_pk_mul_f32 v[172:173], v[172:173], v[164:165] op_sel:[0,0] op_sel_hi:[1,1]
    v_pk_mul_f32 v[174:175], v[174:175], v[166:167] op_sel:[0,0] op_sel_hi:[1,1]
    v_exp_f32 v168, v168
    v_exp_f32 v169, v169
    v_exp_f32 v170, v170
    v_exp_f32 v171, v171
    v_exp_f32 v172, v172
    v_exp_f32 v173, v173
    v_exp_f32 v174, v174
    v_exp_f32 v175, v175
    v_pk_add_f32 v[168:169], v[168:169], 1.0 op_sel:[0,0] op_sel_hi:[1,0]
    v_pk_add_f32 v[170:171], v[170:171], 1.0 op_sel:[0,0] op_sel_hi:[1,0]
    v_pk_add_f32 v[172:173], v[172:173], 1.0 op_sel:[0,0] op_sel_hi:[1,0]
    v_pk_add_f32 v[174:175], v[174:175], 1.0 op_sel:[0,0] op_sel_hi:[1,0]
    v_rcp_f32 v168, v168
    v_rcp_f32 v169, v169
    v_rcp_f32 v170, v170
    v_rcp_f32 v171, v171
    v_rcp_f32 v172, v172
    v_rcp_f32 v173, v173
    v_rcp_f32 v174, v174
    v_rcp_f32 v175, v175
    v_pk_mul_f32 v[160:161], v[160:161], v[168:169] op_sel:[0,0] op_sel_hi:[1,1]
    v_pk_mul_f32 v[162:163], v[162:163], v[170:171] op_sel:[0,0] op_sel_hi:[1,1]
    v_pk_mul_f32 v[164:165], v[164:165], v[172:173] op_sel:[0,0] op_sel_hi:[1,1]
    v_pk_mul_f32 v[166:167], v[166:167], v[174:175] op_sel:[0,0] op_sel_hi:[1,1]
    v_cvt_pk_bf16_f32 v168, v160, v161
    v_cvt_pk_bf16_f32 v169, v162, v163
    v_cvt_pk_bf16_f32 v170, v164, v165
    v_cvt_pk_bf16_f32 v171, v166, v167
    buffer_store_dwordx4 v[168:171], v117, s[52:55], s71 offen offset:0 sc1
    v_accvgpr_read_b32 v176, a172
    v_accvgpr_read_b32 v177, a173
    v_accvgpr_read_b32 v178, a174
    v_accvgpr_read_b32 v179, a175
    v_accvgpr_read_b32 v180, a188
    v_accvgpr_read_b32 v181, a189
    v_accvgpr_read_b32 v182, a190
    v_accvgpr_read_b32 v183, a191
    v_pk_fma_f32 v[176:177], v[106:107], v[8:9], v[176:177] op_sel:[1,0,0] op_sel_hi:[1,1,1]
    v_pk_fma_f32 v[178:179], v[106:107], v[10:11], v[178:179] op_sel:[1,0,0] op_sel_hi:[1,1,1]
    v_pk_fma_f32 v[180:181], v[106:107], v[12:13], v[180:181] op_sel:[1,0,0] op_sel_hi:[1,1,1]
    v_pk_fma_f32 v[182:183], v[106:107], v[14:15], v[182:183] op_sel:[1,0,0] op_sel_hi:[1,1,1]
    v_pk_fma_f32 v[176:177], v[114:115], v[176:177], v[72:73] op_sel:[1,0,0] op_sel_hi:[1,1,1]
    v_pk_fma_f32 v[178:179], v[114:115], v[178:179], v[74:75] op_sel:[1,0,0] op_sel_hi:[1,1,1]
    v_pk_fma_f32 v[180:181], v[114:115], v[180:181], v[76:77] op_sel:[1,0,0] op_sel_hi:[1,1,1]
    v_pk_fma_f32 v[182:183], v[114:115], v[182:183], v[78:79] op_sel:[1,0,0] op_sel_hi:[1,1,1]
    v_pk_mul_f32 v[184:185], v[176:177], v[176:177] op_sel:[0,0] op_sel_hi:[1,1]
    v_pk_mul_f32 v[186:187], v[178:179], v[178:179] op_sel:[0,0] op_sel_hi:[1,1]
    v_pk_mul_f32 v[188:189], v[180:181], v[180:181] op_sel:[0,0] op_sel_hi:[1,1]
    v_pk_mul_f32 v[190:191], v[182:183], v[182:183] op_sel:[0,0] op_sel_hi:[1,1]
    v_pk_fma_f32 v[184:185], v[184:185], s[66:67], v[116:117] op_sel:[0,1,0] op_sel_hi:[1,1,0]
    v_pk_fma_f32 v[186:187], v[186:187], s[66:67], v[116:117] op_sel:[0,1,0] op_sel_hi:[1,1,0]
    v_pk_fma_f32 v[188:189], v[188:189], s[66:67], v[116:117] op_sel:[0,1,0] op_sel_hi:[1,1,0]
    v_pk_fma_f32 v[190:191], v[190:191], s[66:67], v[116:117] op_sel:[0,1,0] op_sel_hi:[1,1,0]
    v_pk_mul_f32 v[184:185], v[184:185], v[176:177] op_sel:[0,0] op_sel_hi:[1,1]
    v_pk_mul_f32 v[186:187], v[186:187], v[178:179] op_sel:[0,0] op_sel_hi:[1,1]
    v_pk_mul_f32 v[188:189], v[188:189], v[180:181] op_sel:[0,0] op_sel_hi:[1,1]
    v_pk_mul_f32 v[190:191], v[190:191], v[182:183] op_sel:[0,0] op_sel_hi:[1,1]
    v_exp_f32 v184, v184
    v_exp_f32 v185, v185
    v_exp_f32 v186, v186
    v_exp_f32 v187, v187
    v_exp_f32 v188, v188
    v_exp_f32 v189, v189
    v_exp_f32 v190, v190
    v_exp_f32 v191, v191
    v_pk_add_f32 v[184:185], v[184:185], 1.0 op_sel:[0,0] op_sel_hi:[1,0]
    v_pk_add_f32 v[186:187], v[186:187], 1.0 op_sel:[0,0] op_sel_hi:[1,0]
    v_pk_add_f32 v[188:189], v[188:189], 1.0 op_sel:[0,0] op_sel_hi:[1,0]
    v_pk_add_f32 v[190:191], v[190:191], 1.0 op_sel:[0,0] op_sel_hi:[1,0]
    v_rcp_f32 v184, v184
    v_rcp_f32 v185, v185
    v_rcp_f32 v186, v186
    v_rcp_f32 v187, v187
    v_rcp_f32 v188, v188
    v_rcp_f32 v189, v189
    v_rcp_f32 v190, v190
    v_rcp_f32 v191, v191
    v_pk_mul_f32 v[176:177], v[176:177], v[184:185] op_sel:[0,0] op_sel_hi:[1,1]
    v_pk_mul_f32 v[178:179], v[178:179], v[186:187] op_sel:[0,0] op_sel_hi:[1,1]
    v_pk_mul_f32 v[180:181], v[180:181], v[188:189] op_sel:[0,0] op_sel_hi:[1,1]
    v_pk_mul_f32 v[182:183], v[182:183], v[190:191] op_sel:[0,0] op_sel_hi:[1,1]
    v_cvt_pk_bf16_f32 v184, v176, v177
    v_cvt_pk_bf16_f32 v185, v178, v179
    v_cvt_pk_bf16_f32 v186, v180, v181
    v_cvt_pk_bf16_f32 v187, v182, v183
    buffer_store_dwordx4 v[184:187], v117, s[52:55], s71 offen offset:1024 sc1
    s_branch L_front_done
L_medium:
    s_waitcnt vmcnt(14)
    s_barrier
    ds_read_b128 a[0:3], v14 offset:0
    ds_read_b128 a[4:7], v14 offset:2048
    ds_read_b128 a[8:11], v14 offset:4096
    ds_read_b128 a[12:15], v14 offset:6144
    ds_read_b128 a[16:19], v15 offset:0
    ds_read_b128 a[20:23], v15 offset:2048
    ds_read_b128 a[24:27], v15 offset:4096
    ds_read_b128 a[28:31], v15 offset:6144
    ds_read_b64_tr_b16 a[64:65], v16 offset:0
    ds_read_b64_tr_b16 a[66:67], v16 offset:1024
    ds_read_b64_tr_b16 a[68:69], v16 offset:8192
    ds_read_b64_tr_b16 a[70:71], v16 offset:9216
    ds_read_b64_tr_b16 a[72:73], v16 offset:8
    ds_read_b64_tr_b16 a[74:75], v16 offset:1032
    ds_read_b64_tr_b16 a[76:77], v16 offset:8200
    ds_read_b64_tr_b16 a[78:79], v16 offset:9224
    s_waitcnt lgkmcnt(4)
    v_mfma_f32_16x16x32_bf16 v[128:131], a[64:67], a[0:3], 0
    ds_read_b64_tr_b16 a[80:81], v17 offset:0
    v_mfma_f32_16x16x32_bf16 v[128:131], a[68:71], a[16:19], v[128:131]
    ds_read_b64_tr_b16 a[82:83], v17 offset:1024
    v_mfma_f32_16x16x32_bf16 v[160:163], a[64:67], a[4:7], 0
    ds_read_b64_tr_b16 a[84:85], v17 offset:8192
    v_mfma_f32_16x16x32_bf16 v[160:163], a[68:71], a[20:23], v[160:163]
    ds_read_b64_tr_b16 a[86:87], v17 offset:9216
    s_add_u32 s78, s28, 2
    s_and_b32 s78, s78, 7
    s_lshl_b32 s78, s78, 7
    s_add_u32 s74, s61, s78
    s_xor_b32 s75, s74, 0x8000
    s_add_u32 m0, s60, 0
    v_mfma_f32_16x16x32_bf16 v[192:195], a[64:67], a[8:11], 0
    buffer_load_dwordx4 v0, s[16:19], s74 offen offset:0 lds
    v_mfma_f32_16x16x32_bf16 v[192:195], a[68:71], a[24:27], v[192:195]
    buffer_load_dwordx4 v1, s[16:19], s74 offen offset:1024 lds
    v_mfma_f32_16x16x32_bf16 v[224:227], a[64:67], a[12:15], 0
    buffer_load_dwordx4 v2, s[16:19], s74 offen offset:2048 lds
    v_mfma_f32_16x16x32_bf16 v[224:227], a[68:71], a[28:31], v[224:227]
    buffer_load_dwordx4 v3, s[16:19], s74 offen offset:3072 lds
    v_mfma_f32_16x16x32_bf16 a[224:227], a[64:67], a[96:99], 0
    v_mfma_f32_16x16x32_bf16 a[224:227], a[68:71], a[96:99], a[224:227]
    s_waitcnt lgkmcnt(4)
    v_mfma_f32_16x16x32_bf16 v[132:135], a[72:75], a[0:3], 0
    ds_read_b64_tr_b16 a[88:89], v17 offset:8
    v_mfma_f32_16x16x32_bf16 v[132:135], a[76:79], a[16:19], v[132:135]
    ds_read_b64_tr_b16 a[90:91], v17 offset:1032
    v_mfma_f32_16x16x32_bf16 v[164:167], a[72:75], a[4:7], 0
    ds_read_b64_tr_b16 a[92:93], v17 offset:8200
    v_mfma_f32_16x16x32_bf16 v[164:167], a[76:79], a[20:23], v[164:167]
    ds_read_b64_tr_b16 a[94:95], v17 offset:9224
    s_add_u32 m0, s60, 4096
    v_mfma_f32_16x16x32_bf16 v[196:199], a[72:75], a[8:11], 0
    buffer_load_dwordx4 v0, s[16:19], s75 offen offset:0 lds
    v_mfma_f32_16x16x32_bf16 v[196:199], a[76:79], a[24:27], v[196:199]
    buffer_load_dwordx4 v1, s[16:19], s75 offen offset:1024 lds
    v_mfma_f32_16x16x32_bf16 v[228:231], a[72:75], a[12:15], 0
    buffer_load_dwordx4 v2, s[16:19], s75 offen offset:2048 lds
    v_mfma_f32_16x16x32_bf16 v[228:231], a[76:79], a[28:31], v[228:231]
    buffer_load_dwordx4 v3, s[16:19], s75 offen offset:3072 lds
    v_mfma_f32_16x16x32_bf16 a[228:231], a[72:75], a[96:99], 0
    v_mfma_f32_16x16x32_bf16 a[228:231], a[76:79], a[96:99], a[228:231]
    s_waitcnt lgkmcnt(4)
    v_mfma_f32_16x16x32_bf16 v[136:139], a[80:83], a[0:3], 0
    ds_read_b64_tr_b16 a[64:65], v18 offset:0
    v_mfma_f32_16x16x32_bf16 v[136:139], a[84:87], a[16:19], v[136:139]
    ds_read_b64_tr_b16 a[66:67], v18 offset:1024
    v_mfma_f32_16x16x32_bf16 v[168:171], a[80:83], a[4:7], 0
    ds_read_b64_tr_b16 a[68:69], v18 offset:8192
    v_mfma_f32_16x16x32_bf16 v[168:171], a[84:87], a[20:23], v[168:171]
    ds_read_b64_tr_b16 a[70:71], v18 offset:9216
    s_add_u32 s78, s28, 2
    s_and_b32 s78, s78, 7
    s_lshl_b32 s79, s78, 19
    s_add_u32 s76, s62, s79
    s_mul_i32 s79, s78, 176128
    s_add_u32 s77, s63, s79
    s_add_u32 m0, s24, 114688
    v_mfma_f32_16x16x32_bf16 v[200:203], a[80:83], a[8:11], 0
    buffer_load_dwordx4 v8, s[40:43], s76 offen offset:0 lds
    v_mfma_f32_16x16x32_bf16 v[200:203], a[84:87], a[24:27], v[200:203]
    buffer_load_dwordx4 v9, s[40:43], s76 offen offset:1024 lds
    v_mfma_f32_16x16x32_bf16 v[232:235], a[80:83], a[12:15], 0
    buffer_load_dwordx4 v10, s[40:43], s76 offen offset:2048 lds
    v_mfma_f32_16x16x32_bf16 v[232:235], a[84:87], a[28:31], v[232:235]
    s_waitcnt lgkmcnt(4)
    v_mfma_f32_16x16x32_bf16 v[140:143], a[88:91], a[0:3], 0
    ds_read_b64_tr_b16 a[72:73], v18 offset:8
    v_mfma_f32_16x16x32_bf16 v[140:143], a[92:95], a[16:19], v[140:143]
    ds_read_b64_tr_b16 a[74:75], v18 offset:1032
    v_mfma_f32_16x16x32_bf16 v[172:175], a[88:91], a[4:7], 0
    ds_read_b64_tr_b16 a[76:77], v18 offset:8200
    v_mfma_f32_16x16x32_bf16 v[172:175], a[92:95], a[20:23], v[172:175]
    ds_read_b64_tr_b16 a[78:79], v18 offset:9224
    v_mfma_f32_16x16x32_bf16 v[204:207], a[88:91], a[8:11], 0
    buffer_load_dwordx4 v11, s[40:43], s76 offen offset:3072 lds
    s_add_u32 m0, s64, 131072
    v_mfma_f32_16x16x32_bf16 v[204:207], a[92:95], a[24:27], v[204:207]
    buffer_load_dwordx4 v12, s[44:47], s77 offen offset:0 lds
    v_mfma_f32_16x16x32_bf16 v[236:239], a[88:91], a[12:15], 0
    buffer_load_dwordx4 v13, s[44:47], s77 offen offset:1024 lds
    v_mfma_f32_16x16x32_bf16 v[236:239], a[92:95], a[28:31], v[236:239]
    s_waitcnt lgkmcnt(4)
    v_mfma_f32_16x16x32_bf16 v[144:147], a[64:67], a[0:3], 0
    ds_read_b64_tr_b16 a[80:81], v19 offset:0
    v_mfma_f32_16x16x32_bf16 v[144:147], a[68:71], a[16:19], v[144:147]
    ds_read_b64_tr_b16 a[82:83], v19 offset:1024
    v_mfma_f32_16x16x32_bf16 v[176:179], a[64:67], a[4:7], 0
    ds_read_b64_tr_b16 a[84:85], v19 offset:8192
    v_mfma_f32_16x16x32_bf16 v[176:179], a[68:71], a[20:23], v[176:179]
    ds_read_b64_tr_b16 a[86:87], v19 offset:9216
    v_mfma_f32_16x16x32_bf16 v[208:211], a[64:67], a[8:11], 0
    v_mfma_f32_16x16x32_bf16 v[208:211], a[68:71], a[24:27], v[208:211]
    v_mfma_f32_16x16x32_bf16 v[240:243], a[64:67], a[12:15], 0
    v_mfma_f32_16x16x32_bf16 v[240:243], a[68:71], a[28:31], v[240:243]
    s_waitcnt lgkmcnt(4)
    v_mfma_f32_16x16x32_bf16 v[148:151], a[72:75], a[0:3], 0
    ds_read_b64_tr_b16 a[88:89], v19 offset:8
    v_mfma_f32_16x16x32_bf16 v[148:151], a[76:79], a[16:19], v[148:151]
    ds_read_b64_tr_b16 a[90:91], v19 offset:1032
    v_mfma_f32_16x16x32_bf16 v[180:183], a[72:75], a[4:7], 0
    ds_read_b64_tr_b16 a[92:93], v19 offset:8200
    v_mfma_f32_16x16x32_bf16 v[180:183], a[76:79], a[20:23], v[180:183]
    ds_read_b64_tr_b16 a[94:95], v19 offset:9224
    v_mfma_f32_16x16x32_bf16 v[212:215], a[72:75], a[8:11], 0
    v_mfma_f32_16x16x32_bf16 v[212:215], a[76:79], a[24:27], v[212:215]
    v_mfma_f32_16x16x32_bf16 v[244:247], a[72:75], a[12:15], 0
    v_mfma_f32_16x16x32_bf16 v[244:247], a[76:79], a[28:31], v[244:247]
    s_waitcnt lgkmcnt(4)
    v_mfma_f32_16x16x32_bf16 v[152:155], a[80:83], a[0:3], 0
    ds_read_b64_tr_b16 a[64:65], v20 offset:0
    v_mfma_f32_16x16x32_bf16 v[152:155], a[84:87], a[16:19], v[152:155]
    ds_read_b64_tr_b16 a[66:67], v20 offset:512
    v_mfma_f32_16x16x32_bf16 v[184:187], a[80:83], a[4:7], 0
    ds_read_b64_tr_b16 a[68:69], v20 offset:4096
    v_mfma_f32_16x16x32_bf16 v[184:187], a[84:87], a[20:23], v[184:187]
    ds_read_b64_tr_b16 a[70:71], v20 offset:4608
    v_mfma_f32_16x16x32_bf16 v[216:219], a[80:83], a[8:11], 0
    v_mfma_f32_16x16x32_bf16 v[216:219], a[84:87], a[24:27], v[216:219]
    v_mfma_f32_16x16x32_bf16 v[248:251], a[80:83], a[12:15], 0
    v_mfma_f32_16x16x32_bf16 v[248:251], a[84:87], a[28:31], v[248:251]
    s_waitcnt lgkmcnt(4)
    v_mfma_f32_16x16x32_bf16 v[156:159], a[88:91], a[0:3], 0
    ds_read_b64_tr_b16 a[72:73], v21 offset:0
    v_mfma_f32_16x16x32_bf16 v[156:159], a[92:95], a[16:19], v[156:159]
    ds_read_b64_tr_b16 a[74:75], v21 offset:512
    v_mfma_f32_16x16x32_bf16 v[188:191], a[88:91], a[4:7], 0
    ds_read_b64_tr_b16 a[76:77], v21 offset:4096
    v_mfma_f32_16x16x32_bf16 v[188:191], a[92:95], a[20:23], v[188:191]
    ds_read_b64_tr_b16 a[78:79], v21 offset:4608
    v_mfma_f32_16x16x32_bf16 v[220:223], a[88:91], a[8:11], 0
    v_mfma_f32_16x16x32_bf16 v[220:223], a[92:95], a[24:27], v[220:223]
    v_mfma_f32_16x16x32_bf16 v[252:255], a[88:91], a[12:15], 0
    v_mfma_f32_16x16x32_bf16 v[252:255], a[92:95], a[28:31], v[252:255]
    s_waitcnt lgkmcnt(4)
    v_mfma_f32_16x16x32_bf16 a[128:131], a[64:67], a[0:3], 0
    ds_read_b64_tr_b16 a[80:81], v22 offset:0
    v_mfma_f32_16x16x32_bf16 a[128:131], a[68:71], a[16:19], a[128:131]
    ds_read_b64_tr_b16 a[82:83], v22 offset:512
    v_mfma_f32_16x16x32_bf16 a[132:135], a[64:67], a[4:7], 0
    ds_read_b64_tr_b16 a[84:85], v22 offset:4096
    v_mfma_f32_16x16x32_bf16 a[132:135], a[68:71], a[20:23], a[132:135]
    ds_read_b64_tr_b16 a[86:87], v22 offset:4608
    v_mfma_f32_16x16x32_bf16 a[136:139], a[64:67], a[8:11], 0
    ds_read_b64_tr_b16 a[100:101], v4 offset:0
    v_mfma_f32_16x16x32_bf16 a[136:139], a[68:71], a[24:27], a[136:139]
    ds_read_b64_tr_b16 a[102:103], v4 offset:512
    v_mfma_f32_16x16x32_bf16 a[140:143], a[64:67], a[12:15], 0
    v_lshrrev_b32 v104, 4, v102
    v_and_b32 v105, 15, v102
    v_mfma_f32_16x16x32_bf16 a[140:143], a[68:71], a[28:31], a[140:143]
    v_add_u32 v106, 0, v104
    v_xor_b32 v106, v106, v105
    s_waitcnt lgkmcnt(6)
    v_mfma_f32_16x16x32_bf16 a[144:147], a[72:75], a[0:3], 0
    ds_read_b64_tr_b16 a[88:89], v23 offset:0
    v_mfma_f32_16x16x32_bf16 a[144:147], a[76:79], a[16:19], a[144:147]
    ds_read_b64_tr_b16 a[90:91], v23 offset:512
    v_mfma_f32_16x16x32_bf16 a[148:151], a[72:75], a[4:7], 0
    ds_read_b64_tr_b16 a[92:93], v23 offset:4096
    v_mfma_f32_16x16x32_bf16 a[148:151], a[76:79], a[20:23], a[148:151]
    ds_read_b64_tr_b16 a[94:95], v23 offset:4608
    v_mfma_f32_16x16x32_bf16 a[152:155], a[72:75], a[8:11], 0
    ds_read_b64_tr_b16 a[104:105], v4 offset:4096
    v_mfma_f32_16x16x32_bf16 a[152:155], a[76:79], a[24:27], a[152:155]
    ds_read_b64_tr_b16 a[106:107], v4 offset:4608
    v_mfma_f32_16x16x32_bf16 a[156:159], a[72:75], a[12:15], 0
    v_lshlrev_b32 v106, 4, v106
    v_lshl_add_u32 v92, v104, 8, v106
    v_mfma_f32_16x16x32_bf16 a[156:159], a[76:79], a[28:31], a[156:159]
    s_xor_b32 s29, s20, 0
    s_lshl_b32 s29, s29, 2
    s_waitcnt lgkmcnt(6)
    v_mfma_f32_16x16x32_bf16 a[160:163], a[80:83], a[0:3], 0
    s_waitcnt vmcnt(20)
    v_mfma_f32_16x16x32_bf16 a[160:163], a[84:87], a[16:19], a[160:163]
    ds_read_b128 a[32:35], v14 offset:32768
    v_mfma_f32_16x16x32_bf16 a[164:167], a[80:83], a[4:7], 0
    ds_read_b128 a[36:39], v14 offset:34816
    v_mfma_f32_16x16x32_bf16 a[164:167], a[84:87], a[20:23], a[164:167]
    ds_read_b128 a[40:43], v14 offset:36864
    ds_read_b128 a[44:47], v14 offset:38912
    s_waitcnt lgkmcnt(4)
    v_mfma_f32_16x16x32_bf16 a[176:179], a[88:91], a[0:3], 0
    ds_read_b128 a[48:51], v15 offset:32768
    v_mfma_f32_16x16x32_bf16 a[176:179], a[92:95], a[16:19], a[176:179]
    ds_read_b128 a[52:55], v15 offset:34816
    v_mfma_f32_16x16x32_bf16 a[180:183], a[88:91], a[4:7], 0
    ds_read_b128 a[56:59], v15 offset:36864
    v_mfma_f32_16x16x32_bf16 a[180:183], a[92:95], a[20:23], a[180:183]
    ds_read_b128 a[60:63], v15 offset:38912
    v_mfma_f32_16x16x32_bf16 a[232:235], a[100:103], a[96:99], 0
    v_add_u32 v106, s29, v104
    v_xor_b32 v106, v106, v105
    v_mfma_f32_16x16x32_bf16 a[232:235], a[104:107], a[96:99], a[232:235]
    v_lshlrev_b32 v106, 4, v106
    v_lshl_add_u32 v80, v105, 8, v106
    v_mfma_f32_16x16x32_bf16 a[192:195], a[96:99], a[0:3], 0
    s_waitcnt vmcnt(14)
    v_mfma_f32_16x16x32_bf16 a[192:195], a[96:99], a[16:19], a[192:195]
    s_barrier
    v_mfma_f32_16x16x32_bf16 a[208:211], a[0:3], a[0:3], 0
    ds_read_b64_tr_b16 a[64:65], v16 offset:24576
    v_mfma_f32_16x16x32_bf16 a[208:211], a[16:19], a[16:19], a[208:211]
    ds_read_b64_tr_b16 a[66:67], v16 offset:25600
    v_mfma_f32_16x16x32_bf16 a[196:199], a[96:99], a[4:7], 0
    ds_read_b64_tr_b16 a[68:69], v16 offset:32768
    v_mfma_f32_16x16x32_bf16 a[196:199], a[96:99], a[20:23], a[196:199]
    ds_read_b64_tr_b16 a[70:71], v16 offset:33792
    s_add_u32 s78, s28, 3
    s_and_b32 s78, s78, 7
    s_lshl_b32 s79, s78, 19
    s_add_u32 s76, s62, s79
    s_mul_i32 s79, s78, 176128
    s_add_u32 s77, s63, s79
    s_add_u32 m0, s24, 65536
    v_mfma_f32_16x16x32_bf16 a[212:215], a[4:7], a[4:7], 0
    buffer_load_dwordx4 v8, s[40:43], s76 offen offset:0 lds
    v_mfma_f32_16x16x32_bf16 a[212:215], a[20:23], a[20:23], a[212:215]
    buffer_load_dwordx4 v9, s[40:43], s76 offen offset:1024 lds
    v_mfma_f32_16x16x32_bf16 a[200:203], a[96:99], a[8:11], 0
    ds_read_b64_tr_b16 a[72:73], v16 offset:24584
    v_mfma_f32_16x16x32_bf16 a[200:203], a[96:99], a[24:27], a[200:203]
    ds_read_b64_tr_b16 a[74:75], v16 offset:25608
    v_mfma_f32_16x16x32_bf16 a[216:219], a[8:11], a[8:11], 0
    ds_read_b64_tr_b16 a[76:77], v16 offset:32776
    v_mfma_f32_16x16x32_bf16 a[216:219], a[24:27], a[24:27], a[216:219]
    ds_read_b64_tr_b16 a[78:79], v16 offset:33800
    v_mfma_f32_16x16x32_bf16 a[204:207], a[96:99], a[12:15], 0
    buffer_load_dwordx4 v10, s[40:43], s76 offen offset:2048 lds
    v_mfma_f32_16x16x32_bf16 a[204:207], a[96:99], a[28:31], a[204:207]
    buffer_load_dwordx4 v11, s[40:43], s76 offen offset:3072 lds
    s_add_u32 m0, s64, 81920
    v_mfma_f32_16x16x32_bf16 a[220:223], a[12:15], a[12:15], 0
    buffer_load_dwordx4 v12, s[44:47], s77 offen offset:0 lds
    v_mfma_f32_16x16x32_bf16 a[220:223], a[28:31], a[28:31], a[220:223]
    buffer_load_dwordx4 v13, s[44:47], s77 offen offset:1024 lds
    s_waitcnt lgkmcnt(4)
    v_mfma_f32_16x16x32_bf16 v[128:131], a[64:67], a[32:35], v[128:131]
    ds_read_b64_tr_b16 a[80:81], v17 offset:24576
    v_mfma_f32_16x16x32_bf16 v[128:131], a[68:71], a[48:51], v[128:131]
    ds_read_b64_tr_b16 a[82:83], v17 offset:25600
    v_mfma_f32_16x16x32_bf16 v[160:163], a[64:67], a[36:39], v[160:163]
    ds_read_b64_tr_b16 a[84:85], v17 offset:32768
    v_mfma_f32_16x16x32_bf16 v[160:163], a[68:71], a[52:55], v[160:163]
    ds_read_b64_tr_b16 a[86:87], v17 offset:33792
    s_add_u32 s78, s28, 3
    s_and_b32 s78, s78, 7
    s_lshl_b32 s78, s78, 7
    s_add_u32 s74, s61, s78
    s_xor_b32 s75, s74, 0x8000
    s_add_u32 m0, s60, 32768
    v_mfma_f32_16x16x32_bf16 v[192:195], a[64:67], a[40:43], v[192:195]
    buffer_load_dwordx4 v0, s[16:19], s74 offen offset:0 lds
    v_mfma_f32_16x16x32_bf16 v[192:195], a[68:71], a[56:59], v[192:195]
    buffer_load_dwordx4 v1, s[16:19], s74 offen offset:1024 lds
    v_mfma_f32_16x16x32_bf16 v[224:227], a[64:67], a[44:47], v[224:227]
    v_add_u32 v106, 4, v104
    v_xor_b32 v106, v106, v105
    v_mfma_f32_16x16x32_bf16 v[224:227], a[68:71], a[60:63], v[224:227]
    v_lshlrev_b32 v106, 4, v106
    v_lshl_add_u32 v93, v104, 8, v106
    v_mfma_f32_16x16x32_bf16 a[224:227], a[64:67], a[96:99], a[224:227]
    s_xor_b32 s29, s20, 1
    s_lshl_b32 s29, s29, 2
    v_mfma_f32_16x16x32_bf16 a[224:227], a[68:71], a[96:99], a[224:227]
    v_add_u32 v106, s29, v104
    v_xor_b32 v106, v106, v105
    s_waitcnt lgkmcnt(4)
    v_mfma_f32_16x16x32_bf16 v[132:135], a[72:75], a[32:35], v[132:135]
    ds_read_b64_tr_b16 a[88:89], v17 offset:24584
    v_mfma_f32_16x16x32_bf16 v[132:135], a[76:79], a[48:51], v[132:135]
    ds_read_b64_tr_b16 a[90:91], v17 offset:25608
    v_mfma_f32_16x16x32_bf16 v[164:167], a[72:75], a[36:39], v[164:167]
    ds_read_b64_tr_b16 a[92:93], v17 offset:32776
    v_mfma_f32_16x16x32_bf16 v[164:167], a[76:79], a[52:55], v[164:167]
    ds_read_b64_tr_b16 a[94:95], v17 offset:33800
    v_mfma_f32_16x16x32_bf16 v[196:199], a[72:75], a[40:43], v[196:199]
    buffer_load_dwordx4 v2, s[16:19], s74 offen offset:2048 lds
    v_mfma_f32_16x16x32_bf16 v[196:199], a[76:79], a[56:59], v[196:199]
    buffer_load_dwordx4 v3, s[16:19], s74 offen offset:3072 lds
    v_mfma_f32_16x16x32_bf16 v[228:231], a[72:75], a[44:47], v[228:231]
    v_lshlrev_b32 v106, 4, v106
    v_lshl_add_u32 v81, v105, 8, v106
    v_mfma_f32_16x16x32_bf16 v[228:231], a[76:79], a[60:63], v[228:231]
    v_add_u32 v106, 8, v104
    v_xor_b32 v106, v106, v105
    v_mfma_f32_16x16x32_bf16 a[228:231], a[72:75], a[96:99], a[228:231]
    v_lshlrev_b32 v106, 4, v106
    v_lshl_add_u32 v94, v104, 8, v106
    v_mfma_f32_16x16x32_bf16 a[228:231], a[76:79], a[96:99], a[228:231]
    s_xor_b32 s29, s20, 2
    s_lshl_b32 s29, s29, 2
    s_waitcnt lgkmcnt(4)
    v_mfma_f32_16x16x32_bf16 v[136:139], a[80:83], a[32:35], v[136:139]
    ds_read_b64_tr_b16 a[64:65], v18 offset:24576
    v_mfma_f32_16x16x32_bf16 v[136:139], a[84:87], a[48:51], v[136:139]
    ds_read_b64_tr_b16 a[66:67], v18 offset:25600
    v_mfma_f32_16x16x32_bf16 v[168:171], a[80:83], a[36:39], v[168:171]
    ds_read_b64_tr_b16 a[68:69], v18 offset:32768
    v_mfma_f32_16x16x32_bf16 v[168:171], a[84:87], a[52:55], v[168:171]
    ds_read_b64_tr_b16 a[70:71], v18 offset:33792
    s_add_u32 m0, s60, 36864
    v_mfma_f32_16x16x32_bf16 v[200:203], a[80:83], a[40:43], v[200:203]
    buffer_load_dwordx4 v0, s[16:19], s75 offen offset:0 lds
    v_mfma_f32_16x16x32_bf16 v[200:203], a[84:87], a[56:59], v[200:203]
    buffer_load_dwordx4 v1, s[16:19], s75 offen offset:1024 lds
    v_mfma_f32_16x16x32_bf16 v[232:235], a[80:83], a[44:47], v[232:235]
    v_add_u32 v106, s29, v104
    v_xor_b32 v106, v106, v105
    v_mfma_f32_16x16x32_bf16 v[232:235], a[84:87], a[60:63], v[232:235]
    v_lshlrev_b32 v106, 4, v106
    v_lshl_add_u32 v82, v105, 8, v106
    s_waitcnt lgkmcnt(4)
    v_mfma_f32_16x16x32_bf16 v[140:143], a[88:91], a[32:35], v[140:143]
    ds_read_b64_tr_b16 a[72:73], v18 offset:24584
    v_mfma_f32_16x16x32_bf16 v[140:143], a[92:95], a[48:51], v[140:143]
    ds_read_b64_tr_b16 a[74:75], v18 offset:25608
    v_mfma_f32_16x16x32_bf16 v[172:175], a[88:91], a[36:39], v[172:175]
    ds_read_b64_tr_b16 a[76:77], v18 offset:32776
    v_mfma_f32_16x16x32_bf16 v[172:175], a[92:95], a[52:55], v[172:175]
    ds_read_b64_tr_b16 a[78:79], v18 offset:33800
    v_mfma_f32_16x16x32_bf16 v[204:207], a[88:91], a[40:43], v[204:207]
    buffer_load_dwordx4 v2, s[16:19], s75 offen offset:2048 lds
    v_mfma_f32_16x16x32_bf16 v[204:207], a[92:95], a[56:59], v[204:207]
    buffer_load_dwordx4 v3, s[16:19], s75 offen offset:3072 lds
    v_mfma_f32_16x16x32_bf16 v[236:239], a[88:91], a[44:47], v[236:239]
    v_add_u32 v106, 12, v104
    v_xor_b32 v106, v106, v105
    v_mfma_f32_16x16x32_bf16 v[236:239], a[92:95], a[60:63], v[236:239]
    v_lshlrev_b32 v106, 4, v106
    v_lshl_add_u32 v95, v104, 8, v106
    s_waitcnt lgkmcnt(4)
    v_mfma_f32_16x16x32_bf16 v[144:147], a[64:67], a[32:35], v[144:147]
    ds_read_b64_tr_b16 a[80:81], v19 offset:24576
    v_mfma_f32_16x16x32_bf16 v[144:147], a[68:71], a[48:51], v[144:147]
    ds_read_b64_tr_b16 a[82:83], v19 offset:25600
    v_mfma_f32_16x16x32_bf16 v[176:179], a[64:67], a[36:39], v[176:179]
    ds_read_b64_tr_b16 a[84:85], v19 offset:32768
    v_mfma_f32_16x16x32_bf16 v[176:179], a[68:71], a[52:55], v[176:179]
    ds_read_b64_tr_b16 a[86:87], v19 offset:33792
    v_mfma_f32_16x16x32_bf16 v[208:211], a[64:67], a[40:43], v[208:211]
    s_xor_b32 s29, s20, 3
    s_lshl_b32 s29, s29, 2
    v_mfma_f32_16x16x32_bf16 v[208:211], a[68:71], a[56:59], v[208:211]
    v_add_u32 v106, s29, v104
    v_xor_b32 v106, v106, v105
    v_mfma_f32_16x16x32_bf16 v[240:243], a[64:67], a[44:47], v[240:243]
    v_lshlrev_b32 v106, 4, v106
    v_lshl_add_u32 v83, v105, 8, v106
    v_mfma_f32_16x16x32_bf16 v[240:243], a[68:71], a[60:63], v[240:243]
    v_add_u32 v106, 0, v104
    v_lshlrev_b32 v106, 1, v106
    s_waitcnt lgkmcnt(4)
    v_mfma_f32_16x16x32_bf16 v[148:151], a[72:75], a[32:35], v[148:151]
    ds_read_b64_tr_b16 a[88:89], v19 offset:24584
    v_mfma_f32_16x16x32_bf16 v[148:151], a[76:79], a[48:51], v[148:151]
    ds_read_b64_tr_b16 a[90:91], v19 offset:25608
    v_mfma_f32_16x16x32_bf16 v[180:183], a[72:75], a[36:39], v[180:183]
    ds_read_b64_tr_b16 a[92:93], v19 offset:32776
    v_mfma_f32_16x16x32_bf16 v[180:183], a[76:79], a[52:55], v[180:183]
    ds_read_b64_tr_b16 a[94:95], v19 offset:33800
    v_mfma_f32_16x16x32_bf16 v[212:215], a[72:75], a[40:43], v[212:215]
    v_xor_b32 v106, v106, v105
    v_lshlrev_b32 v106, 4, v106
    v_mfma_f32_16x16x32_bf16 v[212:215], a[76:79], a[56:59], v[212:215]
    v_lshl_add_u32 v96, v104, 8, v106
    v_add_u32 v106, 4, v104
    v_mfma_f32_16x16x32_bf16 v[244:247], a[72:75], a[44:47], v[244:247]
    v_lshlrev_b32 v106, 1, v106
    v_xor_b32 v106, v106, v105
    v_mfma_f32_16x16x32_bf16 v[244:247], a[76:79], a[60:63], v[244:247]
    v_lshlrev_b32 v106, 4, v106
    v_lshl_add_u32 v97, v104, 8, v106
    s_waitcnt lgkmcnt(4)
    v_mfma_f32_16x16x32_bf16 v[152:155], a[80:83], a[32:35], v[152:155]
    ds_read_b64_tr_b16 a[64:65], v20 offset:24576
    v_mfma_f32_16x16x32_bf16 v[152:155], a[84:87], a[48:51], v[152:155]
    ds_read_b64_tr_b16 a[66:67], v20 offset:25088
    v_mfma_f32_16x16x32_bf16 v[184:187], a[80:83], a[36:39], v[184:187]
    ds_read_b64_tr_b16 a[68:69], v20 offset:28672
    v_mfma_f32_16x16x32_bf16 v[184:187], a[84:87], a[52:55], v[184:187]
    ds_read_b64_tr_b16 a[70:71], v20 offset:29184
    v_mfma_f32_16x16x32_bf16 v[216:219], a[80:83], a[40:43], v[216:219]
    v_lshrrev_b32 v108, 2, v102
    v_and_b32 v106, 3, v102
    v_mfma_f32_16x16x32_bf16 v[216:219], a[84:87], a[56:59], v[216:219]
    v_lshlrev_b32 v106, 3, v106
    v_lshl_add_u32 v109, v108, 8, v106
    v_mfma_f32_16x16x32_bf16 v[248:251], a[80:83], a[44:47], v[248:251]
    v_add_u32 v109, 0x10000, v109
    v_and_b32 v110, 7, v108
    v_mfma_f32_16x16x32_bf16 v[248:251], a[84:87], a[60:63], v[248:251]
    v_xor_b32 v106, 0, v110
    v_lshl_add_u32 v84, v106, 5, v109
    s_waitcnt lgkmcnt(4)
    v_mfma_f32_16x16x32_bf16 v[156:159], a[88:91], a[32:35], v[156:159]
    ds_read_b64_tr_b16 a[72:73], v21 offset:24576
    v_mfma_f32_16x16x32_bf16 v[156:159], a[92:95], a[48:51], v[156:159]
    ds_read_b64_tr_b16 a[74:75], v21 offset:25088
    v_mfma_f32_16x16x32_bf16 v[188:191], a[88:91], a[36:39], v[188:191]
    ds_read_b64_tr_b16 a[76:77], v21 offset:28672
    v_mfma_f32_16x16x32_bf16 v[188:191], a[92:95], a[52:55], v[188:191]
    ds_read_b64_tr_b16 a[78:79], v21 offset:29184
    v_mfma_f32_16x16x32_bf16 v[220:223], a[88:91], a[40:43], v[220:223]
    v_xor_b32 v106, 1, v110
    v_lshl_add_u32 v85, v106, 5, v109
    v_mfma_f32_16x16x32_bf16 v[220:223], a[92:95], a[56:59], v[220:223]
    v_xor_b32 v106, 2, v110
    v_lshl_add_u32 v86, v106, 5, v109
    v_mfma_f32_16x16x32_bf16 v[252:255], a[88:91], a[44:47], v[252:255]
    v_xor_b32 v106, 3, v110
    v_lshl_add_u32 v87, v106, 5, v109
    v_mfma_f32_16x16x32_bf16 v[252:255], a[92:95], a[60:63], v[252:255]
    v_xor_b32 v106, 4, v110
    v_lshl_add_u32 v88, v106, 5, v109
    s_waitcnt lgkmcnt(4)
    v_mfma_f32_16x16x32_bf16 a[128:131], a[64:67], a[32:35], a[128:131]
    ds_read_b64_tr_b16 a[80:81], v22 offset:24576
    v_mfma_f32_16x16x32_bf16 a[128:131], a[68:71], a[48:51], a[128:131]
    ds_read_b64_tr_b16 a[82:83], v22 offset:25088
    v_mfma_f32_16x16x32_bf16 a[132:135], a[64:67], a[36:39], a[132:135]
    ds_read_b64_tr_b16 a[84:85], v22 offset:28672
    v_mfma_f32_16x16x32_bf16 a[132:135], a[68:71], a[52:55], a[132:135]
    ds_read_b64_tr_b16 a[86:87], v22 offset:29184
    v_mfma_f32_16x16x32_bf16 a[136:139], a[64:67], a[40:43], a[136:139]
    ds_read_b64_tr_b16 a[100:101], v4 offset:24576
    v_mfma_f32_16x16x32_bf16 a[136:139], a[68:71], a[56:59], a[136:139]
    ds_read_b64_tr_b16 a[102:103], v4 offset:25088
    v_mfma_f32_16x16x32_bf16 a[140:143], a[64:67], a[44:47], a[140:143]
    v_xor_b32 v106, 5, v110
    v_lshl_add_u32 v89, v106, 5, v109
    v_mfma_f32_16x16x32_bf16 a[140:143], a[68:71], a[60:63], a[140:143]
    v_xor_b32 v106, 6, v110
    v_lshl_add_u32 v90, v106, 5, v109
    s_waitcnt lgkmcnt(6)
    v_mfma_f32_16x16x32_bf16 a[144:147], a[72:75], a[32:35], a[144:147]
    ds_read_b64_tr_b16 a[88:89], v23 offset:24576
    v_mfma_f32_16x16x32_bf16 a[144:147], a[76:79], a[48:51], a[144:147]
    ds_read_b64_tr_b16 a[90:91], v23 offset:25088
    v_mfma_f32_16x16x32_bf16 a[148:151], a[72:75], a[36:39], a[148:151]
    ds_read_b64_tr_b16 a[92:93], v23 offset:28672
    v_mfma_f32_16x16x32_bf16 a[148:151], a[76:79], a[52:55], a[148:151]
    ds_read_b64_tr_b16 a[94:95], v23 offset:29184
    v_mfma_f32_16x16x32_bf16 a[152:155], a[72:75], a[40:43], a[152:155]
    ds_read_b64_tr_b16 a[104:105], v4 offset:28672
    v_mfma_f32_16x16x32_bf16 a[152:155], a[76:79], a[56:59], a[152:155]
    ds_read_b64_tr_b16 a[106:107], v4 offset:29184
    v_mfma_f32_16x16x32_bf16 a[156:159], a[72:75], a[44:47], a[156:159]
    v_xor_b32 v106, 7, v110
    v_lshl_add_u32 v91, v106, 5, v109
    v_mfma_f32_16x16x32_bf16 a[156:159], a[76:79], a[60:63], a[156:159]
    s_lshl_b32 s26, s21, 19
    s_add_u32 s27, s26, 16384
    s_waitcnt lgkmcnt(6)
    v_mfma_f32_16x16x32_bf16 a[160:163], a[80:83], a[32:35], a[160:163]
    s_waitcnt vmcnt(20)
    v_mfma_f32_16x16x32_bf16 a[160:163], a[84:87], a[48:51], a[160:163]
    ds_read_b128 a[0:3], v14 offset:0
    v_mfma_f32_16x16x32_bf16 a[164:167], a[80:83], a[36:39], a[164:167]
    ds_read_b128 a[4:7], v14 offset:2048
    v_mfma_f32_16x16x32_bf16 a[164:167], a[84:87], a[52:55], a[164:167]
    ds_read_b128 a[8:11], v14 offset:4096
    ds_read_b128 a[12:15], v14 offset:6144
    s_waitcnt lgkmcnt(4)
    v_mfma_f32_16x16x32_bf16 a[176:179], a[88:91], a[32:35], a[176:179]
    ds_read_b128 a[16:19], v15 offset:0
    v_mfma_f32_16x16x32_bf16 a[176:179], a[92:95], a[48:51], a[176:179]
    ds_read_b128 a[20:23], v15 offset:2048
    v_mfma_f32_16x16x32_bf16 a[180:183], a[88:91], a[36:39], a[180:183]
    ds_read_b128 a[24:27], v15 offset:4096
    v_mfma_f32_16x16x32_bf16 a[180:183], a[92:95], a[52:55], a[180:183]
    ds_read_b128 a[28:31], v15 offset:6144
    v_mfma_f32_16x16x32_bf16 a[232:235], a[100:103], a[96:99], a[232:235]
    s_add_u32 s4, s34, s27
    s_addc_u32 s5, s35, 0
    s_mov_b32 s6, 507904
    v_mfma_f32_16x16x32_bf16 a[232:235], a[104:107], a[96:99], a[232:235]
    s_mov_b32 s7, 0x20000
    s_add_u32 s48, s34, s26
    s_addc_u32 s49, s35, 0
    v_mfma_f32_16x16x32_bf16 a[192:195], a[96:99], a[32:35], a[192:195]
    s_waitcnt vmcnt(14)
    v_mfma_f32_16x16x32_bf16 a[192:195], a[96:99], a[48:51], a[192:195]
    s_barrier
    v_mfma_f32_16x16x32_bf16 a[208:211], a[32:35], a[32:35], a[208:211]
    ds_read_b64_tr_b16 a[64:65], v16 offset:49152
    v_mfma_f32_16x16x32_bf16 a[208:211], a[48:51], a[48:51], a[208:211]
    ds_read_b64_tr_b16 a[66:67], v16 offset:50176
    v_mfma_f32_16x16x32_bf16 a[196:199], a[96:99], a[36:39], a[196:199]
    ds_read_b64_tr_b16 a[68:69], v16 offset:57344
    v_mfma_f32_16x16x32_bf16 a[196:199], a[96:99], a[52:55], a[196:199]
    ds_read_b64_tr_b16 a[70:71], v16 offset:58368
    s_add_u32 s78, s28, 4
    s_and_b32 s78, s78, 7
    s_lshl_b32 s79, s78, 19
    s_add_u32 s76, s62, s79
    s_mul_i32 s79, s78, 176128
    s_add_u32 s77, s63, s79
    s_add_u32 m0, s24, 90112
    v_mfma_f32_16x16x32_bf16 a[212:215], a[36:39], a[36:39], a[212:215]
    buffer_load_dwordx4 v8, s[40:43], s76 offen offset:0 lds
    v_mfma_f32_16x16x32_bf16 a[212:215], a[52:55], a[52:55], a[212:215]
    buffer_load_dwordx4 v9, s[40:43], s76 offen offset:1024 lds
    v_mfma_f32_16x16x32_bf16 a[200:203], a[96:99], a[40:43], a[200:203]
    ds_read_b64_tr_b16 a[72:73], v16 offset:49160
    v_mfma_f32_16x16x32_bf16 a[200:203], a[96:99], a[56:59], a[200:203]
    ds_read_b64_tr_b16 a[74:75], v16 offset:50184
    v_mfma_f32_16x16x32_bf16 a[216:219], a[40:43], a[40:43], a[216:219]
    ds_read_b64_tr_b16 a[76:77], v16 offset:57352
    v_mfma_f32_16x16x32_bf16 a[216:219], a[56:59], a[56:59], a[216:219]
    ds_read_b64_tr_b16 a[78:79], v16 offset:58376
    v_mfma_f32_16x16x32_bf16 a[204:207], a[96:99], a[44:47], a[204:207]
    buffer_load_dwordx4 v10, s[40:43], s76 offen offset:2048 lds
    v_mfma_f32_16x16x32_bf16 a[204:207], a[96:99], a[60:63], a[204:207]
    buffer_load_dwordx4 v11, s[40:43], s76 offen offset:3072 lds
    s_add_u32 m0, s64, 106496
    v_mfma_f32_16x16x32_bf16 a[220:223], a[44:47], a[44:47], a[220:223]
    buffer_load_dwordx4 v12, s[44:47], s77 offen offset:0 lds
    v_mfma_f32_16x16x32_bf16 a[220:223], a[60:63], a[60:63], a[220:223]
    buffer_load_dwordx4 v13, s[44:47], s77 offen offset:1024 lds
    s_waitcnt lgkmcnt(4)
    v_mfma_f32_16x16x32_bf16 v[128:131], a[64:67], a[0:3], v[128:131]
    ds_read_b64_tr_b16 a[80:81], v17 offset:49152
    v_mfma_f32_16x16x32_bf16 v[128:131], a[68:71], a[16:19], v[128:131]
    ds_read_b64_tr_b16 a[82:83], v17 offset:50176
    v_mfma_f32_16x16x32_bf16 v[160:163], a[64:67], a[4:7], v[160:163]
    ds_read_b64_tr_b16 a[84:85], v17 offset:57344
    v_mfma_f32_16x16x32_bf16 v[160:163], a[68:71], a[20:23], v[160:163]
    ds_read_b64_tr_b16 a[86:87], v17 offset:58368
    s_add_u32 s78, s28, 4
    s_and_b32 s78, s78, 7
    s_lshl_b32 s78, s78, 7
    s_add_u32 s74, s61, s78
    s_xor_b32 s75, s74, 0x8000
    s_add_u32 m0, s60, 0
    v_mfma_f32_16x16x32_bf16 v[192:195], a[64:67], a[8:11], v[192:195]
    buffer_load_dwordx4 v0, s[16:19], s74 offen offset:0 lds
    v_mfma_f32_16x16x32_bf16 v[192:195], a[68:71], a[24:27], v[192:195]
    buffer_load_dwordx4 v1, s[16:19], s74 offen offset:1024 lds
    v_mfma_f32_16x16x32_bf16 v[224:227], a[64:67], a[12:15], v[224:227]
    s_mov_b32 s50, 16384
    s_mov_b32 s51, 0x20000
    v_mfma_f32_16x16x32_bf16 v[224:227], a[68:71], a[28:31], v[224:227]
    s_add_u32 s8, s36, s26
    s_addc_u32 s9, s37, 0
    s_mov_b32 s10, 524288
    v_mfma_f32_16x16x32_bf16 a[224:227], a[64:67], a[96:99], a[224:227]
    s_mov_b32 s11, 0x20000
    s_mov_b32 s12, s72
    v_mfma_f32_16x16x32_bf16 a[224:227], a[68:71], a[96:99], a[224:227]
    s_mov_b32 s13, s73
    s_mov_b32 s14, 16777216
    s_waitcnt lgkmcnt(4)
    v_mfma_f32_16x16x32_bf16 v[132:135], a[72:75], a[0:3], v[132:135]
    ds_read_b64_tr_b16 a[88:89], v17 offset:49160
    v_mfma_f32_16x16x32_bf16 v[132:135], a[76:79], a[16:19], v[132:135]
    ds_read_b64_tr_b16 a[90:91], v17 offset:50184
    v_mfma_f32_16x16x32_bf16 v[164:167], a[72:75], a[4:7], v[164:167]
    ds_read_b64_tr_b16 a[92:93], v17 offset:57352
    v_mfma_f32_16x16x32_bf16 v[164:167], a[76:79], a[20:23], v[164:167]
    ds_read_b64_tr_b16 a[94:95], v17 offset:58376
    v_mfma_f32_16x16x32_bf16 v[196:199], a[72:75], a[8:11], v[196:199]
    buffer_load_dwordx4 v2, s[16:19], s74 offen offset:2048 lds
    v_mfma_f32_16x16x32_bf16 v[196:199], a[76:79], a[24:27], v[196:199]
    buffer_load_dwordx4 v3, s[16:19], s74 offen offset:3072 lds
    v_mfma_f32_16x16x32_bf16 v[228:231], a[72:75], a[12:15], v[228:231]
    s_mov_b32 s15, 0x20000
    s_add_u32 s52, s72, 16777216
    s_addc_u32 s53, s73, 0
    v_mfma_f32_16x16x32_bf16 v[228:231], a[76:79], a[28:31], v[228:231]
    s_mov_b32 s54, 5636096
    s_mov_b32 s55, 0x20000
    v_mfma_f32_16x16x32_bf16 a[228:231], a[72:75], a[96:99], a[228:231]
    s_mov_b32 s56, s70
    s_mov_b32 s57, s71
    v_mfma_f32_16x16x32_bf16 a[228:231], a[76:79], a[96:99], a[228:231]
    s_mov_b32 s58, 2752
    s_mov_b32 s59, 0x20000
    s_waitcnt lgkmcnt(4)
    v_mfma_f32_16x16x32_bf16 v[136:139], a[80:83], a[0:3], v[136:139]
    ds_read_b64_tr_b16 a[64:65], v18 offset:49152
    v_mfma_f32_16x16x32_bf16 v[136:139], a[84:87], a[16:19], v[136:139]
    ds_read_b64_tr_b16 a[66:67], v18 offset:50176
    v_mfma_f32_16x16x32_bf16 v[168:171], a[80:83], a[4:7], v[168:171]
    ds_read_b64_tr_b16 a[68:69], v18 offset:57344
    v_mfma_f32_16x16x32_bf16 v[168:171], a[84:87], a[20:23], v[168:171]
    ds_read_b64_tr_b16 a[70:71], v18 offset:58368
    s_add_u32 m0, s60, 4096
    v_mfma_f32_16x16x32_bf16 v[200:203], a[80:83], a[8:11], v[200:203]
    buffer_load_dwordx4 v0, s[16:19], s75 offen offset:0 lds
    v_mfma_f32_16x16x32_bf16 v[200:203], a[84:87], a[24:27], v[200:203]
    buffer_load_dwordx4 v1, s[16:19], s75 offen offset:1024 lds
    v_mfma_f32_16x16x32_bf16 v[232:235], a[80:83], a[12:15], v[232:235]
    v_lshrrev_b32 v64, 4, v102
    v_lshlrev_b32 v64, 3, v64
    v_mfma_f32_16x16x32_bf16 v[232:235], a[84:87], a[28:31], v[232:235]
    s_lshl_b32 s26, s21, 6
    s_lshl_b32 s27, s25, 6
    s_waitcnt lgkmcnt(4)
    v_mfma_f32_16x16x32_bf16 v[140:143], a[88:91], a[0:3], v[140:143]
    ds_read_b64_tr_b16 a[72:73], v18 offset:49160
    v_mfma_f32_16x16x32_bf16 v[140:143], a[92:95], a[16:19], v[140:143]
    ds_read_b64_tr_b16 a[74:75], v18 offset:50184
    v_mfma_f32_16x16x32_bf16 v[172:175], a[88:91], a[4:7], v[172:175]
    ds_read_b64_tr_b16 a[76:77], v18 offset:57352
    v_mfma_f32_16x16x32_bf16 v[172:175], a[92:95], a[20:23], v[172:175]
    ds_read_b64_tr_b16 a[78:79], v18 offset:58376
    v_mfma_f32_16x16x32_bf16 v[204:207], a[88:91], a[8:11], v[204:207]
    buffer_load_dwordx4 v2, s[16:19], s75 offen offset:2048 lds
    v_mfma_f32_16x16x32_bf16 v[204:207], a[92:95], a[24:27], v[204:207]
    buffer_load_dwordx4 v3, s[16:19], s75 offen offset:3072 lds
    v_mfma_f32_16x16x32_bf16 v[236:239], a[88:91], a[12:15], v[236:239]
    buffer_load_dwordx2 v[24:25], v64, s[56:59], s26 offen offset:0
    v_mfma_f32_16x16x32_bf16 v[236:239], a[92:95], a[28:31], v[236:239]
    buffer_load_dwordx2 v[26:27], v64, s[56:59], s26 offen offset:32
    s_waitcnt lgkmcnt(4)
    v_mfma_f32_16x16x32_bf16 v[144:147], a[64:67], a[0:3], v[144:147]
    ds_read_b64_tr_b16 a[80:81], v19 offset:49152
    v_mfma_f32_16x16x32_bf16 v[144:147], a[68:71], a[16:19], v[144:147]
    ds_read_b64_tr_b16 a[82:83], v19 offset:50176
    v_mfma_f32_16x16x32_bf16 v[176:179], a[64:67], a[4:7], v[176:179]
    ds_read_b64_tr_b16 a[84:85], v19 offset:57344
    v_mfma_f32_16x16x32_bf16 v[176:179], a[68:71], a[20:23], v[176:179]
    ds_read_b64_tr_b16 a[86:87], v19 offset:58368
    v_mfma_f32_16x16x32_bf16 v[208:211], a[64:67], a[8:11], v[208:211]
    buffer_load_dwordx2 v[28:29], v64, s[56:59], s27 offen offset:0
    v_mfma_f32_16x16x32_bf16 v[208:211], a[68:71], a[24:27], v[208:211]
    buffer_load_dwordx2 v[30:31], v64, s[56:59], s27 offen offset:32
    v_mfma_f32_16x16x32_bf16 v[240:243], a[64:67], a[12:15], v[240:243]
    v_mfma_f32_16x16x32_bf16 v[240:243], a[68:71], a[28:31], v[240:243]
    s_waitcnt lgkmcnt(4)
    v_mfma_f32_16x16x32_bf16 v[148:151], a[72:75], a[0:3], v[148:151]
    ds_read_b64_tr_b16 a[88:89], v19 offset:49160
    v_mfma_f32_16x16x32_bf16 v[148:151], a[76:79], a[16:19], v[148:151]
    ds_read_b64_tr_b16 a[90:91], v19 offset:50184
    v_mfma_f32_16x16x32_bf16 v[180:183], a[72:75], a[4:7], v[180:183]
    ds_read_b64_tr_b16 a[92:93], v19 offset:57352
    v_mfma_f32_16x16x32_bf16 v[180:183], a[76:79], a[20:23], v[180:183]
    ds_read_b64_tr_b16 a[94:95], v19 offset:58376
    v_mfma_f32_16x16x32_bf16 v[212:215], a[72:75], a[8:11], v[212:215]
    v_mfma_f32_16x16x32_bf16 v[212:215], a[76:79], a[24:27], v[212:215]
    v_mfma_f32_16x16x32_bf16 v[244:247], a[72:75], a[12:15], v[244:247]
    v_mfma_f32_16x16x32_bf16 v[244:247], a[76:79], a[28:31], v[244:247]
    s_waitcnt lgkmcnt(4)
    v_mfma_f32_16x16x32_bf16 v[152:155], a[80:83], a[0:3], v[152:155]
    ds_read_b64_tr_b16 a[64:65], v20 offset:49152
    v_mfma_f32_16x16x32_bf16 v[152:155], a[84:87], a[16:19], v[152:155]
    ds_read_b64_tr_b16 a[66:67], v20 offset:49664
    v_mfma_f32_16x16x32_bf16 v[184:187], a[80:83], a[4:7], v[184:187]
    ds_read_b64_tr_b16 a[68:69], v20 offset:53248
    v_mfma_f32_16x16x32_bf16 v[184:187], a[84:87], a[20:23], v[184:187]
    ds_read_b64_tr_b16 a[70:71], v20 offset:53760
    v_mfma_f32_16x16x32_bf16 v[216:219], a[80:83], a[8:11], v[216:219]
    v_mfma_f32_16x16x32_bf16 v[216:219], a[84:87], a[24:27], v[216:219]
    v_mfma_f32_16x16x32_bf16 v[248:251], a[80:83], a[12:15], v[248:251]
    v_mfma_f32_16x16x32_bf16 v[248:251], a[84:87], a[28:31], v[248:251]
    s_waitcnt lgkmcnt(4)
    v_mfma_f32_16x16x32_bf16 v[156:159], a[88:91], a[0:3], v[156:159]
    ds_read_b64_tr_b16 a[72:73], v21 offset:49152
    v_mfma_f32_16x16x32_bf16 v[156:159], a[92:95], a[16:19], v[156:159]
    ds_read_b64_tr_b16 a[74:75], v21 offset:49664
    v_mfma_f32_16x16x32_bf16 v[188:191], a[88:91], a[4:7], v[188:191]
    ds_read_b64_tr_b16 a[76:77], v21 offset:53248
    v_mfma_f32_16x16x32_bf16 v[188:191], a[92:95], a[20:23], v[188:191]
    ds_read_b64_tr_b16 a[78:79], v21 offset:53760
    v_mfma_f32_16x16x32_bf16 v[220:223], a[88:91], a[8:11], v[220:223]
    v_mfma_f32_16x16x32_bf16 v[220:223], a[92:95], a[24:27], v[220:223]
    v_mfma_f32_16x16x32_bf16 v[252:255], a[88:91], a[12:15], v[252:255]
    v_mfma_f32_16x16x32_bf16 v[252:255], a[92:95], a[28:31], v[252:255]
    s_waitcnt lgkmcnt(4)
    v_mfma_f32_16x16x32_bf16 a[128:131], a[64:67], a[0:3], a[128:131]
    ds_read_b64_tr_b16 a[80:81], v22 offset:49152
    v_mfma_f32_16x16x32_bf16 a[128:131], a[68:71], a[16:19], a[128:131]
    ds_read_b64_tr_b16 a[82:83], v22 offset:49664
    v_mfma_f32_16x16x32_bf16 a[132:135], a[64:67], a[4:7], a[132:135]
    ds_read_b64_tr_b16 a[84:85], v22 offset:53248
    v_mfma_f32_16x16x32_bf16 a[132:135], a[68:71], a[20:23], a[132:135]
    ds_read_b64_tr_b16 a[86:87], v22 offset:53760
    v_mfma_f32_16x16x32_bf16 a[136:139], a[64:67], a[8:11], a[136:139]
    ds_read_b64_tr_b16 a[100:101], v4 offset:49152
    v_mfma_f32_16x16x32_bf16 a[136:139], a[68:71], a[24:27], a[136:139]
    ds_read_b64_tr_b16 a[102:103], v4 offset:49664
    v_mfma_f32_16x16x32_bf16 a[140:143], a[64:67], a[12:15], a[140:143]
    v_mfma_f32_16x16x32_bf16 a[140:143], a[68:71], a[28:31], a[140:143]
    s_waitcnt lgkmcnt(6)
    v_mfma_f32_16x16x32_bf16 a[144:147], a[72:75], a[0:3], a[144:147]
    ds_read_b64_tr_b16 a[88:89], v23 offset:49152
    v_mfma_f32_16x16x32_bf16 a[144:147], a[76:79], a[16:19], a[144:147]
    ds_read_b64_tr_b16 a[90:91], v23 offset:49664
    v_mfma_f32_16x16x32_bf16 a[148:151], a[72:75], a[4:7], a[148:151]
    ds_read_b64_tr_b16 a[92:93], v23 offset:53248
    v_mfma_f32_16x16x32_bf16 a[148:151], a[76:79], a[20:23], a[148:151]
    ds_read_b64_tr_b16 a[94:95], v23 offset:53760
    v_mfma_f32_16x16x32_bf16 a[152:155], a[72:75], a[8:11], a[152:155]
    ds_read_b64_tr_b16 a[104:105], v4 offset:53248
    v_mfma_f32_16x16x32_bf16 a[152:155], a[76:79], a[24:27], a[152:155]
    ds_read_b64_tr_b16 a[106:107], v4 offset:53760
    v_mfma_f32_16x16x32_bf16 a[156:159], a[72:75], a[12:15], a[156:159]
    v_mfma_f32_16x16x32_bf16 a[156:159], a[76:79], a[28:31], a[156:159]
    s_waitcnt lgkmcnt(6)
    v_mfma_f32_16x16x32_bf16 a[160:163], a[80:83], a[0:3], a[160:163]
    s_waitcnt vmcnt(18)
    v_mfma_f32_16x16x32_bf16 a[160:163], a[84:87], a[16:19], a[160:163]
    ds_read_b128 a[32:35], v14 offset:32768
    v_mfma_f32_16x16x32_bf16 a[164:167], a[80:83], a[4:7], a[164:167]
    ds_read_b128 a[36:39], v14 offset:34816
    v_mfma_f32_16x16x32_bf16 a[164:167], a[84:87], a[20:23], a[164:167]
    ds_read_b128 a[40:43], v14 offset:36864
    ds_read_b128 a[44:47], v14 offset:38912
    s_waitcnt lgkmcnt(4)
    v_mfma_f32_16x16x32_bf16 a[176:179], a[88:91], a[0:3], a[176:179]
    ds_read_b128 a[48:51], v15 offset:32768
    v_mfma_f32_16x16x32_bf16 a[176:179], a[92:95], a[16:19], a[176:179]
    ds_read_b128 a[52:55], v15 offset:34816
    v_mfma_f32_16x16x32_bf16 a[180:183], a[88:91], a[4:7], a[180:183]
    ds_read_b128 a[56:59], v15 offset:36864
    v_mfma_f32_16x16x32_bf16 a[180:183], a[92:95], a[20:23], a[180:183]
    ds_read_b128 a[60:63], v15 offset:38912
    v_mfma_f32_16x16x32_bf16 a[232:235], a[100:103], a[96:99], a[232:235]
    v_mfma_f32_16x16x32_bf16 a[232:235], a[104:107], a[96:99], a[232:235]
    v_mfma_f32_16x16x32_bf16 a[192:195], a[96:99], a[0:3], a[192:195]
    s_waitcnt vmcnt(26)
    v_mfma_f32_16x16x32_bf16 a[192:195], a[96:99], a[16:19], a[192:195]
    s_barrier
    v_mfma_f32_16x16x32_bf16 a[208:211], a[0:3], a[0:3], a[208:211]
    ds_read_b64_tr_b16 a[64:65], v16 offset:0
    v_mfma_f32_16x16x32_bf16 a[208:211], a[16:19], a[16:19], a[208:211]
    ds_read_b64_tr_b16 a[66:67], v16 offset:1024
    v_mfma_f32_16x16x32_bf16 a[196:199], a[96:99], a[4:7], a[196:199]
    ds_read_b64_tr_b16 a[68:69], v16 offset:8192
    v_mfma_f32_16x16x32_bf16 a[196:199], a[96:99], a[20:23], a[196:199]
    ds_read_b64_tr_b16 a[70:71], v16 offset:9216
    s_add_u32 s78, s28, 5
    s_and_b32 s78, s78, 7
    s_lshl_b32 s79, s78, 19
    s_add_u32 s76, s62, s79
    s_mul_i32 s79, s78, 176128
    s_add_u32 s77, s63, s79
    s_add_u32 m0, s24, 114688
    v_mfma_f32_16x16x32_bf16 a[212:215], a[4:7], a[4:7], a[212:215]
    buffer_load_dwordx4 v8, s[40:43], s76 offen offset:0 lds
    v_mfma_f32_16x16x32_bf16 a[212:215], a[20:23], a[20:23], a[212:215]
    buffer_load_dwordx4 v9, s[40:43], s76 offen offset:1024 lds
    v_mfma_f32_16x16x32_bf16 a[200:203], a[96:99], a[8:11], a[200:203]
    ds_read_b64_tr_b16 a[72:73], v16 offset:8
    v_mfma_f32_16x16x32_bf16 a[200:203], a[96:99], a[24:27], a[200:203]
    ds_read_b64_tr_b16 a[74:75], v16 offset:1032
    v_mfma_f32_16x16x32_bf16 a[216:219], a[8:11], a[8:11], a[216:219]
    ds_read_b64_tr_b16 a[76:77], v16 offset:8200
    v_mfma_f32_16x16x32_bf16 a[216:219], a[24:27], a[24:27], a[216:219]
    ds_read_b64_tr_b16 a[78:79], v16 offset:9224
    v_mfma_f32_16x16x32_bf16 a[204:207], a[96:99], a[12:15], a[204:207]
    buffer_load_dwordx4 v10, s[40:43], s76 offen offset:2048 lds
    v_mfma_f32_16x16x32_bf16 a[204:207], a[96:99], a[28:31], a[204:207]
    buffer_load_dwordx4 v11, s[40:43], s76 offen offset:3072 lds
    s_add_u32 m0, s64, 131072
    v_mfma_f32_16x16x32_bf16 a[220:223], a[12:15], a[12:15], a[220:223]
    buffer_load_dwordx4 v12, s[44:47], s77 offen offset:0 lds
    v_mfma_f32_16x16x32_bf16 a[220:223], a[28:31], a[28:31], a[220:223]
    buffer_load_dwordx4 v13, s[44:47], s77 offen offset:1024 lds
    s_waitcnt lgkmcnt(4)
    v_mfma_f32_16x16x32_bf16 v[128:131], a[64:67], a[32:35], v[128:131]
    ds_read_b64_tr_b16 a[80:81], v17 offset:0
    v_mfma_f32_16x16x32_bf16 v[128:131], a[68:71], a[48:51], v[128:131]
    ds_read_b64_tr_b16 a[82:83], v17 offset:1024
    v_mfma_f32_16x16x32_bf16 v[160:163], a[64:67], a[36:39], v[160:163]
    ds_read_b64_tr_b16 a[84:85], v17 offset:8192
    v_mfma_f32_16x16x32_bf16 v[160:163], a[68:71], a[52:55], v[160:163]
    ds_read_b64_tr_b16 a[86:87], v17 offset:9216
    s_add_u32 s78, s28, 5
    s_and_b32 s78, s78, 7
    s_lshl_b32 s78, s78, 7
    s_add_u32 s74, s61, s78
    s_xor_b32 s75, s74, 0x8000
    s_add_u32 m0, s60, 32768
    v_mfma_f32_16x16x32_bf16 v[192:195], a[64:67], a[40:43], v[192:195]
    buffer_load_dwordx4 v0, s[16:19], s74 offen offset:0 lds
    v_mfma_f32_16x16x32_bf16 v[192:195], a[68:71], a[56:59], v[192:195]
    buffer_load_dwordx4 v1, s[16:19], s74 offen offset:1024 lds
    v_mfma_f32_16x16x32_bf16 v[224:227], a[64:67], a[44:47], v[224:227]
    v_mfma_f32_16x16x32_bf16 v[224:227], a[68:71], a[60:63], v[224:227]
    v_mfma_f32_16x16x32_bf16 a[224:227], a[64:67], a[96:99], a[224:227]
    v_mfma_f32_16x16x32_bf16 a[224:227], a[68:71], a[96:99], a[224:227]
    s_waitcnt lgkmcnt(4)
    v_mfma_f32_16x16x32_bf16 v[132:135], a[72:75], a[32:35], v[132:135]
    ds_read_b64_tr_b16 a[88:89], v17 offset:8
    v_mfma_f32_16x16x32_bf16 v[132:135], a[76:79], a[48:51], v[132:135]
    ds_read_b64_tr_b16 a[90:91], v17 offset:1032
    v_mfma_f32_16x16x32_bf16 v[164:167], a[72:75], a[36:39], v[164:167]
    ds_read_b64_tr_b16 a[92:93], v17 offset:8200
    v_mfma_f32_16x16x32_bf16 v[164:167], a[76:79], a[52:55], v[164:167]
    ds_read_b64_tr_b16 a[94:95], v17 offset:9224
    v_mfma_f32_16x16x32_bf16 v[196:199], a[72:75], a[40:43], v[196:199]
    buffer_load_dwordx4 v2, s[16:19], s74 offen offset:2048 lds
    v_mfma_f32_16x16x32_bf16 v[196:199], a[76:79], a[56:59], v[196:199]
    buffer_load_dwordx4 v3, s[16:19], s74 offen offset:3072 lds
    v_mfma_f32_16x16x32_bf16 v[228:231], a[72:75], a[44:47], v[228:231]
    v_mfma_f32_16x16x32_bf16 v[228:231], a[76:79], a[60:63], v[228:231]
    v_mfma_f32_16x16x32_bf16 a[228:231], a[72:75], a[96:99], a[228:231]
    v_mfma_f32_16x16x32_bf16 a[228:231], a[76:79], a[96:99], a[228:231]
    s_waitcnt lgkmcnt(4)
    v_mfma_f32_16x16x32_bf16 v[136:139], a[80:83], a[32:35], v[136:139]
    ds_read_b64_tr_b16 a[64:65], v18 offset:0
    v_mfma_f32_16x16x32_bf16 v[136:139], a[84:87], a[48:51], v[136:139]
    ds_read_b64_tr_b16 a[66:67], v18 offset:1024
    v_mfma_f32_16x16x32_bf16 v[168:171], a[80:83], a[36:39], v[168:171]
    ds_read_b64_tr_b16 a[68:69], v18 offset:8192
    v_mfma_f32_16x16x32_bf16 v[168:171], a[84:87], a[52:55], v[168:171]
    ds_read_b64_tr_b16 a[70:71], v18 offset:9216
    s_add_u32 m0, s60, 36864
    v_mfma_f32_16x16x32_bf16 v[200:203], a[80:83], a[40:43], v[200:203]
    buffer_load_dwordx4 v0, s[16:19], s75 offen offset:0 lds
    v_mfma_f32_16x16x32_bf16 v[200:203], a[84:87], a[56:59], v[200:203]
    buffer_load_dwordx4 v1, s[16:19], s75 offen offset:1024 lds
    v_mfma_f32_16x16x32_bf16 v[232:235], a[80:83], a[44:47], v[232:235]
    v_mfma_f32_16x16x32_bf16 v[232:235], a[84:87], a[60:63], v[232:235]
    s_waitcnt lgkmcnt(4)
    v_mfma_f32_16x16x32_bf16 v[140:143], a[88:91], a[32:35], v[140:143]
    ds_read_b64_tr_b16 a[72:73], v18 offset:8
    v_mfma_f32_16x16x32_bf16 v[140:143], a[92:95], a[48:51], v[140:143]
    ds_read_b64_tr_b16 a[74:75], v18 offset:1032
    v_mfma_f32_16x16x32_bf16 v[172:175], a[88:91], a[36:39], v[172:175]
    ds_read_b64_tr_b16 a[76:77], v18 offset:8200
    v_mfma_f32_16x16x32_bf16 v[172:175], a[92:95], a[52:55], v[172:175]
    ds_read_b64_tr_b16 a[78:79], v18 offset:9224
    v_mfma_f32_16x16x32_bf16 v[204:207], a[88:91], a[40:43], v[204:207]
    buffer_load_dwordx4 v2, s[16:19], s75 offen offset:2048 lds
    v_mfma_f32_16x16x32_bf16 v[204:207], a[92:95], a[56:59], v[204:207]
    buffer_load_dwordx4 v3, s[16:19], s75 offen offset:3072 lds
    v_mfma_f32_16x16x32_bf16 v[236:239], a[88:91], a[44:47], v[236:239]
    v_mfma_f32_16x16x32_bf16 v[236:239], a[92:95], a[60:63], v[236:239]
    s_waitcnt lgkmcnt(4)
    v_mfma_f32_16x16x32_bf16 v[144:147], a[64:67], a[32:35], v[144:147]
    ds_read_b64_tr_b16 a[80:81], v19 offset:0
    v_mfma_f32_16x16x32_bf16 v[144:147], a[68:71], a[48:51], v[144:147]
    ds_read_b64_tr_b16 a[82:83], v19 offset:1024
    v_mfma_f32_16x16x32_bf16 v[176:179], a[64:67], a[36:39], v[176:179]
    ds_read_b64_tr_b16 a[84:85], v19 offset:8192
    v_mfma_f32_16x16x32_bf16 v[176:179], a[68:71], a[52:55], v[176:179]
    ds_read_b64_tr_b16 a[86:87], v19 offset:9216
    v_mfma_f32_16x16x32_bf16 v[208:211], a[64:67], a[40:43], v[208:211]
    v_mfma_f32_16x16x32_bf16 v[208:211], a[68:71], a[56:59], v[208:211]
    v_mfma_f32_16x16x32_bf16 v[240:243], a[64:67], a[44:47], v[240:243]
    v_mfma_f32_16x16x32_bf16 v[240:243], a[68:71], a[60:63], v[240:243]
    s_waitcnt lgkmcnt(4)
    v_mfma_f32_16x16x32_bf16 v[148:151], a[72:75], a[32:35], v[148:151]
    ds_read_b64_tr_b16 a[88:89], v19 offset:8
    v_mfma_f32_16x16x32_bf16 v[148:151], a[76:79], a[48:51], v[148:151]
    ds_read_b64_tr_b16 a[90:91], v19 offset:1032
    v_mfma_f32_16x16x32_bf16 v[180:183], a[72:75], a[36:39], v[180:183]
    ds_read_b64_tr_b16 a[92:93], v19 offset:8200
    v_mfma_f32_16x16x32_bf16 v[180:183], a[76:79], a[52:55], v[180:183]
    ds_read_b64_tr_b16 a[94:95], v19 offset:9224
    v_mfma_f32_16x16x32_bf16 v[212:215], a[72:75], a[40:43], v[212:215]
    v_mfma_f32_16x16x32_bf16 v[212:215], a[76:79], a[56:59], v[212:215]
    v_mfma_f32_16x16x32_bf16 v[244:247], a[72:75], a[44:47], v[244:247]
    v_mfma_f32_16x16x32_bf16 v[244:247], a[76:79], a[60:63], v[244:247]
    s_waitcnt lgkmcnt(4)
    v_mfma_f32_16x16x32_bf16 v[152:155], a[80:83], a[32:35], v[152:155]
    ds_read_b64_tr_b16 a[64:65], v20 offset:0
    v_mfma_f32_16x16x32_bf16 v[152:155], a[84:87], a[48:51], v[152:155]
    ds_read_b64_tr_b16 a[66:67], v20 offset:512
    v_mfma_f32_16x16x32_bf16 v[184:187], a[80:83], a[36:39], v[184:187]
    ds_read_b64_tr_b16 a[68:69], v20 offset:4096
    v_mfma_f32_16x16x32_bf16 v[184:187], a[84:87], a[52:55], v[184:187]
    ds_read_b64_tr_b16 a[70:71], v20 offset:4608
    v_mfma_f32_16x16x32_bf16 v[216:219], a[80:83], a[40:43], v[216:219]
    v_mfma_f32_16x16x32_bf16 v[216:219], a[84:87], a[56:59], v[216:219]
    v_mfma_f32_16x16x32_bf16 v[248:251], a[80:83], a[44:47], v[248:251]
    v_mfma_f32_16x16x32_bf16 v[248:251], a[84:87], a[60:63], v[248:251]
    s_waitcnt lgkmcnt(4)
    v_mfma_f32_16x16x32_bf16 v[156:159], a[88:91], a[32:35], v[156:159]
    ds_read_b64_tr_b16 a[72:73], v21 offset:0
    v_mfma_f32_16x16x32_bf16 v[156:159], a[92:95], a[48:51], v[156:159]
    ds_read_b64_tr_b16 a[74:75], v21 offset:512
    v_mfma_f32_16x16x32_bf16 v[188:191], a[88:91], a[36:39], v[188:191]
    ds_read_b64_tr_b16 a[76:77], v21 offset:4096
    v_mfma_f32_16x16x32_bf16 v[188:191], a[92:95], a[52:55], v[188:191]
    ds_read_b64_tr_b16 a[78:79], v21 offset:4608
    v_mfma_f32_16x16x32_bf16 v[220:223], a[88:91], a[40:43], v[220:223]
    v_mfma_f32_16x16x32_bf16 v[220:223], a[92:95], a[56:59], v[220:223]
    v_mfma_f32_16x16x32_bf16 v[252:255], a[88:91], a[44:47], v[252:255]
    v_mfma_f32_16x16x32_bf16 v[252:255], a[92:95], a[60:63], v[252:255]
    s_waitcnt lgkmcnt(4)
    v_mfma_f32_16x16x32_bf16 a[128:131], a[64:67], a[32:35], a[128:131]
    ds_read_b64_tr_b16 a[80:81], v22 offset:0
    v_mfma_f32_16x16x32_bf16 a[128:131], a[68:71], a[48:51], a[128:131]
    ds_read_b64_tr_b16 a[82:83], v22 offset:512
    v_mfma_f32_16x16x32_bf16 a[132:135], a[64:67], a[36:39], a[132:135]
    ds_read_b64_tr_b16 a[84:85], v22 offset:4096
    v_mfma_f32_16x16x32_bf16 a[132:135], a[68:71], a[52:55], a[132:135]
    ds_read_b64_tr_b16 a[86:87], v22 offset:4608
    v_mfma_f32_16x16x32_bf16 a[136:139], a[64:67], a[40:43], a[136:139]
    ds_read_b64_tr_b16 a[100:101], v4 offset:0
    v_mfma_f32_16x16x32_bf16 a[136:139], a[68:71], a[56:59], a[136:139]
    ds_read_b64_tr_b16 a[102:103], v4 offset:512
    v_mfma_f32_16x16x32_bf16 a[140:143], a[64:67], a[44:47], a[140:143]
    v_mfma_f32_16x16x32_bf16 a[140:143], a[68:71], a[60:63], a[140:143]
    s_waitcnt lgkmcnt(6)
    v_mfma_f32_16x16x32_bf16 a[144:147], a[72:75], a[32:35], a[144:147]
    ds_read_b64_tr_b16 a[88:89], v23 offset:0
    v_mfma_f32_16x16x32_bf16 a[144:147], a[76:79], a[48:51], a[144:147]
    ds_read_b64_tr_b16 a[90:91], v23 offset:512
    v_mfma_f32_16x16x32_bf16 a[148:151], a[72:75], a[36:39], a[148:151]
    ds_read_b64_tr_b16 a[92:93], v23 offset:4096
    v_mfma_f32_16x16x32_bf16 a[148:151], a[76:79], a[52:55], a[148:151]
    ds_read_b64_tr_b16 a[94:95], v23 offset:4608
    v_mfma_f32_16x16x32_bf16 a[152:155], a[72:75], a[40:43], a[152:155]
    ds_read_b64_tr_b16 a[104:105], v4 offset:4096
    v_mfma_f32_16x16x32_bf16 a[152:155], a[76:79], a[56:59], a[152:155]
    ds_read_b64_tr_b16 a[106:107], v4 offset:4608
    v_mfma_f32_16x16x32_bf16 a[156:159], a[72:75], a[44:47], a[156:159]
    v_mfma_f32_16x16x32_bf16 a[156:159], a[76:79], a[60:63], a[156:159]
    s_waitcnt lgkmcnt(6)
    v_mfma_f32_16x16x32_bf16 a[160:163], a[80:83], a[32:35], a[160:163]
    s_waitcnt vmcnt(18)
    v_mfma_f32_16x16x32_bf16 a[160:163], a[84:87], a[48:51], a[160:163]
    ds_read_b128 a[0:3], v14 offset:0
    v_mfma_f32_16x16x32_bf16 a[164:167], a[80:83], a[36:39], a[164:167]
    ds_read_b128 a[4:7], v14 offset:2048
    v_mfma_f32_16x16x32_bf16 a[164:167], a[84:87], a[52:55], a[164:167]
    ds_read_b128 a[8:11], v14 offset:4096
    ds_read_b128 a[12:15], v14 offset:6144
    s_waitcnt lgkmcnt(4)
    v_mfma_f32_16x16x32_bf16 a[176:179], a[88:91], a[32:35], a[176:179]
    ds_read_b128 a[16:19], v15 offset:0
    v_mfma_f32_16x16x32_bf16 a[176:179], a[92:95], a[48:51], a[176:179]
    ds_read_b128 a[20:23], v15 offset:2048
    v_mfma_f32_16x16x32_bf16 a[180:183], a[88:91], a[36:39], a[180:183]
    ds_read_b128 a[24:27], v15 offset:4096
    v_mfma_f32_16x16x32_bf16 a[180:183], a[92:95], a[52:55], a[180:183]
    ds_read_b128 a[28:31], v15 offset:6144
    v_mfma_f32_16x16x32_bf16 a[232:235], a[100:103], a[96:99], a[232:235]
    v_mfma_f32_16x16x32_bf16 a[232:235], a[104:107], a[96:99], a[232:235]
    v_mfma_f32_16x16x32_bf16 a[192:195], a[96:99], a[32:35], a[192:195]
    s_waitcnt vmcnt(26)
    v_mfma_f32_16x16x32_bf16 a[192:195], a[96:99], a[48:51], a[192:195]
    s_barrier
    v_mfma_f32_16x16x32_bf16 a[208:211], a[32:35], a[32:35], a[208:211]
    ds_read_b64_tr_b16 a[64:65], v16 offset:24576
    v_mfma_f32_16x16x32_bf16 a[208:211], a[48:51], a[48:51], a[208:211]
    ds_read_b64_tr_b16 a[66:67], v16 offset:25600
    v_mfma_f32_16x16x32_bf16 a[196:199], a[96:99], a[36:39], a[196:199]
    ds_read_b64_tr_b16 a[68:69], v16 offset:32768
    v_mfma_f32_16x16x32_bf16 a[196:199], a[96:99], a[52:55], a[196:199]
    ds_read_b64_tr_b16 a[70:71], v16 offset:33792
    s_add_u32 s78, s28, 6
    s_and_b32 s78, s78, 7
    s_lshl_b32 s79, s78, 19
    s_add_u32 s76, s62, s79
    s_mul_i32 s79, s78, 176128
    s_add_u32 s77, s63, s79
    s_add_u32 m0, s24, 65536
    v_mfma_f32_16x16x32_bf16 a[212:215], a[36:39], a[36:39], a[212:215]
    buffer_load_dwordx4 v8, s[40:43], s76 offen offset:0 lds
    v_mfma_f32_16x16x32_bf16 a[212:215], a[52:55], a[52:55], a[212:215]
    buffer_load_dwordx4 v9, s[40:43], s76 offen offset:1024 lds
    v_mfma_f32_16x16x32_bf16 a[200:203], a[96:99], a[40:43], a[200:203]
    ds_read_b64_tr_b16 a[72:73], v16 offset:24584
    v_mfma_f32_16x16x32_bf16 a[200:203], a[96:99], a[56:59], a[200:203]
    ds_read_b64_tr_b16 a[74:75], v16 offset:25608
    v_mfma_f32_16x16x32_bf16 a[216:219], a[40:43], a[40:43], a[216:219]
    ds_read_b64_tr_b16 a[76:77], v16 offset:32776
    v_mfma_f32_16x16x32_bf16 a[216:219], a[56:59], a[56:59], a[216:219]
    ds_read_b64_tr_b16 a[78:79], v16 offset:33800
    v_mfma_f32_16x16x32_bf16 a[204:207], a[96:99], a[44:47], a[204:207]
    buffer_load_dwordx4 v10, s[40:43], s76 offen offset:2048 lds
    v_mfma_f32_16x16x32_bf16 a[204:207], a[96:99], a[60:63], a[204:207]
    buffer_load_dwordx4 v11, s[40:43], s76 offen offset:3072 lds
    s_add_u32 m0, s64, 81920
    v_mfma_f32_16x16x32_bf16 a[220:223], a[44:47], a[44:47], a[220:223]
    buffer_load_dwordx4 v12, s[44:47], s77 offen offset:0 lds
    v_mfma_f32_16x16x32_bf16 a[220:223], a[60:63], a[60:63], a[220:223]
    buffer_load_dwordx4 v13, s[44:47], s77 offen offset:1024 lds
    s_waitcnt lgkmcnt(4)
    v_mfma_f32_16x16x32_bf16 v[128:131], a[64:67], a[0:3], v[128:131]
    ds_read_b64_tr_b16 a[80:81], v17 offset:24576
    v_mfma_f32_16x16x32_bf16 v[128:131], a[68:71], a[16:19], v[128:131]
    ds_read_b64_tr_b16 a[82:83], v17 offset:25600
    v_mfma_f32_16x16x32_bf16 v[160:163], a[64:67], a[4:7], v[160:163]
    ds_read_b64_tr_b16 a[84:85], v17 offset:32768
    v_mfma_f32_16x16x32_bf16 v[160:163], a[68:71], a[20:23], v[160:163]
    ds_read_b64_tr_b16 a[86:87], v17 offset:33792
    s_add_u32 s78, s28, 6
    s_and_b32 s78, s78, 7
    s_lshl_b32 s78, s78, 7
    s_add_u32 s74, s61, s78
    s_xor_b32 s75, s74, 0x8000
    s_add_u32 m0, s60, 0
    v_mfma_f32_16x16x32_bf16 v[192:195], a[64:67], a[8:11], v[192:195]
    buffer_load_dwordx4 v0, s[16:19], s74 offen offset:0 lds
    v_mfma_f32_16x16x32_bf16 v[192:195], a[68:71], a[24:27], v[192:195]
    buffer_load_dwordx4 v1, s[16:19], s74 offen offset:1024 lds
    v_mfma_f32_16x16x32_bf16 v[224:227], a[64:67], a[12:15], v[224:227]
    v_mfma_f32_16x16x32_bf16 v[224:227], a[68:71], a[28:31], v[224:227]
    v_mfma_f32_16x16x32_bf16 a[224:227], a[64:67], a[96:99], a[224:227]
    v_mfma_f32_16x16x32_bf16 a[224:227], a[68:71], a[96:99], a[224:227]
    s_waitcnt lgkmcnt(4)
    v_mfma_f32_16x16x32_bf16 v[132:135], a[72:75], a[0:3], v[132:135]
    ds_read_b64_tr_b16 a[88:89], v17 offset:24584
    v_mfma_f32_16x16x32_bf16 v[132:135], a[76:79], a[16:19], v[132:135]
    ds_read_b64_tr_b16 a[90:91], v17 offset:25608
    v_mfma_f32_16x16x32_bf16 v[164:167], a[72:75], a[4:7], v[164:167]
    ds_read_b64_tr_b16 a[92:93], v17 offset:32776
    v_mfma_f32_16x16x32_bf16 v[164:167], a[76:79], a[20:23], v[164:167]
    ds_read_b64_tr_b16 a[94:95], v17 offset:33800
    v_mfma_f32_16x16x32_bf16 v[196:199], a[72:75], a[8:11], v[196:199]
    buffer_load_dwordx4 v2, s[16:19], s74 offen offset:2048 lds
    v_mfma_f32_16x16x32_bf16 v[196:199], a[76:79], a[24:27], v[196:199]
    buffer_load_dwordx4 v3, s[16:19], s74 offen offset:3072 lds
    v_mfma_f32_16x16x32_bf16 v[228:231], a[72:75], a[12:15], v[228:231]
    v_mfma_f32_16x16x32_bf16 v[228:231], a[76:79], a[28:31], v[228:231]
    v_mfma_f32_16x16x32_bf16 a[228:231], a[72:75], a[96:99], a[228:231]
    v_mfma_f32_16x16x32_bf16 a[228:231], a[76:79], a[96:99], a[228:231]
    s_waitcnt lgkmcnt(4)
    v_mfma_f32_16x16x32_bf16 v[136:139], a[80:83], a[0:3], v[136:139]
    ds_read_b64_tr_b16 a[64:65], v18 offset:24576
    v_mfma_f32_16x16x32_bf16 v[136:139], a[84:87], a[16:19], v[136:139]
    ds_read_b64_tr_b16 a[66:67], v18 offset:25600
    v_mfma_f32_16x16x32_bf16 v[168:171], a[80:83], a[4:7], v[168:171]
    ds_read_b64_tr_b16 a[68:69], v18 offset:32768
    v_mfma_f32_16x16x32_bf16 v[168:171], a[84:87], a[20:23], v[168:171]
    ds_read_b64_tr_b16 a[70:71], v18 offset:33792
    s_add_u32 m0, s60, 4096
    v_mfma_f32_16x16x32_bf16 v[200:203], a[80:83], a[8:11], v[200:203]
    buffer_load_dwordx4 v0, s[16:19], s75 offen offset:0 lds
    v_mfma_f32_16x16x32_bf16 v[200:203], a[84:87], a[24:27], v[200:203]
    buffer_load_dwordx4 v1, s[16:19], s75 offen offset:1024 lds
    v_mfma_f32_16x16x32_bf16 v[232:235], a[80:83], a[12:15], v[232:235]
    v_mfma_f32_16x16x32_bf16 v[232:235], a[84:87], a[28:31], v[232:235]
    s_waitcnt lgkmcnt(4)
    v_mfma_f32_16x16x32_bf16 v[140:143], a[88:91], a[0:3], v[140:143]
    ds_read_b64_tr_b16 a[72:73], v18 offset:24584
    v_mfma_f32_16x16x32_bf16 v[140:143], a[92:95], a[16:19], v[140:143]
    ds_read_b64_tr_b16 a[74:75], v18 offset:25608
    v_mfma_f32_16x16x32_bf16 v[172:175], a[88:91], a[4:7], v[172:175]
    ds_read_b64_tr_b16 a[76:77], v18 offset:32776
    v_mfma_f32_16x16x32_bf16 v[172:175], a[92:95], a[20:23], v[172:175]
    ds_read_b64_tr_b16 a[78:79], v18 offset:33800
    v_mfma_f32_16x16x32_bf16 v[204:207], a[88:91], a[8:11], v[204:207]
    buffer_load_dwordx4 v2, s[16:19], s75 offen offset:2048 lds
    v_mfma_f32_16x16x32_bf16 v[204:207], a[92:95], a[24:27], v[204:207]
    buffer_load_dwordx4 v3, s[16:19], s75 offen offset:3072 lds
    v_mfma_f32_16x16x32_bf16 v[236:239], a[88:91], a[12:15], v[236:239]
    v_mfma_f32_16x16x32_bf16 v[236:239], a[92:95], a[28:31], v[236:239]
    s_waitcnt lgkmcnt(4)
    v_mfma_f32_16x16x32_bf16 v[144:147], a[64:67], a[0:3], v[144:147]
    ds_read_b64_tr_b16 a[80:81], v19 offset:24576
    v_mfma_f32_16x16x32_bf16 v[144:147], a[68:71], a[16:19], v[144:147]
    ds_read_b64_tr_b16 a[82:83], v19 offset:25600
    v_mfma_f32_16x16x32_bf16 v[176:179], a[64:67], a[4:7], v[176:179]
    ds_read_b64_tr_b16 a[84:85], v19 offset:32768
    v_mfma_f32_16x16x32_bf16 v[176:179], a[68:71], a[20:23], v[176:179]
    ds_read_b64_tr_b16 a[86:87], v19 offset:33792
    v_mfma_f32_16x16x32_bf16 v[208:211], a[64:67], a[8:11], v[208:211]
    v_mfma_f32_16x16x32_bf16 v[208:211], a[68:71], a[24:27], v[208:211]
    v_mfma_f32_16x16x32_bf16 v[240:243], a[64:67], a[12:15], v[240:243]
    v_mfma_f32_16x16x32_bf16 v[240:243], a[68:71], a[28:31], v[240:243]
    s_waitcnt lgkmcnt(4)
    v_mfma_f32_16x16x32_bf16 v[148:151], a[72:75], a[0:3], v[148:151]
    ds_read_b64_tr_b16 a[88:89], v19 offset:24584
    v_mfma_f32_16x16x32_bf16 v[148:151], a[76:79], a[16:19], v[148:151]
    ds_read_b64_tr_b16 a[90:91], v19 offset:25608
    v_mfma_f32_16x16x32_bf16 v[180:183], a[72:75], a[4:7], v[180:183]
    ds_read_b64_tr_b16 a[92:93], v19 offset:32776
    v_mfma_f32_16x16x32_bf16 v[180:183], a[76:79], a[20:23], v[180:183]
    ds_read_b64_tr_b16 a[94:95], v19 offset:33800
    v_mfma_f32_16x16x32_bf16 v[212:215], a[72:75], a[8:11], v[212:215]
    v_mfma_f32_16x16x32_bf16 v[212:215], a[76:79], a[24:27], v[212:215]
    v_mfma_f32_16x16x32_bf16 v[244:247], a[72:75], a[12:15], v[244:247]
    v_mfma_f32_16x16x32_bf16 v[244:247], a[76:79], a[28:31], v[244:247]
    s_waitcnt lgkmcnt(4)
    v_mfma_f32_16x16x32_bf16 v[152:155], a[80:83], a[0:3], v[152:155]
    ds_read_b64_tr_b16 a[64:65], v20 offset:24576
    v_mfma_f32_16x16x32_bf16 v[152:155], a[84:87], a[16:19], v[152:155]
    ds_read_b64_tr_b16 a[66:67], v20 offset:25088
    v_mfma_f32_16x16x32_bf16 v[184:187], a[80:83], a[4:7], v[184:187]
    ds_read_b64_tr_b16 a[68:69], v20 offset:28672
    v_mfma_f32_16x16x32_bf16 v[184:187], a[84:87], a[20:23], v[184:187]
    ds_read_b64_tr_b16 a[70:71], v20 offset:29184
    v_mfma_f32_16x16x32_bf16 v[216:219], a[80:83], a[8:11], v[216:219]
    v_mfma_f32_16x16x32_bf16 v[216:219], a[84:87], a[24:27], v[216:219]
    v_mfma_f32_16x16x32_bf16 v[248:251], a[80:83], a[12:15], v[248:251]
    v_mfma_f32_16x16x32_bf16 v[248:251], a[84:87], a[28:31], v[248:251]
    s_waitcnt lgkmcnt(4)
    v_mfma_f32_16x16x32_bf16 v[156:159], a[88:91], a[0:3], v[156:159]
    ds_read_b64_tr_b16 a[72:73], v21 offset:24576
    v_mfma_f32_16x16x32_bf16 v[156:159], a[92:95], a[16:19], v[156:159]
    ds_read_b64_tr_b16 a[74:75], v21 offset:25088
    v_mfma_f32_16x16x32_bf16 v[188:191], a[88:91], a[4:7], v[188:191]
    ds_read_b64_tr_b16 a[76:77], v21 offset:28672
    v_mfma_f32_16x16x32_bf16 v[188:191], a[92:95], a[20:23], v[188:191]
    ds_read_b64_tr_b16 a[78:79], v21 offset:29184
    v_mfma_f32_16x16x32_bf16 v[220:223], a[88:91], a[8:11], v[220:223]
    v_mfma_f32_16x16x32_bf16 v[220:223], a[92:95], a[24:27], v[220:223]
    v_mfma_f32_16x16x32_bf16 v[252:255], a[88:91], a[12:15], v[252:255]
    v_mfma_f32_16x16x32_bf16 v[252:255], a[92:95], a[28:31], v[252:255]
    s_waitcnt lgkmcnt(4)
    v_mfma_f32_16x16x32_bf16 a[128:131], a[64:67], a[0:3], a[128:131]
    ds_read_b64_tr_b16 a[80:81], v22 offset:24576
    v_mfma_f32_16x16x32_bf16 a[128:131], a[68:71], a[16:19], a[128:131]
    ds_read_b64_tr_b16 a[82:83], v22 offset:25088
    v_mfma_f32_16x16x32_bf16 a[132:135], a[64:67], a[4:7], a[132:135]
    ds_read_b64_tr_b16 a[84:85], v22 offset:28672
    v_mfma_f32_16x16x32_bf16 a[132:135], a[68:71], a[20:23], a[132:135]
    ds_read_b64_tr_b16 a[86:87], v22 offset:29184
    v_mfma_f32_16x16x32_bf16 a[136:139], a[64:67], a[8:11], a[136:139]
    ds_read_b64_tr_b16 a[100:101], v4 offset:24576
    v_mfma_f32_16x16x32_bf16 a[136:139], a[68:71], a[24:27], a[136:139]
    ds_read_b64_tr_b16 a[102:103], v4 offset:25088
    v_mfma_f32_16x16x32_bf16 a[140:143], a[64:67], a[12:15], a[140:143]
    v_mfma_f32_16x16x32_bf16 a[140:143], a[68:71], a[28:31], a[140:143]
    s_waitcnt lgkmcnt(6)
    v_mfma_f32_16x16x32_bf16 a[144:147], a[72:75], a[0:3], a[144:147]
    ds_read_b64_tr_b16 a[88:89], v23 offset:24576
    v_mfma_f32_16x16x32_bf16 a[144:147], a[76:79], a[16:19], a[144:147]
    ds_read_b64_tr_b16 a[90:91], v23 offset:25088
    v_mfma_f32_16x16x32_bf16 a[148:151], a[72:75], a[4:7], a[148:151]
    ds_read_b64_tr_b16 a[92:93], v23 offset:28672
    v_mfma_f32_16x16x32_bf16 a[148:151], a[76:79], a[20:23], a[148:151]
    ds_read_b64_tr_b16 a[94:95], v23 offset:29184
    v_mfma_f32_16x16x32_bf16 a[152:155], a[72:75], a[8:11], a[152:155]
    ds_read_b64_tr_b16 a[104:105], v4 offset:28672
    v_mfma_f32_16x16x32_bf16 a[152:155], a[76:79], a[24:27], a[152:155]
    ds_read_b64_tr_b16 a[106:107], v4 offset:29184
    v_mfma_f32_16x16x32_bf16 a[156:159], a[72:75], a[12:15], a[156:159]
    v_mfma_f32_16x16x32_bf16 a[156:159], a[76:79], a[28:31], a[156:159]
    s_waitcnt lgkmcnt(6)
    v_mfma_f32_16x16x32_bf16 a[160:163], a[80:83], a[0:3], a[160:163]
    s_waitcnt vmcnt(14)
    v_mfma_f32_16x16x32_bf16 a[160:163], a[84:87], a[16:19], a[160:163]
    ds_read_b128 a[32:35], v14 offset:32768
    v_mfma_f32_16x16x32_bf16 a[164:167], a[80:83], a[4:7], a[164:167]
    ds_read_b128 a[36:39], v14 offset:34816
    v_mfma_f32_16x16x32_bf16 a[164:167], a[84:87], a[20:23], a[164:167]
    ds_read_b128 a[40:43], v14 offset:36864
    ds_read_b128 a[44:47], v14 offset:38912
    s_waitcnt lgkmcnt(4)
    v_mfma_f32_16x16x32_bf16 a[176:179], a[88:91], a[0:3], a[176:179]
    ds_read_b128 a[48:51], v15 offset:32768
    v_mfma_f32_16x16x32_bf16 a[176:179], a[92:95], a[16:19], a[176:179]
    ds_read_b128 a[52:55], v15 offset:34816
    v_mfma_f32_16x16x32_bf16 a[180:183], a[88:91], a[4:7], a[180:183]
    ds_read_b128 a[56:59], v15 offset:36864
    v_mfma_f32_16x16x32_bf16 a[180:183], a[92:95], a[20:23], a[180:183]
    ds_read_b128 a[60:63], v15 offset:38912
    v_mfma_f32_16x16x32_bf16 a[232:235], a[100:103], a[96:99], a[232:235]
    v_mfma_f32_16x16x32_bf16 a[232:235], a[104:107], a[96:99], a[232:235]
    v_mfma_f32_16x16x32_bf16 a[192:195], a[96:99], a[0:3], a[192:195]
    s_waitcnt vmcnt(22)
    v_mfma_f32_16x16x32_bf16 a[192:195], a[96:99], a[16:19], a[192:195]
    s_barrier
    v_mfma_f32_16x16x32_bf16 a[208:211], a[0:3], a[0:3], a[208:211]
    ds_read_b64_tr_b16 a[64:65], v16 offset:49152
    v_mfma_f32_16x16x32_bf16 a[208:211], a[16:19], a[16:19], a[208:211]
    ds_read_b64_tr_b16 a[66:67], v16 offset:50176
    v_mfma_f32_16x16x32_bf16 a[196:199], a[96:99], a[4:7], a[196:199]
    ds_read_b64_tr_b16 a[68:69], v16 offset:57344
    v_mfma_f32_16x16x32_bf16 a[196:199], a[96:99], a[20:23], a[196:199]
    ds_read_b64_tr_b16 a[70:71], v16 offset:58368
    s_add_u32 s78, s28, 7
    s_and_b32 s78, s78, 7
    s_lshl_b32 s79, s78, 19
    s_add_u32 s76, s62, s79
    s_mul_i32 s79, s78, 176128
    s_add_u32 s77, s63, s79
    s_add_u32 m0, s24, 90112
    v_mfma_f32_16x16x32_bf16 a[212:215], a[4:7], a[4:7], a[212:215]
    buffer_load_dwordx4 v8, s[40:43], s76 offen offset:0 lds
    v_mfma_f32_16x16x32_bf16 a[212:215], a[20:23], a[20:23], a[212:215]
    buffer_load_dwordx4 v9, s[40:43], s76 offen offset:1024 lds
    v_mfma_f32_16x16x32_bf16 a[200:203], a[96:99], a[8:11], a[200:203]
    ds_read_b64_tr_b16 a[72:73], v16 offset:49160
    v_mfma_f32_16x16x32_bf16 a[200:203], a[96:99], a[24:27], a[200:203]
    ds_read_b64_tr_b16 a[74:75], v16 offset:50184
    v_mfma_f32_16x16x32_bf16 a[216:219], a[8:11], a[8:11], a[216:219]
    ds_read_b64_tr_b16 a[76:77], v16 offset:57352
    v_mfma_f32_16x16x32_bf16 a[216:219], a[24:27], a[24:27], a[216:219]
    ds_read_b64_tr_b16 a[78:79], v16 offset:58376
    v_mfma_f32_16x16x32_bf16 a[204:207], a[96:99], a[12:15], a[204:207]
    buffer_load_dwordx4 v10, s[40:43], s76 offen offset:2048 lds
    v_mfma_f32_16x16x32_bf16 a[204:207], a[96:99], a[28:31], a[204:207]
    buffer_load_dwordx4 v11, s[40:43], s76 offen offset:3072 lds
    s_add_u32 m0, s64, 106496
    v_mfma_f32_16x16x32_bf16 a[220:223], a[12:15], a[12:15], a[220:223]
    buffer_load_dwordx4 v12, s[44:47], s77 offen offset:0 lds
    v_mfma_f32_16x16x32_bf16 a[220:223], a[28:31], a[28:31], a[220:223]
    buffer_load_dwordx4 v13, s[44:47], s77 offen offset:1024 lds
    s_waitcnt lgkmcnt(4)
    v_mfma_f32_16x16x32_bf16 v[128:131], a[64:67], a[32:35], v[128:131]
    ds_read_b64_tr_b16 a[80:81], v17 offset:49152
    v_mfma_f32_16x16x32_bf16 v[128:131], a[68:71], a[48:51], v[128:131]
    ds_read_b64_tr_b16 a[82:83], v17 offset:50176
    v_mfma_f32_16x16x32_bf16 v[160:163], a[64:67], a[36:39], v[160:163]
    ds_read_b64_tr_b16 a[84:85], v17 offset:57344
    v_mfma_f32_16x16x32_bf16 v[160:163], a[68:71], a[52:55], v[160:163]
    ds_read_b64_tr_b16 a[86:87], v17 offset:58368
    s_add_u32 s78, s28, 7
    s_and_b32 s78, s78, 7
    s_lshl_b32 s78, s78, 7
    s_add_u32 s74, s61, s78
    s_xor_b32 s75, s74, 0x8000
    s_add_u32 m0, s60, 32768
    v_mfma_f32_16x16x32_bf16 v[192:195], a[64:67], a[40:43], v[192:195]
    buffer_load_dwordx4 v0, s[16:19], s74 offen offset:0 lds
    v_mfma_f32_16x16x32_bf16 v[192:195], a[68:71], a[56:59], v[192:195]
    buffer_load_dwordx4 v1, s[16:19], s74 offen offset:1024 lds
    v_mfma_f32_16x16x32_bf16 v[224:227], a[64:67], a[44:47], v[224:227]
    v_mfma_f32_16x16x32_bf16 v[224:227], a[68:71], a[60:63], v[224:227]
    v_mfma_f32_16x16x32_bf16 a[224:227], a[64:67], a[96:99], a[224:227]
    v_mfma_f32_16x16x32_bf16 a[224:227], a[68:71], a[96:99], a[224:227]
    s_waitcnt lgkmcnt(4)
    v_mfma_f32_16x16x32_bf16 v[132:135], a[72:75], a[32:35], v[132:135]
    ds_read_b64_tr_b16 a[88:89], v17 offset:49160
    v_mfma_f32_16x16x32_bf16 v[132:135], a[76:79], a[48:51], v[132:135]
    ds_read_b64_tr_b16 a[90:91], v17 offset:50184
    v_mfma_f32_16x16x32_bf16 v[164:167], a[72:75], a[36:39], v[164:167]
    ds_read_b64_tr_b16 a[92:93], v17 offset:57352
    v_mfma_f32_16x16x32_bf16 v[164:167], a[76:79], a[52:55], v[164:167]
    ds_read_b64_tr_b16 a[94:95], v17 offset:58376
    v_mfma_f32_16x16x32_bf16 v[196:199], a[72:75], a[40:43], v[196:199]
    buffer_load_dwordx4 v2, s[16:19], s74 offen offset:2048 lds
    v_mfma_f32_16x16x32_bf16 v[196:199], a[76:79], a[56:59], v[196:199]
    buffer_load_dwordx4 v3, s[16:19], s74 offen offset:3072 lds
    v_mfma_f32_16x16x32_bf16 v[228:231], a[72:75], a[44:47], v[228:231]
    v_mfma_f32_16x16x32_bf16 v[228:231], a[76:79], a[60:63], v[228:231]
    v_mfma_f32_16x16x32_bf16 a[228:231], a[72:75], a[96:99], a[228:231]
    v_mfma_f32_16x16x32_bf16 a[228:231], a[76:79], a[96:99], a[228:231]
    s_waitcnt lgkmcnt(4)
    v_mfma_f32_16x16x32_bf16 v[136:139], a[80:83], a[32:35], v[136:139]
    ds_read_b64_tr_b16 a[64:65], v18 offset:49152
    v_mfma_f32_16x16x32_bf16 v[136:139], a[84:87], a[48:51], v[136:139]
    ds_read_b64_tr_b16 a[66:67], v18 offset:50176
    v_mfma_f32_16x16x32_bf16 v[168:171], a[80:83], a[36:39], v[168:171]
    ds_read_b64_tr_b16 a[68:69], v18 offset:57344
    v_mfma_f32_16x16x32_bf16 v[168:171], a[84:87], a[52:55], v[168:171]
    ds_read_b64_tr_b16 a[70:71], v18 offset:58368
    s_add_u32 m0, s60, 36864
    v_mfma_f32_16x16x32_bf16 v[200:203], a[80:83], a[40:43], v[200:203]
    buffer_load_dwordx4 v0, s[16:19], s75 offen offset:0 lds
    v_mfma_f32_16x16x32_bf16 v[200:203], a[84:87], a[56:59], v[200:203]
    buffer_load_dwordx4 v1, s[16:19], s75 offen offset:1024 lds
    v_mfma_f32_16x16x32_bf16 v[232:235], a[80:83], a[44:47], v[232:235]
    v_mfma_f32_16x16x32_bf16 v[232:235], a[84:87], a[60:63], v[232:235]
    s_waitcnt lgkmcnt(4)
    v_mfma_f32_16x16x32_bf16 v[140:143], a[88:91], a[32:35], v[140:143]
    ds_read_b64_tr_b16 a[72:73], v18 offset:49160
    v_mfma_f32_16x16x32_bf16 v[140:143], a[92:95], a[48:51], v[140:143]
    ds_read_b64_tr_b16 a[74:75], v18 offset:50184
    v_mfma_f32_16x16x32_bf16 v[172:175], a[88:91], a[36:39], v[172:175]
    ds_read_b64_tr_b16 a[76:77], v18 offset:57352
    v_mfma_f32_16x16x32_bf16 v[172:175], a[92:95], a[52:55], v[172:175]
    ds_read_b64_tr_b16 a[78:79], v18 offset:58376
    v_mfma_f32_16x16x32_bf16 v[204:207], a[88:91], a[40:43], v[204:207]
    buffer_load_dwordx4 v2, s[16:19], s75 offen offset:2048 lds
    v_mfma_f32_16x16x32_bf16 v[204:207], a[92:95], a[56:59], v[204:207]
    buffer_load_dwordx4 v3, s[16:19], s75 offen offset:3072 lds
    v_mfma_f32_16x16x32_bf16 v[236:239], a[88:91], a[44:47], v[236:239]
    v_mfma_f32_16x16x32_bf16 v[236:239], a[92:95], a[60:63], v[236:239]
    s_waitcnt lgkmcnt(4)
    v_mfma_f32_16x16x32_bf16 v[144:147], a[64:67], a[32:35], v[144:147]
    ds_read_b64_tr_b16 a[80:81], v19 offset:49152
    v_mfma_f32_16x16x32_bf16 v[144:147], a[68:71], a[48:51], v[144:147]
    ds_read_b64_tr_b16 a[82:83], v19 offset:50176
    v_mfma_f32_16x16x32_bf16 v[176:179], a[64:67], a[36:39], v[176:179]
    ds_read_b64_tr_b16 a[84:85], v19 offset:57344
    v_mfma_f32_16x16x32_bf16 v[176:179], a[68:71], a[52:55], v[176:179]
    ds_read_b64_tr_b16 a[86:87], v19 offset:58368
    v_mfma_f32_16x16x32_bf16 v[208:211], a[64:67], a[40:43], v[208:211]
    v_mfma_f32_16x16x32_bf16 v[208:211], a[68:71], a[56:59], v[208:211]
    v_mfma_f32_16x16x32_bf16 v[240:243], a[64:67], a[44:47], v[240:243]
    v_mfma_f32_16x16x32_bf16 v[240:243], a[68:71], a[60:63], v[240:243]
    s_waitcnt lgkmcnt(4)
    v_mfma_f32_16x16x32_bf16 v[148:151], a[72:75], a[32:35], v[148:151]
    ds_read_b64_tr_b16 a[88:89], v19 offset:49160
    v_mfma_f32_16x16x32_bf16 v[148:151], a[76:79], a[48:51], v[148:151]
    ds_read_b64_tr_b16 a[90:91], v19 offset:50184
    v_mfma_f32_16x16x32_bf16 v[180:183], a[72:75], a[36:39], v[180:183]
    ds_read_b64_tr_b16 a[92:93], v19 offset:57352
    v_mfma_f32_16x16x32_bf16 v[180:183], a[76:79], a[52:55], v[180:183]
    ds_read_b64_tr_b16 a[94:95], v19 offset:58376
    v_mfma_f32_16x16x32_bf16 v[212:215], a[72:75], a[40:43], v[212:215]
    v_mfma_f32_16x16x32_bf16 v[212:215], a[76:79], a[56:59], v[212:215]
    v_mfma_f32_16x16x32_bf16 v[244:247], a[72:75], a[44:47], v[244:247]
    v_mfma_f32_16x16x32_bf16 v[244:247], a[76:79], a[60:63], v[244:247]
    s_waitcnt lgkmcnt(4)
    v_mfma_f32_16x16x32_bf16 v[152:155], a[80:83], a[32:35], v[152:155]
    ds_read_b64_tr_b16 a[64:65], v20 offset:49152
    v_mfma_f32_16x16x32_bf16 v[152:155], a[84:87], a[48:51], v[152:155]
    ds_read_b64_tr_b16 a[66:67], v20 offset:49664
    v_mfma_f32_16x16x32_bf16 v[184:187], a[80:83], a[36:39], v[184:187]
    ds_read_b64_tr_b16 a[68:69], v20 offset:53248
    v_mfma_f32_16x16x32_bf16 v[184:187], a[84:87], a[52:55], v[184:187]
    ds_read_b64_tr_b16 a[70:71], v20 offset:53760
    v_mfma_f32_16x16x32_bf16 v[216:219], a[80:83], a[40:43], v[216:219]
    v_mfma_f32_16x16x32_bf16 v[216:219], a[84:87], a[56:59], v[216:219]
    v_mfma_f32_16x16x32_bf16 v[248:251], a[80:83], a[44:47], v[248:251]
    v_mfma_f32_16x16x32_bf16 v[248:251], a[84:87], a[60:63], v[248:251]
    s_waitcnt lgkmcnt(4)
    v_mfma_f32_16x16x32_bf16 v[156:159], a[88:91], a[32:35], v[156:159]
    ds_read_b64_tr_b16 a[72:73], v21 offset:49152
    v_mfma_f32_16x16x32_bf16 v[156:159], a[92:95], a[48:51], v[156:159]
    ds_read_b64_tr_b16 a[74:75], v21 offset:49664
    v_mfma_f32_16x16x32_bf16 v[188:191], a[88:91], a[36:39], v[188:191]
    ds_read_b64_tr_b16 a[76:77], v21 offset:53248
    v_mfma_f32_16x16x32_bf16 v[188:191], a[92:95], a[52:55], v[188:191]
    ds_read_b64_tr_b16 a[78:79], v21 offset:53760
    v_mfma_f32_16x16x32_bf16 v[220:223], a[88:91], a[40:43], v[220:223]
    v_mfma_f32_16x16x32_bf16 v[220:223], a[92:95], a[56:59], v[220:223]
    v_mfma_f32_16x16x32_bf16 v[252:255], a[88:91], a[44:47], v[252:255]
    v_mfma_f32_16x16x32_bf16 v[252:255], a[92:95], a[60:63], v[252:255]
    s_waitcnt lgkmcnt(4)
    v_mfma_f32_16x16x32_bf16 a[128:131], a[64:67], a[32:35], a[128:131]
    ds_read_b64_tr_b16 a[80:81], v22 offset:49152
    v_mfma_f32_16x16x32_bf16 a[128:131], a[68:71], a[48:51], a[128:131]
    ds_read_b64_tr_b16 a[82:83], v22 offset:49664
    v_mfma_f32_16x16x32_bf16 a[132:135], a[64:67], a[36:39], a[132:135]
    ds_read_b64_tr_b16 a[84:85], v22 offset:53248
    v_mfma_f32_16x16x32_bf16 a[132:135], a[68:71], a[52:55], a[132:135]
    ds_read_b64_tr_b16 a[86:87], v22 offset:53760
    v_mfma_f32_16x16x32_bf16 a[136:139], a[64:67], a[40:43], a[136:139]
    ds_read_b64_tr_b16 a[100:101], v4 offset:49152
    v_mfma_f32_16x16x32_bf16 a[136:139], a[68:71], a[56:59], a[136:139]
    ds_read_b64_tr_b16 a[102:103], v4 offset:49664
    v_mfma_f32_16x16x32_bf16 a[140:143], a[64:67], a[44:47], a[140:143]
    v_mfma_f32_16x16x32_bf16 a[140:143], a[68:71], a[60:63], a[140:143]
    s_waitcnt lgkmcnt(6)
    v_mfma_f32_16x16x32_bf16 a[144:147], a[72:75], a[32:35], a[144:147]
    ds_read_b64_tr_b16 a[88:89], v23 offset:49152
    v_mfma_f32_16x16x32_bf16 a[144:147], a[76:79], a[48:51], a[144:147]
    ds_read_b64_tr_b16 a[90:91], v23 offset:49664
    v_mfma_f32_16x16x32_bf16 a[148:151], a[72:75], a[36:39], a[148:151]
    ds_read_b64_tr_b16 a[92:93], v23 offset:53248
    v_mfma_f32_16x16x32_bf16 a[148:151], a[76:79], a[52:55], a[148:151]
    ds_read_b64_tr_b16 a[94:95], v23 offset:53760
    v_mfma_f32_16x16x32_bf16 a[152:155], a[72:75], a[40:43], a[152:155]
    ds_read_b64_tr_b16 a[104:105], v4 offset:53248
    v_mfma_f32_16x16x32_bf16 a[152:155], a[76:79], a[56:59], a[152:155]
    ds_read_b64_tr_b16 a[106:107], v4 offset:53760
    v_mfma_f32_16x16x32_bf16 a[156:159], a[72:75], a[44:47], a[156:159]
    v_mfma_f32_16x16x32_bf16 a[156:159], a[76:79], a[60:63], a[156:159]
    s_waitcnt lgkmcnt(6)
    v_mfma_f32_16x16x32_bf16 a[160:163], a[80:83], a[32:35], a[160:163]
    s_waitcnt vmcnt(14)
    v_mfma_f32_16x16x32_bf16 a[160:163], a[84:87], a[48:51], a[160:163]
    ds_read_b128 a[0:3], v14 offset:0
    v_mfma_f32_16x16x32_bf16 a[164:167], a[80:83], a[36:39], a[164:167]
    ds_read_b128 a[4:7], v14 offset:2048
    v_mfma_f32_16x16x32_bf16 a[164:167], a[84:87], a[52:55], a[164:167]
    ds_read_b128 a[8:11], v14 offset:4096
    ds_read_b128 a[12:15], v14 offset:6144
    s_waitcnt lgkmcnt(4)
    v_mfma_f32_16x16x32_bf16 a[176:179], a[88:91], a[32:35], a[176:179]
    ds_read_b128 a[16:19], v15 offset:0
    v_mfma_f32_16x16x32_bf16 a[176:179], a[92:95], a[48:51], a[176:179]
    ds_read_b128 a[20:23], v15 offset:2048
    v_mfma_f32_16x16x32_bf16 a[180:183], a[88:91], a[36:39], a[180:183]
    ds_read_b128 a[24:27], v15 offset:4096
    v_mfma_f32_16x16x32_bf16 a[180:183], a[92:95], a[52:55], a[180:183]
    ds_read_b128 a[28:31], v15 offset:6144
    v_mfma_f32_16x16x32_bf16 a[232:235], a[100:103], a[96:99], a[232:235]
    v_mfma_f32_16x16x32_bf16 a[232:235], a[104:107], a[96:99], a[232:235]
    v_mfma_f32_16x16x32_bf16 a[192:195], a[96:99], a[32:35], a[192:195]
    s_waitcnt vmcnt(22)
    v_mfma_f32_16x16x32_bf16 a[192:195], a[96:99], a[48:51], a[192:195]
    s_barrier
    v_mfma_f32_16x16x32_bf16 a[208:211], a[32:35], a[32:35], a[208:211]
    ds_read_b64_tr_b16 a[64:65], v16 offset:0
    v_mfma_f32_16x16x32_bf16 a[208:211], a[48:51], a[48:51], a[208:211]
    ds_read_b64_tr_b16 a[66:67], v16 offset:1024
    v_mfma_f32_16x16x32_bf16 a[196:199], a[96:99], a[36:39], a[196:199]
    ds_read_b64_tr_b16 a[68:69], v16 offset:8192
    v_mfma_f32_16x16x32_bf16 a[196:199], a[96:99], a[52:55], a[196:199]
    ds_read_b64_tr_b16 a[70:71], v16 offset:9216
    v_mfma_f32_16x16x32_bf16 a[212:215], a[36:39], a[36:39], a[212:215]
    v_mfma_f32_16x16x32_bf16 a[212:215], a[52:55], a[52:55], a[212:215]
    v_mfma_f32_16x16x32_bf16 a[200:203], a[96:99], a[40:43], a[200:203]
    ds_read_b64_tr_b16 a[72:73], v16 offset:8
    v_mfma_f32_16x16x32_bf16 a[200:203], a[96:99], a[56:59], a[200:203]
    ds_read_b64_tr_b16 a[74:75], v16 offset:1032
    v_mfma_f32_16x16x32_bf16 a[216:219], a[40:43], a[40:43], a[216:219]
    ds_read_b64_tr_b16 a[76:77], v16 offset:8200
    v_mfma_f32_16x16x32_bf16 a[216:219], a[56:59], a[56:59], a[216:219]
    ds_read_b64_tr_b16 a[78:79], v16 offset:9224
    v_mfma_f32_16x16x32_bf16 a[204:207], a[96:99], a[44:47], a[204:207]
    v_mfma_f32_16x16x32_bf16 a[204:207], a[96:99], a[60:63], a[204:207]
    v_mfma_f32_16x16x32_bf16 a[220:223], a[44:47], a[44:47], a[220:223]
    v_mfma_f32_16x16x32_bf16 a[220:223], a[60:63], a[60:63], a[220:223]
    s_waitcnt lgkmcnt(4)
    v_mfma_f32_16x16x32_bf16 v[128:131], a[64:67], a[0:3], v[128:131]
    ds_read_b64_tr_b16 a[80:81], v17 offset:0
    v_mfma_f32_16x16x32_bf16 v[128:131], a[68:71], a[16:19], v[128:131]
    ds_read_b64_tr_b16 a[82:83], v17 offset:1024
    v_mfma_f32_16x16x32_bf16 v[160:163], a[64:67], a[4:7], v[160:163]
    ds_read_b64_tr_b16 a[84:85], v17 offset:8192
    v_mfma_f32_16x16x32_bf16 v[160:163], a[68:71], a[20:23], v[160:163]
    ds_read_b64_tr_b16 a[86:87], v17 offset:9216
    v_mfma_f32_16x16x32_bf16 v[192:195], a[64:67], a[8:11], v[192:195]
    v_mfma_f32_16x16x32_bf16 v[192:195], a[68:71], a[24:27], v[192:195]
    v_mfma_f32_16x16x32_bf16 v[224:227], a[64:67], a[12:15], v[224:227]
    v_mfma_f32_16x16x32_bf16 v[224:227], a[68:71], a[28:31], v[224:227]
    v_mfma_f32_16x16x32_bf16 a[224:227], a[64:67], a[96:99], a[224:227]
    v_mfma_f32_16x16x32_bf16 a[224:227], a[68:71], a[96:99], a[224:227]
    s_waitcnt lgkmcnt(4)
    v_mfma_f32_16x16x32_bf16 v[132:135], a[72:75], a[0:3], v[132:135]
    ds_read_b64_tr_b16 a[88:89], v17 offset:8
    v_mfma_f32_16x16x32_bf16 v[132:135], a[76:79], a[16:19], v[132:135]
    ds_read_b64_tr_b16 a[90:91], v17 offset:1032
    v_mfma_f32_16x16x32_bf16 v[164:167], a[72:75], a[4:7], v[164:167]
    ds_read_b64_tr_b16 a[92:93], v17 offset:8200
    v_mfma_f32_16x16x32_bf16 v[164:167], a[76:79], a[20:23], v[164:167]
    ds_read_b64_tr_b16 a[94:95], v17 offset:9224
    v_mfma_f32_16x16x32_bf16 v[196:199], a[72:75], a[8:11], v[196:199]
    v_mfma_f32_16x16x32_bf16 v[196:199], a[76:79], a[24:27], v[196:199]
    v_mfma_f32_16x16x32_bf16 v[228:231], a[72:75], a[12:15], v[228:231]
    v_mfma_f32_16x16x32_bf16 v[228:231], a[76:79], a[28:31], v[228:231]
    v_mfma_f32_16x16x32_bf16 a[228:231], a[72:75], a[96:99], a[228:231]
    v_mfma_f32_16x16x32_bf16 a[228:231], a[76:79], a[96:99], a[228:231]
    s_waitcnt lgkmcnt(4)
    v_mfma_f32_16x16x32_bf16 v[136:139], a[80:83], a[0:3], v[136:139]
    ds_read_b64_tr_b16 a[64:65], v18 offset:0
    v_mfma_f32_16x16x32_bf16 v[136:139], a[84:87], a[16:19], v[136:139]
    ds_read_b64_tr_b16 a[66:67], v18 offset:1024
    v_mfma_f32_16x16x32_bf16 v[168:171], a[80:83], a[4:7], v[168:171]
    ds_read_b64_tr_b16 a[68:69], v18 offset:8192
    v_mfma_f32_16x16x32_bf16 v[168:171], a[84:87], a[20:23], v[168:171]
    ds_read_b64_tr_b16 a[70:71], v18 offset:9216
    v_mfma_f32_16x16x32_bf16 v[200:203], a[80:83], a[8:11], v[200:203]
    v_mfma_f32_16x16x32_bf16 v[200:203], a[84:87], a[24:27], v[200:203]
    v_mfma_f32_16x16x32_bf16 v[232:235], a[80:83], a[12:15], v[232:235]
    v_mfma_f32_16x16x32_bf16 v[232:235], a[84:87], a[28:31], v[232:235]
    s_waitcnt lgkmcnt(4)
    v_mfma_f32_16x16x32_bf16 v[140:143], a[88:91], a[0:3], v[140:143]
    ds_read_b64_tr_b16 a[72:73], v18 offset:8
    v_mfma_f32_16x16x32_bf16 v[140:143], a[92:95], a[16:19], v[140:143]
    ds_read_b64_tr_b16 a[74:75], v18 offset:1032
    v_mfma_f32_16x16x32_bf16 v[172:175], a[88:91], a[4:7], v[172:175]
    ds_read_b64_tr_b16 a[76:77], v18 offset:8200
    v_mfma_f32_16x16x32_bf16 v[172:175], a[92:95], a[20:23], v[172:175]
    ds_read_b64_tr_b16 a[78:79], v18 offset:9224
    v_mfma_f32_16x16x32_bf16 v[204:207], a[88:91], a[8:11], v[204:207]
    v_mfma_f32_16x16x32_bf16 v[204:207], a[92:95], a[24:27], v[204:207]
    v_mfma_f32_16x16x32_bf16 v[236:239], a[88:91], a[12:15], v[236:239]
    v_mfma_f32_16x16x32_bf16 v[236:239], a[92:95], a[28:31], v[236:239]
    s_waitcnt lgkmcnt(4)
    v_mfma_f32_16x16x32_bf16 v[144:147], a[64:67], a[0:3], v[144:147]
    ds_read_b64_tr_b16 a[80:81], v19 offset:0
    v_mfma_f32_16x16x32_bf16 v[144:147], a[68:71], a[16:19], v[144:147]
    ds_read_b64_tr_b16 a[82:83], v19 offset:1024
    v_mfma_f32_16x16x32_bf16 v[176:179], a[64:67], a[4:7], v[176:179]
    ds_read_b64_tr_b16 a[84:85], v19 offset:8192
    v_mfma_f32_16x16x32_bf16 v[176:179], a[68:71], a[20:23], v[176:179]
    ds_read_b64_tr_b16 a[86:87], v19 offset:9216
    s_add_u32 m0, s24, 139264
    v_mfma_f32_16x16x32_bf16 v[208:211], a[64:67], a[8:11], v[208:211]
    buffer_load_dwordx4 v92, s[48:51], s23 offen offset:0 lds
    v_mfma_f32_16x16x32_bf16 v[208:211], a[68:71], a[24:27], v[208:211]
    buffer_load_dwordx4 v93, s[48:51], s23 offen offset:1024 lds
    v_mfma_f32_16x16x32_bf16 v[240:243], a[64:67], a[12:15], v[240:243]
    buffer_load_dwordx4 v94, s[48:51], s23 offen offset:2048 lds
    v_mfma_f32_16x16x32_bf16 v[240:243], a[68:71], a[28:31], v[240:243]
    buffer_load_dwordx4 v95, s[48:51], s23 offen offset:3072 lds
    s_waitcnt lgkmcnt(4)
    v_mfma_f32_16x16x32_bf16 v[148:151], a[72:75], a[0:3], v[148:151]
    ds_read_b64_tr_b16 a[88:89], v19 offset:8
    v_mfma_f32_16x16x32_bf16 v[148:151], a[76:79], a[16:19], v[148:151]
    ds_read_b64_tr_b16 a[90:91], v19 offset:1032
    v_mfma_f32_16x16x32_bf16 v[180:183], a[72:75], a[4:7], v[180:183]
    ds_read_b64_tr_b16 a[92:93], v19 offset:8200
    v_mfma_f32_16x16x32_bf16 v[180:183], a[76:79], a[20:23], v[180:183]
    ds_read_b64_tr_b16 a[94:95], v19 offset:9224
    v_mfma_f32_16x16x32_bf16 v[212:215], a[72:75], a[8:11], v[212:215]
    v_mfma_f32_16x16x32_bf16 v[212:215], a[76:79], a[24:27], v[212:215]
    v_mfma_f32_16x16x32_bf16 v[244:247], a[72:75], a[12:15], v[244:247]
    v_mfma_f32_16x16x32_bf16 v[244:247], a[76:79], a[28:31], v[244:247]
    s_waitcnt lgkmcnt(4)
    v_mfma_f32_16x16x32_bf16 v[152:155], a[80:83], a[0:3], v[152:155]
    ds_read_b64_tr_b16 a[64:65], v20 offset:0
    v_mfma_f32_16x16x32_bf16 v[152:155], a[84:87], a[16:19], v[152:155]
    ds_read_b64_tr_b16 a[66:67], v20 offset:512
    v_mfma_f32_16x16x32_bf16 v[184:187], a[80:83], a[4:7], v[184:187]
    ds_read_b64_tr_b16 a[68:69], v20 offset:4096
    v_mfma_f32_16x16x32_bf16 v[184:187], a[84:87], a[20:23], v[184:187]
    ds_read_b64_tr_b16 a[70:71], v20 offset:4608
    v_mfma_f32_16x16x32_bf16 v[216:219], a[80:83], a[8:11], v[216:219]
    v_mfma_f32_16x16x32_bf16 v[216:219], a[84:87], a[24:27], v[216:219]
    v_mfma_f32_16x16x32_bf16 v[248:251], a[80:83], a[12:15], v[248:251]
    v_mfma_f32_16x16x32_bf16 v[248:251], a[84:87], a[28:31], v[248:251]
    s_waitcnt lgkmcnt(4)
    v_mfma_f32_16x16x32_bf16 v[156:159], a[88:91], a[0:3], v[156:159]
    ds_read_b64_tr_b16 a[72:73], v21 offset:0
    v_mfma_f32_16x16x32_bf16 v[156:159], a[92:95], a[16:19], v[156:159]
    ds_read_b64_tr_b16 a[74:75], v21 offset:512
    v_mfma_f32_16x16x32_bf16 v[188:191], a[88:91], a[4:7], v[188:191]
    ds_read_b64_tr_b16 a[76:77], v21 offset:4096
    v_mfma_f32_16x16x32_bf16 v[188:191], a[92:95], a[20:23], v[188:191]
    ds_read_b64_tr_b16 a[78:79], v21 offset:4608
    v_mfma_f32_16x16x32_bf16 v[220:223], a[88:91], a[8:11], v[220:223]
    v_mfma_f32_16x16x32_bf16 v[220:223], a[92:95], a[24:27], v[220:223]
    v_mfma_f32_16x16x32_bf16 v[252:255], a[88:91], a[12:15], v[252:255]
    v_mfma_f32_16x16x32_bf16 v[252:255], a[92:95], a[28:31], v[252:255]
    s_waitcnt lgkmcnt(4)
    v_mfma_f32_16x16x32_bf16 a[128:131], a[64:67], a[0:3], a[128:131]
    ds_read_b64_tr_b16 a[80:81], v22 offset:0
    v_mfma_f32_16x16x32_bf16 a[128:131], a[68:71], a[16:19], a[128:131]
    ds_read_b64_tr_b16 a[82:83], v22 offset:512
    v_mfma_f32_16x16x32_bf16 a[132:135], a[64:67], a[4:7], a[132:135]
    ds_read_b64_tr_b16 a[84:85], v22 offset:4096
    v_mfma_f32_16x16x32_bf16 a[132:135], a[68:71], a[20:23], a[132:135]
    ds_read_b64_tr_b16 a[86:87], v22 offset:4608
    v_mfma_f32_16x16x32_bf16 a[136:139], a[64:67], a[8:11], a[136:139]
    ds_read_b64_tr_b16 a[100:101], v4 offset:0
    v_mfma_f32_16x16x32_bf16 a[136:139], a[68:71], a[24:27], a[136:139]
    ds_read_b64_tr_b16 a[102:103], v4 offset:512
    v_mfma_f32_16x16x32_bf16 a[140:143], a[64:67], a[12:15], a[140:143]
    v_mfma_f32_16x16x32_bf16 a[140:143], a[68:71], a[28:31], a[140:143]
    s_waitcnt lgkmcnt(6)
    v_mfma_f32_16x16x32_bf16 a[144:147], a[72:75], a[0:3], a[144:147]
    ds_read_b64_tr_b16 a[88:89], v23 offset:0
    v_mfma_f32_16x16x32_bf16 a[144:147], a[76:79], a[16:19], a[144:147]
    ds_read_b64_tr_b16 a[90:91], v23 offset:512
    v_mfma_f32_16x16x32_bf16 a[148:151], a[72:75], a[4:7], a[148:151]
    ds_read_b64_tr_b16 a[92:93], v23 offset:4096
    v_mfma_f32_16x16x32_bf16 a[148:151], a[76:79], a[20:23], a[148:151]
    ds_read_b64_tr_b16 a[94:95], v23 offset:4608
    v_mfma_f32_16x16x32_bf16 a[152:155], a[72:75], a[8:11], a[152:155]
    ds_read_b64_tr_b16 a[104:105], v4 offset:4096
    v_mfma_f32_16x16x32_bf16 a[152:155], a[76:79], a[24:27], a[152:155]
    ds_read_b64_tr_b16 a[106:107], v4 offset:4608
    v_mfma_f32_16x16x32_bf16 a[156:159], a[72:75], a[12:15], a[156:159]
    v_mfma_f32_16x16x32_bf16 a[156:159], a[76:79], a[28:31], a[156:159]
    s_waitcnt lgkmcnt(6)
    v_mfma_f32_16x16x32_bf16 a[160:163], a[80:83], a[0:3], a[160:163]
    s_waitcnt vmcnt(4)
    v_mfma_f32_16x16x32_bf16 a[160:163], a[84:87], a[16:19], a[160:163]
    ds_read_b128 a[32:35], v14 offset:32768
    v_mfma_f32_16x16x32_bf16 a[164:167], a[80:83], a[4:7], a[164:167]
    ds_read_b128 a[36:39], v14 offset:34816
    v_mfma_f32_16x16x32_bf16 a[164:167], a[84:87], a[20:23], a[164:167]
    ds_read_b128 a[40:43], v14 offset:36864
    ds_read_b128 a[44:47], v14 offset:38912
    s_waitcnt lgkmcnt(4)
    v_mfma_f32_16x16x32_bf16 a[176:179], a[88:91], a[0:3], a[176:179]
    ds_read_b128 a[48:51], v15 offset:32768
    v_mfma_f32_16x16x32_bf16 a[176:179], a[92:95], a[16:19], a[176:179]
    ds_read_b128 a[52:55], v15 offset:34816
    v_mfma_f32_16x16x32_bf16 a[180:183], a[88:91], a[4:7], a[180:183]
    ds_read_b128 a[56:59], v15 offset:36864
    v_mfma_f32_16x16x32_bf16 a[180:183], a[92:95], a[20:23], a[180:183]
    ds_read_b128 a[60:63], v15 offset:38912
    v_mfma_f32_16x16x32_bf16 a[232:235], a[100:103], a[96:99], a[232:235]
    v_mfma_f32_16x16x32_bf16 a[232:235], a[104:107], a[96:99], a[232:235]
    v_mfma_f32_16x16x32_bf16 a[192:195], a[96:99], a[0:3], a[192:195]
    s_waitcnt vmcnt(12)
    v_mfma_f32_16x16x32_bf16 a[192:195], a[96:99], a[16:19], a[192:195]
    s_barrier
    v_mfma_f32_16x16x32_bf16 a[208:211], a[0:3], a[0:3], a[208:211]
    ds_read_b64_tr_b16 a[64:65], v20 offset:24576
    v_mfma_f32_16x16x32_bf16 a[208:211], a[16:19], a[16:19], a[208:211]
    ds_read_b64_tr_b16 a[66:67], v20 offset:25088
    v_mfma_f32_16x16x32_bf16 a[196:199], a[96:99], a[4:7], a[196:199]
    ds_read_b64_tr_b16 a[68:69], v20 offset:28672
    v_mfma_f32_16x16x32_bf16 a[196:199], a[96:99], a[20:23], a[196:199]
    ds_read_b64_tr_b16 a[70:71], v20 offset:29184
    v_mfma_f32_16x16x32_bf16 a[212:215], a[4:7], a[4:7], a[212:215]
    v_mfma_f32_16x16x32_bf16 a[212:215], a[20:23], a[20:23], a[212:215]
    v_mfma_f32_16x16x32_bf16 a[200:203], a[96:99], a[8:11], a[200:203]
    ds_read_b64_tr_b16 a[72:73], v21 offset:24576
    v_mfma_f32_16x16x32_bf16 a[200:203], a[96:99], a[24:27], a[200:203]
    ds_read_b64_tr_b16 a[74:75], v21 offset:25088
    v_mfma_f32_16x16x32_bf16 a[216:219], a[8:11], a[8:11], a[216:219]
    ds_read_b64_tr_b16 a[76:77], v21 offset:28672
    v_mfma_f32_16x16x32_bf16 a[216:219], a[24:27], a[24:27], a[216:219]
    ds_read_b64_tr_b16 a[78:79], v21 offset:29184
    v_mfma_f32_16x16x32_bf16 a[204:207], a[96:99], a[12:15], a[204:207]
    v_mfma_f32_16x16x32_bf16 a[204:207], a[96:99], a[28:31], a[204:207]
    v_mfma_f32_16x16x32_bf16 a[220:223], a[12:15], a[12:15], a[220:223]
    v_mfma_f32_16x16x32_bf16 a[220:223], a[28:31], a[28:31], a[220:223]
    v_mfma_f32_16x16x32_bf16 a[192:195], a[96:99], a[32:35], a[192:195]
    ds_read_b64_tr_b16 a[80:81], v22 offset:24576
    v_mfma_f32_16x16x32_bf16 a[192:195], a[96:99], a[48:51], a[192:195]
    ds_read_b64_tr_b16 a[82:83], v22 offset:25088
    v_mfma_f32_16x16x32_bf16 a[208:211], a[32:35], a[32:35], a[208:211]
    ds_read_b64_tr_b16 a[84:85], v22 offset:28672
    v_mfma_f32_16x16x32_bf16 a[208:211], a[48:51], a[48:51], a[208:211]
    ds_read_b64_tr_b16 a[86:87], v22 offset:29184
    v_mfma_f32_16x16x32_bf16 a[196:199], a[96:99], a[36:39], a[196:199]
    ds_read_b64_tr_b16 a[100:101], v4 offset:24576
    v_mfma_f32_16x16x32_bf16 a[196:199], a[96:99], a[52:55], a[196:199]
    ds_read_b64_tr_b16 a[102:103], v4 offset:25088
    s_add_u32 m0, s24, 0
    v_mfma_f32_16x16x32_bf16 a[212:215], a[36:39], a[36:39], a[212:215]
    buffer_load_dwordx4 v92, s[4:7], s23 offen offset:0 lds
    v_mfma_f32_16x16x32_bf16 a[212:215], a[52:55], a[52:55], a[212:215]
    buffer_load_dwordx4 v93, s[4:7], s23 offen offset:1024 lds
    buffer_load_dwordx4 v94, s[4:7], s23 offen offset:2048 lds
    buffer_load_dwordx4 v95, s[4:7], s23 offen offset:3072 lds
    v_mfma_f32_16x16x32_bf16 a[200:203], a[96:99], a[40:43], a[200:203]
    ds_read_b64_tr_b16 a[88:89], v23 offset:24576
    v_mfma_f32_16x16x32_bf16 a[200:203], a[96:99], a[56:59], a[200:203]
    ds_read_b64_tr_b16 a[90:91], v23 offset:25088
    v_mfma_f32_16x16x32_bf16 a[216:219], a[40:43], a[40:43], a[216:219]
    ds_read_b64_tr_b16 a[92:93], v23 offset:28672
    v_mfma_f32_16x16x32_bf16 a[216:219], a[56:59], a[56:59], a[216:219]
    ds_read_b64_tr_b16 a[94:95], v23 offset:29184
    v_mfma_f32_16x16x32_bf16 a[204:207], a[96:99], a[44:47], a[204:207]
    ds_read_b64_tr_b16 a[104:105], v4 offset:28672
    v_mfma_f32_16x16x32_bf16 a[204:207], a[96:99], a[60:63], a[204:207]
    ds_read_b64_tr_b16 a[106:107], v4 offset:29184
    s_add_u32 m0, s24, 65536
    v_mfma_f32_16x16x32_bf16 a[220:223], a[44:47], a[44:47], a[220:223]
    buffer_load_dwordx4 v96, s[8:11], s23 offen offset:0 lds
    v_mfma_f32_16x16x32_bf16 a[220:223], a[60:63], a[60:63], a[220:223]
    buffer_load_dwordx4 v97, s[8:11], s23 offen offset:1024 lds
    buffer_load_dwordx4 v96, s[8:11], s23 offen offset:2048 lds
    buffer_load_dwordx4 v97, s[8:11], s23 offen offset:3072 lds
    s_add_u32 s23, s23, 16384
    s_waitcnt lgkmcnt(15)
    v_mfma_f32_16x16x32_bf16 a[128:131], a[64:67], a[32:35], a[128:131]
    s_add_u32 m0, s24, 16384
    v_mfma_f32_16x16x32_bf16 a[128:131], a[68:71], a[48:51], a[128:131]
    buffer_load_dwordx4 v92, s[4:7], s23 offen offset:0 lds
    v_mfma_f32_16x16x32_bf16 a[132:135], a[64:67], a[36:39], a[132:135]
    buffer_load_dwordx4 v93, s[4:7], s23 offen offset:1024 lds
    v_mfma_f32_16x16x32_bf16 a[132:135], a[68:71], a[52:55], a[132:135]
    buffer_load_dwordx4 v94, s[4:7], s23 offen offset:2048 lds
    v_mfma_f32_16x16x32_bf16 a[136:139], a[64:67], a[40:43], a[136:139]
    buffer_load_dwordx4 v95, s[4:7], s23 offen offset:3072 lds
    v_mfma_f32_16x16x32_bf16 a[136:139], a[68:71], a[56:59], a[136:139]
    v_mfma_f32_16x16x32_bf16 a[140:143], a[64:67], a[44:47], a[140:143]
    v_mfma_f32_16x16x32_bf16 a[140:143], a[68:71], a[60:63], a[140:143]
    s_waitcnt lgkmcnt(12)
    v_mfma_f32_16x16x32_bf16 a[144:147], a[72:75], a[32:35], a[144:147]
    ds_read_b64_tr_b16 a[64:65], v16 offset:24576
    v_and_b32 v66, 3, v102
    v_mfma_f32_16x16x32_bf16 a[144:147], a[76:79], a[48:51], a[144:147]
    ds_read_b64_tr_b16 a[66:67], v16 offset:25600
    v_cmp_eq_u32 s[68:69], 1, v66
    v_mfma_f32_16x16x32_bf16 a[148:151], a[72:75], a[36:39], a[148:151]
    ds_read_b64_tr_b16 a[68:69], v16 offset:32768
    v_cmp_eq_u32 s[70:71], 2, v66
    v_mfma_f32_16x16x32_bf16 a[148:151], a[76:79], a[52:55], a[148:151]
    ds_read_b64_tr_b16 a[70:71], v16 offset:33792
    v_cmp_eq_u32 s[72:73], 3, v66
    v_mfma_f32_16x16x32_bf16 a[152:155], a[72:75], a[40:43], a[152:155]
    v_bfe_u32 v66, v102, 2, 2
    v_lshrrev_b32 v67, 4, v102
    v_mfma_f32_16x16x32_bf16 a[152:155], a[76:79], a[56:59], a[152:155]
    v_cmp_eq_u32 s[74:75], v66, v67
    s_mov_b32 s76, 0x3b000000
    v_mfma_f32_16x16x32_bf16 a[156:159], a[72:75], a[44:47], a[156:159]
    s_mov_b32 s77, 0x3727c5ac
    s_mov_b32 s78, 0x3e0293ee
    v_mfma_f32_16x16x32_bf16 a[156:159], a[76:79], a[60:63], a[156:159]
    v_lshlrev_b32 v117, 4, v102
    v_accvgpr_read_b32 v72, a208
    s_waitcnt lgkmcnt(10)
    v_mfma_f32_16x16x32_bf16 a[160:163], a[80:83], a[32:35], a[160:163]
    ds_read_b64_tr_b16 a[72:73], v16 offset:24584
    v_accvgpr_read_b32 v73, a209
    v_mfma_f32_16x16x32_bf16 a[160:163], a[84:87], a[48:51], a[160:163]
    ds_read_b64_tr_b16 a[74:75], v16 offset:25608
    v_accvgpr_read_b32 v74, a210
    v_mfma_f32_16x16x32_bf16 a[164:167], a[80:83], a[36:39], a[164:167]
    ds_read_b64_tr_b16 a[76:77], v16 offset:32776
    v_accvgpr_read_b32 v75, a211
    v_mfma_f32_16x16x32_bf16 a[164:167], a[84:87], a[52:55], a[164:167]
    ds_read_b64_tr_b16 a[78:79], v16 offset:33800
    v_accvgpr_read_b32 v66, a192
    s_waitcnt lgkmcnt(8)
    v_mfma_f32_16x16x32_bf16 a[176:179], a[88:91], a[32:35], a[176:179]
    ds_read_b64_tr_b16 a[80:81], v17 offset:24576
    v_cndmask_b32 v72, v72, v73, s[68:69]
    v_mfma_f32_16x16x32_bf16 a[176:179], a[92:95], a[48:51], a[176:179]
    ds_read_b64_tr_b16 a[82:83], v17 offset:25600
    v_cndmask_b32 v72, v72, v74, s[70:71]
    v_mfma_f32_16x16x32_bf16 a[180:183], a[88:91], a[36:39], a[180:183]
    ds_read_b64_tr_b16 a[84:85], v17 offset:32768
    v_cndmask_b32 v72, v72, v75, s[72:73]
    v_mfma_f32_16x16x32_bf16 a[180:183], a[92:95], a[52:55], a[180:183]
    ds_read_b64_tr_b16 a[86:87], v17 offset:33792
    v_cndmask_b32 v72, 0, v72, s[74:75]
    v_mfma_f32_16x16x32_bf16 a[232:235], a[100:103], a[96:99], a[232:235]
    v_mov_b32 v73, v72
    s_nop 1
    v_permlane32_swap_b32 v72, v73
    v_mfma_f32_16x16x32_bf16 a[232:235], a[104:107], a[96:99], a[232:235]
    v_add_f32 v72, v72, v73
    v_mov_b32 v73, v72
    s_waitcnt lgkmcnt(8)
    v_mfma_f32_16x16x32_bf16 v[128:131], a[64:67], a[32:35], v[128:131]
    ds_read_b64_tr_b16 a[88:89], v17 offset:24584
    v_permlane16_swap_b32 v72, v73
    v_mfma_f32_16x16x32_bf16 v[128:131], a[68:71], a[48:51], v[128:131]
    ds_read_b64_tr_b16 a[90:91], v17 offset:25608
    v_add_f32 v72, v72, v73
    v_mfma_f32_16x16x32_bf16 v[160:163], a[64:67], a[36:39], v[160:163]
    ds_read_b64_tr_b16 a[92:93], v17 offset:32776
    v_mul_f32 v66, s76, v66
    v_mfma_f32_16x16x32_bf16 v[160:163], a[68:71], a[52:55], v[160:163]
    ds_read_b64_tr_b16 a[94:95], v17 offset:33800
    v_mul_f32 v72, s76, v72
    v_mfma_f32_16x16x32_bf16 v[192:195], a[64:67], a[40:43], v[192:195]
    v_fma_f32 v72, -v66, v66, v72
    v_max_f32 v72, 0, v72
    v_mfma_f32_16x16x32_bf16 v[192:195], a[68:71], a[56:59], v[192:195]
    v_add_f32 v67, s77, v72
    v_rsq_f32 v67, v67
    v_mfma_f32_16x16x32_bf16 v[224:227], a[64:67], a[44:47], v[224:227]
    v_sub_f32 v104, 0, v66
    v_mul_f32 v72, v72, v67
    v_mfma_f32_16x16x32_bf16 v[224:227], a[68:71], a[60:63], v[224:227]
    v_fma_f32 v72, v72, v67, s77
    v_rsq_f32 v72, v72
    v_mfma_f32_16x16x32_bf16 a[224:227], a[64:67], a[96:99], a[224:227]
    v_mul_f32 v108, s78, v67
    v_mul_f32 v112, v72, v67
    v_mfma_f32_16x16x32_bf16 a[224:227], a[68:71], a[96:99], a[224:227]
    v_accvgpr_read_b32 v72, a212
    v_accvgpr_read_b32 v73, a213
    s_waitcnt lgkmcnt(8)
    v_mfma_f32_16x16x32_bf16 v[132:135], a[72:75], a[32:35], v[132:135]
    ds_read_b64_tr_b16 a[64:65], v18 offset:24576
    v_accvgpr_read_b32 v74, a214
    v_mfma_f32_16x16x32_bf16 v[132:135], a[76:79], a[48:51], v[132:135]
    ds_read_b64_tr_b16 a[66:67], v18 offset:25600
    v_accvgpr_read_b32 v75, a215
    v_mfma_f32_16x16x32_bf16 v[164:167], a[72:75], a[36:39], v[164:167]
    ds_read_b64_tr_b16 a[68:69], v18 offset:32768
    v_accvgpr_read_b32 v66, a196
    v_mfma_f32_16x16x32_bf16 v[164:167], a[76:79], a[52:55], v[164:167]
    ds_read_b64_tr_b16 a[70:71], v18 offset:33792
    v_cndmask_b32 v72, v72, v73, s[68:69]
    v_mfma_f32_16x16x32_bf16 v[196:199], a[72:75], a[40:43], v[196:199]
    v_cndmask_b32 v72, v72, v74, s[70:71]
    v_cndmask_b32 v72, v72, v75, s[72:73]
    v_mfma_f32_16x16x32_bf16 v[196:199], a[76:79], a[56:59], v[196:199]
    v_cndmask_b32 v72, 0, v72, s[74:75]
    v_mov_b32 v73, v72
    v_mfma_f32_16x16x32_bf16 v[228:231], a[72:75], a[44:47], v[228:231]
    s_nop 0
    v_permlane32_swap_b32 v72, v73
    v_add_f32 v72, v72, v73
    v_mfma_f32_16x16x32_bf16 v[228:231], a[76:79], a[60:63], v[228:231]
    v_mov_b32 v73, v72
    s_nop 1
    v_permlane16_swap_b32 v72, v73
    v_mfma_f32_16x16x32_bf16 a[228:231], a[72:75], a[96:99], a[228:231]
    v_add_f32 v72, v72, v73
    v_mul_f32 v66, s76, v66
    v_mfma_f32_16x16x32_bf16 a[228:231], a[76:79], a[96:99], a[228:231]
    v_mul_f32 v72, s76, v72
    v_fma_f32 v72, -v66, v66, v72
    s_waitcnt lgkmcnt(8)
    v_mfma_f32_16x16x32_bf16 v[136:139], a[80:83], a[32:35], v[136:139]
    ds_read_b64_tr_b16 a[72:73], v18 offset:24584
    v_max_f32 v72, 0, v72
    v_mfma_f32_16x16x32_bf16 v[136:139], a[84:87], a[48:51], v[136:139]
    ds_read_b64_tr_b16 a[74:75], v18 offset:25608
    v_add_f32 v67, s77, v72
    v_mfma_f32_16x16x32_bf16 v[168:171], a[80:83], a[36:39], v[168:171]
    ds_read_b64_tr_b16 a[76:77], v18 offset:32776
    v_rsq_f32 v67, v67
    v_mfma_f32_16x16x32_bf16 v[168:171], a[84:87], a[52:55], v[168:171]
    ds_read_b64_tr_b16 a[78:79], v18 offset:33800
    v_sub_f32 v105, 0, v66
    v_mfma_f32_16x16x32_bf16 v[200:203], a[80:83], a[40:43], v[200:203]
    v_mul_f32 v72, v72, v67
    v_fma_f32 v72, v72, v67, s77
    v_mfma_f32_16x16x32_bf16 v[200:203], a[84:87], a[56:59], v[200:203]
    v_rsq_f32 v72, v72
    v_mul_f32 v109, s78, v67
    v_mfma_f32_16x16x32_bf16 v[232:235], a[80:83], a[44:47], v[232:235]
    v_mul_f32 v113, v72, v67
    v_accvgpr_read_b32 v72, a216
    v_mfma_f32_16x16x32_bf16 v[232:235], a[84:87], a[60:63], v[232:235]
    v_accvgpr_read_b32 v73, a217
    v_accvgpr_read_b32 v74, a218
    s_waitcnt lgkmcnt(8)
    v_mfma_f32_16x16x32_bf16 v[140:143], a[88:91], a[32:35], v[140:143]
    ds_read_b64_tr_b16 a[80:81], v19 offset:24576
    v_accvgpr_read_b32 v75, a219
    v_mfma_f32_16x16x32_bf16 v[140:143], a[92:95], a[48:51], v[140:143]
    ds_read_b64_tr_b16 a[82:83], v19 offset:25600
    v_accvgpr_read_b32 v66, a200
    v_mfma_f32_16x16x32_bf16 v[172:175], a[88:91], a[36:39], v[172:175]
    ds_read_b64_tr_b16 a[84:85], v19 offset:32768
    v_cndmask_b32 v72, v72, v73, s[68:69]
    v_mfma_f32_16x16x32_bf16 v[172:175], a[92:95], a[52:55], v[172:175]
    ds_read_b64_tr_b16 a[86:87], v19 offset:33792
    v_cndmask_b32 v72, v72, v74, s[70:71]
    v_mfma_f32_16x16x32_bf16 v[204:207], a[88:91], a[40:43], v[204:207]
    v_cndmask_b32 v72, v72, v75, s[72:73]
    v_cndmask_b32 v72, 0, v72, s[74:75]
    v_mfma_f32_16x16x32_bf16 v[204:207], a[92:95], a[56:59], v[204:207]
    s_lshl_b32 s29, s20, 8
    s_add_u32 s29, s29, 155648
    v_and_b32 v118, 0x30, v102
    v_add_u32 v118, s29, v118
    ds_write_b128 v118, a[224:227] offset:0
    ds_write_b128 v118, a[228:231] offset:64
    ds_write_b128 v118, a[232:235] offset:128
    v_mov_b32 v73, v72
    v_mfma_f32_16x16x32_bf16 v[236:239], a[88:91], a[44:47], v[236:239]
    s_nop 0
    v_permlane32_swap_b32 v72, v73
    v_add_f32 v72, v72, v73
    v_mfma_f32_16x16x32_bf16 v[236:239], a[92:95], a[60:63], v[236:239]
    v_mov_b32 v73, v72
    s_nop 1
    v_permlane16_swap_b32 v72, v73
    s_waitcnt lgkmcnt(8)
    v_mfma_f32_16x16x32_bf16 v[144:147], a[64:67], a[32:35], v[144:147]
    ds_read_b64_tr_b16 a[88:89], v19 offset:24584
    v_add_f32 v72, v72, v73
    v_mfma_f32_16x16x32_bf16 v[144:147], a[68:71], a[48:51], v[144:147]
    ds_read_b64_tr_b16 a[90:91], v19 offset:25608
    v_mul_f32 v66, s76, v66
    v_mfma_f32_16x16x32_bf16 v[176:179], a[64:67], a[36:39], v[176:179]
    ds_read_b64_tr_b16 a[92:93], v19 offset:32776
    v_mul_f32 v72, s76, v72
    v_mfma_f32_16x16x32_bf16 v[176:179], a[68:71], a[52:55], v[176:179]
    ds_read_b64_tr_b16 a[94:95], v19 offset:33800
    v_fma_f32 v72, -v66, v66, v72
    v_mfma_f32_16x16x32_bf16 v[208:211], a[64:67], a[40:43], v[208:211]
    v_max_f32 v72, 0, v72
    v_add_f32 v67, s77, v72
    v_mfma_f32_16x16x32_bf16 v[208:211], a[68:71], a[56:59], v[208:211]
    v_rsq_f32 v67, v67
    v_sub_f32 v106, 0, v66
    v_mfma_f32_16x16x32_bf16 v[240:243], a[64:67], a[44:47], v[240:243]
    v_mul_f32 v72, v72, v67
    v_fma_f32 v72, v72, v67, s77
    v_mfma_f32_16x16x32_bf16 v[240:243], a[68:71], a[60:63], v[240:243]
    v_rsq_f32 v72, v72
    v_mul_f32 v110, s78, v67
    s_waitcnt lgkmcnt(8)
    v_mfma_f32_16x16x32_bf16 v[148:151], a[72:75], a[32:35], v[148:151]
    v_mul_f32 v114, v72, v67
    v_accvgpr_read_b32 v72, a220
    v_mfma_f32_16x16x32_bf16 v[148:151], a[76:79], a[48:51], v[148:151]
    v_accvgpr_read_b32 v73, a221
    v_accvgpr_read_b32 v74, a222
    v_mfma_f32_16x16x32_bf16 v[180:183], a[72:75], a[36:39], v[180:183]
    v_accvgpr_read_b32 v75, a223
    v_accvgpr_read_b32 v66, a204
    v_mfma_f32_16x16x32_bf16 v[180:183], a[76:79], a[52:55], v[180:183]
    v_cndmask_b32 v72, v72, v73, s[68:69]
    v_cndmask_b32 v72, v72, v74, s[70:71]
    v_mfma_f32_16x16x32_bf16 v[212:215], a[72:75], a[40:43], v[212:215]
    v_cndmask_b32 v72, v72, v75, s[72:73]
    v_cndmask_b32 v72, 0, v72, s[74:75]
    v_mfma_f32_16x16x32_bf16 v[212:215], a[76:79], a[56:59], v[212:215]
    v_mov_b32 v73, v72
    s_nop 1
    v_permlane32_swap_b32 v72, v73
    v_mfma_f32_16x16x32_bf16 v[244:247], a[72:75], a[44:47], v[244:247]
    v_add_f32 v72, v72, v73
    v_mov_b32 v73, v72
    v_mfma_f32_16x16x32_bf16 v[244:247], a[76:79], a[60:63], v[244:247]
    s_nop 0
    v_permlane16_swap_b32 v72, v73
    v_add_f32 v72, v72, v73
    v_mfma_f32_16x16x32_bf16 v[152:155], a[80:83], a[32:35], v[152:155]
    s_waitcnt vmcnt(12) lgkmcnt(0)
    s_barrier
    s_add_u32 m0, s24, 81920
    v_mfma_f32_16x16x32_bf16 v[152:155], a[84:87], a[48:51], v[152:155]
    buffer_load_dwordx4 v96, s[8:11], s23 offen offset:0 lds
    v_mul_f32 v66, s76, v66
    v_mfma_f32_16x16x32_bf16 v[184:187], a[80:83], a[36:39], v[184:187]
    buffer_load_dwordx4 v97, s[8:11], s23 offen offset:1024 lds
    v_mul_f32 v72, s76, v72
    v_mfma_f32_16x16x32_bf16 v[184:187], a[84:87], a[52:55], v[184:187]
    buffer_load_dwordx4 v96, s[8:11], s23 offen offset:2048 lds
    v_fma_f32 v72, -v66, v66, v72
    v_mfma_f32_16x16x32_bf16 v[216:219], a[80:83], a[40:43], v[216:219]
    buffer_load_dwordx4 v97, s[8:11], s23 offen offset:3072 lds
    v_max_f32 v72, 0, v72
    v_mfma_f32_16x16x32_bf16 v[216:219], a[84:87], a[56:59], v[216:219]
    v_add_f32 v67, s77, v72
    v_rsq_f32 v67, v67
    v_mfma_f32_16x16x32_bf16 v[248:251], a[80:83], a[44:47], v[248:251]
    v_sub_f32 v107, 0, v66
    v_mul_f32 v72, v72, v67
    v_mfma_f32_16x16x32_bf16 v[248:251], a[84:87], a[60:63], v[248:251]
    s_add_u32 s23, s23, 16384
    v_fma_f32 v72, v72, v67, s77
    v_mfma_f32_16x16x32_bf16 v[156:159], a[88:91], a[32:35], v[156:159]
    v_xor_b32 v119, 0, v118
    ds_read_b128 v[32:35], v119 offset:0
    v_rsq_f32 v72, v72
    v_mfma_f32_16x16x32_bf16 v[156:159], a[92:95], a[48:51], v[156:159]
    ds_read_b128 v[36:39], v119 offset:64
    v_mul_f32 v111, s78, v67
    v_mfma_f32_16x16x32_bf16 v[188:191], a[88:91], a[36:39], v[188:191]
    v_xor_b32 v119, 256, v118
    ds_read_b128 v[40:43], v119 offset:0
    v_mul_f32 v115, v72, v67
    v_mfma_f32_16x16x32_bf16 v[188:191], a[92:95], a[52:55], v[188:191]
    ds_read_b128 v[44:47], v119 offset:64
    v_mfma_f32_16x16x32_bf16 v[220:223], a[88:91], a[40:43], v[220:223]
    v_xor_b32 v119, 512, v118
    ds_read_b128 v[48:51], v119 offset:0
    v_mfma_f32_16x16x32_bf16 v[220:223], a[92:95], a[56:59], v[220:223]
    ds_read_b128 v[52:55], v119 offset:64
    v_mfma_f32_16x16x32_bf16 v[252:255], a[88:91], a[44:47], v[252:255]
    v_xor_b32 v119, 768, v118
    ds_read_b128 v[56:59], v119 offset:0
    v_mfma_f32_16x16x32_bf16 v[252:255], a[92:95], a[60:63], v[252:255]
    ds_read_b128 v[60:63], v119 offset:64
    v_and_b32 v119, 0x30, v102
    v_add_u32 v119, 155648, v119
    ds_read_b128 v[0:3], v119 offset:128
    ds_read_b128 v[4:7], v119 offset:384
    ds_read_b128 v[8:11], v119 offset:640
    ds_read_b128 v[12:15], v119 offset:896
    v_lshlrev_b32 v64, 16, v24
    v_and_b32 v65, 0xffff0000, v24
    v_lshlrev_b32 v66, 16, v25
    v_and_b32 v67, 0xffff0000, v25
    v_lshlrev_b32 v68, 16, v26
    v_and_b32 v69, 0xffff0000, v26
    v_lshlrev_b32 v70, 16, v27
    v_and_b32 v71, 0xffff0000, v27
    v_lshlrev_b32 v72, 16, v28
    v_and_b32 v73, 0xffff0000, v28
    v_lshlrev_b32 v74, 16, v29
    v_and_b32 v75, 0xffff0000, v29
    v_lshlrev_b32 v76, 16, v30
    v_and_b32 v77, 0xffff0000, v30
    v_lshlrev_b32 v78, 16, v31
    v_and_b32 v79, 0xffff0000, v31
    s_mov_b32 s67, 0xbdd2d3e8
    v_mov_b32 v116, 0xc0135761
    s_lshl_b32 s26, s22, 4
    s_lshl_b32 s30, s20, 2
    s_add_u32 s26, s26, s30
    s_lshl_b32 s26, s26, 10
    s_lshl_b32 s30, s65, 6
    s_lshl_b32 s31, s21, 17
    s_add_u32 s31, s31, s26
    s_add_u32 s68, s31, s30
    s_xor_b32 s69, s68, 2048
    s_lshl_b32 s31, s25, 17
    s_add_u32 s31, s31, s26
    s_add_u32 s70, s31, s30
    s_xor_b32 s71, s70, 2048
    s_waitcnt lgkmcnt(0)
    v_pk_fma_f32 v[128:129], v[104:105], v[32:33], v[128:129] op_sel:[0,0,0] op_sel_hi:[0,1,1]
    v_pk_fma_f32 v[130:131], v[104:105], v[34:35], v[130:131] op_sel:[0,0,0] op_sel_hi:[0,1,1]
    v_pk_fma_f32 v[132:133], v[104:105], v[36:37], v[132:133] op_sel:[0,0,0] op_sel_hi:[0,1,1]
    v_pk_fma_f32 v[134:135], v[104:105], v[38:39], v[134:135] op_sel:[0,0,0] op_sel_hi:[0,1,1]
    v_pk_mul_f32 v[128:129], v[108:109], v[128:129] op_sel:[0,0] op_sel_hi:[0,1]
    v_pk_mul_f32 v[130:131], v[108:109], v[130:131] op_sel:[0,0] op_sel_hi:[0,1]
    v_pk_mul_f32 v[132:133], v[108:109], v[132:133] op_sel:[0,0] op_sel_hi:[0,1]
    v_pk_mul_f32 v[134:135], v[108:109], v[134:135] op_sel:[0,0] op_sel_hi:[0,1]
    v_cvt_pk_bf16_f32 v128, v128, v129
    v_cvt_pk_bf16_f32 v129, v130, v131
    v_cvt_pk_bf16_f32 v130, v132, v133
    v_cvt_pk_bf16_f32 v131, v134, v135
    v_accvgpr_write_b32 a0, v128
    v_accvgpr_write_b32 a1, v129
    v_accvgpr_write_b32 a2, v130
    v_accvgpr_write_b32 a3, v131
    v_pk_fma_f32 v[136:137], v[104:105], v[40:41], v[136:137] op_sel:[0,0,0] op_sel_hi:[0,1,1]
    v_pk_fma_f32 v[138:139], v[104:105], v[42:43], v[138:139] op_sel:[0,0,0] op_sel_hi:[0,1,1]
    v_pk_fma_f32 v[140:141], v[104:105], v[44:45], v[140:141] op_sel:[0,0,0] op_sel_hi:[0,1,1]
    v_pk_fma_f32 v[142:143], v[104:105], v[46:47], v[142:143] op_sel:[0,0,0] op_sel_hi:[0,1,1]
    v_pk_mul_f32 v[136:137], v[108:109], v[136:137] op_sel:[0,0] op_sel_hi:[0,1]
    v_pk_mul_f32 v[138:139], v[108:109], v[138:139] op_sel:[0,0] op_sel_hi:[0,1]
    v_pk_mul_f32 v[140:141], v[108:109], v[140:141] op_sel:[0,0] op_sel_hi:[0,1]
    v_pk_mul_f32 v[142:143], v[108:109], v[142:143] op_sel:[0,0] op_sel_hi:[0,1]
    v_cvt_pk_bf16_f32 v136, v136, v137
    v_cvt_pk_bf16_f32 v137, v138, v139
    v_cvt_pk_bf16_f32 v138, v140, v141
    v_cvt_pk_bf16_f32 v139, v142, v143
    v_accvgpr_write_b32 a4, v136
    v_accvgpr_write_b32 a5, v137
    v_accvgpr_write_b32 a6, v138
    v_accvgpr_write_b32 a7, v139
    v_pk_fma_f32 v[144:145], v[104:105], v[48:49], v[144:145] op_sel:[0,0,0] op_sel_hi:[0,1,1]
    v_pk_fma_f32 v[146:147], v[104:105], v[50:51], v[146:147] op_sel:[0,0,0] op_sel_hi:[0,1,1]
    v_pk_fma_f32 v[148:149], v[104:105], v[52:53], v[148:149] op_sel:[0,0,0] op_sel_hi:[0,1,1]
    v_pk_fma_f32 v[150:151], v[104:105], v[54:55], v[150:151] op_sel:[0,0,0] op_sel_hi:[0,1,1]
    v_pk_mul_f32 v[144:145], v[108:109], v[144:145] op_sel:[0,0] op_sel_hi:[0,1]
    v_pk_mul_f32 v[146:147], v[108:109], v[146:147] op_sel:[0,0] op_sel_hi:[0,1]
    v_pk_mul_f32 v[148:149], v[108:109], v[148:149] op_sel:[0,0] op_sel_hi:[0,1]
    v_pk_mul_f32 v[150:151], v[108:109], v[150:151] op_sel:[0,0] op_sel_hi:[0,1]
    v_cvt_pk_bf16_f32 v144, v144, v145
    v_cvt_pk_bf16_f32 v145, v146, v147
    v_cvt_pk_bf16_f32 v146, v148, v149
    v_cvt_pk_bf16_f32 v147, v150, v151
    v_accvgpr_write_b32 a8, v144
    v_accvgpr_write_b32 a9, v145
    v_accvgpr_write_b32 a10, v146
    v_accvgpr_write_b32 a11, v147
    v_pk_fma_f32 v[152:153], v[104:105], v[56:57], v[152:153] op_sel:[0,0,0] op_sel_hi:[0,1,1]
    v_pk_fma_f32 v[154:155], v[104:105], v[58:59], v[154:155] op_sel:[0,0,0] op_sel_hi:[0,1,1]
    v_pk_fma_f32 v[156:157], v[104:105], v[60:61], v[156:157] op_sel:[0,0,0] op_sel_hi:[0,1,1]
    v_pk_fma_f32 v[158:159], v[104:105], v[62:63], v[158:159] op_sel:[0,0,0] op_sel_hi:[0,1,1]
    v_pk_mul_f32 v[152:153], v[108:109], v[152:153] op_sel:[0,0] op_sel_hi:[0,1]
    v_pk_mul_f32 v[154:155], v[108:109], v[154:155] op_sel:[0,0] op_sel_hi:[0,1]
    v_pk_mul_f32 v[156:157], v[108:109], v[156:157] op_sel:[0,0] op_sel_hi:[0,1]
    v_pk_mul_f32 v[158:159], v[108:109], v[158:159] op_sel:[0,0] op_sel_hi:[0,1]
    v_cvt_pk_bf16_f32 v152, v152, v153
    v_cvt_pk_bf16_f32 v153, v154, v155
    v_cvt_pk_bf16_f32 v154, v156, v157
    v_cvt_pk_bf16_f32 v155, v158, v159
    v_accvgpr_write_b32 a12, v152
    v_accvgpr_write_b32 a13, v153
    v_accvgpr_write_b32 a14, v154
    v_accvgpr_write_b32 a15, v155
    v_pk_fma_f32 v[160:161], v[104:105], v[32:33], v[160:161] op_sel:[1,0,0] op_sel_hi:[1,1,1]
    v_pk_fma_f32 v[162:163], v[104:105], v[34:35], v[162:163] op_sel:[1,0,0] op_sel_hi:[1,1,1]
    v_pk_fma_f32 v[164:165], v[104:105], v[36:37], v[164:165] op_sel:[1,0,0] op_sel_hi:[1,1,1]
    v_pk_fma_f32 v[166:167], v[104:105], v[38:39], v[166:167] op_sel:[1,0,0] op_sel_hi:[1,1,1]
    v_pk_mul_f32 v[160:161], v[108:109], v[160:161] op_sel:[1,0] op_sel_hi:[1,1]
    v_pk_mul_f32 v[162:163], v[108:109], v[162:163] op_sel:[1,0] op_sel_hi:[1,1]
    v_pk_mul_f32 v[164:165], v[108:109], v[164:165] op_sel:[1,0] op_sel_hi:[1,1]
    v_pk_mul_f32 v[166:167], v[108:109], v[166:167] op_sel:[1,0] op_sel_hi:[1,1]
    v_cvt_pk_bf16_f32 v160, v160, v161
    v_cvt_pk_bf16_f32 v161, v162, v163
    v_cvt_pk_bf16_f32 v162, v164, v165
    v_cvt_pk_bf16_f32 v163, v166, v167
    v_accvgpr_write_b32 a16, v160
    v_accvgpr_write_b32 a17, v161
    v_accvgpr_write_b32 a18, v162
    v_accvgpr_write_b32 a19, v163
    v_pk_fma_f32 v[168:169], v[104:105], v[40:41], v[168:169] op_sel:[1,0,0] op_sel_hi:[1,1,1]
    v_pk_fma_f32 v[170:171], v[104:105], v[42:43], v[170:171] op_sel:[1,0,0] op_sel_hi:[1,1,1]
    v_pk_fma_f32 v[172:173], v[104:105], v[44:45], v[172:173] op_sel:[1,0,0] op_sel_hi:[1,1,1]
    v_pk_fma_f32 v[174:175], v[104:105], v[46:47], v[174:175] op_sel:[1,0,0] op_sel_hi:[1,1,1]
    v_pk_mul_f32 v[168:169], v[108:109], v[168:169] op_sel:[1,0] op_sel_hi:[1,1]
    v_pk_mul_f32 v[170:171], v[108:109], v[170:171] op_sel:[1,0] op_sel_hi:[1,1]
    v_pk_mul_f32 v[172:173], v[108:109], v[172:173] op_sel:[1,0] op_sel_hi:[1,1]
    v_pk_mul_f32 v[174:175], v[108:109], v[174:175] op_sel:[1,0] op_sel_hi:[1,1]
    v_cvt_pk_bf16_f32 v168, v168, v169
    v_cvt_pk_bf16_f32 v169, v170, v171
    v_cvt_pk_bf16_f32 v170, v172, v173
    v_cvt_pk_bf16_f32 v171, v174, v175
    v_accvgpr_write_b32 a20, v168
    v_accvgpr_write_b32 a21, v169
    v_accvgpr_write_b32 a22, v170
    v_accvgpr_write_b32 a23, v171
    v_pk_fma_f32 v[176:177], v[104:105], v[48:49], v[176:177] op_sel:[1,0,0] op_sel_hi:[1,1,1]
    v_pk_fma_f32 v[178:179], v[104:105], v[50:51], v[178:179] op_sel:[1,0,0] op_sel_hi:[1,1,1]
    v_pk_fma_f32 v[180:181], v[104:105], v[52:53], v[180:181] op_sel:[1,0,0] op_sel_hi:[1,1,1]
    v_pk_fma_f32 v[182:183], v[104:105], v[54:55], v[182:183] op_sel:[1,0,0] op_sel_hi:[1,1,1]
    v_pk_mul_f32 v[176:177], v[108:109], v[176:177] op_sel:[1,0] op_sel_hi:[1,1]
    v_pk_mul_f32 v[178:179], v[108:109], v[178:179] op_sel:[1,0] op_sel_hi:[1,1]
    v_pk_mul_f32 v[180:181], v[108:109], v[180:181] op_sel:[1,0] op_sel_hi:[1,1]
    v_pk_mul_f32 v[182:183], v[108:109], v[182:183] op_sel:[1,0] op_sel_hi:[1,1]
    v_cvt_pk_bf16_f32 v176, v176, v177
    v_cvt_pk_bf16_f32 v177, v178, v179
    v_cvt_pk_bf16_f32 v178, v180, v181
    v_cvt_pk_bf16_f32 v179, v182, v183
    v_accvgpr_write_b32 a24, v176
    v_accvgpr_write_b32 a25, v177
    v_accvgpr_write_b32 a26, v178
    v_accvgpr_write_b32 a27, v179
    v_pk_fma_f32 v[184:185], v[104:105], v[56:57], v[184:185] op_sel:[1,0,0] op_sel_hi:[1,1,1]
    v_pk_fma_f32 v[186:187], v[104:105], v[58:59], v[186:187] op_sel:[1,0,0] op_sel_hi:[1,1,1]
    v_pk_fma_f32 v[188:189], v[104:105], v[60:61], v[188:189] op_sel:[1,0,0] op_sel_hi:[1,1,1]
    v_pk_fma_f32 v[190:191], v[104:105], v[62:63], v[190:191] op_sel:[1,0,0] op_sel_hi:[1,1,1]
    v_pk_mul_f32 v[184:185], v[108:109], v[184:185] op_sel:[1,0] op_sel_hi:[1,1]
    v_pk_mul_f32 v[186:187], v[108:109], v[186:187] op_sel:[1,0] op_sel_hi:[1,1]
    v_pk_mul_f32 v[188:189], v[108:109], v[188:189] op_sel:[1,0] op_sel_hi:[1,1]
    v_pk_mul_f32 v[190:191], v[108:109], v[190:191] op_sel:[1,0] op_sel_hi:[1,1]
    v_cvt_pk_bf16_f32 v184, v184, v185
    v_cvt_pk_bf16_f32 v185, v186, v187
    v_cvt_pk_bf16_f32 v186, v188, v189
    v_cvt_pk_bf16_f32 v187, v190, v191
    v_accvgpr_write_b32 a28, v184
    v_accvgpr_write_b32 a29, v185
    v_accvgpr_write_b32 a30, v186
    v_accvgpr_write_b32 a31, v187
    v_pk_fma_f32 v[192:193], v[106:107], v[32:33], v[192:193] op_sel:[0,0,0] op_sel_hi:[0,1,1]
    v_pk_fma_f32 v[194:195], v[106:107], v[34:35], v[194:195] op_sel:[0,0,0] op_sel_hi:[0,1,1]
    v_pk_fma_f32 v[196:197], v[106:107], v[36:37], v[196:197] op_sel:[0,0,0] op_sel_hi:[0,1,1]
    v_pk_fma_f32 v[198:199], v[106:107], v[38:39], v[198:199] op_sel:[0,0,0] op_sel_hi:[0,1,1]
    v_pk_mul_f32 v[192:193], v[110:111], v[192:193] op_sel:[0,0] op_sel_hi:[0,1]
    v_pk_mul_f32 v[194:195], v[110:111], v[194:195] op_sel:[0,0] op_sel_hi:[0,1]
    v_pk_mul_f32 v[196:197], v[110:111], v[196:197] op_sel:[0,0] op_sel_hi:[0,1]
    v_pk_mul_f32 v[198:199], v[110:111], v[198:199] op_sel:[0,0] op_sel_hi:[0,1]
    v_cvt_pk_bf16_f32 v192, v192, v193
    v_cvt_pk_bf16_f32 v193, v194, v195
    v_cvt_pk_bf16_f32 v194, v196, v197
    v_cvt_pk_bf16_f32 v195, v198, v199
    v_accvgpr_write_b32 a32, v192
    v_accvgpr_write_b32 a33, v193
    v_accvgpr_write_b32 a34, v194
    v_accvgpr_write_b32 a35, v195
    v_pk_fma_f32 v[200:201], v[106:107], v[40:41], v[200:201] op_sel:[0,0,0] op_sel_hi:[0,1,1]
    v_pk_fma_f32 v[202:203], v[106:107], v[42:43], v[202:203] op_sel:[0,0,0] op_sel_hi:[0,1,1]
    v_pk_fma_f32 v[204:205], v[106:107], v[44:45], v[204:205] op_sel:[0,0,0] op_sel_hi:[0,1,1]
    v_pk_fma_f32 v[206:207], v[106:107], v[46:47], v[206:207] op_sel:[0,0,0] op_sel_hi:[0,1,1]
    v_pk_mul_f32 v[200:201], v[110:111], v[200:201] op_sel:[0,0] op_sel_hi:[0,1]
    v_pk_mul_f32 v[202:203], v[110:111], v[202:203] op_sel:[0,0] op_sel_hi:[0,1]
    v_pk_mul_f32 v[204:205], v[110:111], v[204:205] op_sel:[0,0] op_sel_hi:[0,1]
    v_pk_mul_f32 v[206:207], v[110:111], v[206:207] op_sel:[0,0] op_sel_hi:[0,1]
    v_cvt_pk_bf16_f32 v200, v200, v201
    v_cvt_pk_bf16_f32 v201, v202, v203
    v_cvt_pk_bf16_f32 v202, v204, v205
    v_cvt_pk_bf16_f32 v203, v206, v207
    v_accvgpr_write_b32 a36, v200
    v_accvgpr_write_b32 a37, v201
    v_accvgpr_write_b32 a38, v202
    v_accvgpr_write_b32 a39, v203
    v_pk_fma_f32 v[208:209], v[106:107], v[48:49], v[208:209] op_sel:[0,0,0] op_sel_hi:[0,1,1]
    v_pk_fma_f32 v[210:211], v[106:107], v[50:51], v[210:211] op_sel:[0,0,0] op_sel_hi:[0,1,1]
    v_pk_fma_f32 v[212:213], v[106:107], v[52:53], v[212:213] op_sel:[0,0,0] op_sel_hi:[0,1,1]
    v_pk_fma_f32 v[214:215], v[106:107], v[54:55], v[214:215] op_sel:[0,0,0] op_sel_hi:[0,1,1]
    v_pk_mul_f32 v[208:209], v[110:111], v[208:209] op_sel:[0,0] op_sel_hi:[0,1]
    v_pk_mul_f32 v[210:211], v[110:111], v[210:211] op_sel:[0,0] op_sel_hi:[0,1]
    v_pk_mul_f32 v[212:213], v[110:111], v[212:213] op_sel:[0,0] op_sel_hi:[0,1]
    v_pk_mul_f32 v[214:215], v[110:111], v[214:215] op_sel:[0,0] op_sel_hi:[0,1]
    v_cvt_pk_bf16_f32 v208, v208, v209
    v_cvt_pk_bf16_f32 v209, v210, v211
    v_cvt_pk_bf16_f32 v210, v212, v213
    v_cvt_pk_bf16_f32 v211, v214, v215
    v_accvgpr_write_b32 a40, v208
    v_accvgpr_write_b32 a41, v209
    v_accvgpr_write_b32 a42, v210
    v_accvgpr_write_b32 a43, v211
    v_pk_fma_f32 v[216:217], v[106:107], v[56:57], v[216:217] op_sel:[0,0,0] op_sel_hi:[0,1,1]
    v_pk_fma_f32 v[218:219], v[106:107], v[58:59], v[218:219] op_sel:[0,0,0] op_sel_hi:[0,1,1]
    v_pk_fma_f32 v[220:221], v[106:107], v[60:61], v[220:221] op_sel:[0,0,0] op_sel_hi:[0,1,1]
    v_pk_fma_f32 v[222:223], v[106:107], v[62:63], v[222:223] op_sel:[0,0,0] op_sel_hi:[0,1,1]
    v_pk_mul_f32 v[216:217], v[110:111], v[216:217] op_sel:[0,0] op_sel_hi:[0,1]
    v_pk_mul_f32 v[218:219], v[110:111], v[218:219] op_sel:[0,0] op_sel_hi:[0,1]
    v_pk_mul_f32 v[220:221], v[110:111], v[220:221] op_sel:[0,0] op_sel_hi:[0,1]
    v_pk_mul_f32 v[222:223], v[110:111], v[222:223] op_sel:[0,0] op_sel_hi:[0,1]
    v_cvt_pk_bf16_f32 v216, v216, v217
    v_cvt_pk_bf16_f32 v217, v218, v219
    v_cvt_pk_bf16_f32 v218, v220, v221
    v_cvt_pk_bf16_f32 v219, v222, v223
    v_accvgpr_write_b32 a44, v216
    v_accvgpr_write_b32 a45, v217
    v_accvgpr_write_b32 a46, v218
    v_accvgpr_write_b32 a47, v219
    v_pk_fma_f32 v[224:225], v[106:107], v[32:33], v[224:225] op_sel:[1,0,0] op_sel_hi:[1,1,1]
    v_pk_fma_f32 v[226:227], v[106:107], v[34:35], v[226:227] op_sel:[1,0,0] op_sel_hi:[1,1,1]
    v_pk_fma_f32 v[228:229], v[106:107], v[36:37], v[228:229] op_sel:[1,0,0] op_sel_hi:[1,1,1]
    v_pk_fma_f32 v[230:231], v[106:107], v[38:39], v[230:231] op_sel:[1,0,0] op_sel_hi:[1,1,1]
    v_pk_mul_f32 v[224:225], v[110:111], v[224:225] op_sel:[1,0] op_sel_hi:[1,1]
    v_pk_mul_f32 v[226:227], v[110:111], v[226:227] op_sel:[1,0] op_sel_hi:[1,1]
    v_pk_mul_f32 v[228:229], v[110:111], v[228:229] op_sel:[1,0] op_sel_hi:[1,1]
    v_pk_mul_f32 v[230:231], v[110:111], v[230:231] op_sel:[1,0] op_sel_hi:[1,1]
    v_cvt_pk_bf16_f32 v224, v224, v225
    v_cvt_pk_bf16_f32 v225, v226, v227
    v_cvt_pk_bf16_f32 v226, v228, v229
    v_cvt_pk_bf16_f32 v227, v230, v231
    v_accvgpr_write_b32 a48, v224
    v_accvgpr_write_b32 a49, v225
    v_accvgpr_write_b32 a50, v226
    v_accvgpr_write_b32 a51, v227
    v_pk_fma_f32 v[232:233], v[106:107], v[40:41], v[232:233] op_sel:[1,0,0] op_sel_hi:[1,1,1]
    v_pk_fma_f32 v[234:235], v[106:107], v[42:43], v[234:235] op_sel:[1,0,0] op_sel_hi:[1,1,1]
    v_pk_fma_f32 v[236:237], v[106:107], v[44:45], v[236:237] op_sel:[1,0,0] op_sel_hi:[1,1,1]
    v_pk_fma_f32 v[238:239], v[106:107], v[46:47], v[238:239] op_sel:[1,0,0] op_sel_hi:[1,1,1]
    v_pk_mul_f32 v[232:233], v[110:111], v[232:233] op_sel:[1,0] op_sel_hi:[1,1]
    v_pk_mul_f32 v[234:235], v[110:111], v[234:235] op_sel:[1,0] op_sel_hi:[1,1]
    v_pk_mul_f32 v[236:237], v[110:111], v[236:237] op_sel:[1,0] op_sel_hi:[1,1]
    v_pk_mul_f32 v[238:239], v[110:111], v[238:239] op_sel:[1,0] op_sel_hi:[1,1]
    v_cvt_pk_bf16_f32 v232, v232, v233
    v_cvt_pk_bf16_f32 v233, v234, v235
    v_cvt_pk_bf16_f32 v234, v236, v237
    v_cvt_pk_bf16_f32 v235, v238, v239
    v_accvgpr_write_b32 a52, v232
    v_accvgpr_write_b32 a53, v233
    v_accvgpr_write_b32 a54, v234
    v_accvgpr_write_b32 a55, v235
    v_pk_fma_f32 v[240:241], v[106:107], v[48:49], v[240:241] op_sel:[1,0,0] op_sel_hi:[1,1,1]
    v_pk_fma_f32 v[242:243], v[106:107], v[50:51], v[242:243] op_sel:[1,0,0] op_sel_hi:[1,1,1]
    v_pk_fma_f32 v[244:245], v[106:107], v[52:53], v[244:245] op_sel:[1,0,0] op_sel_hi:[1,1,1]
    v_pk_fma_f32 v[246:247], v[106:107], v[54:55], v[246:247] op_sel:[1,0,0] op_sel_hi:[1,1,1]
    v_pk_mul_f32 v[240:241], v[110:111], v[240:241] op_sel:[1,0] op_sel_hi:[1,1]
    v_pk_mul_f32 v[242:243], v[110:111], v[242:243] op_sel:[1,0] op_sel_hi:[1,1]
    v_pk_mul_f32 v[244:245], v[110:111], v[244:245] op_sel:[1,0] op_sel_hi:[1,1]
    v_pk_mul_f32 v[246:247], v[110:111], v[246:247] op_sel:[1,0] op_sel_hi:[1,1]
    v_cvt_pk_bf16_f32 v240, v240, v241
    v_cvt_pk_bf16_f32 v241, v242, v243
    v_cvt_pk_bf16_f32 v242, v244, v245
    v_cvt_pk_bf16_f32 v243, v246, v247
    v_accvgpr_write_b32 a56, v240
    v_accvgpr_write_b32 a57, v241
    v_accvgpr_write_b32 a58, v242
    v_accvgpr_write_b32 a59, v243
    v_pk_fma_f32 v[248:249], v[106:107], v[56:57], v[248:249] op_sel:[1,0,0] op_sel_hi:[1,1,1]
    v_pk_fma_f32 v[250:251], v[106:107], v[58:59], v[250:251] op_sel:[1,0,0] op_sel_hi:[1,1,1]
    v_pk_fma_f32 v[252:253], v[106:107], v[60:61], v[252:253] op_sel:[1,0,0] op_sel_hi:[1,1,1]
    v_pk_fma_f32 v[254:255], v[106:107], v[62:63], v[254:255] op_sel:[1,0,0] op_sel_hi:[1,1,1]
    v_pk_mul_f32 v[248:249], v[110:111], v[248:249] op_sel:[1,0] op_sel_hi:[1,1]
    v_pk_mul_f32 v[250:251], v[110:111], v[250:251] op_sel:[1,0] op_sel_hi:[1,1]
    v_pk_mul_f32 v[252:253], v[110:111], v[252:253] op_sel:[1,0] op_sel_hi:[1,1]
    v_pk_mul_f32 v[254:255], v[110:111], v[254:255] op_sel:[1,0] op_sel_hi:[1,1]
    v_cvt_pk_bf16_f32 v248, v248, v249
    v_cvt_pk_bf16_f32 v249, v250, v251
    v_cvt_pk_bf16_f32 v250, v252, v253
    v_cvt_pk_bf16_f32 v251, v254, v255
    v_accvgpr_write_b32 a60, v248
    v_accvgpr_write_b32 a61, v249
    v_accvgpr_write_b32 a62, v250
    v_accvgpr_write_b32 a63, v251
    v_accvgpr_read_b32 v128, a128
    v_accvgpr_read_b32 v129, a129
    v_accvgpr_read_b32 v130, a130
    v_accvgpr_read_b32 v131, a131
    v_accvgpr_read_b32 v132, a144
    v_accvgpr_read_b32 v133, a145
    v_accvgpr_read_b32 v134, a146
    v_accvgpr_read_b32 v135, a147
    v_pk_fma_f32 v[128:129], v[104:105], v[0:1], v[128:129] op_sel:[0,0,0] op_sel_hi:[0,1,1]
    v_pk_fma_f32 v[130:131], v[104:105], v[2:3], v[130:131] op_sel:[0,0,0] op_sel_hi:[0,1,1]
    v_pk_fma_f32 v[132:133], v[104:105], v[4:5], v[132:133] op_sel:[0,0,0] op_sel_hi:[0,1,1]
    v_pk_fma_f32 v[134:135], v[104:105], v[6:7], v[134:135] op_sel:[0,0,0] op_sel_hi:[0,1,1]
    v_pk_fma_f32 v[128:129], v[112:113], v[128:129], v[64:65] op_sel:[0,0,0] op_sel_hi:[0,1,1]
    v_pk_fma_f32 v[130:131], v[112:113], v[130:131], v[66:67] op_sel:[0,0,0] op_sel_hi:[0,1,1]
    v_pk_fma_f32 v[132:133], v[112:113], v[132:133], v[68:69] op_sel:[0,0,0] op_sel_hi:[0,1,1]
    v_pk_fma_f32 v[134:135], v[112:113], v[134:135], v[70:71] op_sel:[0,0,0] op_sel_hi:[0,1,1]
    v_pk_mul_f32 v[136:137], v[128:129], v[128:129] op_sel:[0,0] op_sel_hi:[1,1]
    v_pk_mul_f32 v[138:139], v[130:131], v[130:131] op_sel:[0,0] op_sel_hi:[1,1]
    v_pk_mul_f32 v[140:141], v[132:133], v[132:133] op_sel:[0,0] op_sel_hi:[1,1]
    v_pk_mul_f32 v[142:143], v[134:135], v[134:135] op_sel:[0,0] op_sel_hi:[1,1]
    v_pk_fma_f32 v[136:137], v[136:137], s[66:67], v[116:117] op_sel:[0,1,0] op_sel_hi:[1,1,0]
    v_pk_fma_f32 v[138:139], v[138:139], s[66:67], v[116:117] op_sel:[0,1,0] op_sel_hi:[1,1,0]
    v_pk_fma_f32 v[140:141], v[140:141], s[66:67], v[116:117] op_sel:[0,1,0] op_sel_hi:[1,1,0]
    v_pk_fma_f32 v[142:143], v[142:143], s[66:67], v[116:117] op_sel:[0,1,0] op_sel_hi:[1,1,0]
    v_pk_mul_f32 v[136:137], v[136:137], v[128:129] op_sel:[0,0] op_sel_hi:[1,1]
    v_pk_mul_f32 v[138:139], v[138:139], v[130:131] op_sel:[0,0] op_sel_hi:[1,1]
    v_pk_mul_f32 v[140:141], v[140:141], v[132:133] op_sel:[0,0] op_sel_hi:[1,1]
    v_pk_mul_f32 v[142:143], v[142:143], v[134:135] op_sel:[0,0] op_sel_hi:[1,1]
    v_exp_f32 v136, v136
    v_exp_f32 v137, v137
    v_exp_f32 v138, v138
    v_exp_f32 v139, v139
    v_exp_f32 v140, v140
    v_exp_f32 v141, v141
    v_exp_f32 v142, v142
    v_exp_f32 v143, v143
    v_pk_add_f32 v[136:137], v[136:137], 1.0 op_sel:[0,0] op_sel_hi:[1,0]
    v_pk_add_f32 v[138:139], v[138:139], 1.0 op_sel:[0,0] op_sel_hi:[1,0]
    v_pk_add_f32 v[140:141], v[140:141], 1.0 op_sel:[0,0] op_sel_hi:[1,0]
    v_pk_add_f32 v[142:143], v[142:143], 1.0 op_sel:[0,0] op_sel_hi:[1,0]
    v_rcp_f32 v136, v136
    v_rcp_f32 v137, v137
    v_rcp_f32 v138, v138
    v_rcp_f32 v139, v139
    v_rcp_f32 v140, v140
    v_rcp_f32 v141, v141
    v_rcp_f32 v142, v142
    v_rcp_f32 v143, v143
    v_pk_mul_f32 v[128:129], v[128:129], v[136:137] op_sel:[0,0] op_sel_hi:[1,1]
    v_pk_mul_f32 v[130:131], v[130:131], v[138:139] op_sel:[0,0] op_sel_hi:[1,1]
    v_pk_mul_f32 v[132:133], v[132:133], v[140:141] op_sel:[0,0] op_sel_hi:[1,1]
    v_pk_mul_f32 v[134:135], v[134:135], v[142:143] op_sel:[0,0] op_sel_hi:[1,1]
    v_cvt_pk_bf16_f32 v136, v128, v129
    v_cvt_pk_bf16_f32 v137, v130, v131
    v_cvt_pk_bf16_f32 v138, v132, v133
    v_cvt_pk_bf16_f32 v139, v134, v135
    buffer_store_dwordx4 v[136:139], v117, s[52:55], s68 offen offset:0 sc1
    v_accvgpr_read_b32 v144, a132
    v_accvgpr_read_b32 v145, a133
    v_accvgpr_read_b32 v146, a134
    v_accvgpr_read_b32 v147, a135
    v_accvgpr_read_b32 v148, a148
    v_accvgpr_read_b32 v149, a149
    v_accvgpr_read_b32 v150, a150
    v_accvgpr_read_b32 v151, a151
    v_pk_fma_f32 v[144:145], v[104:105], v[0:1], v[144:145] op_sel:[1,0,0] op_sel_hi:[1,1,1]
    v_pk_fma_f32 v[146:147], v[104:105], v[2:3], v[146:147] op_sel:[1,0,0] op_sel_hi:[1,1,1]
    v_pk_fma_f32 v[148:149], v[104:105], v[4:5], v[148:149] op_sel:[1,0,0] op_sel_hi:[1,1,1]
    v_pk_fma_f32 v[150:151], v[104:105], v[6:7], v[150:151] op_sel:[1,0,0] op_sel_hi:[1,1,1]
    v_pk_fma_f32 v[144:145], v[112:113], v[144:145], v[64:65] op_sel:[1,0,0] op_sel_hi:[1,1,1]
    v_pk_fma_f32 v[146:147], v[112:113], v[146:147], v[66:67] op_sel:[1,0,0] op_sel_hi:[1,1,1]
    v_pk_fma_f32 v[148:149], v[112:113], v[148:149], v[68:69] op_sel:[1,0,0] op_sel_hi:[1,1,1]
    v_pk_fma_f32 v[150:151], v[112:113], v[150:151], v[70:71] op_sel:[1,0,0] op_sel_hi:[1,1,1]
    v_pk_mul_f32 v[152:153], v[144:145], v[144:145] op_sel:[0,0] op_sel_hi:[1,1]
    v_pk_mul_f32 v[154:155], v[146:147], v[146:147] op_sel:[0,0] op_sel_hi:[1,1]
    v_pk_mul_f32 v[156:157], v[148:149], v[148:149] op_sel:[0,0] op_sel_hi:[1,1]
    v_pk_mul_f32 v[158:159], v[150:151], v[150:151] op_sel:[0,0] op_sel_hi:[1,1]
    v_pk_fma_f32 v[152:153], v[152:153], s[66:67], v[116:117] op_sel:[0,1,0] op_sel_hi:[1,1,0]
    v_pk_fma_f32 v[154:155], v[154:155], s[66:67], v[116:117] op_sel:[0,1,0] op_sel_hi:[1,1,0]
    v_pk_fma_f32 v[156:157], v[156:157], s[66:67], v[116:117] op_sel:[0,1,0] op_sel_hi:[1,1,0]
    v_pk_fma_f32 v[158:159], v[158:159], s[66:67], v[116:117] op_sel:[0,1,0] op_sel_hi:[1,1,0]
    v_pk_mul_f32 v[152:153], v[152:153], v[144:145] op_sel:[0,0] op_sel_hi:[1,1]
    v_pk_mul_f32 v[154:155], v[154:155], v[146:147] op_sel:[0,0] op_sel_hi:[1,1]
    v_pk_mul_f32 v[156:157], v[156:157], v[148:149] op_sel:[0,0] op_sel_hi:[1,1]
    v_pk_mul_f32 v[158:159], v[158:159], v[150:151] op_sel:[0,0] op_sel_hi:[1,1]
    v_exp_f32 v152, v152
    v_exp_f32 v153, v153
    v_exp_f32 v154, v154
    v_exp_f32 v155, v155
    v_exp_f32 v156, v156
    v_exp_f32 v157, v157
    v_exp_f32 v158, v158
    v_exp_f32 v159, v159
    v_pk_add_f32 v[152:153], v[152:153], 1.0 op_sel:[0,0] op_sel_hi:[1,0]
    v_pk_add_f32 v[154:155], v[154:155], 1.0 op_sel:[0,0] op_sel_hi:[1,0]
    v_pk_add_f32 v[156:157], v[156:157], 1.0 op_sel:[0,0] op_sel_hi:[1,0]
    v_pk_add_f32 v[158:159], v[158:159], 1.0 op_sel:[0,0] op_sel_hi:[1,0]
    v_rcp_f32 v152, v152
    v_rcp_f32 v153, v153
    v_rcp_f32 v154, v154
    v_rcp_f32 v155, v155
    v_rcp_f32 v156, v156
    v_rcp_f32 v157, v157
    v_rcp_f32 v158, v158
    v_rcp_f32 v159, v159
    v_pk_mul_f32 v[144:145], v[144:145], v[152:153] op_sel:[0,0] op_sel_hi:[1,1]
    v_pk_mul_f32 v[146:147], v[146:147], v[154:155] op_sel:[0,0] op_sel_hi:[1,1]
    v_pk_mul_f32 v[148:149], v[148:149], v[156:157] op_sel:[0,0] op_sel_hi:[1,1]
    v_pk_mul_f32 v[150:151], v[150:151], v[158:159] op_sel:[0,0] op_sel_hi:[1,1]
    v_cvt_pk_bf16_f32 v152, v144, v145
    v_cvt_pk_bf16_f32 v153, v146, v147
    v_cvt_pk_bf16_f32 v154, v148, v149
    v_cvt_pk_bf16_f32 v155, v150, v151
    buffer_store_dwordx4 v[152:155], v117, s[52:55], s68 offen offset:1024 sc1
    v_accvgpr_read_b32 v160, a136
    v_accvgpr_read_b32 v161, a137
    v_accvgpr_read_b32 v162, a138
    v_accvgpr_read_b32 v163, a139
    v_accvgpr_read_b32 v164, a152
    v_accvgpr_read_b32 v165, a153
    v_accvgpr_read_b32 v166, a154
    v_accvgpr_read_b32 v167, a155
    v_pk_fma_f32 v[160:161], v[106:107], v[0:1], v[160:161] op_sel:[0,0,0] op_sel_hi:[0,1,1]
    v_pk_fma_f32 v[162:163], v[106:107], v[2:3], v[162:163] op_sel:[0,0,0] op_sel_hi:[0,1,1]
    v_pk_fma_f32 v[164:165], v[106:107], v[4:5], v[164:165] op_sel:[0,0,0] op_sel_hi:[0,1,1]
    v_pk_fma_f32 v[166:167], v[106:107], v[6:7], v[166:167] op_sel:[0,0,0] op_sel_hi:[0,1,1]
    v_pk_fma_f32 v[160:161], v[114:115], v[160:161], v[64:65] op_sel:[0,0,0] op_sel_hi:[0,1,1]
    v_pk_fma_f32 v[162:163], v[114:115], v[162:163], v[66:67] op_sel:[0,0,0] op_sel_hi:[0,1,1]
    v_pk_fma_f32 v[164:165], v[114:115], v[164:165], v[68:69] op_sel:[0,0,0] op_sel_hi:[0,1,1]
    v_pk_fma_f32 v[166:167], v[114:115], v[166:167], v[70:71] op_sel:[0,0,0] op_sel_hi:[0,1,1]
    v_pk_mul_f32 v[168:169], v[160:161], v[160:161] op_sel:[0,0] op_sel_hi:[1,1]
    v_pk_mul_f32 v[170:171], v[162:163], v[162:163] op_sel:[0,0] op_sel_hi:[1,1]
    v_pk_mul_f32 v[172:173], v[164:165], v[164:165] op_sel:[0,0] op_sel_hi:[1,1]
    v_pk_mul_f32 v[174:175], v[166:167], v[166:167] op_sel:[0,0] op_sel_hi:[1,1]
    v_pk_fma_f32 v[168:169], v[168:169], s[66:67], v[116:117] op_sel:[0,1,0] op_sel_hi:[1,1,0]
    v_pk_fma_f32 v[170:171], v[170:171], s[66:67], v[116:117] op_sel:[0,1,0] op_sel_hi:[1,1,0]
    v_pk_fma_f32 v[172:173], v[172:173], s[66:67], v[116:117] op_sel:[0,1,0] op_sel_hi:[1,1,0]
    v_pk_fma_f32 v[174:175], v[174:175], s[66:67], v[116:117] op_sel:[0,1,0] op_sel_hi:[1,1,0]
    v_pk_mul_f32 v[168:169], v[168:169], v[160:161] op_sel:[0,0] op_sel_hi:[1,1]
    v_pk_mul_f32 v[170:171], v[170:171], v[162:163] op_sel:[0,0] op_sel_hi:[1,1]
    v_pk_mul_f32 v[172:173], v[172:173], v[164:165] op_sel:[0,0] op_sel_hi:[1,1]
    v_pk_mul_f32 v[174:175], v[174:175], v[166:167] op_sel:[0,0] op_sel_hi:[1,1]
    v_exp_f32 v168, v168
    v_exp_f32 v169, v169
    v_exp_f32 v170, v170
    v_exp_f32 v171, v171
    v_exp_f32 v172, v172
    v_exp_f32 v173, v173
    v_exp_f32 v174, v174
    v_exp_f32 v175, v175
    v_pk_add_f32 v[168:169], v[168:169], 1.0 op_sel:[0,0] op_sel_hi:[1,0]
    v_pk_add_f32 v[170:171], v[170:171], 1.0 op_sel:[0,0] op_sel_hi:[1,0]
    v_pk_add_f32 v[172:173], v[172:173], 1.0 op_sel:[0,0] op_sel_hi:[1,0]
    v_pk_add_f32 v[174:175], v[174:175], 1.0 op_sel:[0,0] op_sel_hi:[1,0]
    v_rcp_f32 v168, v168
    v_rcp_f32 v169, v169
    v_rcp_f32 v170, v170
    v_rcp_f32 v171, v171
    v_rcp_f32 v172, v172
    v_rcp_f32 v173, v173
    v_rcp_f32 v174, v174
    v_rcp_f32 v175, v175
    v_pk_mul_f32 v[160:161], v[160:161], v[168:169] op_sel:[0,0] op_sel_hi:[1,1]
    v_pk_mul_f32 v[162:163], v[162:163], v[170:171] op_sel:[0,0] op_sel_hi:[1,1]
    v_pk_mul_f32 v[164:165], v[164:165], v[172:173] op_sel:[0,0] op_sel_hi:[1,1]
    v_pk_mul_f32 v[166:167], v[166:167], v[174:175] op_sel:[0,0] op_sel_hi:[1,1]
    v_cvt_pk_bf16_f32 v168, v160, v161
    v_cvt_pk_bf16_f32 v169, v162, v163
    v_cvt_pk_bf16_f32 v170, v164, v165
    v_cvt_pk_bf16_f32 v171, v166, v167
    buffer_store_dwordx4 v[168:171], v117, s[52:55], s69 offen offset:0 sc1
    v_accvgpr_read_b32 v176, a140
    v_accvgpr_read_b32 v177, a141
    v_accvgpr_read_b32 v178, a142
    v_accvgpr_read_b32 v179, a143
    v_accvgpr_read_b32 v180, a156
    v_accvgpr_read_b32 v181, a157
    v_accvgpr_read_b32 v182, a158
    v_accvgpr_read_b32 v183, a159
    v_pk_fma_f32 v[176:177], v[106:107], v[0:1], v[176:177] op_sel:[1,0,0] op_sel_hi:[1,1,1]
    v_pk_fma_f32 v[178:179], v[106:107], v[2:3], v[178:179] op_sel:[1,0,0] op_sel_hi:[1,1,1]
    v_pk_fma_f32 v[180:181], v[106:107], v[4:5], v[180:181] op_sel:[1,0,0] op_sel_hi:[1,1,1]
    v_pk_fma_f32 v[182:183], v[106:107], v[6:7], v[182:183] op_sel:[1,0,0] op_sel_hi:[1,1,1]
    v_pk_fma_f32 v[176:177], v[114:115], v[176:177], v[64:65] op_sel:[1,0,0] op_sel_hi:[1,1,1]
    v_pk_fma_f32 v[178:179], v[114:115], v[178:179], v[66:67] op_sel:[1,0,0] op_sel_hi:[1,1,1]
    v_pk_fma_f32 v[180:181], v[114:115], v[180:181], v[68:69] op_sel:[1,0,0] op_sel_hi:[1,1,1]
    v_pk_fma_f32 v[182:183], v[114:115], v[182:183], v[70:71] op_sel:[1,0,0] op_sel_hi:[1,1,1]
    v_pk_mul_f32 v[184:185], v[176:177], v[176:177] op_sel:[0,0] op_sel_hi:[1,1]
    v_pk_mul_f32 v[186:187], v[178:179], v[178:179] op_sel:[0,0] op_sel_hi:[1,1]
    v_pk_mul_f32 v[188:189], v[180:181], v[180:181] op_sel:[0,0] op_sel_hi:[1,1]
    v_pk_mul_f32 v[190:191], v[182:183], v[182:183] op_sel:[0,0] op_sel_hi:[1,1]
    v_pk_fma_f32 v[184:185], v[184:185], s[66:67], v[116:117] op_sel:[0,1,0] op_sel_hi:[1,1,0]
    v_pk_fma_f32 v[186:187], v[186:187], s[66:67], v[116:117] op_sel:[0,1,0] op_sel_hi:[1,1,0]
    v_pk_fma_f32 v[188:189], v[188:189], s[66:67], v[116:117] op_sel:[0,1,0] op_sel_hi:[1,1,0]
    v_pk_fma_f32 v[190:191], v[190:191], s[66:67], v[116:117] op_sel:[0,1,0] op_sel_hi:[1,1,0]
    v_pk_mul_f32 v[184:185], v[184:185], v[176:177] op_sel:[0,0] op_sel_hi:[1,1]
    v_pk_mul_f32 v[186:187], v[186:187], v[178:179] op_sel:[0,0] op_sel_hi:[1,1]
    v_pk_mul_f32 v[188:189], v[188:189], v[180:181] op_sel:[0,0] op_sel_hi:[1,1]
    v_pk_mul_f32 v[190:191], v[190:191], v[182:183] op_sel:[0,0] op_sel_hi:[1,1]
    v_exp_f32 v184, v184
    v_exp_f32 v185, v185
    v_exp_f32 v186, v186
    v_exp_f32 v187, v187
    v_exp_f32 v188, v188
    v_exp_f32 v189, v189
    v_exp_f32 v190, v190
    v_exp_f32 v191, v191
    v_pk_add_f32 v[184:185], v[184:185], 1.0 op_sel:[0,0] op_sel_hi:[1,0]
    v_pk_add_f32 v[186:187], v[186:187], 1.0 op_sel:[0,0] op_sel_hi:[1,0]
    v_pk_add_f32 v[188:189], v[188:189], 1.0 op_sel:[0,0] op_sel_hi:[1,0]
    v_pk_add_f32 v[190:191], v[190:191], 1.0 op_sel:[0,0] op_sel_hi:[1,0]
    v_rcp_f32 v184, v184
    v_rcp_f32 v185, v185
    v_rcp_f32 v186, v186
    v_rcp_f32 v187, v187
    v_rcp_f32 v188, v188
    v_rcp_f32 v189, v189
    v_rcp_f32 v190, v190
    v_rcp_f32 v191, v191
    v_pk_mul_f32 v[176:177], v[176:177], v[184:185] op_sel:[0,0] op_sel_hi:[1,1]
    v_pk_mul_f32 v[178:179], v[178:179], v[186:187] op_sel:[0,0] op_sel_hi:[1,1]
    v_pk_mul_f32 v[180:181], v[180:181], v[188:189] op_sel:[0,0] op_sel_hi:[1,1]
    v_pk_mul_f32 v[182:183], v[182:183], v[190:191] op_sel:[0,0] op_sel_hi:[1,1]
    v_cvt_pk_bf16_f32 v184, v176, v177
    v_cvt_pk_bf16_f32 v185, v178, v179
    v_cvt_pk_bf16_f32 v186, v180, v181
    v_cvt_pk_bf16_f32 v187, v182, v183
    buffer_store_dwordx4 v[184:187], v117, s[52:55], s69 offen offset:1024 sc1
    v_accvgpr_read_b32 v128, a160
    v_accvgpr_read_b32 v129, a161
    v_accvgpr_read_b32 v130, a162
    v_accvgpr_read_b32 v131, a163
    v_accvgpr_read_b32 v132, a176
    v_accvgpr_read_b32 v133, a177
    v_accvgpr_read_b32 v134, a178
    v_accvgpr_read_b32 v135, a179
    v_pk_fma_f32 v[128:129], v[104:105], v[8:9], v[128:129] op_sel:[0,0,0] op_sel_hi:[0,1,1]
    v_pk_fma_f32 v[130:131], v[104:105], v[10:11], v[130:131] op_sel:[0,0,0] op_sel_hi:[0,1,1]
    v_pk_fma_f32 v[132:133], v[104:105], v[12:13], v[132:133] op_sel:[0,0,0] op_sel_hi:[0,1,1]
    v_pk_fma_f32 v[134:135], v[104:105], v[14:15], v[134:135] op_sel:[0,0,0] op_sel_hi:[0,1,1]
    v_pk_fma_f32 v[128:129], v[112:113], v[128:129], v[72:73] op_sel:[0,0,0] op_sel_hi:[0,1,1]
    v_pk_fma_f32 v[130:131], v[112:113], v[130:131], v[74:75] op_sel:[0,0,0] op_sel_hi:[0,1,1]
    v_pk_fma_f32 v[132:133], v[112:113], v[132:133], v[76:77] op_sel:[0,0,0] op_sel_hi:[0,1,1]
    v_pk_fma_f32 v[134:135], v[112:113], v[134:135], v[78:79] op_sel:[0,0,0] op_sel_hi:[0,1,1]
    v_pk_mul_f32 v[136:137], v[128:129], v[128:129] op_sel:[0,0] op_sel_hi:[1,1]
    v_pk_mul_f32 v[138:139], v[130:131], v[130:131] op_sel:[0,0] op_sel_hi:[1,1]
    v_pk_mul_f32 v[140:141], v[132:133], v[132:133] op_sel:[0,0] op_sel_hi:[1,1]
    v_pk_mul_f32 v[142:143], v[134:135], v[134:135] op_sel:[0,0] op_sel_hi:[1,1]
    v_pk_fma_f32 v[136:137], v[136:137], s[66:67], v[116:117] op_sel:[0,1,0] op_sel_hi:[1,1,0]
    v_pk_fma_f32 v[138:139], v[138:139], s[66:67], v[116:117] op_sel:[0,1,0] op_sel_hi:[1,1,0]
    v_pk_fma_f32 v[140:141], v[140:141], s[66:67], v[116:117] op_sel:[0,1,0] op_sel_hi:[1,1,0]
    v_pk_fma_f32 v[142:143], v[142:143], s[66:67], v[116:117] op_sel:[0,1,0] op_sel_hi:[1,1,0]
    v_pk_mul_f32 v[136:137], v[136:137], v[128:129] op_sel:[0,0] op_sel_hi:[1,1]
    v_pk_mul_f32 v[138:139], v[138:139], v[130:131] op_sel:[0,0] op_sel_hi:[1,1]
    v_pk_mul_f32 v[140:141], v[140:141], v[132:133] op_sel:[0,0] op_sel_hi:[1,1]
    v_pk_mul_f32 v[142:143], v[142:143], v[134:135] op_sel:[0,0] op_sel_hi:[1,1]
    v_exp_f32 v136, v136
    v_exp_f32 v137, v137
    v_exp_f32 v138, v138
    v_exp_f32 v139, v139
    v_exp_f32 v140, v140
    v_exp_f32 v141, v141
    v_exp_f32 v142, v142
    v_exp_f32 v143, v143
    v_pk_add_f32 v[136:137], v[136:137], 1.0 op_sel:[0,0] op_sel_hi:[1,0]
    v_pk_add_f32 v[138:139], v[138:139], 1.0 op_sel:[0,0] op_sel_hi:[1,0]
    v_pk_add_f32 v[140:141], v[140:141], 1.0 op_sel:[0,0] op_sel_hi:[1,0]
    v_pk_add_f32 v[142:143], v[142:143], 1.0 op_sel:[0,0] op_sel_hi:[1,0]
    v_rcp_f32 v136, v136
    v_rcp_f32 v137, v137
    v_rcp_f32 v138, v138
    v_rcp_f32 v139, v139
    v_rcp_f32 v140, v140
    v_rcp_f32 v141, v141
    v_rcp_f32 v142, v142
    v_rcp_f32 v143, v143
    v_pk_mul_f32 v[128:129], v[128:129], v[136:137] op_sel:[0,0] op_sel_hi:[1,1]
    v_pk_mul_f32 v[130:131], v[130:131], v[138:139] op_sel:[0,0] op_sel_hi:[1,1]
    v_pk_mul_f32 v[132:133], v[132:133], v[140:141] op_sel:[0,0] op_sel_hi:[1,1]
    v_pk_mul_f32 v[134:135], v[134:135], v[142:143] op_sel:[0,0] op_sel_hi:[1,1]
    v_cvt_pk_bf16_f32 v136, v128, v129
    v_cvt_pk_bf16_f32 v137, v130, v131
    v_cvt_pk_bf16_f32 v138, v132, v133
    v_cvt_pk_bf16_f32 v139, v134, v135
    buffer_store_dwordx4 v[136:139], v117, s[52:55], s70 offen offset:0 sc1
    v_accvgpr_read_b32 v144, a164
    v_accvgpr_read_b32 v145, a165
    v_accvgpr_read_b32 v146, a166
    v_accvgpr_read_b32 v147, a167
    v_accvgpr_read_b32 v148, a180
    v_accvgpr_read_b32 v149, a181
    v_accvgpr_read_b32 v150, a182
    v_accvgpr_read_b32 v151, a183
    v_pk_fma_f32 v[144:145], v[104:105], v[8:9], v[144:145] op_sel:[1,0,0] op_sel_hi:[1,1,1]
    v_pk_fma_f32 v[146:147], v[104:105], v[10:11], v[146:147] op_sel:[1,0,0] op_sel_hi:[1,1,1]
    v_pk_fma_f32 v[148:149], v[104:105], v[12:13], v[148:149] op_sel:[1,0,0] op_sel_hi:[1,1,1]
    v_pk_fma_f32 v[150:151], v[104:105], v[14:15], v[150:151] op_sel:[1,0,0] op_sel_hi:[1,1,1]
    v_pk_fma_f32 v[144:145], v[112:113], v[144:145], v[72:73] op_sel:[1,0,0] op_sel_hi:[1,1,1]
    v_pk_fma_f32 v[146:147], v[112:113], v[146:147], v[74:75] op_sel:[1,0,0] op_sel_hi:[1,1,1]
    v_pk_fma_f32 v[148:149], v[112:113], v[148:149], v[76:77] op_sel:[1,0,0] op_sel_hi:[1,1,1]
    v_pk_fma_f32 v[150:151], v[112:113], v[150:151], v[78:79] op_sel:[1,0,0] op_sel_hi:[1,1,1]
    v_pk_mul_f32 v[152:153], v[144:145], v[144:145] op_sel:[0,0] op_sel_hi:[1,1]
    v_pk_mul_f32 v[154:155], v[146:147], v[146:147] op_sel:[0,0] op_sel_hi:[1,1]
    v_pk_mul_f32 v[156:157], v[148:149], v[148:149] op_sel:[0,0] op_sel_hi:[1,1]
    v_pk_mul_f32 v[158:159], v[150:151], v[150:151] op_sel:[0,0] op_sel_hi:[1,1]
    v_pk_fma_f32 v[152:153], v[152:153], s[66:67], v[116:117] op_sel:[0,1,0] op_sel_hi:[1,1,0]
    v_pk_fma_f32 v[154:155], v[154:155], s[66:67], v[116:117] op_sel:[0,1,0] op_sel_hi:[1,1,0]
    v_pk_fma_f32 v[156:157], v[156:157], s[66:67], v[116:117] op_sel:[0,1,0] op_sel_hi:[1,1,0]
    v_pk_fma_f32 v[158:159], v[158:159], s[66:67], v[116:117] op_sel:[0,1,0] op_sel_hi:[1,1,0]
    v_pk_mul_f32 v[152:153], v[152:153], v[144:145] op_sel:[0,0] op_sel_hi:[1,1]
    v_pk_mul_f32 v[154:155], v[154:155], v[146:147] op_sel:[0,0] op_sel_hi:[1,1]
    v_pk_mul_f32 v[156:157], v[156:157], v[148:149] op_sel:[0,0] op_sel_hi:[1,1]
    v_pk_mul_f32 v[158:159], v[158:159], v[150:151] op_sel:[0,0] op_sel_hi:[1,1]
    v_exp_f32 v152, v152
    v_exp_f32 v153, v153
    v_exp_f32 v154, v154
    v_exp_f32 v155, v155
    v_exp_f32 v156, v156
    v_exp_f32 v157, v157
    v_exp_f32 v158, v158
    v_exp_f32 v159, v159
    v_pk_add_f32 v[152:153], v[152:153], 1.0 op_sel:[0,0] op_sel_hi:[1,0]
    v_pk_add_f32 v[154:155], v[154:155], 1.0 op_sel:[0,0] op_sel_hi:[1,0]
    v_pk_add_f32 v[156:157], v[156:157], 1.0 op_sel:[0,0] op_sel_hi:[1,0]
    v_pk_add_f32 v[158:159], v[158:159], 1.0 op_sel:[0,0] op_sel_hi:[1,0]
    v_rcp_f32 v152, v152
    v_rcp_f32 v153, v153
    v_rcp_f32 v154, v154
    v_rcp_f32 v155, v155
    v_rcp_f32 v156, v156
    v_rcp_f32 v157, v157
    v_rcp_f32 v158, v158
    v_rcp_f32 v159, v159
    v_pk_mul_f32 v[144:145], v[144:145], v[152:153] op_sel:[0,0] op_sel_hi:[1,1]
    v_pk_mul_f32 v[146:147], v[146:147], v[154:155] op_sel:[0,0] op_sel_hi:[1,1]
    v_pk_mul_f32 v[148:149], v[148:149], v[156:157] op_sel:[0,0] op_sel_hi:[1,1]
    v_pk_mul_f32 v[150:151], v[150:151], v[158:159] op_sel:[0,0] op_sel_hi:[1,1]
    v_cvt_pk_bf16_f32 v152, v144, v145
    v_cvt_pk_bf16_f32 v153, v146, v147
    v_cvt_pk_bf16_f32 v154, v148, v149
    v_cvt_pk_bf16_f32 v155, v150, v151
    buffer_store_dwordx4 v[152:155], v117, s[52:55], s70 offen offset:1024 sc1
    s_branch L_front_done
L_light:
    s_waitcnt vmcnt(14)
    s_barrier
    ds_read_b128 a[0:3], v14 offset:0
    ds_read_b128 a[4:7], v14 offset:2048
    ds_read_b128 a[8:11], v14 offset:4096
    ds_read_b128 a[12:15], v14 offset:6144
    ds_read_b128 a[16:19], v15 offset:0
    ds_read_b128 a[20:23], v15 offset:2048
    ds_read_b128 a[24:27], v15 offset:4096
    ds_read_b128 a[28:31], v15 offset:6144
    ds_read_b64_tr_b16 a[64:65], v16 offset:0
    ds_read_b64_tr_b16 a[66:67], v16 offset:1024
    ds_read_b64_tr_b16 a[68:69], v16 offset:8192
    ds_read_b64_tr_b16 a[70:71], v16 offset:9216
    ds_read_b64_tr_b16 a[72:73], v16 offset:8
    ds_read_b64_tr_b16 a[74:75], v16 offset:1032
    ds_read_b64_tr_b16 a[76:77], v16 offset:8200
    ds_read_b64_tr_b16 a[78:79], v16 offset:9224
    s_waitcnt lgkmcnt(4)
    v_mfma_f32_16x16x32_bf16 v[128:131], a[64:67], a[0:3], 0
    ds_read_b64_tr_b16 a[80:81], v17 offset:0
    v_mfma_f32_16x16x32_bf16 v[128:131], a[68:71], a[16:19], v[128:131]
    ds_read_b64_tr_b16 a[82:83], v17 offset:1024
    v_mfma_f32_16x16x32_bf16 v[160:163], a[64:67], a[4:7], 0
    ds_read_b64_tr_b16 a[84:85], v17 offset:8192
    v_mfma_f32_16x16x32_bf16 v[160:163], a[68:71], a[20:23], v[160:163]
    ds_read_b64_tr_b16 a[86:87], v17 offset:9216
    s_add_u32 s78, s28, 2
    s_and_b32 s78, s78, 7
    s_lshl_b32 s78, s78, 7
    s_add_u32 s74, s61, s78
    s_xor_b32 s75, s74, 0x8000
    s_add_u32 m0, s60, 0
    v_mfma_f32_16x16x32_bf16 v[192:195], a[64:67], a[8:11], 0
    buffer_load_dwordx4 v0, s[16:19], s74 offen offset:0 lds
    v_mfma_f32_16x16x32_bf16 v[192:195], a[68:71], a[24:27], v[192:195]
    buffer_load_dwordx4 v1, s[16:19], s74 offen offset:1024 lds
    v_mfma_f32_16x16x32_bf16 v[224:227], a[64:67], a[12:15], 0
    buffer_load_dwordx4 v2, s[16:19], s74 offen offset:2048 lds
    v_mfma_f32_16x16x32_bf16 v[224:227], a[68:71], a[28:31], v[224:227]
    buffer_load_dwordx4 v3, s[16:19], s74 offen offset:3072 lds
    v_mfma_f32_16x16x32_bf16 a[224:227], a[64:67], a[96:99], 0
    v_mfma_f32_16x16x32_bf16 a[224:227], a[68:71], a[96:99], a[224:227]
    s_waitcnt lgkmcnt(4)
    v_mfma_f32_16x16x32_bf16 v[132:135], a[72:75], a[0:3], 0
    ds_read_b64_tr_b16 a[88:89], v17 offset:8
    v_mfma_f32_16x16x32_bf16 v[132:135], a[76:79], a[16:19], v[132:135]
    ds_read_b64_tr_b16 a[90:91], v17 offset:1032
    v_mfma_f32_16x16x32_bf16 v[164:167], a[72:75], a[4:7], 0
    ds_read_b64_tr_b16 a[92:93], v17 offset:8200
    v_mfma_f32_16x16x32_bf16 v[164:167], a[76:79], a[20:23], v[164:167]
    ds_read_b64_tr_b16 a[94:95], v17 offset:9224
    s_add_u32 m0, s60, 4096
    v_mfma_f32_16x16x32_bf16 v[196:199], a[72:75], a[8:11], 0
    buffer_load_dwordx4 v0, s[16:19], s75 offen offset:0 lds
    v_mfma_f32_16x16x32_bf16 v[196:199], a[76:79], a[24:27], v[196:199]
    buffer_load_dwordx4 v1, s[16:19], s75 offen offset:1024 lds
    v_mfma_f32_16x16x32_bf16 v[228:231], a[72:75], a[12:15], 0
    buffer_load_dwordx4 v2, s[16:19], s75 offen offset:2048 lds
    v_mfma_f32_16x16x32_bf16 v[228:231], a[76:79], a[28:31], v[228:231]
    buffer_load_dwordx4 v3, s[16:19], s75 offen offset:3072 lds
    v_mfma_f32_16x16x32_bf16 a[228:231], a[72:75], a[96:99], 0
    v_mfma_f32_16x16x32_bf16 a[228:231], a[76:79], a[96:99], a[228:231]
    s_waitcnt lgkmcnt(4)
    v_mfma_f32_16x16x32_bf16 v[136:139], a[80:83], a[0:3], 0
    ds_read_b64_tr_b16 a[64:65], v18 offset:0
    v_mfma_f32_16x16x32_bf16 v[136:139], a[84:87], a[16:19], v[136:139]
    ds_read_b64_tr_b16 a[66:67], v18 offset:1024
    v_mfma_f32_16x16x32_bf16 v[168:171], a[80:83], a[4:7], 0
    ds_read_b64_tr_b16 a[68:69], v18 offset:8192
    v_mfma_f32_16x16x32_bf16 v[168:171], a[84:87], a[20:23], v[168:171]
    ds_read_b64_tr_b16 a[70:71], v18 offset:9216
    s_add_u32 s78, s28, 2
    s_and_b32 s78, s78, 7
    s_lshl_b32 s79, s78, 19
    s_add_u32 s76, s62, s79
    s_mul_i32 s79, s78, 176128
    s_add_u32 s77, s63, s79
    s_add_u32 m0, s24, 114688
    v_mfma_f32_16x16x32_bf16 v[200:203], a[80:83], a[8:11], 0
    buffer_load_dwordx4 v8, s[40:43], s76 offen offset:0 lds
    v_mfma_f32_16x16x32_bf16 v[200:203], a[84:87], a[24:27], v[200:203]
    buffer_load_dwordx4 v9, s[40:43], s76 offen offset:1024 lds
    v_mfma_f32_16x16x32_bf16 v[232:235], a[80:83], a[12:15], 0
    buffer_load_dwordx4 v10, s[40:43], s76 offen offset:2048 lds
    v_mfma_f32_16x16x32_bf16 v[232:235], a[84:87], a[28:31], v[232:235]
    s_waitcnt lgkmcnt(4)
    v_mfma_f32_16x16x32_bf16 v[140:143], a[88:91], a[0:3], 0
    ds_read_b64_tr_b16 a[72:73], v18 offset:8
    v_mfma_f32_16x16x32_bf16 v[140:143], a[92:95], a[16:19], v[140:143]
    ds_read_b64_tr_b16 a[74:75], v18 offset:1032
    v_mfma_f32_16x16x32_bf16 v[172:175], a[88:91], a[4:7], 0
    ds_read_b64_tr_b16 a[76:77], v18 offset:8200
    v_mfma_f32_16x16x32_bf16 v[172:175], a[92:95], a[20:23], v[172:175]
    ds_read_b64_tr_b16 a[78:79], v18 offset:9224
    v_mfma_f32_16x16x32_bf16 v[204:207], a[88:91], a[8:11], 0
    buffer_load_dwordx4 v11, s[40:43], s76 offen offset:3072 lds
    s_add_u32 m0, s64, 131072
    v_mfma_f32_16x16x32_bf16 v[204:207], a[92:95], a[24:27], v[204:207]
    buffer_load_dwordx4 v12, s[44:47], s77 offen offset:0 lds
    v_mfma_f32_16x16x32_bf16 v[236:239], a[88:91], a[12:15], 0
    buffer_load_dwordx4 v13, s[44:47], s77 offen offset:1024 lds
    v_mfma_f32_16x16x32_bf16 v[236:239], a[92:95], a[28:31], v[236:239]
    s_waitcnt lgkmcnt(4)
    v_mfma_f32_16x16x32_bf16 v[144:147], a[64:67], a[0:3], 0
    ds_read_b64_tr_b16 a[80:81], v19 offset:0
    v_mfma_f32_16x16x32_bf16 v[144:147], a[68:71], a[16:19], v[144:147]
    ds_read_b64_tr_b16 a[82:83], v19 offset:1024
    v_mfma_f32_16x16x32_bf16 v[176:179], a[64:67], a[4:7], 0
    ds_read_b64_tr_b16 a[84:85], v19 offset:8192
    v_mfma_f32_16x16x32_bf16 v[176:179], a[68:71], a[20:23], v[176:179]
    ds_read_b64_tr_b16 a[86:87], v19 offset:9216
    v_mfma_f32_16x16x32_bf16 v[208:211], a[64:67], a[8:11], 0
    v_mfma_f32_16x16x32_bf16 v[208:211], a[68:71], a[24:27], v[208:211]
    v_mfma_f32_16x16x32_bf16 v[240:243], a[64:67], a[12:15], 0
    v_mfma_f32_16x16x32_bf16 v[240:243], a[68:71], a[28:31], v[240:243]
    s_waitcnt lgkmcnt(4)
    v_mfma_f32_16x16x32_bf16 v[148:151], a[72:75], a[0:3], 0
    ds_read_b64_tr_b16 a[88:89], v19 offset:8
    v_mfma_f32_16x16x32_bf16 v[148:151], a[76:79], a[16:19], v[148:151]
    ds_read_b64_tr_b16 a[90:91], v19 offset:1032
    v_mfma_f32_16x16x32_bf16 v[180:183], a[72:75], a[4:7], 0
    ds_read_b64_tr_b16 a[92:93], v19 offset:8200
    v_mfma_f32_16x16x32_bf16 v[180:183], a[76:79], a[20:23], v[180:183]
    ds_read_b64_tr_b16 a[94:95], v19 offset:9224
    v_mfma_f32_16x16x32_bf16 v[212:215], a[72:75], a[8:11], 0
    v_mfma_f32_16x16x32_bf16 v[212:215], a[76:79], a[24:27], v[212:215]
    v_mfma_f32_16x16x32_bf16 v[244:247], a[72:75], a[12:15], 0
    v_mfma_f32_16x16x32_bf16 v[244:247], a[76:79], a[28:31], v[244:247]
    s_waitcnt lgkmcnt(4)
    v_mfma_f32_16x16x32_bf16 v[152:155], a[80:83], a[0:3], 0
    ds_read_b64_tr_b16 a[64:65], v20 offset:0
    v_mfma_f32_16x16x32_bf16 v[152:155], a[84:87], a[16:19], v[152:155]
    ds_read_b64_tr_b16 a[66:67], v20 offset:512
    v_mfma_f32_16x16x32_bf16 v[184:187], a[80:83], a[4:7], 0
    ds_read_b64_tr_b16 a[68:69], v20 offset:4096
    v_mfma_f32_16x16x32_bf16 v[184:187], a[84:87], a[20:23], v[184:187]
    ds_read_b64_tr_b16 a[70:71], v20 offset:4608
    v_mfma_f32_16x16x32_bf16 v[216:219], a[80:83], a[8:11], 0
    ds_read_b64_tr_b16 a[100:101], v4 offset:0
    v_mfma_f32_16x16x32_bf16 v[216:219], a[84:87], a[24:27], v[216:219]
    ds_read_b64_tr_b16 a[102:103], v4 offset:512
    v_mfma_f32_16x16x32_bf16 v[248:251], a[80:83], a[12:15], 0
    v_mfma_f32_16x16x32_bf16 v[248:251], a[84:87], a[28:31], v[248:251]
    s_waitcnt lgkmcnt(6)
    v_mfma_f32_16x16x32_bf16 v[156:159], a[88:91], a[0:3], 0
    ds_read_b64_tr_b16 a[72:73], v21 offset:0
    v_mfma_f32_16x16x32_bf16 v[156:159], a[92:95], a[16:19], v[156:159]
    ds_read_b64_tr_b16 a[74:75], v21 offset:512
    v_mfma_f32_16x16x32_bf16 v[188:191], a[88:91], a[4:7], 0
    ds_read_b64_tr_b16 a[76:77], v21 offset:4096
    v_mfma_f32_16x16x32_bf16 v[188:191], a[92:95], a[20:23], v[188:191]
    ds_read_b64_tr_b16 a[78:79], v21 offset:4608
    v_mfma_f32_16x16x32_bf16 v[220:223], a[88:91], a[8:11], 0
    ds_read_b64_tr_b16 a[104:105], v4 offset:4096
    v_mfma_f32_16x16x32_bf16 v[220:223], a[92:95], a[24:27], v[220:223]
    ds_read_b64_tr_b16 a[106:107], v4 offset:4608
    v_mfma_f32_16x16x32_bf16 v[252:255], a[88:91], a[12:15], 0
    v_mfma_f32_16x16x32_bf16 v[252:255], a[92:95], a[28:31], v[252:255]
    s_waitcnt lgkmcnt(6)
    v_mfma_f32_16x16x32_bf16 a[128:131], a[64:67], a[0:3], 0
    s_waitcnt vmcnt(20)
    v_mfma_f32_16x16x32_bf16 a[128:131], a[68:71], a[16:19], a[128:131]
    ds_read_b128 a[32:35], v14 offset:32768
    v_mfma_f32_16x16x32_bf16 a[132:135], a[64:67], a[4:7], 0
    ds_read_b128 a[36:39], v14 offset:34816
    v_mfma_f32_16x16x32_bf16 a[132:135], a[68:71], a[20:23], a[132:135]
    ds_read_b128 a[40:43], v14 offset:36864
    v_mfma_f32_16x16x32_bf16 a[136:139], a[64:67], a[8:11], 0
    ds_read_b128 a[44:47], v14 offset:38912
    v_mfma_f32_16x16x32_bf16 a[136:139], a[68:71], a[24:27], a[136:139]
    v_lshrrev_b32 v104, 4, v102
    v_and_b32 v105, 15, v102
    v_mfma_f32_16x16x32_bf16 a[140:143], a[64:67], a[12:15], 0
    v_add_u32 v106, 0, v104
    v_xor_b32 v106, v106, v105
    v_mfma_f32_16x16x32_bf16 a[140:143], a[68:71], a[28:31], a[140:143]
    v_lshlrev_b32 v106, 4, v106
    v_lshl_add_u32 v92, v104, 8, v106
    s_waitcnt lgkmcnt(4)
    v_mfma_f32_16x16x32_bf16 a[144:147], a[72:75], a[0:3], 0
    ds_read_b128 a[48:51], v15 offset:32768
    v_mfma_f32_16x16x32_bf16 a[144:147], a[76:79], a[16:19], a[144:147]
    ds_read_b128 a[52:55], v15 offset:34816
    v_mfma_f32_16x16x32_bf16 a[148:151], a[72:75], a[4:7], 0
    ds_read_b128 a[56:59], v15 offset:36864
    v_mfma_f32_16x16x32_bf16 a[148:151], a[76:79], a[20:23], a[148:151]
    ds_read_b128 a[60:63], v15 offset:38912
    v_mfma_f32_16x16x32_bf16 a[152:155], a[72:75], a[8:11], 0
    s_xor_b32 s29, s20, 0
    s_lshl_b32 s29, s29, 2
    v_mfma_f32_16x16x32_bf16 a[152:155], a[76:79], a[24:27], a[152:155]
    v_add_u32 v106, s29, v104
    v_xor_b32 v106, v106, v105
    v_mfma_f32_16x16x32_bf16 a[156:159], a[72:75], a[12:15], 0
    v_lshlrev_b32 v106, 4, v106
    v_lshl_add_u32 v80, v105, 8, v106
    v_mfma_f32_16x16x32_bf16 a[156:159], a[76:79], a[28:31], a[156:159]
    v_add_u32 v106, 4, v104
    v_xor_b32 v106, v106, v105
    v_mfma_f32_16x16x32_bf16 a[232:235], a[100:103], a[96:99], 0
    v_lshlrev_b32 v106, 4, v106
    v_lshl_add_u32 v93, v104, 8, v106
    v_mfma_f32_16x16x32_bf16 a[232:235], a[104:107], a[96:99], a[232:235]
    s_xor_b32 s29, s20, 1
    s_lshl_b32 s29, s29, 2
    v_mfma_f32_16x16x32_bf16 a[192:195], a[96:99], a[0:3], 0
    s_waitcnt vmcnt(14)
    v_mfma_f32_16x16x32_bf16 a[192:195], a[96:99], a[16:19], a[192:195]
    s_barrier
    v_mfma_f32_16x16x32_bf16 a[208:211], a[0:3], a[0:3], 0
    ds_read_b64_tr_b16 a[64:65], v16 offset:24576
    v_mfma_f32_16x16x32_bf16 a[208:211], a[16:19], a[16:19], a[208:211]
    ds_read_b64_tr_b16 a[66:67], v16 offset:25600
    v_mfma_f32_16x16x32_bf16 a[196:199], a[96:99], a[4:7], 0
    ds_read_b64_tr_b16 a[68:69], v16 offset:32768
    v_mfma_f32_16x16x32_bf16 a[196:199], a[96:99], a[20:23], a[196:199]
    ds_read_b64_tr_b16 a[70:71], v16 offset:33792
    s_add_u32 s78, s28, 3
    s_and_b32 s78, s78, 7
    s_lshl_b32 s79, s78, 19
    s_add_u32 s76, s62, s79
    s_mul_i32 s79, s78, 176128
    s_add_u32 s77, s63, s79
    s_add_u32 m0, s24, 65536
    v_mfma_f32_16x16x32_bf16 a[212:215], a[4:7], a[4:7], 0
    buffer_load_dwordx4 v8, s[40:43], s76 offen offset:0 lds
    v_mfma_f32_16x16x32_bf16 a[212:215], a[20:23], a[20:23], a[212:215]
    buffer_load_dwordx4 v9, s[40:43], s76 offen offset:1024 lds
    v_mfma_f32_16x16x32_bf16 a[200:203], a[96:99], a[8:11], 0
    ds_read_b64_tr_b16 a[72:73], v16 offset:24584
    v_mfma_f32_16x16x32_bf16 a[200:203], a[96:99], a[24:27], a[200:203]
    ds_read_b64_tr_b16 a[74:75], v16 offset:25608
    v_mfma_f32_16x16x32_bf16 a[216:219], a[8:11], a[8:11], 0
    ds_read_b64_tr_b16 a[76:77], v16 offset:32776
    v_mfma_f32_16x16x32_bf16 a[216:219], a[24:27], a[24:27], a[216:219]
    ds_read_b64_tr_b16 a[78:79], v16 offset:33800
    v_mfma_f32_16x16x32_bf16 a[204:207], a[96:99], a[12:15], 0
    buffer_load_dwordx4 v10, s[40:43], s76 offen offset:2048 lds
    v_mfma_f32_16x16x32_bf16 a[204:207], a[96:99], a[28:31], a[204:207]
    buffer_load_dwordx4 v11, s[40:43], s76 offen offset:3072 lds
    s_add_u32 m0, s64, 81920
    v_mfma_f32_16x16x32_bf16 a[220:223], a[12:15], a[12:15], 0
    buffer_load_dwordx4 v12, s[44:47], s77 offen offset:0 lds
    v_mfma_f32_16x16x32_bf16 a[220:223], a[28:31], a[28:31], a[220:223]
    buffer_load_dwordx4 v13, s[44:47], s77 offen offset:1024 lds
    s_waitcnt lgkmcnt(4)
    v_mfma_f32_16x16x32_bf16 v[128:131], a[64:67], a[32:35], v[128:131]
    ds_read_b64_tr_b16 a[80:81], v17 offset:24576
    v_mfma_f32_16x16x32_bf16 v[128:131], a[68:71], a[48:51], v[128:131]
    ds_read_b64_tr_b16 a[82:83], v17 offset:25600
    v_mfma_f32_16x16x32_bf16 v[160:163], a[64:67], a[36:39], v[160:163]
    ds_read_b64_tr_b16 a[84:85], v17 offset:32768
    v_mfma_f32_16x16x32_bf16 v[160:163], a[68:71], a[52:55], v[160:163]
    ds_read_b64_tr_b16 a[86:87], v17 offset:33792
    s_add_u32 s78, s28, 3
    s_and_b32 s78, s78, 7
    s_lshl_b32 s78, s78, 7
    s_add_u32 s74, s61, s78
    s_xor_b32 s75, s74, 0x8000
    s_add_u32 m0, s60, 32768
    v_mfma_f32_16x16x32_bf16 v[192:195], a[64:67], a[40:43], v[192:195]
    buffer_load_dwordx4 v0, s[16:19], s74 offen offset:0 lds
    v_mfma_f32_16x16x32_bf16 v[192:195], a[68:71], a[56:59], v[192:195]
    buffer_load_dwordx4 v1, s[16:19], s74 offen offset:1024 lds
    v_mfma_f32_16x16x32_bf16 v[224:227], a[64:67], a[44:47], v[224:227]
    v_add_u32 v106, s29, v104
    v_xor_b32 v106, v106, v105
    v_mfma_f32_16x16x32_bf16 v[224:227], a[68:71], a[60:63], v[224:227]
    v_lshlrev_b32 v106, 4, v106
    v_lshl_add_u32 v81, v105, 8, v106
    v_mfma_f32_16x16x32_bf16 a[224:227], a[64:67], a[96:99], a[224:227]
    v_add_u32 v106, 8, v104
    v_xor_b32 v106, v106, v105
    v_mfma_f32_16x16x32_bf16 a[224:227], a[68:71], a[96:99], a[224:227]
    v_lshlrev_b32 v106, 4, v106
    v_lshl_add_u32 v94, v104, 8, v106
    s_waitcnt lgkmcnt(4)
    v_mfma_f32_16x16x32_bf16 v[132:135], a[72:75], a[32:35], v[132:135]
    ds_read_b64_tr_b16 a[88:89], v17 offset:24584
    v_mfma_f32_16x16x32_bf16 v[132:135], a[76:79], a[48:51], v[132:135]
    ds_read_b64_tr_b16 a[90:91], v17 offset:25608
    v_mfma_f32_16x16x32_bf16 v[164:167], a[72:75], a[36:39], v[164:167]
    ds_read_b64_tr_b16 a[92:93], v17 offset:32776
    v_mfma_f32_16x16x32_bf16 v[164:167], a[76:79], a[52:55], v[164:167]
    ds_read_b64_tr_b16 a[94:95], v17 offset:33800
    v_mfma_f32_16x16x32_bf16 v[196:199], a[72:75], a[40:43], v[196:199]
    buffer_load_dwordx4 v2, s[16:19], s74 offen offset:2048 lds
    v_mfma_f32_16x16x32_bf16 v[196:199], a[76:79], a[56:59], v[196:199]
    buffer_load_dwordx4 v3, s[16:19], s74 offen offset:3072 lds
    v_mfma_f32_16x16x32_bf16 v[228:231], a[72:75], a[44:47], v[228:231]
    s_xor_b32 s29, s20, 2
    s_lshl_b32 s29, s29, 2
    v_mfma_f32_16x16x32_bf16 v[228:231], a[76:79], a[60:63], v[228:231]
    v_add_u32 v106, s29, v104
    v_xor_b32 v106, v106, v105
    v_mfma_f32_16x16x32_bf16 a[228:231], a[72:75], a[96:99], a[228:231]
    v_lshlrev_b32 v106, 4, v106
    v_lshl_add_u32 v82, v105, 8, v106
    v_mfma_f32_16x16x32_bf16 a[228:231], a[76:79], a[96:99], a[228:231]
    v_add_u32 v106, 12, v104
    v_xor_b32 v106, v106, v105
    s_waitcnt lgkmcnt(4)
    v_mfma_f32_16x16x32_bf16 v[136:139], a[80:83], a[32:35], v[136:139]
    ds_read_b64_tr_b16 a[64:65], v18 offset:24576
    v_mfma_f32_16x16x32_bf16 v[136:139], a[84:87], a[48:51], v[136:139]
    ds_read_b64_tr_b16 a[66:67], v18 offset:25600
    v_mfma_f32_16x16x32_bf16 v[168:171], a[80:83], a[36:39], v[168:171]
    ds_read_b64_tr_b16 a[68:69], v18 offset:32768
    v_mfma_f32_16x16x32_bf16 v[168:171], a[84:87], a[52:55], v[168:171]
    ds_read_b64_tr_b16 a[70:71], v18 offset:33792
    s_add_u32 m0, s60, 36864
    v_mfma_f32_16x16x32_bf16 v[200:203], a[80:83], a[40:43], v[200:203]
    buffer_load_dwordx4 v0, s[16:19], s75 offen offset:0 lds
    v_mfma_f32_16x16x32_bf16 v[200:203], a[84:87], a[56:59], v[200:203]
    buffer_load_dwordx4 v1, s[16:19], s75 offen offset:1024 lds
    v_mfma_f32_16x16x32_bf16 v[232:235], a[80:83], a[44:47], v[232:235]
    v_lshlrev_b32 v106, 4, v106
    v_lshl_add_u32 v95, v104, 8, v106
    v_mfma_f32_16x16x32_bf16 v[232:235], a[84:87], a[60:63], v[232:235]
    s_xor_b32 s29, s20, 3
    s_lshl_b32 s29, s29, 2
    s_waitcnt lgkmcnt(4)
    v_mfma_f32_16x16x32_bf16 v[140:143], a[88:91], a[32:35], v[140:143]
    ds_read_b64_tr_b16 a[72:73], v18 offset:24584
    v_mfma_f32_16x16x32_bf16 v[140:143], a[92:95], a[48:51], v[140:143]
    ds_read_b64_tr_b16 a[74:75], v18 offset:25608
    v_mfma_f32_16x16x32_bf16 v[172:175], a[88:91], a[36:39], v[172:175]
    ds_read_b64_tr_b16 a[76:77], v18 offset:32776
    v_mfma_f32_16x16x32_bf16 v[172:175], a[92:95], a[52:55], v[172:175]
    ds_read_b64_tr_b16 a[78:79], v18 offset:33800
    v_mfma_f32_16x16x32_bf16 v[204:207], a[88:91], a[40:43], v[204:207]
    buffer_load_dwordx4 v2, s[16:19], s75 offen offset:2048 lds
    v_mfma_f32_16x16x32_bf16 v[204:207], a[92:95], a[56:59], v[204:207]
    buffer_load_dwordx4 v3, s[16:19], s75 offen offset:3072 lds
    v_mfma_f32_16x16x32_bf16 v[236:239], a[88:91], a[44:47], v[236:239]
    v_add_u32 v106, s29, v104
    v_xor_b32 v106, v106, v105
    v_mfma_f32_16x16x32_bf16 v[236:239], a[92:95], a[60:63], v[236:239]
    v_lshlrev_b32 v106, 4, v106
    v_lshl_add_u32 v83, v105, 8, v106
    s_waitcnt lgkmcnt(4)
    v_mfma_f32_16x16x32_bf16 v[144:147], a[64:67], a[32:35], v[144:147]
    ds_read_b64_tr_b16 a[80:81], v19 offset:24576
    v_mfma_f32_16x16x32_bf16 v[144:147], a[68:71], a[48:51], v[144:147]
    ds_read_b64_tr_b16 a[82:83], v19 offset:25600
    v_mfma_f32_16x16x32_bf16 v[176:179], a[64:67], a[36:39], v[176:179]
    ds_read_b64_tr_b16 a[84:85], v19 offset:32768
    v_mfma_f32_16x16x32_bf16 v[176:179], a[68:71], a[52:55], v[176:179]
    ds_read_b64_tr_b16 a[86:87], v19 offset:33792
    v_mfma_f32_16x16x32_bf16 v[208:211], a[64:67], a[40:43], v[208:211]
    v_add_u32 v106, 0, v104
    v_lshlrev_b32 v106, 1, v106
    v_mfma_f32_16x16x32_bf16 v[208:211], a[68:71], a[56:59], v[208:211]
    v_xor_b32 v106, v106, v105
    v_lshlrev_b32 v106, 4, v106
    v_mfma_f32_16x16x32_bf16 v[240:243], a[64:67], a[44:47], v[240:243]
    v_lshl_add_u32 v96, v104, 8, v106
    v_add_u32 v106, 4, v104
    v_mfma_f32_16x16x32_bf16 v[240:243], a[68:71], a[60:63], v[240:243]
    v_lshlrev_b32 v106, 1, v106
    v_xor_b32 v106, v106, v105
    s_waitcnt lgkmcnt(4)
    v_mfma_f32_16x16x32_bf16 v[148:151], a[72:75], a[32:35], v[148:151]
    ds_read_b64_tr_b16 a[88:89], v19 offset:24584
    v_mfma_f32_16x16x32_bf16 v[148:151], a[76:79], a[48:51], v[148:151]
    ds_read_b64_tr_b16 a[90:91], v19 offset:25608
    v_mfma_f32_16x16x32_bf16 v[180:183], a[72:75], a[36:39], v[180:183]
    ds_read_b64_tr_b16 a[92:93], v19 offset:32776
    v_mfma_f32_16x16x32_bf16 v[180:183], a[76:79], a[52:55], v[180:183]
    ds_read_b64_tr_b16 a[94:95], v19 offset:33800
    v_mfma_f32_16x16x32_bf16 v[212:215], a[72:75], a[40:43], v[212:215]
    v_lshlrev_b32 v106, 4, v106
    v_lshl_add_u32 v97, v104, 8, v106
    v_mfma_f32_16x16x32_bf16 v[212:215], a[76:79], a[56:59], v[212:215]
    v_lshrrev_b32 v108, 2, v102
    v_and_b32 v106, 3, v102
    v_mfma_f32_16x16x32_bf16 v[244:247], a[72:75], a[44:47], v[244:247]
    v_lshlrev_b32 v106, 3, v106
    v_lshl_add_u32 v109, v108, 8, v106
    v_mfma_f32_16x16x32_bf16 v[244:247], a[76:79], a[60:63], v[244:247]
    v_add_u32 v109, 0x10000, v109
    v_and_b32 v110, 7, v108
    s_waitcnt lgkmcnt(4)
    v_mfma_f32_16x16x32_bf16 v[152:155], a[80:83], a[32:35], v[152:155]
    ds_read_b64_tr_b16 a[64:65], v20 offset:24576
    v_mfma_f32_16x16x32_bf16 v[152:155], a[84:87], a[48:51], v[152:155]
    ds_read_b64_tr_b16 a[66:67], v20 offset:25088
    v_mfma_f32_16x16x32_bf16 v[184:187], a[80:83], a[36:39], v[184:187]
    ds_read_b64_tr_b16 a[68:69], v20 offset:28672
    v_mfma_f32_16x16x32_bf16 v[184:187], a[84:87], a[52:55], v[184:187]
    ds_read_b64_tr_b16 a[70:71], v20 offset:29184
    v_mfma_f32_16x16x32_bf16 v[216:219], a[80:83], a[40:43], v[216:219]
    ds_read_b64_tr_b16 a[100:101], v4 offset:24576
    v_mfma_f32_16x16x32_bf16 v[216:219], a[84:87], a[56:59], v[216:219]
    ds_read_b64_tr_b16 a[102:103], v4 offset:25088
    v_mfma_f32_16x16x32_bf16 v[248:251], a[80:83], a[44:47], v[248:251]
    v_xor_b32 v106, 0, v110
    v_lshl_add_u32 v84, v106, 5, v109
    v_mfma_f32_16x16x32_bf16 v[248:251], a[84:87], a[60:63], v[248:251]
    v_xor_b32 v106, 1, v110
    v_lshl_add_u32 v85, v106, 5, v109
    s_waitcnt lgkmcnt(6)
    v_mfma_f32_16x16x32_bf16 v[156:159], a[88:91], a[32:35], v[156:159]
    ds_read_b64_tr_b16 a[72:73], v21 offset:24576
    v_mfma_f32_16x16x32_bf16 v[156:159], a[92:95], a[48:51], v[156:159]
    ds_read_b64_tr_b16 a[74:75], v21 offset:25088
    v_mfma_f32_16x16x32_bf16 v[188:191], a[88:91], a[36:39], v[188:191]
    ds_read_b64_tr_b16 a[76:77], v21 offset:28672
    v_mfma_f32_16x16x32_bf16 v[188:191], a[92:95], a[52:55], v[188:191]
    ds_read_b64_tr_b16 a[78:79], v21 offset:29184
    v_mfma_f32_16x16x32_bf16 v[220:223], a[88:91], a[40:43], v[220:223]
    ds_read_b64_tr_b16 a[104:105], v4 offset:28672
    v_mfma_f32_16x16x32_bf16 v[220:223], a[92:95], a[56:59], v[220:223]
    ds_read_b64_tr_b16 a[106:107], v4 offset:29184
    v_mfma_f32_16x16x32_bf16 v[252:255], a[88:91], a[44:47], v[252:255]
    v_xor_b32 v106, 2, v110
    v_lshl_add_u32 v86, v106, 5, v109
    v_mfma_f32_16x16x32_bf16 v[252:255], a[92:95], a[60:63], v[252:255]
    v_xor_b32 v106, 3, v110
    v_lshl_add_u32 v87, v106, 5, v109
    s_waitcnt lgkmcnt(6)
    v_mfma_f32_16x16x32_bf16 a[128:131], a[64:67], a[32:35], a[128:131]
    s_waitcnt vmcnt(20)
    v_mfma_f32_16x16x32_bf16 a[128:131], a[68:71], a[48:51], a[128:131]
    ds_read_b128 a[0:3], v14 offset:0
    v_mfma_f32_16x16x32_bf16 a[132:135], a[64:67], a[36:39], a[132:135]
    ds_read_b128 a[4:7], v14 offset:2048
    v_mfma_f32_16x16x32_bf16 a[132:135], a[68:71], a[52:55], a[132:135]
    ds_read_b128 a[8:11], v14 offset:4096
    v_mfma_f32_16x16x32_bf16 a[136:139], a[64:67], a[40:43], a[136:139]
    ds_read_b128 a[12:15], v14 offset:6144
    v_mfma_f32_16x16x32_bf16 a[136:139], a[68:71], a[56:59], a[136:139]
    v_xor_b32 v106, 4, v110
    v_lshl_add_u32 v88, v106, 5, v109
    v_mfma_f32_16x16x32_bf16 a[140:143], a[64:67], a[44:47], a[140:143]
    v_xor_b32 v106, 5, v110
    v_lshl_add_u32 v89, v106, 5, v109
    v_mfma_f32_16x16x32_bf16 a[140:143], a[68:71], a[60:63], a[140:143]
    v_xor_b32 v106, 6, v110
    v_lshl_add_u32 v90, v106, 5, v109
    s_waitcnt lgkmcnt(4)
    v_mfma_f32_16x16x32_bf16 a[144:147], a[72:75], a[32:35], a[144:147]
    ds_read_b128 a[16:19], v15 offset:0
    v_mfma_f32_16x16x32_bf16 a[144:147], a[76:79], a[48:51], a[144:147]
    ds_read_b128 a[20:23], v15 offset:2048
    v_mfma_f32_16x16x32_bf16 a[148:151], a[72:75], a[36:39], a[148:151]
    ds_read_b128 a[24:27], v15 offset:4096
    v_mfma_f32_16x16x32_bf16 a[148:151], a[76:79], a[52:55], a[148:151]
    ds_read_b128 a[28:31], v15 offset:6144
    v_mfma_f32_16x16x32_bf16 a[152:155], a[72:75], a[40:43], a[152:155]
    v_xor_b32 v106, 7, v110
    v_lshl_add_u32 v91, v106, 5, v109
    v_mfma_f32_16x16x32_bf16 a[152:155], a[76:79], a[56:59], a[152:155]
    s_lshl_b32 s26, s21, 19
    s_add_u32 s27, s26, 16384
    v_mfma_f32_16x16x32_bf16 a[156:159], a[72:75], a[44:47], a[156:159]
    s_add_u32 s4, s34, s27
    s_addc_u32 s5, s35, 0
    s_mov_b32 s6, 507904
    v_mfma_f32_16x16x32_bf16 a[156:159], a[76:79], a[60:63], a[156:159]
    s_mov_b32 s7, 0x20000
    s_add_u32 s48, s34, s26
    s_addc_u32 s49, s35, 0
    v_mfma_f32_16x16x32_bf16 a[232:235], a[100:103], a[96:99], a[232:235]
    s_mov_b32 s50, 16384
    s_mov_b32 s51, 0x20000
    v_mfma_f32_16x16x32_bf16 a[232:235], a[104:107], a[96:99], a[232:235]
    s_add_u32 s8, s36, s26
    s_addc_u32 s9, s37, 0
    s_mov_b32 s10, 524288
    v_mfma_f32_16x16x32_bf16 a[192:195], a[96:99], a[32:35], a[192:195]
    s_waitcnt vmcnt(14)
    v_mfma_f32_16x16x32_bf16 a[192:195], a[96:99], a[48:51], a[192:195]
    s_barrier
    v_mfma_f32_16x16x32_bf16 a[208:211], a[32:35], a[32:35], a[208:211]
    ds_read_b64_tr_b16 a[64:65], v16 offset:49152
    v_mfma_f32_16x16x32_bf16 a[208:211], a[48:51], a[48:51], a[208:211]
    ds_read_b64_tr_b16 a[66:67], v16 offset:50176
    v_mfma_f32_16x16x32_bf16 a[196:199], a[96:99], a[36:39], a[196:199]
    ds_read_b64_tr_b16 a[68:69], v16 offset:57344
    v_mfma_f32_16x16x32_bf16 a[196:199], a[96:99], a[52:55], a[196:199]
    ds_read_b64_tr_b16 a[70:71], v16 offset:58368
    s_add_u32 s78, s28, 4
    s_and_b32 s78, s78, 7
    s_lshl_b32 s79, s78, 19
    s_add_u32 s76, s62, s79
    s_mul_i32 s79, s78, 176128
    s_add_u32 s77, s63, s79
    s_add_u32 m0, s24, 90112
    v_mfma_f32_16x16x32_bf16 a[212:215], a[36:39], a[36:39], a[212:215]
    buffer_load_dwordx4 v8, s[40:43], s76 offen offset:0 lds
    v_mfma_f32_16x16x32_bf16 a[212:215], a[52:55], a[52:55], a[212:215]
    buffer_load_dwordx4 v9, s[40:43], s76 offen offset:1024 lds
    v_mfma_f32_16x16x32_bf16 a[200:203], a[96:99], a[40:43], a[200:203]
    ds_read_b64_tr_b16 a[72:73], v16 offset:49160
    v_mfma_f32_16x16x32_bf16 a[200:203], a[96:99], a[56:59], a[200:203]
    ds_read_b64_tr_b16 a[74:75], v16 offset:50184
    v_mfma_f32_16x16x32_bf16 a[216:219], a[40:43], a[40:43], a[216:219]
    ds_read_b64_tr_b16 a[76:77], v16 offset:57352
    v_mfma_f32_16x16x32_bf16 a[216:219], a[56:59], a[56:59], a[216:219]
    ds_read_b64_tr_b16 a[78:79], v16 offset:58376
    v_mfma_f32_16x16x32_bf16 a[204:207], a[96:99], a[44:47], a[204:207]
    buffer_load_dwordx4 v10, s[40:43], s76 offen offset:2048 lds
    v_mfma_f32_16x16x32_bf16 a[204:207], a[96:99], a[60:63], a[204:207]
    buffer_load_dwordx4 v11, s[40:43], s76 offen offset:3072 lds
    s_add_u32 m0, s64, 106496
    v_mfma_f32_16x16x32_bf16 a[220:223], a[44:47], a[44:47], a[220:223]
    buffer_load_dwordx4 v12, s[44:47], s77 offen offset:0 lds
    v_mfma_f32_16x16x32_bf16 a[220:223], a[60:63], a[60:63], a[220:223]
    buffer_load_dwordx4 v13, s[44:47], s77 offen offset:1024 lds
    s_waitcnt lgkmcnt(4)
    v_mfma_f32_16x16x32_bf16 v[128:131], a[64:67], a[0:3], v[128:131]
    ds_read_b64_tr_b16 a[80:81], v17 offset:49152
    v_mfma_f32_16x16x32_bf16 v[128:131], a[68:71], a[16:19], v[128:131]
    ds_read_b64_tr_b16 a[82:83], v17 offset:50176
    v_mfma_f32_16x16x32_bf16 v[160:163], a[64:67], a[4:7], v[160:163]
    ds_read_b64_tr_b16 a[84:85], v17 offset:57344
    v_mfma_f32_16x16x32_bf16 v[160:163], a[68:71], a[20:23], v[160:163]
    ds_read_b64_tr_b16 a[86:87], v17 offset:58368
    s_add_u32 s78, s28, 4
    s_and_b32 s78, s78, 7
    s_lshl_b32 s78, s78, 7
    s_add_u32 s74, s61, s78
    s_xor_b32 s75, s74, 0x8000
    s_add_u32 m0, s60, 0
    v_mfma_f32_16x16x32_bf16 v[192:195], a[64:67], a[8:11], v[192:195]
    buffer_load_dwordx4 v0, s[16:19], s74 offen offset:0 lds
    v_mfma_f32_16x16x32_bf16 v[192:195], a[68:71], a[24:27], v[192:195]
    buffer_load_dwordx4 v1, s[16:19], s74 offen offset:1024 lds
    v_mfma_f32_16x16x32_bf16 v[224:227], a[64:67], a[12:15], v[224:227]
    s_mov_b32 s11, 0x20000
    s_mov_b32 s12, s72
    v_mfma_f32_16x16x32_bf16 v[224:227], a[68:71], a[28:31], v[224:227]
    s_mov_b32 s13, s73
    s_mov_b32 s14, 16777216
    v_mfma_f32_16x16x32_bf16 a[224:227], a[64:67], a[96:99], a[224:227]
    s_mov_b32 s15, 0x20000
    s_add_u32 s52, s72, 16777216
    s_addc_u32 s53, s73, 0
    v_mfma_f32_16x16x32_bf16 a[224:227], a[68:71], a[96:99], a[224:227]
    s_mov_b32 s54, 5636096
    s_mov_b32 s55, 0x20000
    s_waitcnt lgkmcnt(4)
    v_mfma_f32_16x16x32_bf16 v[132:135], a[72:75], a[0:3], v[132:135]
    ds_read_b64_tr_b16 a[88:89], v17 offset:49160
    v_mfma_f32_16x16x32_bf16 v[132:135], a[76:79], a[16:19], v[132:135]
    ds_read_b64_tr_b16 a[90:91], v17 offset:50184
    v_mfma_f32_16x16x32_bf16 v[164:167], a[72:75], a[4:7], v[164:167]
    ds_read_b64_tr_b16 a[92:93], v17 offset:57352
    v_mfma_f32_16x16x32_bf16 v[164:167], a[76:79], a[20:23], v[164:167]
    ds_read_b64_tr_b16 a[94:95], v17 offset:58376
    v_mfma_f32_16x16x32_bf16 v[196:199], a[72:75], a[8:11], v[196:199]
    buffer_load_dwordx4 v2, s[16:19], s74 offen offset:2048 lds
    v_mfma_f32_16x16x32_bf16 v[196:199], a[76:79], a[24:27], v[196:199]
    buffer_load_dwordx4 v3, s[16:19], s74 offen offset:3072 lds
    v_mfma_f32_16x16x32_bf16 v[228:231], a[72:75], a[12:15], v[228:231]
    s_mov_b32 s56, s70
    s_mov_b32 s57, s71
    v_mfma_f32_16x16x32_bf16 v[228:231], a[76:79], a[28:31], v[228:231]
    s_mov_b32 s58, 2752
    s_mov_b32 s59, 0x20000
    v_mfma_f32_16x16x32_bf16 a[228:231], a[72:75], a[96:99], a[228:231]
    v_lshrrev_b32 v64, 4, v102
    v_lshlrev_b32 v64, 3, v64
    v_mfma_f32_16x16x32_bf16 a[228:231], a[76:79], a[96:99], a[228:231]
    s_lshl_b32 s26, s21, 6
    s_lshl_b32 s27, s25, 6
    s_waitcnt lgkmcnt(4)
    v_mfma_f32_16x16x32_bf16 v[136:139], a[80:83], a[0:3], v[136:139]
    ds_read_b64_tr_b16 a[64:65], v18 offset:49152
    v_mfma_f32_16x16x32_bf16 v[136:139], a[84:87], a[16:19], v[136:139]
    ds_read_b64_tr_b16 a[66:67], v18 offset:50176
    v_mfma_f32_16x16x32_bf16 v[168:171], a[80:83], a[4:7], v[168:171]
    ds_read_b64_tr_b16 a[68:69], v18 offset:57344
    v_mfma_f32_16x16x32_bf16 v[168:171], a[84:87], a[20:23], v[168:171]
    ds_read_b64_tr_b16 a[70:71], v18 offset:58368
    s_add_u32 m0, s60, 4096
    v_mfma_f32_16x16x32_bf16 v[200:203], a[80:83], a[8:11], v[200:203]
    buffer_load_dwordx4 v0, s[16:19], s75 offen offset:0 lds
    v_mfma_f32_16x16x32_bf16 v[200:203], a[84:87], a[24:27], v[200:203]
    buffer_load_dwordx4 v1, s[16:19], s75 offen offset:1024 lds
    v_mfma_f32_16x16x32_bf16 v[232:235], a[80:83], a[12:15], v[232:235]
    buffer_load_dwordx2 v[24:25], v64, s[56:59], s26 offen offset:0
    v_mfma_f32_16x16x32_bf16 v[232:235], a[84:87], a[28:31], v[232:235]
    buffer_load_dwordx2 v[26:27], v64, s[56:59], s26 offen offset:32
    s_waitcnt lgkmcnt(4)
    v_mfma_f32_16x16x32_bf16 v[140:143], a[88:91], a[0:3], v[140:143]
    ds_read_b64_tr_b16 a[72:73], v18 offset:49160
    v_mfma_f32_16x16x32_bf16 v[140:143], a[92:95], a[16:19], v[140:143]
    ds_read_b64_tr_b16 a[74:75], v18 offset:50184
    v_mfma_f32_16x16x32_bf16 v[172:175], a[88:91], a[4:7], v[172:175]
    ds_read_b64_tr_b16 a[76:77], v18 offset:57352
    v_mfma_f32_16x16x32_bf16 v[172:175], a[92:95], a[20:23], v[172:175]
    ds_read_b64_tr_b16 a[78:79], v18 offset:58376
    v_mfma_f32_16x16x32_bf16 v[204:207], a[88:91], a[8:11], v[204:207]
    buffer_load_dwordx4 v2, s[16:19], s75 offen offset:2048 lds
    v_mfma_f32_16x16x32_bf16 v[204:207], a[92:95], a[24:27], v[204:207]
    buffer_load_dwordx4 v3, s[16:19], s75 offen offset:3072 lds
    v_mfma_f32_16x16x32_bf16 v[236:239], a[88:91], a[12:15], v[236:239]
    buffer_load_dwordx2 v[28:29], v64, s[56:59], s27 offen offset:0
    v_mfma_f32_16x16x32_bf16 v[236:239], a[92:95], a[28:31], v[236:239]
    buffer_load_dwordx2 v[30:31], v64, s[56:59], s27 offen offset:32
    s_waitcnt lgkmcnt(4)
    v_mfma_f32_16x16x32_bf16 v[144:147], a[64:67], a[0:3], v[144:147]
    ds_read_b64_tr_b16 a[80:81], v19 offset:49152
    v_mfma_f32_16x16x32_bf16 v[144:147], a[68:71], a[16:19], v[144:147]
    ds_read_b64_tr_b16 a[82:83], v19 offset:50176
    v_mfma_f32_16x16x32_bf16 v[176:179], a[64:67], a[4:7], v[176:179]
    ds_read_b64_tr_b16 a[84:85], v19 offset:57344
    v_mfma_f32_16x16x32_bf16 v[176:179], a[68:71], a[20:23], v[176:179]
    ds_read_b64_tr_b16 a[86:87], v19 offset:58368
    v_mfma_f32_16x16x32_bf16 v[208:211], a[64:67], a[8:11], v[208:211]
    v_mfma_f32_16x16x32_bf16 v[208:211], a[68:71], a[24:27], v[208:211]
    v_mfma_f32_16x16x32_bf16 v[240:243], a[64:67], a[12:15], v[240:243]
    v_mfma_f32_16x16x32_bf16 v[240:243], a[68:71], a[28:31], v[240:243]
    s_waitcnt lgkmcnt(4)
    v_mfma_f32_16x16x32_bf16 v[148:151], a[72:75], a[0:3], v[148:151]
    ds_read_b64_tr_b16 a[88:89], v19 offset:49160
    v_mfma_f32_16x16x32_bf16 v[148:151], a[76:79], a[16:19], v[148:151]
    ds_read_b64_tr_b16 a[90:91], v19 offset:50184
    v_mfma_f32_16x16x32_bf16 v[180:183], a[72:75], a[4:7], v[180:183]
    ds_read_b64_tr_b16 a[92:93], v19 offset:57352
    v_mfma_f32_16x16x32_bf16 v[180:183], a[76:79], a[20:23], v[180:183]
    ds_read_b64_tr_b16 a[94:95], v19 offset:58376
    v_mfma_f32_16x16x32_bf16 v[212:215], a[72:75], a[8:11], v[212:215]
    v_mfma_f32_16x16x32_bf16 v[212:215], a[76:79], a[24:27], v[212:215]
    v_mfma_f32_16x16x32_bf16 v[244:247], a[72:75], a[12:15], v[244:247]
    v_mfma_f32_16x16x32_bf16 v[244:247], a[76:79], a[28:31], v[244:247]
    s_waitcnt lgkmcnt(4)
    v_mfma_f32_16x16x32_bf16 v[152:155], a[80:83], a[0:3], v[152:155]
    ds_read_b64_tr_b16 a[64:65], v20 offset:49152
    v_mfma_f32_16x16x32_bf16 v[152:155], a[84:87], a[16:19], v[152:155]
    ds_read_b64_tr_b16 a[66:67], v20 offset:49664
    v_mfma_f32_16x16x32_bf16 v[184:187], a[80:83], a[4:7], v[184:187]
    ds_read_b64_tr_b16 a[68:69], v20 offset:53248
    v_mfma_f32_16x16x32_bf16 v[184:187], a[84:87], a[20:23], v[184:187]
    ds_read_b64_tr_b16 a[70:71], v20 offset:53760
    v_mfma_f32_16x16x32_bf16 v[216:219], a[80:83], a[8:11], v[216:219]
    ds_read_b64_tr_b16 a[100:101], v4 offset:49152
    v_mfma_f32_16x16x32_bf16 v[216:219], a[84:87], a[24:27], v[216:219]
    ds_read_b64_tr_b16 a[102:103], v4 offset:49664
    v_mfma_f32_16x16x32_bf16 v[248:251], a[80:83], a[12:15], v[248:251]
    v_mfma_f32_16x16x32_bf16 v[248:251], a[84:87], a[28:31], v[248:251]
    s_waitcnt lgkmcnt(6)
    v_mfma_f32_16x16x32_bf16 v[156:159], a[88:91], a[0:3], v[156:159]
    ds_read_b64_tr_b16 a[72:73], v21 offset:49152
    v_mfma_f32_16x16x32_bf16 v[156:159], a[92:95], a[16:19], v[156:159]
    ds_read_b64_tr_b16 a[74:75], v21 offset:49664
    v_mfma_f32_16x16x32_bf16 v[188:191], a[88:91], a[4:7], v[188:191]
    ds_read_b64_tr_b16 a[76:77], v21 offset:53248
    v_mfma_f32_16x16x32_bf16 v[188:191], a[92:95], a[20:23], v[188:191]
    ds_read_b64_tr_b16 a[78:79], v21 offset:53760
    v_mfma_f32_16x16x32_bf16 v[220:223], a[88:91], a[8:11], v[220:223]
    ds_read_b64_tr_b16 a[104:105], v4 offset:53248
    v_mfma_f32_16x16x32_bf16 v[220:223], a[92:95], a[24:27], v[220:223]
    ds_read_b64_tr_b16 a[106:107], v4 offset:53760
    v_mfma_f32_16x16x32_bf16 v[252:255], a[88:91], a[12:15], v[252:255]
    v_mfma_f32_16x16x32_bf16 v[252:255], a[92:95], a[28:31], v[252:255]
    s_waitcnt lgkmcnt(6)
    v_mfma_f32_16x16x32_bf16 a[128:131], a[64:67], a[0:3], a[128:131]
    s_waitcnt vmcnt(18)
    v_mfma_f32_16x16x32_bf16 a[128:131], a[68:71], a[16:19], a[128:131]
    ds_read_b128 a[32:35], v14 offset:32768
    v_mfma_f32_16x16x32_bf16 a[132:135], a[64:67], a[4:7], a[132:135]
    ds_read_b128 a[36:39], v14 offset:34816
    v_mfma_f32_16x16x32_bf16 a[132:135], a[68:71], a[20:23], a[132:135]
    ds_read_b128 a[40:43], v14 offset:36864
    v_mfma_f32_16x16x32_bf16 a[136:139], a[64:67], a[8:11], a[136:139]
    ds_read_b128 a[44:47], v14 offset:38912
    v_mfma_f32_16x16x32_bf16 a[136:139], a[68:71], a[24:27], a[136:139]
    v_mfma_f32_16x16x32_bf16 a[140:143], a[64:67], a[12:15], a[140:143]
    v_mfma_f32_16x16x32_bf16 a[140:143], a[68:71], a[28:31], a[140:143]
    s_waitcnt lgkmcnt(4)
    v_mfma_f32_16x16x32_bf16 a[144:147], a[72:75], a[0:3], a[144:147]
    ds_read_b128 a[48:51], v15 offset:32768
    v_mfma_f32_16x16x32_bf16 a[144:147], a[76:79], a[16:19], a[144:147]
    ds_read_b128 a[52:55], v15 offset:34816
    v_mfma_f32_16x16x32_bf16 a[148:151], a[72:75], a[4:7], a[148:151]
    ds_read_b128 a[56:59], v15 offset:36864
    v_mfma_f32_16x16x32_bf16 a[148:151], a[76:79], a[20:23], a[148:151]
    ds_read_b128 a[60:63], v15 offset:38912
    v_mfma_f32_16x16x32_bf16 a[152:155], a[72:75], a[8:11], a[152:155]
    v_mfma_f32_16x16x32_bf16 a[152:155], a[76:79], a[24:27], a[152:155]
    v_mfma_f32_16x16x32_bf16 a[156:159], a[72:75], a[12:15], a[156:159]
    v_mfma_f32_16x16x32_bf16 a[156:159], a[76:79], a[28:31], a[156:159]
    v_mfma_f32_16x16x32_bf16 a[232:235], a[100:103], a[96:99], a[232:235]
    v_mfma_f32_16x16x32_bf16 a[232:235], a[104:107], a[96:99], a[232:235]
    v_mfma_f32_16x16x32_bf16 a[192:195], a[96:99], a[0:3], a[192:195]
    s_waitcnt vmcnt(26)
    v_mfma_f32_16x16x32_bf16 a[192:195], a[96:99], a[16:19], a[192:195]
    s_barrier
    v_mfma_f32_16x16x32_bf16 a[208:211], a[0:3], a[0:3], a[208:211]
    ds_read_b64_tr_b16 a[64:65], v16 offset:0
    v_mfma_f32_16x16x32_bf16 a[208:211], a[16:19], a[16:19], a[208:211]
    ds_read_b64_tr_b16 a[66:67], v16 offset:1024
    v_mfma_f32_16x16x32_bf16 a[196:199], a[96:99], a[4:7], a[196:199]
    ds_read_b64_tr_b16 a[68:69], v16 offset:8192
    v_mfma_f32_16x16x32_bf16 a[196:199], a[96:99], a[20:23], a[196:199]
    ds_read_b64_tr_b16 a[70:71], v16 offset:9216
    s_add_u32 s78, s28, 5
    s_and_b32 s78, s78, 7
    s_lshl_b32 s79, s78, 19
    s_add_u32 s76, s62, s79
    s_mul_i32 s79, s78, 176128
    s_add_u32 s77, s63, s79
    s_add_u32 m0, s24, 114688
    v_mfma_f32_16x16x32_bf16 a[212:215], a[4:7], a[4:7], a[212:215]
    buffer_load_dwordx4 v8, s[40:43], s76 offen offset:0 lds
    v_mfma_f32_16x16x32_bf16 a[212:215], a[20:23], a[20:23], a[212:215]
    buffer_load_dwordx4 v9, s[40:43], s76 offen offset:1024 lds
    v_mfma_f32_16x16x32_bf16 a[200:203], a[96:99], a[8:11], a[200:203]
    ds_read_b64_tr_b16 a[72:73], v16 offset:8
    v_mfma_f32_16x16x32_bf16 a[200:203], a[96:99], a[24:27], a[200:203]
    ds_read_b64_tr_b16 a[74:75], v16 offset:1032
    v_mfma_f32_16x16x32_bf16 a[216:219], a[8:11], a[8:11], a[216:219]
    ds_read_b64_tr_b16 a[76:77], v16 offset:8200
    v_mfma_f32_16x16x32_bf16 a[216:219], a[24:27], a[24:27], a[216:219]
    ds_read_b64_tr_b16 a[78:79], v16 offset:9224
    v_mfma_f32_16x16x32_bf16 a[204:207], a[96:99], a[12:15], a[204:207]
    buffer_load_dwordx4 v10, s[40:43], s76 offen offset:2048 lds
    v_mfma_f32_16x16x32_bf16 a[204:207], a[96:99], a[28:31], a[204:207]
    buffer_load_dwordx4 v11, s[40:43], s76 offen offset:3072 lds
    s_add_u32 m0, s64, 131072
    v_mfma_f32_16x16x32_bf16 a[220:223], a[12:15], a[12:15], a[220:223]
    buffer_load_dwordx4 v12, s[44:47], s77 offen offset:0 lds
    v_mfma_f32_16x16x32_bf16 a[220:223], a[28:31], a[28:31], a[220:223]
    buffer_load_dwordx4 v13, s[44:47], s77 offen offset:1024 lds
    s_waitcnt lgkmcnt(4)
    v_mfma_f32_16x16x32_bf16 v[128:131], a[64:67], a[32:35], v[128:131]
    ds_read_b64_tr_b16 a[80:81], v17 offset:0
    v_mfma_f32_16x16x32_bf16 v[128:131], a[68:71], a[48:51], v[128:131]
    ds_read_b64_tr_b16 a[82:83], v17 offset:1024
    v_mfma_f32_16x16x32_bf16 v[160:163], a[64:67], a[36:39], v[160:163]
    ds_read_b64_tr_b16 a[84:85], v17 offset:8192
    v_mfma_f32_16x16x32_bf16 v[160:163], a[68:71], a[52:55], v[160:163]
    ds_read_b64_tr_b16 a[86:87], v17 offset:9216
    s_add_u32 s78, s28, 5
    s_and_b32 s78, s78, 7
    s_lshl_b32 s78, s78, 7
    s_add_u32 s74, s61, s78
    s_xor_b32 s75, s74, 0x8000
    s_add_u32 m0, s60, 32768
    v_mfma_f32_16x16x32_bf16 v[192:195], a[64:67], a[40:43], v[192:195]
    buffer_load_dwordx4 v0, s[16:19], s74 offen offset:0 lds
    v_mfma_f32_16x16x32_bf16 v[192:195], a[68:71], a[56:59], v[192:195]
    buffer_load_dwordx4 v1, s[16:19], s74 offen offset:1024 lds
    v_mfma_f32_16x16x32_bf16 v[224:227], a[64:67], a[44:47], v[224:227]
    v_mfma_f32_16x16x32_bf16 v[224:227], a[68:71], a[60:63], v[224:227]
    v_mfma_f32_16x16x32_bf16 a[224:227], a[64:67], a[96:99], a[224:227]
    v_mfma_f32_16x16x32_bf16 a[224:227], a[68:71], a[96:99], a[224:227]
    s_waitcnt lgkmcnt(4)
    v_mfma_f32_16x16x32_bf16 v[132:135], a[72:75], a[32:35], v[132:135]
    ds_read_b64_tr_b16 a[88:89], v17 offset:8
    v_mfma_f32_16x16x32_bf16 v[132:135], a[76:79], a[48:51], v[132:135]
    ds_read_b64_tr_b16 a[90:91], v17 offset:1032
    v_mfma_f32_16x16x32_bf16 v[164:167], a[72:75], a[36:39], v[164:167]
    ds_read_b64_tr_b16 a[92:93], v17 offset:8200
    v_mfma_f32_16x16x32_bf16 v[164:167], a[76:79], a[52:55], v[164:167]
    ds_read_b64_tr_b16 a[94:95], v17 offset:9224
    v_mfma_f32_16x16x32_bf16 v[196:199], a[72:75], a[40:43], v[196:199]
    buffer_load_dwordx4 v2, s[16:19], s74 offen offset:2048 lds
    v_mfma_f32_16x16x32_bf16 v[196:199], a[76:79], a[56:59], v[196:199]
    buffer_load_dwordx4 v3, s[16:19], s74 offen offset:3072 lds
    v_mfma_f32_16x16x32_bf16 v[228:231], a[72:75], a[44:47], v[228:231]
    v_mfma_f32_16x16x32_bf16 v[228:231], a[76:79], a[60:63], v[228:231]
    v_mfma_f32_16x16x32_bf16 a[228:231], a[72:75], a[96:99], a[228:231]
    v_mfma_f32_16x16x32_bf16 a[228:231], a[76:79], a[96:99], a[228:231]
    s_waitcnt lgkmcnt(4)
    v_mfma_f32_16x16x32_bf16 v[136:139], a[80:83], a[32:35], v[136:139]
    ds_read_b64_tr_b16 a[64:65], v18 offset:0
    v_mfma_f32_16x16x32_bf16 v[136:139], a[84:87], a[48:51], v[136:139]
    ds_read_b64_tr_b16 a[66:67], v18 offset:1024
    v_mfma_f32_16x16x32_bf16 v[168:171], a[80:83], a[36:39], v[168:171]
    ds_read_b64_tr_b16 a[68:69], v18 offset:8192
    v_mfma_f32_16x16x32_bf16 v[168:171], a[84:87], a[52:55], v[168:171]
    ds_read_b64_tr_b16 a[70:71], v18 offset:9216
    s_add_u32 m0, s60, 36864
    v_mfma_f32_16x16x32_bf16 v[200:203], a[80:83], a[40:43], v[200:203]
    buffer_load_dwordx4 v0, s[16:19], s75 offen offset:0 lds
    v_mfma_f32_16x16x32_bf16 v[200:203], a[84:87], a[56:59], v[200:203]
    buffer_load_dwordx4 v1, s[16:19], s75 offen offset:1024 lds
    v_mfma_f32_16x16x32_bf16 v[232:235], a[80:83], a[44:47], v[232:235]
    v_mfma_f32_16x16x32_bf16 v[232:235], a[84:87], a[60:63], v[232:235]
    s_waitcnt lgkmcnt(4)
    v_mfma_f32_16x16x32_bf16 v[140:143], a[88:91], a[32:35], v[140:143]
    ds_read_b64_tr_b16 a[72:73], v18 offset:8
    v_mfma_f32_16x16x32_bf16 v[140:143], a[92:95], a[48:51], v[140:143]
    ds_read_b64_tr_b16 a[74:75], v18 offset:1032
    v_mfma_f32_16x16x32_bf16 v[172:175], a[88:91], a[36:39], v[172:175]
    ds_read_b64_tr_b16 a[76:77], v18 offset:8200
    v_mfma_f32_16x16x32_bf16 v[172:175], a[92:95], a[52:55], v[172:175]
    ds_read_b64_tr_b16 a[78:79], v18 offset:9224
    v_mfma_f32_16x16x32_bf16 v[204:207], a[88:91], a[40:43], v[204:207]
    buffer_load_dwordx4 v2, s[16:19], s75 offen offset:2048 lds
    v_mfma_f32_16x16x32_bf16 v[204:207], a[92:95], a[56:59], v[204:207]
    buffer_load_dwordx4 v3, s[16:19], s75 offen offset:3072 lds
    v_mfma_f32_16x16x32_bf16 v[236:239], a[88:91], a[44:47], v[236:239]
    v_mfma_f32_16x16x32_bf16 v[236:239], a[92:95], a[60:63], v[236:239]
    s_waitcnt lgkmcnt(4)
    v_mfma_f32_16x16x32_bf16 v[144:147], a[64:67], a[32:35], v[144:147]
    ds_read_b64_tr_b16 a[80:81], v19 offset:0
    v_mfma_f32_16x16x32_bf16 v[144:147], a[68:71], a[48:51], v[144:147]
    ds_read_b64_tr_b16 a[82:83], v19 offset:1024
    v_mfma_f32_16x16x32_bf16 v[176:179], a[64:67], a[36:39], v[176:179]
    ds_read_b64_tr_b16 a[84:85], v19 offset:8192
    v_mfma_f32_16x16x32_bf16 v[176:179], a[68:71], a[52:55], v[176:179]
    ds_read_b64_tr_b16 a[86:87], v19 offset:9216
    v_mfma_f32_16x16x32_bf16 v[208:211], a[64:67], a[40:43], v[208:211]
    v_mfma_f32_16x16x32_bf16 v[208:211], a[68:71], a[56:59], v[208:211]
    v_mfma_f32_16x16x32_bf16 v[240:243], a[64:67], a[44:47], v[240:243]
    v_mfma_f32_16x16x32_bf16 v[240:243], a[68:71], a[60:63], v[240:243]
    s_waitcnt lgkmcnt(4)
    v_mfma_f32_16x16x32_bf16 v[148:151], a[72:75], a[32:35], v[148:151]
    ds_read_b64_tr_b16 a[88:89], v19 offset:8
    v_mfma_f32_16x16x32_bf16 v[148:151], a[76:79], a[48:51], v[148:151]
    ds_read_b64_tr_b16 a[90:91], v19 offset:1032
    v_mfma_f32_16x16x32_bf16 v[180:183], a[72:75], a[36:39], v[180:183]
    ds_read_b64_tr_b16 a[92:93], v19 offset:8200
    v_mfma_f32_16x16x32_bf16 v[180:183], a[76:79], a[52:55], v[180:183]
    ds_read_b64_tr_b16 a[94:95], v19 offset:9224
    v_mfma_f32_16x16x32_bf16 v[212:215], a[72:75], a[40:43], v[212:215]
    v_mfma_f32_16x16x32_bf16 v[212:215], a[76:79], a[56:59], v[212:215]
    v_mfma_f32_16x16x32_bf16 v[244:247], a[72:75], a[44:47], v[244:247]
    v_mfma_f32_16x16x32_bf16 v[244:247], a[76:79], a[60:63], v[244:247]
    s_waitcnt lgkmcnt(4)
    v_mfma_f32_16x16x32_bf16 v[152:155], a[80:83], a[32:35], v[152:155]
    ds_read_b64_tr_b16 a[64:65], v20 offset:0
    v_mfma_f32_16x16x32_bf16 v[152:155], a[84:87], a[48:51], v[152:155]
    ds_read_b64_tr_b16 a[66:67], v20 offset:512
    v_mfma_f32_16x16x32_bf16 v[184:187], a[80:83], a[36:39], v[184:187]
    ds_read_b64_tr_b16 a[68:69], v20 offset:4096
    v_mfma_f32_16x16x32_bf16 v[184:187], a[84:87], a[52:55], v[184:187]
    ds_read_b64_tr_b16 a[70:71], v20 offset:4608
    v_mfma_f32_16x16x32_bf16 v[216:219], a[80:83], a[40:43], v[216:219]
    ds_read_b64_tr_b16 a[100:101], v4 offset:0
    v_mfma_f32_16x16x32_bf16 v[216:219], a[84:87], a[56:59], v[216:219]
    ds_read_b64_tr_b16 a[102:103], v4 offset:512
    v_mfma_f32_16x16x32_bf16 v[248:251], a[80:83], a[44:47], v[248:251]
    v_mfma_f32_16x16x32_bf16 v[248:251], a[84:87], a[60:63], v[248:251]
    s_waitcnt lgkmcnt(6)
    v_mfma_f32_16x16x32_bf16 v[156:159], a[88:91], a[32:35], v[156:159]
    ds_read_b64_tr_b16 a[72:73], v21 offset:0
    v_mfma_f32_16x16x32_bf16 v[156:159], a[92:95], a[48:51], v[156:159]
    ds_read_b64_tr_b16 a[74:75], v21 offset:512
    v_mfma_f32_16x16x32_bf16 v[188:191], a[88:91], a[36:39], v[188:191]
    ds_read_b64_tr_b16 a[76:77], v21 offset:4096
    v_mfma_f32_16x16x32_bf16 v[188:191], a[92:95], a[52:55], v[188:191]
    ds_read_b64_tr_b16 a[78:79], v21 offset:4608
    v_mfma_f32_16x16x32_bf16 v[220:223], a[88:91], a[40:43], v[220:223]
    ds_read_b64_tr_b16 a[104:105], v4 offset:4096
    v_mfma_f32_16x16x32_bf16 v[220:223], a[92:95], a[56:59], v[220:223]
    ds_read_b64_tr_b16 a[106:107], v4 offset:4608
    v_mfma_f32_16x16x32_bf16 v[252:255], a[88:91], a[44:47], v[252:255]
    v_mfma_f32_16x16x32_bf16 v[252:255], a[92:95], a[60:63], v[252:255]
    s_waitcnt lgkmcnt(6)
    v_mfma_f32_16x16x32_bf16 a[128:131], a[64:67], a[32:35], a[128:131]
    s_waitcnt vmcnt(16)
    v_mfma_f32_16x16x32_bf16 a[128:131], a[68:71], a[48:51], a[128:131]
    ds_read_b128 a[0:3], v14 offset:0
    v_mfma_f32_16x16x32_bf16 a[132:135], a[64:67], a[36:39], a[132:135]
    ds_read_b128 a[4:7], v14 offset:2048
    v_mfma_f32_16x16x32_bf16 a[132:135], a[68:71], a[52:55], a[132:135]
    ds_read_b128 a[8:11], v14 offset:4096
    v_mfma_f32_16x16x32_bf16 a[136:139], a[64:67], a[40:43], a[136:139]
    ds_read_b128 a[12:15], v14 offset:6144
    v_mfma_f32_16x16x32_bf16 a[136:139], a[68:71], a[56:59], a[136:139]
    v_mfma_f32_16x16x32_bf16 a[140:143], a[64:67], a[44:47], a[140:143]
    v_mfma_f32_16x16x32_bf16 a[140:143], a[68:71], a[60:63], a[140:143]
    s_waitcnt lgkmcnt(4)
    v_mfma_f32_16x16x32_bf16 a[144:147], a[72:75], a[32:35], a[144:147]
    ds_read_b128 a[16:19], v15 offset:0
    v_mfma_f32_16x16x32_bf16 a[144:147], a[76:79], a[48:51], a[144:147]
    ds_read_b128 a[20:23], v15 offset:2048
    v_mfma_f32_16x16x32_bf16 a[148:151], a[72:75], a[36:39], a[148:151]
    ds_read_b128 a[24:27], v15 offset:4096
    v_mfma_f32_16x16x32_bf16 a[148:151], a[76:79], a[52:55], a[148:151]
    ds_read_b128 a[28:31], v15 offset:6144
    v_mfma_f32_16x16x32_bf16 a[152:155], a[72:75], a[40:43], a[152:155]
    v_mfma_f32_16x16x32_bf16 a[152:155], a[76:79], a[56:59], a[152:155]
    v_mfma_f32_16x16x32_bf16 a[156:159], a[72:75], a[44:47], a[156:159]
    v_mfma_f32_16x16x32_bf16 a[156:159], a[76:79], a[60:63], a[156:159]
    v_mfma_f32_16x16x32_bf16 a[232:235], a[100:103], a[96:99], a[232:235]
    v_mfma_f32_16x16x32_bf16 a[232:235], a[104:107], a[96:99], a[232:235]
    v_mfma_f32_16x16x32_bf16 a[192:195], a[96:99], a[32:35], a[192:195]
    s_waitcnt vmcnt(26)
    v_mfma_f32_16x16x32_bf16 a[192:195], a[96:99], a[48:51], a[192:195]
    s_barrier
    v_mfma_f32_16x16x32_bf16 a[208:211], a[32:35], a[32:35], a[208:211]
    ds_read_b64_tr_b16 a[64:65], v16 offset:24576
    v_mfma_f32_16x16x32_bf16 a[208:211], a[48:51], a[48:51], a[208:211]
    ds_read_b64_tr_b16 a[66:67], v16 offset:25600
    v_mfma_f32_16x16x32_bf16 a[196:199], a[96:99], a[36:39], a[196:199]
    ds_read_b64_tr_b16 a[68:69], v16 offset:32768
    v_mfma_f32_16x16x32_bf16 a[196:199], a[96:99], a[52:55], a[196:199]
    ds_read_b64_tr_b16 a[70:71], v16 offset:33792
    s_add_u32 s78, s28, 6
    s_and_b32 s78, s78, 7
    s_lshl_b32 s79, s78, 19
    s_add_u32 s76, s62, s79
    s_mul_i32 s79, s78, 176128
    s_add_u32 s77, s63, s79
    s_add_u32 m0, s24, 65536
    v_mfma_f32_16x16x32_bf16 a[212:215], a[36:39], a[36:39], a[212:215]
    buffer_load_dwordx4 v8, s[40:43], s76 offen offset:0 lds
    v_mfma_f32_16x16x32_bf16 a[212:215], a[52:55], a[52:55], a[212:215]
    buffer_load_dwordx4 v9, s[40:43], s76 offen offset:1024 lds
    v_mfma_f32_16x16x32_bf16 a[200:203], a[96:99], a[40:43], a[200:203]
    ds_read_b64_tr_b16 a[72:73], v16 offset:24584
    v_mfma_f32_16x16x32_bf16 a[200:203], a[96:99], a[56:59], a[200:203]
    ds_read_b64_tr_b16 a[74:75], v16 offset:25608
    v_mfma_f32_16x16x32_bf16 a[216:219], a[40:43], a[40:43], a[216:219]
    ds_read_b64_tr_b16 a[76:77], v16 offset:32776
    v_mfma_f32_16x16x32_bf16 a[216:219], a[56:59], a[56:59], a[216:219]
    ds_read_b64_tr_b16 a[78:79], v16 offset:33800
    v_mfma_f32_16x16x32_bf16 a[204:207], a[96:99], a[44:47], a[204:207]
    buffer_load_dwordx4 v10, s[40:43], s76 offen offset:2048 lds
    v_mfma_f32_16x16x32_bf16 a[204:207], a[96:99], a[60:63], a[204:207]
    buffer_load_dwordx4 v11, s[40:43], s76 offen offset:3072 lds
    s_add_u32 m0, s64, 81920
    v_mfma_f32_16x16x32_bf16 a[220:223], a[44:47], a[44:47], a[220:223]
    buffer_load_dwordx4 v12, s[44:47], s77 offen offset:0 lds
    v_mfma_f32_16x16x32_bf16 a[220:223], a[60:63], a[60:63], a[220:223]
    buffer_load_dwordx4 v13, s[44:47], s77 offen offset:1024 lds
    s_waitcnt lgkmcnt(4)
    v_mfma_f32_16x16x32_bf16 v[128:131], a[64:67], a[0:3], v[128:131]
    ds_read_b64_tr_b16 a[80:81], v17 offset:24576
    v_mfma_f32_16x16x32_bf16 v[128:131], a[68:71], a[16:19], v[128:131]
    ds_read_b64_tr_b16 a[82:83], v17 offset:25600
    v_mfma_f32_16x16x32_bf16 v[160:163], a[64:67], a[4:7], v[160:163]
    ds_read_b64_tr_b16 a[84:85], v17 offset:32768
    v_mfma_f32_16x16x32_bf16 v[160:163], a[68:71], a[20:23], v[160:163]
    ds_read_b64_tr_b16 a[86:87], v17 offset:33792
    s_add_u32 s78, s28, 6
    s_and_b32 s78, s78, 7
    s_lshl_b32 s78, s78, 7
    s_add_u32 s74, s61, s78
    s_xor_b32 s75, s74, 0x8000
    s_add_u32 m0, s60, 0
    v_mfma_f32_16x16x32_bf16 v[192:195], a[64:67], a[8:11], v[192:195]
    buffer_load_dwordx4 v0, s[16:19], s74 offen offset:0 lds
    v_mfma_f32_16x16x32_bf16 v[192:195], a[68:71], a[24:27], v[192:195]
    buffer_load_dwordx4 v1, s[16:19], s74 offen offset:1024 lds
    v_mfma_f32_16x16x32_bf16 v[224:227], a[64:67], a[12:15], v[224:227]
    v_mfma_f32_16x16x32_bf16 v[224:227], a[68:71], a[28:31], v[224:227]
    v_mfma_f32_16x16x32_bf16 a[224:227], a[64:67], a[96:99], a[224:227]
    v_mfma_f32_16x16x32_bf16 a[224:227], a[68:71], a[96:99], a[224:227]
    s_waitcnt lgkmcnt(4)
    v_mfma_f32_16x16x32_bf16 v[132:135], a[72:75], a[0:3], v[132:135]
    ds_read_b64_tr_b16 a[88:89], v17 offset:24584
    v_mfma_f32_16x16x32_bf16 v[132:135], a[76:79], a[16:19], v[132:135]
    ds_read_b64_tr_b16 a[90:91], v17 offset:25608
    v_mfma_f32_16x16x32_bf16 v[164:167], a[72:75], a[4:7], v[164:167]
    ds_read_b64_tr_b16 a[92:93], v17 offset:32776
    v_mfma_f32_16x16x32_bf16 v[164:167], a[76:79], a[20:23], v[164:167]
    ds_read_b64_tr_b16 a[94:95], v17 offset:33800
    v_mfma_f32_16x16x32_bf16 v[196:199], a[72:75], a[8:11], v[196:199]
    buffer_load_dwordx4 v2, s[16:19], s74 offen offset:2048 lds
    v_mfma_f32_16x16x32_bf16 v[196:199], a[76:79], a[24:27], v[196:199]
    buffer_load_dwordx4 v3, s[16:19], s74 offen offset:3072 lds
    v_mfma_f32_16x16x32_bf16 v[228:231], a[72:75], a[12:15], v[228:231]
    v_mfma_f32_16x16x32_bf16 v[228:231], a[76:79], a[28:31], v[228:231]
    v_mfma_f32_16x16x32_bf16 a[228:231], a[72:75], a[96:99], a[228:231]
    v_mfma_f32_16x16x32_bf16 a[228:231], a[76:79], a[96:99], a[228:231]
    s_waitcnt lgkmcnt(4)
    v_mfma_f32_16x16x32_bf16 v[136:139], a[80:83], a[0:3], v[136:139]
    ds_read_b64_tr_b16 a[64:65], v18 offset:24576
    v_mfma_f32_16x16x32_bf16 v[136:139], a[84:87], a[16:19], v[136:139]
    ds_read_b64_tr_b16 a[66:67], v18 offset:25600
    v_mfma_f32_16x16x32_bf16 v[168:171], a[80:83], a[4:7], v[168:171]
    ds_read_b64_tr_b16 a[68:69], v18 offset:32768
    v_mfma_f32_16x16x32_bf16 v[168:171], a[84:87], a[20:23], v[168:171]
    ds_read_b64_tr_b16 a[70:71], v18 offset:33792
    s_add_u32 m0, s60, 4096
    v_mfma_f32_16x16x32_bf16 v[200:203], a[80:83], a[8:11], v[200:203]
    buffer_load_dwordx4 v0, s[16:19], s75 offen offset:0 lds
    v_mfma_f32_16x16x32_bf16 v[200:203], a[84:87], a[24:27], v[200:203]
    buffer_load_dwordx4 v1, s[16:19], s75 offen offset:1024 lds
    v_mfma_f32_16x16x32_bf16 v[232:235], a[80:83], a[12:15], v[232:235]
    v_mfma_f32_16x16x32_bf16 v[232:235], a[84:87], a[28:31], v[232:235]
    s_waitcnt lgkmcnt(4)
    v_mfma_f32_16x16x32_bf16 v[140:143], a[88:91], a[0:3], v[140:143]
    ds_read_b64_tr_b16 a[72:73], v18 offset:24584
    v_mfma_f32_16x16x32_bf16 v[140:143], a[92:95], a[16:19], v[140:143]
    ds_read_b64_tr_b16 a[74:75], v18 offset:25608
    v_mfma_f32_16x16x32_bf16 v[172:175], a[88:91], a[4:7], v[172:175]
    ds_read_b64_tr_b16 a[76:77], v18 offset:32776
    v_mfma_f32_16x16x32_bf16 v[172:175], a[92:95], a[20:23], v[172:175]
    ds_read_b64_tr_b16 a[78:79], v18 offset:33800
    v_mfma_f32_16x16x32_bf16 v[204:207], a[88:91], a[8:11], v[204:207]
    buffer_load_dwordx4 v2, s[16:19], s75 offen offset:2048 lds
    v_mfma_f32_16x16x32_bf16 v[204:207], a[92:95], a[24:27], v[204:207]
    buffer_load_dwordx4 v3, s[16:19], s75 offen offset:3072 lds
    v_mfma_f32_16x16x32_bf16 v[236:239], a[88:91], a[12:15], v[236:239]
    v_mfma_f32_16x16x32_bf16 v[236:239], a[92:95], a[28:31], v[236:239]
    s_waitcnt lgkmcnt(4)
    v_mfma_f32_16x16x32_bf16 v[144:147], a[64:67], a[0:3], v[144:147]
    ds_read_b64_tr_b16 a[80:81], v19 offset:24576
    v_mfma_f32_16x16x32_bf16 v[144:147], a[68:71], a[16:19], v[144:147]
    ds_read_b64_tr_b16 a[82:83], v19 offset:25600
    v_mfma_f32_16x16x32_bf16 v[176:179], a[64:67], a[4:7], v[176:179]
    ds_read_b64_tr_b16 a[84:85], v19 offset:32768
    v_mfma_f32_16x16x32_bf16 v[176:179], a[68:71], a[20:23], v[176:179]
    ds_read_b64_tr_b16 a[86:87], v19 offset:33792
    v_mfma_f32_16x16x32_bf16 v[208:211], a[64:67], a[8:11], v[208:211]
    v_mfma_f32_16x16x32_bf16 v[208:211], a[68:71], a[24:27], v[208:211]
    v_mfma_f32_16x16x32_bf16 v[240:243], a[64:67], a[12:15], v[240:243]
    v_mfma_f32_16x16x32_bf16 v[240:243], a[68:71], a[28:31], v[240:243]
    s_waitcnt lgkmcnt(4)
    v_mfma_f32_16x16x32_bf16 v[148:151], a[72:75], a[0:3], v[148:151]
    ds_read_b64_tr_b16 a[88:89], v19 offset:24584
    v_mfma_f32_16x16x32_bf16 v[148:151], a[76:79], a[16:19], v[148:151]
    ds_read_b64_tr_b16 a[90:91], v19 offset:25608
    v_mfma_f32_16x16x32_bf16 v[180:183], a[72:75], a[4:7], v[180:183]
    ds_read_b64_tr_b16 a[92:93], v19 offset:32776
    v_mfma_f32_16x16x32_bf16 v[180:183], a[76:79], a[20:23], v[180:183]
    ds_read_b64_tr_b16 a[94:95], v19 offset:33800
    v_mfma_f32_16x16x32_bf16 v[212:215], a[72:75], a[8:11], v[212:215]
    v_mfma_f32_16x16x32_bf16 v[212:215], a[76:79], a[24:27], v[212:215]
    v_mfma_f32_16x16x32_bf16 v[244:247], a[72:75], a[12:15], v[244:247]
    v_mfma_f32_16x16x32_bf16 v[244:247], a[76:79], a[28:31], v[244:247]
    s_waitcnt lgkmcnt(4)
    v_mfma_f32_16x16x32_bf16 v[152:155], a[80:83], a[0:3], v[152:155]
    ds_read_b64_tr_b16 a[64:65], v20 offset:24576
    v_mfma_f32_16x16x32_bf16 v[152:155], a[84:87], a[16:19], v[152:155]
    ds_read_b64_tr_b16 a[66:67], v20 offset:25088
    v_mfma_f32_16x16x32_bf16 v[184:187], a[80:83], a[4:7], v[184:187]
    ds_read_b64_tr_b16 a[68:69], v20 offset:28672
    v_mfma_f32_16x16x32_bf16 v[184:187], a[84:87], a[20:23], v[184:187]
    ds_read_b64_tr_b16 a[70:71], v20 offset:29184
    v_mfma_f32_16x16x32_bf16 v[216:219], a[80:83], a[8:11], v[216:219]
    ds_read_b64_tr_b16 a[100:101], v4 offset:24576
    v_mfma_f32_16x16x32_bf16 v[216:219], a[84:87], a[24:27], v[216:219]
    ds_read_b64_tr_b16 a[102:103], v4 offset:25088
    v_mfma_f32_16x16x32_bf16 v[248:251], a[80:83], a[12:15], v[248:251]
    v_mfma_f32_16x16x32_bf16 v[248:251], a[84:87], a[28:31], v[248:251]
    s_waitcnt lgkmcnt(6)
    v_mfma_f32_16x16x32_bf16 v[156:159], a[88:91], a[0:3], v[156:159]
    ds_read_b64_tr_b16 a[72:73], v21 offset:24576
    v_mfma_f32_16x16x32_bf16 v[156:159], a[92:95], a[16:19], v[156:159]
    ds_read_b64_tr_b16 a[74:75], v21 offset:25088
    v_mfma_f32_16x16x32_bf16 v[188:191], a[88:91], a[4:7], v[188:191]
    ds_read_b64_tr_b16 a[76:77], v21 offset:28672
    v_mfma_f32_16x16x32_bf16 v[188:191], a[92:95], a[20:23], v[188:191]
    ds_read_b64_tr_b16 a[78:79], v21 offset:29184
    v_mfma_f32_16x16x32_bf16 v[220:223], a[88:91], a[8:11], v[220:223]
    ds_read_b64_tr_b16 a[104:105], v4 offset:28672
    v_mfma_f32_16x16x32_bf16 v[220:223], a[92:95], a[24:27], v[220:223]
    ds_read_b64_tr_b16 a[106:107], v4 offset:29184
    v_mfma_f32_16x16x32_bf16 v[252:255], a[88:91], a[12:15], v[252:255]
    v_mfma_f32_16x16x32_bf16 v[252:255], a[92:95], a[28:31], v[252:255]
    s_waitcnt lgkmcnt(6)
    v_mfma_f32_16x16x32_bf16 a[128:131], a[64:67], a[0:3], a[128:131]
    s_waitcnt vmcnt(14)
    v_mfma_f32_16x16x32_bf16 a[128:131], a[68:71], a[16:19], a[128:131]
    ds_read_b128 a[32:35], v14 offset:32768
    v_mfma_f32_16x16x32_bf16 a[132:135], a[64:67], a[4:7], a[132:135]
    ds_read_b128 a[36:39], v14 offset:34816
    v_mfma_f32_16x16x32_bf16 a[132:135], a[68:71], a[20:23], a[132:135]
    ds_read_b128 a[40:43], v14 offset:36864
    v_mfma_f32_16x16x32_bf16 a[136:139], a[64:67], a[8:11], a[136:139]
    ds_read_b128 a[44:47], v14 offset:38912
    v_mfma_f32_16x16x32_bf16 a[136:139], a[68:71], a[24:27], a[136:139]
    v_mfma_f32_16x16x32_bf16 a[140:143], a[64:67], a[12:15], a[140:143]
    v_mfma_f32_16x16x32_bf16 a[140:143], a[68:71], a[28:31], a[140:143]
    s_waitcnt lgkmcnt(4)
    v_mfma_f32_16x16x32_bf16 a[144:147], a[72:75], a[0:3], a[144:147]
    ds_read_b128 a[48:51], v15 offset:32768
    v_mfma_f32_16x16x32_bf16 a[144:147], a[76:79], a[16:19], a[144:147]
    ds_read_b128 a[52:55], v15 offset:34816
    v_mfma_f32_16x16x32_bf16 a[148:151], a[72:75], a[4:7], a[148:151]
    ds_read_b128 a[56:59], v15 offset:36864
    v_mfma_f32_16x16x32_bf16 a[148:151], a[76:79], a[20:23], a[148:151]
    ds_read_b128 a[60:63], v15 offset:38912
    v_mfma_f32_16x16x32_bf16 a[152:155], a[72:75], a[8:11], a[152:155]
    v_mfma_f32_16x16x32_bf16 a[152:155], a[76:79], a[24:27], a[152:155]
    v_mfma_f32_16x16x32_bf16 a[156:159], a[72:75], a[12:15], a[156:159]
    v_mfma_f32_16x16x32_bf16 a[156:159], a[76:79], a[28:31], a[156:159]
    v_mfma_f32_16x16x32_bf16 a[232:235], a[100:103], a[96:99], a[232:235]
    v_mfma_f32_16x16x32_bf16 a[232:235], a[104:107], a[96:99], a[232:235]
    v_mfma_f32_16x16x32_bf16 a[192:195], a[96:99], a[0:3], a[192:195]
    s_waitcnt vmcnt(22)
    v_mfma_f32_16x16x32_bf16 a[192:195], a[96:99], a[16:19], a[192:195]
    s_barrier
    v_mfma_f32_16x16x32_bf16 a[208:211], a[0:3], a[0:3], a[208:211]
    ds_read_b64_tr_b16 a[64:65], v16 offset:49152
    v_mfma_f32_16x16x32_bf16 a[208:211], a[16:19], a[16:19], a[208:211]
    ds_read_b64_tr_b16 a[66:67], v16 offset:50176
    v_mfma_f32_16x16x32_bf16 a[196:199], a[96:99], a[4:7], a[196:199]
    ds_read_b64_tr_b16 a[68:69], v16 offset:57344
    v_mfma_f32_16x16x32_bf16 a[196:199], a[96:99], a[20:23], a[196:199]
    ds_read_b64_tr_b16 a[70:71], v16 offset:58368
    s_add_u32 s78, s28, 7
    s_and_b32 s78, s78, 7
    s_lshl_b32 s79, s78, 19
    s_add_u32 s76, s62, s79
    s_mul_i32 s79, s78, 176128
    s_add_u32 s77, s63, s79
    s_add_u32 m0, s24, 90112
    v_mfma_f32_16x16x32_bf16 a[212:215], a[4:7], a[4:7], a[212:215]
    buffer_load_dwordx4 v8, s[40:43], s76 offen offset:0 lds
    v_mfma_f32_16x16x32_bf16 a[212:215], a[20:23], a[20:23], a[212:215]
    buffer_load_dwordx4 v9, s[40:43], s76 offen offset:1024 lds
    v_mfma_f32_16x16x32_bf16 a[200:203], a[96:99], a[8:11], a[200:203]
    ds_read_b64_tr_b16 a[72:73], v16 offset:49160
    v_mfma_f32_16x16x32_bf16 a[200:203], a[96:99], a[24:27], a[200:203]
    ds_read_b64_tr_b16 a[74:75], v16 offset:50184
    v_mfma_f32_16x16x32_bf16 a[216:219], a[8:11], a[8:11], a[216:219]
    ds_read_b64_tr_b16 a[76:77], v16 offset:57352
    v_mfma_f32_16x16x32_bf16 a[216:219], a[24:27], a[24:27], a[216:219]
    ds_read_b64_tr_b16 a[78:79], v16 offset:58376
    v_mfma_f32_16x16x32_bf16 a[204:207], a[96:99], a[12:15], a[204:207]
    buffer_load_dwordx4 v10, s[40:43], s76 offen offset:2048 lds
    v_mfma_f32_16x16x32_bf16 a[204:207], a[96:99], a[28:31], a[204:207]
    buffer_load_dwordx4 v11, s[40:43], s76 offen offset:3072 lds
    s_add_u32 m0, s64, 106496
    v_mfma_f32_16x16x32_bf16 a[220:223], a[12:15], a[12:15], a[220:223]
    buffer_load_dwordx4 v12, s[44:47], s77 offen offset:0 lds
    v_mfma_f32_16x16x32_bf16 a[220:223], a[28:31], a[28:31], a[220:223]
    buffer_load_dwordx4 v13, s[44:47], s77 offen offset:1024 lds
    s_waitcnt lgkmcnt(4)
    v_mfma_f32_16x16x32_bf16 v[128:131], a[64:67], a[32:35], v[128:131]
    ds_read_b64_tr_b16 a[80:81], v17 offset:49152
    v_mfma_f32_16x16x32_bf16 v[128:131], a[68:71], a[48:51], v[128:131]
    ds_read_b64_tr_b16 a[82:83], v17 offset:50176
    v_mfma_f32_16x16x32_bf16 v[160:163], a[64:67], a[36:39], v[160:163]
    ds_read_b64_tr_b16 a[84:85], v17 offset:57344
    v_mfma_f32_16x16x32_bf16 v[160:163], a[68:71], a[52:55], v[160:163]
    ds_read_b64_tr_b16 a[86:87], v17 offset:58368
    s_add_u32 s78, s28, 7
    s_and_b32 s78, s78, 7
    s_lshl_b32 s78, s78, 7
    s_add_u32 s74, s61, s78
    s_xor_b32 s75, s74, 0x8000
    s_add_u32 m0, s60, 32768
    v_mfma_f32_16x16x32_bf16 v[192:195], a[64:67], a[40:43], v[192:195]
    buffer_load_dwordx4 v0, s[16:19], s74 offen offset:0 lds
    v_mfma_f32_16x16x32_bf16 v[192:195], a[68:71], a[56:59], v[192:195]
    buffer_load_dwordx4 v1, s[16:19], s74 offen offset:1024 lds
    v_mfma_f32_16x16x32_bf16 v[224:227], a[64:67], a[44:47], v[224:227]
    v_mfma_f32_16x16x32_bf16 v[224:227], a[68:71], a[60:63], v[224:227]
    v_mfma_f32_16x16x32_bf16 a[224:227], a[64:67], a[96:99], a[224:227]
    v_mfma_f32_16x16x32_bf16 a[224:227], a[68:71], a[96:99], a[224:227]
    s_waitcnt lgkmcnt(4)
    v_mfma_f32_16x16x32_bf16 v[132:135], a[72:75], a[32:35], v[132:135]
    ds_read_b64_tr_b16 a[88:89], v17 offset:49160
    v_mfma_f32_16x16x32_bf16 v[132:135], a[76:79], a[48:51], v[132:135]
    ds_read_b64_tr_b16 a[90:91], v17 offset:50184
    v_mfma_f32_16x16x32_bf16 v[164:167], a[72:75], a[36:39], v[164:167]
    ds_read_b64_tr_b16 a[92:93], v17 offset:57352
    v_mfma_f32_16x16x32_bf16 v[164:167], a[76:79], a[52:55], v[164:167]
    ds_read_b64_tr_b16 a[94:95], v17 offset:58376
    v_mfma_f32_16x16x32_bf16 v[196:199], a[72:75], a[40:43], v[196:199]
    buffer_load_dwordx4 v2, s[16:19], s74 offen offset:2048 lds
    v_mfma_f32_16x16x32_bf16 v[196:199], a[76:79], a[56:59], v[196:199]
    buffer_load_dwordx4 v3, s[16:19], s74 offen offset:3072 lds
    v_mfma_f32_16x16x32_bf16 v[228:231], a[72:75], a[44:47], v[228:231]
    v_mfma_f32_16x16x32_bf16 v[228:231], a[76:79], a[60:63], v[228:231]
    v_mfma_f32_16x16x32_bf16 a[228:231], a[72:75], a[96:99], a[228:231]
    v_mfma_f32_16x16x32_bf16 a[228:231], a[76:79], a[96:99], a[228:231]
    s_waitcnt lgkmcnt(4)
    v_mfma_f32_16x16x32_bf16 v[136:139], a[80:83], a[32:35], v[136:139]
    ds_read_b64_tr_b16 a[64:65], v18 offset:49152
    v_mfma_f32_16x16x32_bf16 v[136:139], a[84:87], a[48:51], v[136:139]
    ds_read_b64_tr_b16 a[66:67], v18 offset:50176
    v_mfma_f32_16x16x32_bf16 v[168:171], a[80:83], a[36:39], v[168:171]
    ds_read_b64_tr_b16 a[68:69], v18 offset:57344
    v_mfma_f32_16x16x32_bf16 v[168:171], a[84:87], a[52:55], v[168:171]
    ds_read_b64_tr_b16 a[70:71], v18 offset:58368
    s_add_u32 m0, s60, 36864
    v_mfma_f32_16x16x32_bf16 v[200:203], a[80:83], a[40:43], v[200:203]
    buffer_load_dwordx4 v0, s[16:19], s75 offen offset:0 lds
    v_mfma_f32_16x16x32_bf16 v[200:203], a[84:87], a[56:59], v[200:203]
    buffer_load_dwordx4 v1, s[16:19], s75 offen offset:1024 lds
    v_mfma_f32_16x16x32_bf16 v[232:235], a[80:83], a[44:47], v[232:235]
    v_mfma_f32_16x16x32_bf16 v[232:235], a[84:87], a[60:63], v[232:235]
    s_waitcnt lgkmcnt(4)
    v_mfma_f32_16x16x32_bf16 v[140:143], a[88:91], a[32:35], v[140:143]
    ds_read_b64_tr_b16 a[72:73], v18 offset:49160
    v_mfma_f32_16x16x32_bf16 v[140:143], a[92:95], a[48:51], v[140:143]
    ds_read_b64_tr_b16 a[74:75], v18 offset:50184
    v_mfma_f32_16x16x32_bf16 v[172:175], a[88:91], a[36:39], v[172:175]
    ds_read_b64_tr_b16 a[76:77], v18 offset:57352
    v_mfma_f32_16x16x32_bf16 v[172:175], a[92:95], a[52:55], v[172:175]
    ds_read_b64_tr_b16 a[78:79], v18 offset:58376
    v_mfma_f32_16x16x32_bf16 v[204:207], a[88:91], a[40:43], v[204:207]
    buffer_load_dwordx4 v2, s[16:19], s75 offen offset:2048 lds
    v_mfma_f32_16x16x32_bf16 v[204:207], a[92:95], a[56:59], v[204:207]
    buffer_load_dwordx4 v3, s[16:19], s75 offen offset:3072 lds
    v_mfma_f32_16x16x32_bf16 v[236:239], a[88:91], a[44:47], v[236:239]
    v_mfma_f32_16x16x32_bf16 v[236:239], a[92:95], a[60:63], v[236:239]
    s_waitcnt lgkmcnt(4)
    v_mfma_f32_16x16x32_bf16 v[144:147], a[64:67], a[32:35], v[144:147]
    ds_read_b64_tr_b16 a[80:81], v19 offset:49152
    v_mfma_f32_16x16x32_bf16 v[144:147], a[68:71], a[48:51], v[144:147]
    ds_read_b64_tr_b16 a[82:83], v19 offset:50176
    v_mfma_f32_16x16x32_bf16 v[176:179], a[64:67], a[36:39], v[176:179]
    ds_read_b64_tr_b16 a[84:85], v19 offset:57344
    v_mfma_f32_16x16x32_bf16 v[176:179], a[68:71], a[52:55], v[176:179]
    ds_read_b64_tr_b16 a[86:87], v19 offset:58368
    v_mfma_f32_16x16x32_bf16 v[208:211], a[64:67], a[40:43], v[208:211]
    v_mfma_f32_16x16x32_bf16 v[208:211], a[68:71], a[56:59], v[208:211]
    v_mfma_f32_16x16x32_bf16 v[240:243], a[64:67], a[44:47], v[240:243]
    v_mfma_f32_16x16x32_bf16 v[240:243], a[68:71], a[60:63], v[240:243]
    s_waitcnt lgkmcnt(4)
    v_mfma_f32_16x16x32_bf16 v[148:151], a[72:75], a[32:35], v[148:151]
    ds_read_b64_tr_b16 a[88:89], v19 offset:49160
    v_mfma_f32_16x16x32_bf16 v[148:151], a[76:79], a[48:51], v[148:151]
    ds_read_b64_tr_b16 a[90:91], v19 offset:50184
    v_mfma_f32_16x16x32_bf16 v[180:183], a[72:75], a[36:39], v[180:183]
    ds_read_b64_tr_b16 a[92:93], v19 offset:57352
    v_mfma_f32_16x16x32_bf16 v[180:183], a[76:79], a[52:55], v[180:183]
    ds_read_b64_tr_b16 a[94:95], v19 offset:58376
    v_mfma_f32_16x16x32_bf16 v[212:215], a[72:75], a[40:43], v[212:215]
    v_mfma_f32_16x16x32_bf16 v[212:215], a[76:79], a[56:59], v[212:215]
    v_mfma_f32_16x16x32_bf16 v[244:247], a[72:75], a[44:47], v[244:247]
    v_mfma_f32_16x16x32_bf16 v[244:247], a[76:79], a[60:63], v[244:247]
    s_waitcnt lgkmcnt(4)
    v_mfma_f32_16x16x32_bf16 v[152:155], a[80:83], a[32:35], v[152:155]
    ds_read_b64_tr_b16 a[64:65], v20 offset:49152
    v_mfma_f32_16x16x32_bf16 v[152:155], a[84:87], a[48:51], v[152:155]
    ds_read_b64_tr_b16 a[66:67], v20 offset:49664
    v_mfma_f32_16x16x32_bf16 v[184:187], a[80:83], a[36:39], v[184:187]
    ds_read_b64_tr_b16 a[68:69], v20 offset:53248
    v_mfma_f32_16x16x32_bf16 v[184:187], a[84:87], a[52:55], v[184:187]
    ds_read_b64_tr_b16 a[70:71], v20 offset:53760
    v_mfma_f32_16x16x32_bf16 v[216:219], a[80:83], a[40:43], v[216:219]
    ds_read_b64_tr_b16 a[100:101], v4 offset:49152
    v_mfma_f32_16x16x32_bf16 v[216:219], a[84:87], a[56:59], v[216:219]
    ds_read_b64_tr_b16 a[102:103], v4 offset:49664
    v_mfma_f32_16x16x32_bf16 v[248:251], a[80:83], a[44:47], v[248:251]
    v_mfma_f32_16x16x32_bf16 v[248:251], a[84:87], a[60:63], v[248:251]
    s_waitcnt lgkmcnt(6)
    v_mfma_f32_16x16x32_bf16 v[156:159], a[88:91], a[32:35], v[156:159]
    ds_read_b64_tr_b16 a[72:73], v21 offset:49152
    v_mfma_f32_16x16x32_bf16 v[156:159], a[92:95], a[48:51], v[156:159]
    ds_read_b64_tr_b16 a[74:75], v21 offset:49664
    v_mfma_f32_16x16x32_bf16 v[188:191], a[88:91], a[36:39], v[188:191]
    ds_read_b64_tr_b16 a[76:77], v21 offset:53248
    v_mfma_f32_16x16x32_bf16 v[188:191], a[92:95], a[52:55], v[188:191]
    ds_read_b64_tr_b16 a[78:79], v21 offset:53760
    v_mfma_f32_16x16x32_bf16 v[220:223], a[88:91], a[40:43], v[220:223]
    ds_read_b64_tr_b16 a[104:105], v4 offset:53248
    v_mfma_f32_16x16x32_bf16 v[220:223], a[92:95], a[56:59], v[220:223]
    ds_read_b64_tr_b16 a[106:107], v4 offset:53760
    v_mfma_f32_16x16x32_bf16 v[252:255], a[88:91], a[44:47], v[252:255]
    v_mfma_f32_16x16x32_bf16 v[252:255], a[92:95], a[60:63], v[252:255]
    s_waitcnt lgkmcnt(6)
    v_mfma_f32_16x16x32_bf16 a[128:131], a[64:67], a[32:35], a[128:131]
    s_waitcnt vmcnt(14)
    v_mfma_f32_16x16x32_bf16 a[128:131], a[68:71], a[48:51], a[128:131]
    ds_read_b128 a[0:3], v14 offset:0
    v_mfma_f32_16x16x32_bf16 a[132:135], a[64:67], a[36:39], a[132:135]
    ds_read_b128 a[4:7], v14 offset:2048
    v_mfma_f32_16x16x32_bf16 a[132:135], a[68:71], a[52:55], a[132:135]
    ds_read_b128 a[8:11], v14 offset:4096
    v_mfma_f32_16x16x32_bf16 a[136:139], a[64:67], a[40:43], a[136:139]
    ds_read_b128 a[12:15], v14 offset:6144
    v_mfma_f32_16x16x32_bf16 a[136:139], a[68:71], a[56:59], a[136:139]
    v_mfma_f32_16x16x32_bf16 a[140:143], a[64:67], a[44:47], a[140:143]
    v_mfma_f32_16x16x32_bf16 a[140:143], a[68:71], a[60:63], a[140:143]
    s_waitcnt lgkmcnt(4)
    v_mfma_f32_16x16x32_bf16 a[144:147], a[72:75], a[32:35], a[144:147]
    ds_read_b128 a[16:19], v15 offset:0
    v_mfma_f32_16x16x32_bf16 a[144:147], a[76:79], a[48:51], a[144:147]
    ds_read_b128 a[20:23], v15 offset:2048
    v_mfma_f32_16x16x32_bf16 a[148:151], a[72:75], a[36:39], a[148:151]
    ds_read_b128 a[24:27], v15 offset:4096
    v_mfma_f32_16x16x32_bf16 a[148:151], a[76:79], a[52:55], a[148:151]
    ds_read_b128 a[28:31], v15 offset:6144
    v_mfma_f32_16x16x32_bf16 a[152:155], a[72:75], a[40:43], a[152:155]
    v_mfma_f32_16x16x32_bf16 a[152:155], a[76:79], a[56:59], a[152:155]
    v_mfma_f32_16x16x32_bf16 a[156:159], a[72:75], a[44:47], a[156:159]
    v_mfma_f32_16x16x32_bf16 a[156:159], a[76:79], a[60:63], a[156:159]
    v_mfma_f32_16x16x32_bf16 a[232:235], a[100:103], a[96:99], a[232:235]
    v_mfma_f32_16x16x32_bf16 a[232:235], a[104:107], a[96:99], a[232:235]
    v_mfma_f32_16x16x32_bf16 a[192:195], a[96:99], a[32:35], a[192:195]
    s_waitcnt vmcnt(22)
    v_mfma_f32_16x16x32_bf16 a[192:195], a[96:99], a[48:51], a[192:195]
    s_barrier
    v_mfma_f32_16x16x32_bf16 a[208:211], a[32:35], a[32:35], a[208:211]
    ds_read_b64_tr_b16 a[64:65], v16 offset:0
    v_mfma_f32_16x16x32_bf16 a[208:211], a[48:51], a[48:51], a[208:211]
    ds_read_b64_tr_b16 a[66:67], v16 offset:1024
    v_mfma_f32_16x16x32_bf16 a[196:199], a[96:99], a[36:39], a[196:199]
    ds_read_b64_tr_b16 a[68:69], v16 offset:8192
    v_mfma_f32_16x16x32_bf16 a[196:199], a[96:99], a[52:55], a[196:199]
    ds_read_b64_tr_b16 a[70:71], v16 offset:9216
    v_mfma_f32_16x16x32_bf16 a[212:215], a[36:39], a[36:39], a[212:215]
    v_mfma_f32_16x16x32_bf16 a[212:215], a[52:55], a[52:55], a[212:215]
    v_mfma_f32_16x16x32_bf16 a[200:203], a[96:99], a[40:43], a[200:203]
    ds_read_b64_tr_b16 a[72:73], v16 offset:8
    v_mfma_f32_16x16x32_bf16 a[200:203], a[96:99], a[56:59], a[200:203]
    ds_read_b64_tr_b16 a[74:75], v16 offset:1032
    v_mfma_f32_16x16x32_bf16 a[216:219], a[40:43], a[40:43], a[216:219]
    ds_read_b64_tr_b16 a[76:77], v16 offset:8200
    v_mfma_f32_16x16x32_bf16 a[216:219], a[56:59], a[56:59], a[216:219]
    ds_read_b64_tr_b16 a[78:79], v16 offset:9224
    v_mfma_f32_16x16x32_bf16 a[204:207], a[96:99], a[44:47], a[204:207]
    v_mfma_f32_16x16x32_bf16 a[204:207], a[96:99], a[60:63], a[204:207]
    v_mfma_f32_16x16x32_bf16 a[220:223], a[44:47], a[44:47], a[220:223]
    v_mfma_f32_16x16x32_bf16 a[220:223], a[60:63], a[60:63], a[220:223]
    s_waitcnt lgkmcnt(4)
    v_mfma_f32_16x16x32_bf16 v[128:131], a[64:67], a[0:3], v[128:131]
    ds_read_b64_tr_b16 a[80:81], v17 offset:0
    v_mfma_f32_16x16x32_bf16 v[128:131], a[68:71], a[16:19], v[128:131]
    ds_read_b64_tr_b16 a[82:83], v17 offset:1024
    v_mfma_f32_16x16x32_bf16 v[160:163], a[64:67], a[4:7], v[160:163]
    ds_read_b64_tr_b16 a[84:85], v17 offset:8192
    v_mfma_f32_16x16x32_bf16 v[160:163], a[68:71], a[20:23], v[160:163]
    ds_read_b64_tr_b16 a[86:87], v17 offset:9216
    v_mfma_f32_16x16x32_bf16 v[192:195], a[64:67], a[8:11], v[192:195]
    v_mfma_f32_16x16x32_bf16 v[192:195], a[68:71], a[24:27], v[192:195]
    v_mfma_f32_16x16x32_bf16 v[224:227], a[64:67], a[12:15], v[224:227]
    v_mfma_f32_16x16x32_bf16 v[224:227], a[68:71], a[28:31], v[224:227]
    v_mfma_f32_16x16x32_bf16 a[224:227], a[64:67], a[96:99], a[224:227]
    v_mfma_f32_16x16x32_bf16 a[224:227], a[68:71], a[96:99], a[224:227]
    s_waitcnt lgkmcnt(4)
    v_mfma_f32_16x16x32_bf16 v[132:135], a[72:75], a[0:3], v[132:135]
    ds_read_b64_tr_b16 a[88:89], v17 offset:8
    v_mfma_f32_16x16x32_bf16 v[132:135], a[76:79], a[16:19], v[132:135]
    ds_read_b64_tr_b16 a[90:91], v17 offset:1032
    v_mfma_f32_16x16x32_bf16 v[164:167], a[72:75], a[4:7], v[164:167]
    ds_read_b64_tr_b16 a[92:93], v17 offset:8200
    v_mfma_f32_16x16x32_bf16 v[164:167], a[76:79], a[20:23], v[164:167]
    ds_read_b64_tr_b16 a[94:95], v17 offset:9224
    v_mfma_f32_16x16x32_bf16 v[196:199], a[72:75], a[8:11], v[196:199]
    v_mfma_f32_16x16x32_bf16 v[196:199], a[76:79], a[24:27], v[196:199]
    v_mfma_f32_16x16x32_bf16 v[228:231], a[72:75], a[12:15], v[228:231]
    v_mfma_f32_16x16x32_bf16 v[228:231], a[76:79], a[28:31], v[228:231]
    v_mfma_f32_16x16x32_bf16 a[228:231], a[72:75], a[96:99], a[228:231]
    v_mfma_f32_16x16x32_bf16 a[228:231], a[76:79], a[96:99], a[228:231]
    s_waitcnt lgkmcnt(4)
    v_mfma_f32_16x16x32_bf16 v[136:139], a[80:83], a[0:3], v[136:139]
    ds_read_b64_tr_b16 a[64:65], v18 offset:0
    v_mfma_f32_16x16x32_bf16 v[136:139], a[84:87], a[16:19], v[136:139]
    ds_read_b64_tr_b16 a[66:67], v18 offset:1024
    v_mfma_f32_16x16x32_bf16 v[168:171], a[80:83], a[4:7], v[168:171]
    ds_read_b64_tr_b16 a[68:69], v18 offset:8192
    v_mfma_f32_16x16x32_bf16 v[168:171], a[84:87], a[20:23], v[168:171]
    ds_read_b64_tr_b16 a[70:71], v18 offset:9216
    v_mfma_f32_16x16x32_bf16 v[200:203], a[80:83], a[8:11], v[200:203]
    v_mfma_f32_16x16x32_bf16 v[200:203], a[84:87], a[24:27], v[200:203]
    v_mfma_f32_16x16x32_bf16 v[232:235], a[80:83], a[12:15], v[232:235]
    v_mfma_f32_16x16x32_bf16 v[232:235], a[84:87], a[28:31], v[232:235]
    s_waitcnt lgkmcnt(4)
    v_mfma_f32_16x16x32_bf16 v[140:143], a[88:91], a[0:3], v[140:143]
    ds_read_b64_tr_b16 a[72:73], v18 offset:8
    v_mfma_f32_16x16x32_bf16 v[140:143], a[92:95], a[16:19], v[140:143]
    ds_read_b64_tr_b16 a[74:75], v18 offset:1032
    v_mfma_f32_16x16x32_bf16 v[172:175], a[88:91], a[4:7], v[172:175]
    ds_read_b64_tr_b16 a[76:77], v18 offset:8200
    v_mfma_f32_16x16x32_bf16 v[172:175], a[92:95], a[20:23], v[172:175]
    ds_read_b64_tr_b16 a[78:79], v18 offset:9224
    v_mfma_f32_16x16x32_bf16 v[204:207], a[88:91], a[8:11], v[204:207]
    v_mfma_f32_16x16x32_bf16 v[204:207], a[92:95], a[24:27], v[204:207]
    v_mfma_f32_16x16x32_bf16 v[236:239], a[88:91], a[12:15], v[236:239]
    v_mfma_f32_16x16x32_bf16 v[236:239], a[92:95], a[28:31], v[236:239]
    s_waitcnt lgkmcnt(4)
    v_mfma_f32_16x16x32_bf16 v[144:147], a[64:67], a[0:3], v[144:147]
    ds_read_b64_tr_b16 a[80:81], v19 offset:0
    v_mfma_f32_16x16x32_bf16 v[144:147], a[68:71], a[16:19], v[144:147]
    ds_read_b64_tr_b16 a[82:83], v19 offset:1024
    v_mfma_f32_16x16x32_bf16 v[176:179], a[64:67], a[4:7], v[176:179]
    ds_read_b64_tr_b16 a[84:85], v19 offset:8192
    v_mfma_f32_16x16x32_bf16 v[176:179], a[68:71], a[20:23], v[176:179]
    ds_read_b64_tr_b16 a[86:87], v19 offset:9216
    s_add_u32 m0, s24, 139264
    v_mfma_f32_16x16x32_bf16 v[208:211], a[64:67], a[8:11], v[208:211]
    buffer_load_dwordx4 v92, s[48:51], s23 offen offset:0 lds
    v_mfma_f32_16x16x32_bf16 v[208:211], a[68:71], a[24:27], v[208:211]
    buffer_load_dwordx4 v93, s[48:51], s23 offen offset:1024 lds
    v_mfma_f32_16x16x32_bf16 v[240:243], a[64:67], a[12:15], v[240:243]
    buffer_load_dwordx4 v94, s[48:51], s23 offen offset:2048 lds
    v_mfma_f32_16x16x32_bf16 v[240:243], a[68:71], a[28:31], v[240:243]
    buffer_load_dwordx4 v95, s[48:51], s23 offen offset:3072 lds
    s_waitcnt lgkmcnt(4)
    v_mfma_f32_16x16x32_bf16 v[148:151], a[72:75], a[0:3], v[148:151]
    ds_read_b64_tr_b16 a[88:89], v19 offset:8
    v_mfma_f32_16x16x32_bf16 v[148:151], a[76:79], a[16:19], v[148:151]
    ds_read_b64_tr_b16 a[90:91], v19 offset:1032
    v_mfma_f32_16x16x32_bf16 v[180:183], a[72:75], a[4:7], v[180:183]
    ds_read_b64_tr_b16 a[92:93], v19 offset:8200
    v_mfma_f32_16x16x32_bf16 v[180:183], a[76:79], a[20:23], v[180:183]
    ds_read_b64_tr_b16 a[94:95], v19 offset:9224
    v_mfma_f32_16x16x32_bf16 v[212:215], a[72:75], a[8:11], v[212:215]
    v_mfma_f32_16x16x32_bf16 v[212:215], a[76:79], a[24:27], v[212:215]
    v_mfma_f32_16x16x32_bf16 v[244:247], a[72:75], a[12:15], v[244:247]
    v_mfma_f32_16x16x32_bf16 v[244:247], a[76:79], a[28:31], v[244:247]
    s_waitcnt lgkmcnt(4)
    v_mfma_f32_16x16x32_bf16 v[152:155], a[80:83], a[0:3], v[152:155]
    ds_read_b64_tr_b16 a[64:65], v20 offset:0
    v_mfma_f32_16x16x32_bf16 v[152:155], a[84:87], a[16:19], v[152:155]
    ds_read_b64_tr_b16 a[66:67], v20 offset:512
    v_mfma_f32_16x16x32_bf16 v[184:187], a[80:83], a[4:7], v[184:187]
    ds_read_b64_tr_b16 a[68:69], v20 offset:4096
    v_mfma_f32_16x16x32_bf16 v[184:187], a[84:87], a[20:23], v[184:187]
    ds_read_b64_tr_b16 a[70:71], v20 offset:4608
    v_mfma_f32_16x16x32_bf16 v[216:219], a[80:83], a[8:11], v[216:219]
    ds_read_b64_tr_b16 a[100:101], v4 offset:0
    v_mfma_f32_16x16x32_bf16 v[216:219], a[84:87], a[24:27], v[216:219]
    ds_read_b64_tr_b16 a[102:103], v4 offset:512
    v_mfma_f32_16x16x32_bf16 v[248:251], a[80:83], a[12:15], v[248:251]
    v_mfma_f32_16x16x32_bf16 v[248:251], a[84:87], a[28:31], v[248:251]
    s_waitcnt lgkmcnt(6)
    v_mfma_f32_16x16x32_bf16 v[156:159], a[88:91], a[0:3], v[156:159]
    ds_read_b64_tr_b16 a[72:73], v21 offset:0
    v_mfma_f32_16x16x32_bf16 v[156:159], a[92:95], a[16:19], v[156:159]
    ds_read_b64_tr_b16 a[74:75], v21 offset:512
    v_mfma_f32_16x16x32_bf16 v[188:191], a[88:91], a[4:7], v[188:191]
    ds_read_b64_tr_b16 a[76:77], v21 offset:4096
    v_mfma_f32_16x16x32_bf16 v[188:191], a[92:95], a[20:23], v[188:191]
    ds_read_b64_tr_b16 a[78:79], v21 offset:4608
    v_mfma_f32_16x16x32_bf16 v[220:223], a[88:91], a[8:11], v[220:223]
    ds_read_b64_tr_b16 a[104:105], v4 offset:4096
    v_mfma_f32_16x16x32_bf16 v[220:223], a[92:95], a[24:27], v[220:223]
    ds_read_b64_tr_b16 a[106:107], v4 offset:4608
    v_mfma_f32_16x16x32_bf16 v[252:255], a[88:91], a[12:15], v[252:255]
    v_mfma_f32_16x16x32_bf16 v[252:255], a[92:95], a[28:31], v[252:255]
    s_waitcnt lgkmcnt(6)
    v_mfma_f32_16x16x32_bf16 a[128:131], a[64:67], a[0:3], a[128:131]
    s_waitcnt vmcnt(4)
    v_mfma_f32_16x16x32_bf16 a[128:131], a[68:71], a[16:19], a[128:131]
    ds_read_b128 a[32:35], v14 offset:32768
    v_mfma_f32_16x16x32_bf16 a[132:135], a[64:67], a[4:7], a[132:135]
    ds_read_b128 a[36:39], v14 offset:34816
    v_mfma_f32_16x16x32_bf16 a[132:135], a[68:71], a[20:23], a[132:135]
    ds_read_b128 a[40:43], v14 offset:36864
    v_mfma_f32_16x16x32_bf16 a[136:139], a[64:67], a[8:11], a[136:139]
    ds_read_b128 a[44:47], v14 offset:38912
    v_mfma_f32_16x16x32_bf16 a[136:139], a[68:71], a[24:27], a[136:139]
    v_mfma_f32_16x16x32_bf16 a[140:143], a[64:67], a[12:15], a[140:143]
    v_mfma_f32_16x16x32_bf16 a[140:143], a[68:71], a[28:31], a[140:143]
    s_waitcnt lgkmcnt(4)
    v_mfma_f32_16x16x32_bf16 a[144:147], a[72:75], a[0:3], a[144:147]
    ds_read_b128 a[48:51], v15 offset:32768
    v_mfma_f32_16x16x32_bf16 a[144:147], a[76:79], a[16:19], a[144:147]
    ds_read_b128 a[52:55], v15 offset:34816
    v_mfma_f32_16x16x32_bf16 a[148:151], a[72:75], a[4:7], a[148:151]
    ds_read_b128 a[56:59], v15 offset:36864
    v_mfma_f32_16x16x32_bf16 a[148:151], a[76:79], a[20:23], a[148:151]
    ds_read_b128 a[60:63], v15 offset:38912
    v_mfma_f32_16x16x32_bf16 a[152:155], a[72:75], a[8:11], a[152:155]
    v_mfma_f32_16x16x32_bf16 a[152:155], a[76:79], a[24:27], a[152:155]
    v_mfma_f32_16x16x32_bf16 a[156:159], a[72:75], a[12:15], a[156:159]
    v_mfma_f32_16x16x32_bf16 a[156:159], a[76:79], a[28:31], a[156:159]
    v_mfma_f32_16x16x32_bf16 a[232:235], a[100:103], a[96:99], a[232:235]
    v_mfma_f32_16x16x32_bf16 a[232:235], a[104:107], a[96:99], a[232:235]
    v_mfma_f32_16x16x32_bf16 a[192:195], a[96:99], a[0:3], a[192:195]
    s_waitcnt vmcnt(12)
    v_mfma_f32_16x16x32_bf16 a[192:195], a[96:99], a[16:19], a[192:195]
    s_barrier
    v_mfma_f32_16x16x32_bf16 a[208:211], a[0:3], a[0:3], a[208:211]
    ds_read_b64_tr_b16 a[64:65], v20 offset:24576
    v_mfma_f32_16x16x32_bf16 a[208:211], a[16:19], a[16:19], a[208:211]
    ds_read_b64_tr_b16 a[66:67], v20 offset:25088
    v_mfma_f32_16x16x32_bf16 a[196:199], a[96:99], a[4:7], a[196:199]
    ds_read_b64_tr_b16 a[68:69], v20 offset:28672
    v_mfma_f32_16x16x32_bf16 a[196:199], a[96:99], a[20:23], a[196:199]
    ds_read_b64_tr_b16 a[70:71], v20 offset:29184
    v_mfma_f32_16x16x32_bf16 a[212:215], a[4:7], a[4:7], a[212:215]
    ds_read_b64_tr_b16 a[100:101], v4 offset:24576
    v_mfma_f32_16x16x32_bf16 a[212:215], a[20:23], a[20:23], a[212:215]
    ds_read_b64_tr_b16 a[102:103], v4 offset:25088
    v_mfma_f32_16x16x32_bf16 a[200:203], a[96:99], a[8:11], a[200:203]
    ds_read_b64_tr_b16 a[72:73], v21 offset:24576
    v_mfma_f32_16x16x32_bf16 a[200:203], a[96:99], a[24:27], a[200:203]
    ds_read_b64_tr_b16 a[74:75], v21 offset:25088
    v_mfma_f32_16x16x32_bf16 a[216:219], a[8:11], a[8:11], a[216:219]
    ds_read_b64_tr_b16 a[76:77], v21 offset:28672
    v_mfma_f32_16x16x32_bf16 a[216:219], a[24:27], a[24:27], a[216:219]
    ds_read_b64_tr_b16 a[78:79], v21 offset:29184
    v_mfma_f32_16x16x32_bf16 a[204:207], a[96:99], a[12:15], a[204:207]
    ds_read_b64_tr_b16 a[104:105], v4 offset:28672
    v_mfma_f32_16x16x32_bf16 a[204:207], a[96:99], a[28:31], a[204:207]
    ds_read_b64_tr_b16 a[106:107], v4 offset:29184
    v_mfma_f32_16x16x32_bf16 a[220:223], a[12:15], a[12:15], a[220:223]
    v_mfma_f32_16x16x32_bf16 a[220:223], a[28:31], a[28:31], a[220:223]
    v_mfma_f32_16x16x32_bf16 a[192:195], a[96:99], a[32:35], a[192:195]
    ds_read_b64_tr_b16 a[80:81], v16 offset:24576
    v_mfma_f32_16x16x32_bf16 a[192:195], a[96:99], a[48:51], a[192:195]
    ds_read_b64_tr_b16 a[82:83], v16 offset:25600
    v_mfma_f32_16x16x32_bf16 a[208:211], a[32:35], a[32:35], a[208:211]
    ds_read_b64_tr_b16 a[84:85], v16 offset:32768
    v_mfma_f32_16x16x32_bf16 a[208:211], a[48:51], a[48:51], a[208:211]
    ds_read_b64_tr_b16 a[86:87], v16 offset:33792
    s_add_u32 m0, s24, 0
    v_mfma_f32_16x16x32_bf16 a[196:199], a[96:99], a[36:39], a[196:199]
    buffer_load_dwordx4 v92, s[4:7], s23 offen offset:0 lds
    v_mfma_f32_16x16x32_bf16 a[196:199], a[96:99], a[52:55], a[196:199]
    buffer_load_dwordx4 v93, s[4:7], s23 offen offset:1024 lds
    v_mfma_f32_16x16x32_bf16 a[212:215], a[36:39], a[36:39], a[212:215]
    buffer_load_dwordx4 v94, s[4:7], s23 offen offset:2048 lds
    v_mfma_f32_16x16x32_bf16 a[212:215], a[52:55], a[52:55], a[212:215]
    buffer_load_dwordx4 v95, s[4:7], s23 offen offset:3072 lds
    v_mfma_f32_16x16x32_bf16 a[200:203], a[96:99], a[40:43], a[200:203]
    ds_read_b64_tr_b16 a[88:89], v16 offset:24584
    v_mfma_f32_16x16x32_bf16 a[200:203], a[96:99], a[56:59], a[200:203]
    ds_read_b64_tr_b16 a[90:91], v16 offset:25608
    v_mfma_f32_16x16x32_bf16 a[216:219], a[40:43], a[40:43], a[216:219]
    ds_read_b64_tr_b16 a[92:93], v16 offset:32776
    v_mfma_f32_16x16x32_bf16 a[216:219], a[56:59], a[56:59], a[216:219]
    ds_read_b64_tr_b16 a[94:95], v16 offset:33800
    s_add_u32 m0, s24, 65536
    v_mfma_f32_16x16x32_bf16 a[204:207], a[96:99], a[44:47], a[204:207]
    buffer_load_dwordx4 v96, s[8:11], s23 offen offset:0 lds
    v_mfma_f32_16x16x32_bf16 a[204:207], a[96:99], a[60:63], a[204:207]
    buffer_load_dwordx4 v97, s[8:11], s23 offen offset:1024 lds
    v_mfma_f32_16x16x32_bf16 a[220:223], a[44:47], a[44:47], a[220:223]
    buffer_load_dwordx4 v96, s[8:11], s23 offen offset:2048 lds
    v_mfma_f32_16x16x32_bf16 a[220:223], a[60:63], a[60:63], a[220:223]
    buffer_load_dwordx4 v97, s[8:11], s23 offen offset:3072 lds
    s_add_u32 s23, s23, 16384
    s_waitcnt lgkmcnt(14)
    v_mfma_f32_16x16x32_bf16 a[128:131], a[64:67], a[32:35], a[128:131]
    s_add_u32 m0, s24, 16384
    v_mfma_f32_16x16x32_bf16 a[128:131], a[68:71], a[48:51], a[128:131]
    buffer_load_dwordx4 v92, s[4:7], s23 offen offset:0 lds
    v_mfma_f32_16x16x32_bf16 a[132:135], a[64:67], a[36:39], a[132:135]
    buffer_load_dwordx4 v93, s[4:7], s23 offen offset:1024 lds
    v_mfma_f32_16x16x32_bf16 a[132:135], a[68:71], a[52:55], a[132:135]
    buffer_load_dwordx4 v94, s[4:7], s23 offen offset:2048 lds
    v_mfma_f32_16x16x32_bf16 a[136:139], a[64:67], a[40:43], a[136:139]
    buffer_load_dwordx4 v95, s[4:7], s23 offen offset:3072 lds
    v_mfma_f32_16x16x32_bf16 a[136:139], a[68:71], a[56:59], a[136:139]
    v_mfma_f32_16x16x32_bf16 a[140:143], a[64:67], a[44:47], a[140:143]
    v_mfma_f32_16x16x32_bf16 a[140:143], a[68:71], a[60:63], a[140:143]
    s_waitcnt lgkmcnt(8)
    v_mfma_f32_16x16x32_bf16 a[144:147], a[72:75], a[32:35], a[144:147]
    ds_read_b64_tr_b16 a[64:65], v17 offset:24576
    v_and_b32 v66, 3, v102
    v_mfma_f32_16x16x32_bf16 a[144:147], a[76:79], a[48:51], a[144:147]
    ds_read_b64_tr_b16 a[66:67], v17 offset:25600
    v_cmp_eq_u32 s[68:69], 1, v66
    v_mfma_f32_16x16x32_bf16 a[148:151], a[72:75], a[36:39], a[148:151]
    ds_read_b64_tr_b16 a[68:69], v17 offset:32768
    v_cmp_eq_u32 s[70:71], 2, v66
    v_mfma_f32_16x16x32_bf16 a[148:151], a[76:79], a[52:55], a[148:151]
    ds_read_b64_tr_b16 a[70:71], v17 offset:33792
    v_cmp_eq_u32 s[72:73], 3, v66
    v_mfma_f32_16x16x32_bf16 a[152:155], a[72:75], a[40:43], a[152:155]
    v_bfe_u32 v66, v102, 2, 2
    v_lshrrev_b32 v67, 4, v102
    v_mfma_f32_16x16x32_bf16 a[152:155], a[76:79], a[56:59], a[152:155]
    v_cmp_eq_u32 s[74:75], v66, v67
    s_mov_b32 s76, 0x3b000000
    v_mfma_f32_16x16x32_bf16 a[156:159], a[72:75], a[44:47], a[156:159]
    s_mov_b32 s77, 0x3727c5ac
    s_mov_b32 s78, 0x3e0293ee
    v_mfma_f32_16x16x32_bf16 a[156:159], a[76:79], a[60:63], a[156:159]
    v_lshlrev_b32 v117, 4, v102
    v_accvgpr_read_b32 v72, a208
    v_mfma_f32_16x16x32_bf16 a[232:235], a[100:103], a[96:99], a[232:235]
    v_accvgpr_read_b32 v73, a209
    v_accvgpr_read_b32 v74, a210
    v_mfma_f32_16x16x32_bf16 a[232:235], a[104:107], a[96:99], a[232:235]
    v_accvgpr_read_b32 v75, a211
    v_accvgpr_read_b32 v66, a192
    s_waitcnt lgkmcnt(8)
    v_mfma_f32_16x16x32_bf16 v[128:131], a[80:83], a[32:35], v[128:131]
    ds_read_b64_tr_b16 a[72:73], v17 offset:24584
    v_cndmask_b32 v72, v72, v73, s[68:69]
    v_mfma_f32_16x16x32_bf16 v[128:131], a[84:87], a[48:51], v[128:131]
    ds_read_b64_tr_b16 a[74:75], v17 offset:25608
    v_cndmask_b32 v72, v72, v74, s[70:71]
    v_mfma_f32_16x16x32_bf16 v[160:163], a[80:83], a[36:39], v[160:163]
    ds_read_b64_tr_b16 a[76:77], v17 offset:32776
    v_cndmask_b32 v72, v72, v75, s[72:73]
    v_mfma_f32_16x16x32_bf16 v[160:163], a[84:87], a[52:55], v[160:163]
    ds_read_b64_tr_b16 a[78:79], v17 offset:33800
    v_cndmask_b32 v72, 0, v72, s[74:75]
    v_mfma_f32_16x16x32_bf16 v[192:195], a[80:83], a[40:43], v[192:195]
    v_mov_b32 v73, v72
    s_nop 1
    v_permlane32_swap_b32 v72, v73
    v_mfma_f32_16x16x32_bf16 v[192:195], a[84:87], a[56:59], v[192:195]
    v_add_f32 v72, v72, v73
    v_mov_b32 v73, v72
    v_mfma_f32_16x16x32_bf16 v[224:227], a[80:83], a[44:47], v[224:227]
    s_nop 0
    v_permlane16_swap_b32 v72, v73
    v_add_f32 v72, v72, v73
    v_mfma_f32_16x16x32_bf16 v[224:227], a[84:87], a[60:63], v[224:227]
    v_mul_f32 v66, s76, v66
    v_mul_f32 v72, s76, v72
    v_mfma_f32_16x16x32_bf16 a[224:227], a[80:83], a[96:99], a[224:227]
    v_fma_f32 v72, -v66, v66, v72
    v_max_f32 v72, 0, v72
    v_mfma_f32_16x16x32_bf16 a[224:227], a[84:87], a[96:99], a[224:227]
    v_add_f32 v67, s77, v72
    v_rsq_f32 v67, v67
    s_waitcnt lgkmcnt(8)
    v_mfma_f32_16x16x32_bf16 v[132:135], a[88:91], a[32:35], v[132:135]
    ds_read_b64_tr_b16 a[80:81], v18 offset:24576
    v_sub_f32 v104, 0, v66
    v_mfma_f32_16x16x32_bf16 v[132:135], a[92:95], a[48:51], v[132:135]
    ds_read_b64_tr_b16 a[82:83], v18 offset:25600
    v_mul_f32 v72, v72, v67
    v_mfma_f32_16x16x32_bf16 v[164:167], a[88:91], a[36:39], v[164:167]
    ds_read_b64_tr_b16 a[84:85], v18 offset:32768
    v_fma_f32 v72, v72, v67, s77
    v_mfma_f32_16x16x32_bf16 v[164:167], a[92:95], a[52:55], v[164:167]
    ds_read_b64_tr_b16 a[86:87], v18 offset:33792
    v_rsq_f32 v72, v72
    v_mfma_f32_16x16x32_bf16 v[196:199], a[88:91], a[40:43], v[196:199]
    v_mul_f32 v108, s78, v67
    v_mul_f32 v112, v72, v67
    v_mfma_f32_16x16x32_bf16 v[196:199], a[92:95], a[56:59], v[196:199]
    v_accvgpr_read_b32 v72, a212
    v_accvgpr_read_b32 v73, a213
    v_mfma_f32_16x16x32_bf16 v[228:231], a[88:91], a[44:47], v[228:231]
    v_accvgpr_read_b32 v74, a214
    v_accvgpr_read_b32 v75, a215
    v_mfma_f32_16x16x32_bf16 v[228:231], a[92:95], a[60:63], v[228:231]
    v_accvgpr_read_b32 v66, a196
    v_cndmask_b32 v72, v72, v73, s[68:69]
    v_mfma_f32_16x16x32_bf16 a[228:231], a[88:91], a[96:99], a[228:231]
    v_cndmask_b32 v72, v72, v74, s[70:71]
    v_cndmask_b32 v72, v72, v75, s[72:73]
    v_mfma_f32_16x16x32_bf16 a[228:231], a[92:95], a[96:99], a[228:231]
    v_cndmask_b32 v72, 0, v72, s[74:75]
    v_mov_b32 v73, v72
    s_waitcnt lgkmcnt(8)
    v_mfma_f32_16x16x32_bf16 v[136:139], a[64:67], a[32:35], v[136:139]
    ds_read_b64_tr_b16 a[88:89], v18 offset:24584
    v_permlane32_swap_b32 v72, v73
    v_mfma_f32_16x16x32_bf16 v[136:139], a[68:71], a[48:51], v[136:139]
    ds_read_b64_tr_b16 a[90:91], v18 offset:25608
    v_add_f32 v72, v72, v73
    v_mfma_f32_16x16x32_bf16 v[168:171], a[64:67], a[36:39], v[168:171]
    ds_read_b64_tr_b16 a[92:93], v18 offset:32776
    v_mov_b32 v73, v72
    v_mfma_f32_16x16x32_bf16 v[168:171], a[68:71], a[52:55], v[168:171]
    ds_read_b64_tr_b16 a[94:95], v18 offset:33800
    v_permlane16_swap_b32 v72, v73
    v_mfma_f32_16x16x32_bf16 v[200:203], a[64:67], a[40:43], v[200:203]
    v_add_f32 v72, v72, v73
    v_mul_f32 v66, s76, v66
    v_mfma_f32_16x16x32_bf16 v[200:203], a[68:71], a[56:59], v[200:203]
    v_mul_f32 v72, s76, v72
    v_fma_f32 v72, -v66, v66, v72
    v_mfma_f32_16x16x32_bf16 v[232:235], a[64:67], a[44:47], v[232:235]
    v_max_f32 v72, 0, v72
    v_add_f32 v67, s77, v72
    v_mfma_f32_16x16x32_bf16 v[232:235], a[68:71], a[60:63], v[232:235]
    v_rsq_f32 v67, v67
    v_sub_f32 v105, 0, v66
    s_waitcnt lgkmcnt(8)
    v_mfma_f32_16x16x32_bf16 v[140:143], a[72:75], a[32:35], v[140:143]
    ds_read_b64_tr_b16 a[64:65], v19 offset:24576
    v_mul_f32 v72, v72, v67
    v_mfma_f32_16x16x32_bf16 v[140:143], a[76:79], a[48:51], v[140:143]
    ds_read_b64_tr_b16 a[66:67], v19 offset:25600
    v_fma_f32 v72, v72, v67, s77
    v_mfma_f32_16x16x32_bf16 v[172:175], a[72:75], a[36:39], v[172:175]
    ds_read_b64_tr_b16 a[68:69], v19 offset:32768
    v_rsq_f32 v72, v72
    v_mfma_f32_16x16x32_bf16 v[172:175], a[76:79], a[52:55], v[172:175]
    ds_read_b64_tr_b16 a[70:71], v19 offset:33792
    v_mul_f32 v109, s78, v67
    v_mfma_f32_16x16x32_bf16 v[204:207], a[72:75], a[40:43], v[204:207]
    v_mul_f32 v113, v72, v67
    v_accvgpr_read_b32 v72, a216
    v_mfma_f32_16x16x32_bf16 v[204:207], a[76:79], a[56:59], v[204:207]
    s_lshl_b32 s29, s20, 8
    s_add_u32 s29, s29, 155648
    v_and_b32 v118, 0x30, v102
    v_add_u32 v118, s29, v118
    ds_write_b128 v118, a[224:227] offset:0
    ds_write_b128 v118, a[228:231] offset:64
    ds_write_b128 v118, a[232:235] offset:128
    v_accvgpr_read_b32 v73, a217
    v_mfma_f32_16x16x32_bf16 v[236:239], a[72:75], a[44:47], v[236:239]
    v_accvgpr_read_b32 v74, a218
    v_accvgpr_read_b32 v75, a219
    v_mfma_f32_16x16x32_bf16 v[236:239], a[76:79], a[60:63], v[236:239]
    v_accvgpr_read_b32 v66, a200
    v_cndmask_b32 v72, v72, v73, s[68:69]
    s_waitcnt lgkmcnt(8)
    v_mfma_f32_16x16x32_bf16 v[144:147], a[80:83], a[32:35], v[144:147]
    ds_read_b64_tr_b16 a[72:73], v19 offset:24584
    v_cndmask_b32 v72, v72, v74, s[70:71]
    v_mfma_f32_16x16x32_bf16 v[144:147], a[84:87], a[48:51], v[144:147]
    ds_read_b64_tr_b16 a[74:75], v19 offset:25608
    v_cndmask_b32 v72, v72, v75, s[72:73]
    v_mfma_f32_16x16x32_bf16 v[176:179], a[80:83], a[36:39], v[176:179]
    ds_read_b64_tr_b16 a[76:77], v19 offset:32776
    v_cndmask_b32 v72, 0, v72, s[74:75]
    v_mfma_f32_16x16x32_bf16 v[176:179], a[84:87], a[52:55], v[176:179]
    ds_read_b64_tr_b16 a[78:79], v19 offset:33800
    v_mov_b32 v73, v72
    v_mfma_f32_16x16x32_bf16 v[208:211], a[80:83], a[40:43], v[208:211]
    s_nop 0
    v_permlane32_swap_b32 v72, v73
    v_add_f32 v72, v72, v73
    v_mfma_f32_16x16x32_bf16 v[208:211], a[84:87], a[56:59], v[208:211]
    v_mov_b32 v73, v72
    s_nop 1
    v_permlane16_swap_b32 v72, v73
    v_mfma_f32_16x16x32_bf16 v[240:243], a[80:83], a[44:47], v[240:243]
    v_add_f32 v72, v72, v73
    v_mul_f32 v66, s76, v66
    v_mfma_f32_16x16x32_bf16 v[240:243], a[84:87], a[60:63], v[240:243]
    v_mul_f32 v72, s76, v72
    v_fma_f32 v72, -v66, v66, v72
    s_waitcnt lgkmcnt(8)
    v_mfma_f32_16x16x32_bf16 v[148:151], a[88:91], a[32:35], v[148:151]
    v_max_f32 v72, 0, v72
    v_add_f32 v67, s77, v72
    v_mfma_f32_16x16x32_bf16 v[148:151], a[92:95], a[48:51], v[148:151]
    v_rsq_f32 v67, v67
    v_sub_f32 v106, 0, v66
    v_mfma_f32_16x16x32_bf16 v[180:183], a[88:91], a[36:39], v[180:183]
    v_mul_f32 v72, v72, v67
    v_fma_f32 v72, v72, v67, s77
    v_mfma_f32_16x16x32_bf16 v[180:183], a[92:95], a[52:55], v[180:183]
    v_rsq_f32 v72, v72
    v_mul_f32 v110, s78, v67
    v_mfma_f32_16x16x32_bf16 v[212:215], a[88:91], a[40:43], v[212:215]
    v_mul_f32 v114, v72, v67
    v_accvgpr_read_b32 v72, a220
    v_mfma_f32_16x16x32_bf16 v[212:215], a[92:95], a[56:59], v[212:215]
    v_accvgpr_read_b32 v73, a221
    v_accvgpr_read_b32 v74, a222
    v_mfma_f32_16x16x32_bf16 v[244:247], a[88:91], a[44:47], v[244:247]
    v_accvgpr_read_b32 v75, a223
    v_accvgpr_read_b32 v66, a204
    v_mfma_f32_16x16x32_bf16 v[244:247], a[92:95], a[60:63], v[244:247]
    v_cndmask_b32 v72, v72, v73, s[68:69]
    v_cndmask_b32 v72, v72, v74, s[70:71]
    v_mfma_f32_16x16x32_bf16 v[152:155], a[64:67], a[32:35], v[152:155]
    s_waitcnt vmcnt(12) lgkmcnt(0)
    s_barrier
    s_add_u32 m0, s24, 81920
    v_mfma_f32_16x16x32_bf16 v[152:155], a[68:71], a[48:51], v[152:155]
    buffer_load_dwordx4 v96, s[8:11], s23 offen offset:0 lds
    v_cndmask_b32 v72, v72, v75, s[72:73]
    v_mfma_f32_16x16x32_bf16 v[184:187], a[64:67], a[36:39], v[184:187]
    buffer_load_dwordx4 v97, s[8:11], s23 offen offset:1024 lds
    v_cndmask_b32 v72, 0, v72, s[74:75]
    v_mfma_f32_16x16x32_bf16 v[184:187], a[68:71], a[52:55], v[184:187]
    buffer_load_dwordx4 v96, s[8:11], s23 offen offset:2048 lds
    v_mov_b32 v73, v72
    v_mfma_f32_16x16x32_bf16 v[216:219], a[64:67], a[40:43], v[216:219]
    buffer_load_dwordx4 v97, s[8:11], s23 offen offset:3072 lds
    v_permlane32_swap_b32 v72, v73
    v_mfma_f32_16x16x32_bf16 v[216:219], a[68:71], a[56:59], v[216:219]
    v_add_f32 v72, v72, v73
    v_mov_b32 v73, v72
    v_mfma_f32_16x16x32_bf16 v[248:251], a[64:67], a[44:47], v[248:251]
    s_nop 0
    v_permlane16_swap_b32 v72, v73
    v_add_f32 v72, v72, v73
    v_mfma_f32_16x16x32_bf16 v[248:251], a[68:71], a[60:63], v[248:251]
    s_add_u32 s23, s23, 16384
    v_mul_f32 v66, s76, v66
    v_mfma_f32_16x16x32_bf16 v[156:159], a[72:75], a[32:35], v[156:159]
    v_xor_b32 v119, 0, v118
    ds_read_b128 v[32:35], v119 offset:0
    v_mul_f32 v72, s76, v72
    v_mfma_f32_16x16x32_bf16 v[156:159], a[76:79], a[48:51], v[156:159]
    ds_read_b128 v[36:39], v119 offset:64
    v_fma_f32 v72, -v66, v66, v72
    v_mfma_f32_16x16x32_bf16 v[188:191], a[72:75], a[36:39], v[188:191]
    v_xor_b32 v119, 256, v118
    ds_read_b128 v[40:43], v119 offset:0
    v_max_f32 v72, 0, v72
    v_mfma_f32_16x16x32_bf16 v[188:191], a[76:79], a[52:55], v[188:191]
    ds_read_b128 v[44:47], v119 offset:64
    v_add_f32 v67, s77, v72
    v_mfma_f32_16x16x32_bf16 v[220:223], a[72:75], a[40:43], v[220:223]
    v_xor_b32 v119, 512, v118
    ds_read_b128 v[48:51], v119 offset:0
    v_rsq_f32 v67, v67
    v_mfma_f32_16x16x32_bf16 v[220:223], a[76:79], a[56:59], v[220:223]
    ds_read_b128 v[52:55], v119 offset:64
    v_sub_f32 v107, 0, v66
    v_mfma_f32_16x16x32_bf16 v[252:255], a[72:75], a[44:47], v[252:255]
    v_xor_b32 v119, 768, v118
    ds_read_b128 v[56:59], v119 offset:0
    v_mul_f32 v72, v72, v67
    v_mfma_f32_16x16x32_bf16 v[252:255], a[76:79], a[60:63], v[252:255]
    ds_read_b128 v[60:63], v119 offset:64
    v_and_b32 v119, 0x30, v102
    v_add_u32 v119, 155648, v119
    ds_read_b128 v[0:3], v119 offset:128
    ds_read_b128 v[4:7], v119 offset:384
    ds_read_b128 v[8:11], v119 offset:640
    ds_read_b128 v[12:15], v119 offset:896
    v_fma_f32 v72, v72, v67, s77
    v_rsq_f32 v72, v72
    v_mul_f32 v111, s78, v67
    v_mul_f32 v115, v72, v67
    v_lshlrev_b32 v64, 16, v24
    v_and_b32 v65, 0xffff0000, v24
    v_lshlrev_b32 v66, 16, v25
    v_and_b32 v67, 0xffff0000, v25
    v_lshlrev_b32 v68, 16, v26
    v_and_b32 v69, 0xffff0000, v26
    v_lshlrev_b32 v70, 16, v27
    v_and_b32 v71, 0xffff0000, v27
    s_mov_b32 s67, 0xbdd2d3e8
    v_mov_b32 v116, 0xc0135761
    s_lshl_b32 s26, s22, 4
    s_lshl_b32 s30, s20, 2
    s_add_u32 s26, s26, s30
    s_lshl_b32 s26, s26, 10
    s_lshl_b32 s30, s65, 6
    s_lshl_b32 s31, s21, 17
    s_add_u32 s31, s31, s26
    s_add_u32 s68, s31, s30
    s_xor_b32 s69, s68, 2048
    s_lshl_b32 s31, s25, 17
    s_add_u32 s31, s31, s26
    s_add_u32 s70, s31, s30
    s_xor_b32 s71, s70, 2048
    s_waitcnt lgkmcnt(0)
    v_pk_fma_f32 v[128:129], v[104:105], v[32:33], v[128:129] op_sel:[0,0,0] op_sel_hi:[0,1,1]
    v_pk_fma_f32 v[130:131], v[104:105], v[34:35], v[130:131] op_sel:[0,0,0] op_sel_hi:[0,1,1]
    v_pk_fma_f32 v[132:133], v[104:105], v[36:37], v[132:133] op_sel:[0,0,0] op_sel_hi:[0,1,1]
    v_pk_fma_f32 v[134:135], v[104:105], v[38:39], v[134:135] op_sel:[0,0,0] op_sel_hi:[0,1,1]
    v_pk_mul_f32 v[128:129], v[108:109], v[128:129] op_sel:[0,0] op_sel_hi:[0,1]
    v_pk_mul_f32 v[130:131], v[108:109], v[130:131] op_sel:[0,0] op_sel_hi:[0,1]
    v_pk_mul_f32 v[132:133], v[108:109], v[132:133] op_sel:[0,0] op_sel_hi:[0,1]
    v_pk_mul_f32 v[134:135], v[108:109], v[134:135] op_sel:[0,0] op_sel_hi:[0,1]
    v_cvt_pk_bf16_f32 v128, v128, v129
    v_cvt_pk_bf16_f32 v129, v130, v131
    v_cvt_pk_bf16_f32 v130, v132, v133
    v_cvt_pk_bf16_f32 v131, v134, v135
    v_accvgpr_write_b32 a0, v128
    v_accvgpr_write_b32 a1, v129
    v_accvgpr_write_b32 a2, v130
    v_accvgpr_write_b32 a3, v131
    v_pk_fma_f32 v[136:137], v[104:105], v[40:41], v[136:137] op_sel:[0,0,0] op_sel_hi:[0,1,1]
    v_pk_fma_f32 v[138:139], v[104:105], v[42:43], v[138:139] op_sel:[0,0,0] op_sel_hi:[0,1,1]
    v_pk_fma_f32 v[140:141], v[104:105], v[44:45], v[140:141] op_sel:[0,0,0] op_sel_hi:[0,1,1]
    v_pk_fma_f32 v[142:143], v[104:105], v[46:47], v[142:143] op_sel:[0,0,0] op_sel_hi:[0,1,1]
    v_pk_mul_f32 v[136:137], v[108:109], v[136:137] op_sel:[0,0] op_sel_hi:[0,1]
    v_pk_mul_f32 v[138:139], v[108:109], v[138:139] op_sel:[0,0] op_sel_hi:[0,1]
    v_pk_mul_f32 v[140:141], v[108:109], v[140:141] op_sel:[0,0] op_sel_hi:[0,1]
    v_pk_mul_f32 v[142:143], v[108:109], v[142:143] op_sel:[0,0] op_sel_hi:[0,1]
    v_cvt_pk_bf16_f32 v136, v136, v137
    v_cvt_pk_bf16_f32 v137, v138, v139
    v_cvt_pk_bf16_f32 v138, v140, v141
    v_cvt_pk_bf16_f32 v139, v142, v143
    v_accvgpr_write_b32 a4, v136
    v_accvgpr_write_b32 a5, v137
    v_accvgpr_write_b32 a6, v138
    v_accvgpr_write_b32 a7, v139
    v_pk_fma_f32 v[144:145], v[104:105], v[48:49], v[144:145] op_sel:[0,0,0] op_sel_hi:[0,1,1]
    v_pk_fma_f32 v[146:147], v[104:105], v[50:51], v[146:147] op_sel:[0,0,0] op_sel_hi:[0,1,1]
    v_pk_fma_f32 v[148:149], v[104:105], v[52:53], v[148:149] op_sel:[0,0,0] op_sel_hi:[0,1,1]
    v_pk_fma_f32 v[150:151], v[104:105], v[54:55], v[150:151] op_sel:[0,0,0] op_sel_hi:[0,1,1]
    v_pk_mul_f32 v[144:145], v[108:109], v[144:145] op_sel:[0,0] op_sel_hi:[0,1]
    v_pk_mul_f32 v[146:147], v[108:109], v[146:147] op_sel:[0,0] op_sel_hi:[0,1]
    v_pk_mul_f32 v[148:149], v[108:109], v[148:149] op_sel:[0,0] op_sel_hi:[0,1]
    v_pk_mul_f32 v[150:151], v[108:109], v[150:151] op_sel:[0,0] op_sel_hi:[0,1]
    v_cvt_pk_bf16_f32 v144, v144, v145
    v_cvt_pk_bf16_f32 v145, v146, v147
    v_cvt_pk_bf16_f32 v146, v148, v149
    v_cvt_pk_bf16_f32 v147, v150, v151
    v_accvgpr_write_b32 a8, v144
    v_accvgpr_write_b32 a9, v145
    v_accvgpr_write_b32 a10, v146
    v_accvgpr_write_b32 a11, v147
    v_pk_fma_f32 v[152:153], v[104:105], v[56:57], v[152:153] op_sel:[0,0,0] op_sel_hi:[0,1,1]
    v_pk_fma_f32 v[154:155], v[104:105], v[58:59], v[154:155] op_sel:[0,0,0] op_sel_hi:[0,1,1]
    v_pk_fma_f32 v[156:157], v[104:105], v[60:61], v[156:157] op_sel:[0,0,0] op_sel_hi:[0,1,1]
    v_pk_fma_f32 v[158:159], v[104:105], v[62:63], v[158:159] op_sel:[0,0,0] op_sel_hi:[0,1,1]
    v_pk_mul_f32 v[152:153], v[108:109], v[152:153] op_sel:[0,0] op_sel_hi:[0,1]
    v_pk_mul_f32 v[154:155], v[108:109], v[154:155] op_sel:[0,0] op_sel_hi:[0,1]
    v_pk_mul_f32 v[156:157], v[108:109], v[156:157] op_sel:[0,0] op_sel_hi:[0,1]
    v_pk_mul_f32 v[158:159], v[108:109], v[158:159] op_sel:[0,0] op_sel_hi:[0,1]
    v_cvt_pk_bf16_f32 v152, v152, v153
    v_cvt_pk_bf16_f32 v153, v154, v155
    v_cvt_pk_bf16_f32 v154, v156, v157
    v_cvt_pk_bf16_f32 v155, v158, v159
    v_accvgpr_write_b32 a12, v152
    v_accvgpr_write_b32 a13, v153
    v_accvgpr_write_b32 a14, v154
    v_accvgpr_write_b32 a15, v155
    v_pk_fma_f32 v[160:161], v[104:105], v[32:33], v[160:161] op_sel:[1,0,0] op_sel_hi:[1,1,1]
    v_pk_fma_f32 v[162:163], v[104:105], v[34:35], v[162:163] op_sel:[1,0,0] op_sel_hi:[1,1,1]
    v_pk_fma_f32 v[164:165], v[104:105], v[36:37], v[164:165] op_sel:[1,0,0] op_sel_hi:[1,1,1]
    v_pk_fma_f32 v[166:167], v[104:105], v[38:39], v[166:167] op_sel:[1,0,0] op_sel_hi:[1,1,1]
    v_pk_mul_f32 v[160:161], v[108:109], v[160:161] op_sel:[1,0] op_sel_hi:[1,1]
    v_pk_mul_f32 v[162:163], v[108:109], v[162:163] op_sel:[1,0] op_sel_hi:[1,1]
    v_pk_mul_f32 v[164:165], v[108:109], v[164:165] op_sel:[1,0] op_sel_hi:[1,1]
    v_pk_mul_f32 v[166:167], v[108:109], v[166:167] op_sel:[1,0] op_sel_hi:[1,1]
    v_cvt_pk_bf16_f32 v160, v160, v161
    v_cvt_pk_bf16_f32 v161, v162, v163
    v_cvt_pk_bf16_f32 v162, v164, v165
    v_cvt_pk_bf16_f32 v163, v166, v167
    v_accvgpr_write_b32 a16, v160
    v_accvgpr_write_b32 a17, v161
    v_accvgpr_write_b32 a18, v162
    v_accvgpr_write_b32 a19, v163
    v_pk_fma_f32 v[168:169], v[104:105], v[40:41], v[168:169] op_sel:[1,0,0] op_sel_hi:[1,1,1]
    v_pk_fma_f32 v[170:171], v[104:105], v[42:43], v[170:171] op_sel:[1,0,0] op_sel_hi:[1,1,1]
    v_pk_fma_f32 v[172:173], v[104:105], v[44:45], v[172:173] op_sel:[1,0,0] op_sel_hi:[1,1,1]
    v_pk_fma_f32 v[174:175], v[104:105], v[46:47], v[174:175] op_sel:[1,0,0] op_sel_hi:[1,1,1]
    v_pk_mul_f32 v[168:169], v[108:109], v[168:169] op_sel:[1,0] op_sel_hi:[1,1]
    v_pk_mul_f32 v[170:171], v[108:109], v[170:171] op_sel:[1,0] op_sel_hi:[1,1]
    v_pk_mul_f32 v[172:173], v[108:109], v[172:173] op_sel:[1,0] op_sel_hi:[1,1]
    v_pk_mul_f32 v[174:175], v[108:109], v[174:175] op_sel:[1,0] op_sel_hi:[1,1]
    v_cvt_pk_bf16_f32 v168, v168, v169
    v_cvt_pk_bf16_f32 v169, v170, v171
    v_cvt_pk_bf16_f32 v170, v172, v173
    v_cvt_pk_bf16_f32 v171, v174, v175
    v_accvgpr_write_b32 a20, v168
    v_accvgpr_write_b32 a21, v169
    v_accvgpr_write_b32 a22, v170
    v_accvgpr_write_b32 a23, v171
    v_pk_fma_f32 v[176:177], v[104:105], v[48:49], v[176:177] op_sel:[1,0,0] op_sel_hi:[1,1,1]
    v_pk_fma_f32 v[178:179], v[104:105], v[50:51], v[178:179] op_sel:[1,0,0] op_sel_hi:[1,1,1]
    v_pk_fma_f32 v[180:181], v[104:105], v[52:53], v[180:181] op_sel:[1,0,0] op_sel_hi:[1,1,1]
    v_pk_fma_f32 v[182:183], v[104:105], v[54:55], v[182:183] op_sel:[1,0,0] op_sel_hi:[1,1,1]
    v_pk_mul_f32 v[176:177], v[108:109], v[176:177] op_sel:[1,0] op_sel_hi:[1,1]
    v_pk_mul_f32 v[178:179], v[108:109], v[178:179] op_sel:[1,0] op_sel_hi:[1,1]
    v_pk_mul_f32 v[180:181], v[108:109], v[180:181] op_sel:[1,0] op_sel_hi:[1,1]
    v_pk_mul_f32 v[182:183], v[108:109], v[182:183] op_sel:[1,0] op_sel_hi:[1,1]
    v_cvt_pk_bf16_f32 v176, v176, v177
    v_cvt_pk_bf16_f32 v177, v178, v179
    v_cvt_pk_bf16_f32 v178, v180, v181
    v_cvt_pk_bf16_f32 v179, v182, v183
    v_accvgpr_write_b32 a24, v176
    v_accvgpr_write_b32 a25, v177
    v_accvgpr_write_b32 a26, v178
    v_accvgpr_write_b32 a27, v179
    v_pk_fma_f32 v[184:185], v[104:105], v[56:57], v[184:185] op_sel:[1,0,0] op_sel_hi:[1,1,1]
    v_pk_fma_f32 v[186:187], v[104:105], v[58:59], v[186:187] op_sel:[1,0,0] op_sel_hi:[1,1,1]
    v_pk_fma_f32 v[188:189], v[104:105], v[60:61], v[188:189] op_sel:[1,0,0] op_sel_hi:[1,1,1]
    v_pk_fma_f32 v[190:191], v[104:105], v[62:63], v[190:191] op_sel:[1,0,0] op_sel_hi:[1,1,1]
    v_pk_mul_f32 v[184:185], v[108:109], v[184:185] op_sel:[1,0] op_sel_hi:[1,1]
    v_pk_mul_f32 v[186:187], v[108:109], v[186:187] op_sel:[1,0] op_sel_hi:[1,1]
    v_pk_mul_f32 v[188:189], v[108:109], v[188:189] op_sel:[1,0] op_sel_hi:[1,1]
    v_pk_mul_f32 v[190:191], v[108:109], v[190:191] op_sel:[1,0] op_sel_hi:[1,1]
    v_cvt_pk_bf16_f32 v184, v184, v185
    v_cvt_pk_bf16_f32 v185, v186, v187
    v_cvt_pk_bf16_f32 v186, v188, v189
    v_cvt_pk_bf16_f32 v187, v190, v191
    v_accvgpr_write_b32 a28, v184
    v_accvgpr_write_b32 a29, v185
    v_accvgpr_write_b32 a30, v186
    v_accvgpr_write_b32 a31, v187
    v_pk_fma_f32 v[192:193], v[106:107], v[32:33], v[192:193] op_sel:[0,0,0] op_sel_hi:[0,1,1]
    v_pk_fma_f32 v[194:195], v[106:107], v[34:35], v[194:195] op_sel:[0,0,0] op_sel_hi:[0,1,1]
    v_pk_fma_f32 v[196:197], v[106:107], v[36:37], v[196:197] op_sel:[0,0,0] op_sel_hi:[0,1,1]
    v_pk_fma_f32 v[198:199], v[106:107], v[38:39], v[198:199] op_sel:[0,0,0] op_sel_hi:[0,1,1]
    v_pk_mul_f32 v[192:193], v[110:111], v[192:193] op_sel:[0,0] op_sel_hi:[0,1]
    v_pk_mul_f32 v[194:195], v[110:111], v[194:195] op_sel:[0,0] op_sel_hi:[0,1]
    v_pk_mul_f32 v[196:197], v[110:111], v[196:197] op_sel:[0,0] op_sel_hi:[0,1]
    v_pk_mul_f32 v[198:199], v[110:111], v[198:199] op_sel:[0,0] op_sel_hi:[0,1]
    v_cvt_pk_bf16_f32 v192, v192, v193
    v_cvt_pk_bf16_f32 v193, v194, v195
    v_cvt_pk_bf16_f32 v194, v196, v197
    v_cvt_pk_bf16_f32 v195, v198, v199
    v_accvgpr_write_b32 a32, v192
    v_accvgpr_write_b32 a33, v193
    v_accvgpr_write_b32 a34, v194
    v_accvgpr_write_b32 a35, v195
    v_pk_fma_f32 v[200:201], v[106:107], v[40:41], v[200:201] op_sel:[0,0,0] op_sel_hi:[0,1,1]
    v_pk_fma_f32 v[202:203], v[106:107], v[42:43], v[202:203] op_sel:[0,0,0] op_sel_hi:[0,1,1]
    v_pk_fma_f32 v[204:205], v[106:107], v[44:45], v[204:205] op_sel:[0,0,0] op_sel_hi:[0,1,1]
    v_pk_fma_f32 v[206:207], v[106:107], v[46:47], v[206:207] op_sel:[0,0,0] op_sel_hi:[0,1,1]
    v_pk_mul_f32 v[200:201], v[110:111], v[200:201] op_sel:[0,0] op_sel_hi:[0,1]
    v_pk_mul_f32 v[202:203], v[110:111], v[202:203] op_sel:[0,0] op_sel_hi:[0,1]
    v_pk_mul_f32 v[204:205], v[110:111], v[204:205] op_sel:[0,0] op_sel_hi:[0,1]
    v_pk_mul_f32 v[206:207], v[110:111], v[206:207] op_sel:[0,0] op_sel_hi:[0,1]
    v_cvt_pk_bf16_f32 v200, v200, v201
    v_cvt_pk_bf16_f32 v201, v202, v203
    v_cvt_pk_bf16_f32 v202, v204, v205
    v_cvt_pk_bf16_f32 v203, v206, v207
    v_accvgpr_write_b32 a36, v200
    v_accvgpr_write_b32 a37, v201
    v_accvgpr_write_b32 a38, v202
    v_accvgpr_write_b32 a39, v203
    v_pk_fma_f32 v[208:209], v[106:107], v[48:49], v[208:209] op_sel:[0,0,0] op_sel_hi:[0,1,1]
    v_pk_fma_f32 v[210:211], v[106:107], v[50:51], v[210:211] op_sel:[0,0,0] op_sel_hi:[0,1,1]
    v_pk_fma_f32 v[212:213], v[106:107], v[52:53], v[212:213] op_sel:[0,0,0] op_sel_hi:[0,1,1]
    v_pk_fma_f32 v[214:215], v[106:107], v[54:55], v[214:215] op_sel:[0,0,0] op_sel_hi:[0,1,1]
    v_pk_mul_f32 v[208:209], v[110:111], v[208:209] op_sel:[0,0] op_sel_hi:[0,1]
    v_pk_mul_f32 v[210:211], v[110:111], v[210:211] op_sel:[0,0] op_sel_hi:[0,1]
    v_pk_mul_f32 v[212:213], v[110:111], v[212:213] op_sel:[0,0] op_sel_hi:[0,1]
    v_pk_mul_f32 v[214:215], v[110:111], v[214:215] op_sel:[0,0] op_sel_hi:[0,1]
    v_cvt_pk_bf16_f32 v208, v208, v209
    v_cvt_pk_bf16_f32 v209, v210, v211
    v_cvt_pk_bf16_f32 v210, v212, v213
    v_cvt_pk_bf16_f32 v211, v214, v215
    v_accvgpr_write_b32 a40, v208
    v_accvgpr_write_b32 a41, v209
    v_accvgpr_write_b32 a42, v210
    v_accvgpr_write_b32 a43, v211
    v_pk_fma_f32 v[216:217], v[106:107], v[56:57], v[216:217] op_sel:[0,0,0] op_sel_hi:[0,1,1]
    v_pk_fma_f32 v[218:219], v[106:107], v[58:59], v[218:219] op_sel:[0,0,0] op_sel_hi:[0,1,1]
    v_pk_fma_f32 v[220:221], v[106:107], v[60:61], v[220:221] op_sel:[0,0,0] op_sel_hi:[0,1,1]
    v_pk_fma_f32 v[222:223], v[106:107], v[62:63], v[222:223] op_sel:[0,0,0] op_sel_hi:[0,1,1]
    v_pk_mul_f32 v[216:217], v[110:111], v[216:217] op_sel:[0,0] op_sel_hi:[0,1]
    v_pk_mul_f32 v[218:219], v[110:111], v[218:219] op_sel:[0,0] op_sel_hi:[0,1]
    v_pk_mul_f32 v[220:221], v[110:111], v[220:221] op_sel:[0,0] op_sel_hi:[0,1]
    v_pk_mul_f32 v[222:223], v[110:111], v[222:223] op_sel:[0,0] op_sel_hi:[0,1]
    v_cvt_pk_bf16_f32 v216, v216, v217
    v_cvt_pk_bf16_f32 v217, v218, v219
    v_cvt_pk_bf16_f32 v218, v220, v221
    v_cvt_pk_bf16_f32 v219, v222, v223
    v_accvgpr_write_b32 a44, v216
    v_accvgpr_write_b32 a45, v217
    v_accvgpr_write_b32 a46, v218
    v_accvgpr_write_b32 a47, v219
    v_pk_fma_f32 v[224:225], v[106:107], v[32:33], v[224:225] op_sel:[1,0,0] op_sel_hi:[1,1,1]
    v_pk_fma_f32 v[226:227], v[106:107], v[34:35], v[226:227] op_sel:[1,0,0] op_sel_hi:[1,1,1]
    v_pk_fma_f32 v[228:229], v[106:107], v[36:37], v[228:229] op_sel:[1,0,0] op_sel_hi:[1,1,1]
    v_pk_fma_f32 v[230:231], v[106:107], v[38:39], v[230:231] op_sel:[1,0,0] op_sel_hi:[1,1,1]
    v_pk_mul_f32 v[224:225], v[110:111], v[224:225] op_sel:[1,0] op_sel_hi:[1,1]
    v_pk_mul_f32 v[226:227], v[110:111], v[226:227] op_sel:[1,0] op_sel_hi:[1,1]
    v_pk_mul_f32 v[228:229], v[110:111], v[228:229] op_sel:[1,0] op_sel_hi:[1,1]
    v_pk_mul_f32 v[230:231], v[110:111], v[230:231] op_sel:[1,0] op_sel_hi:[1,1]
    v_cvt_pk_bf16_f32 v224, v224, v225
    v_cvt_pk_bf16_f32 v225, v226, v227
    v_cvt_pk_bf16_f32 v226, v228, v229
    v_cvt_pk_bf16_f32 v227, v230, v231
    v_accvgpr_write_b32 a48, v224
    v_accvgpr_write_b32 a49, v225
    v_accvgpr_write_b32 a50, v226
    v_accvgpr_write_b32 a51, v227
    v_pk_fma_f32 v[232:233], v[106:107], v[40:41], v[232:233] op_sel:[1,0,0] op_sel_hi:[1,1,1]
    v_pk_fma_f32 v[234:235], v[106:107], v[42:43], v[234:235] op_sel:[1,0,0] op_sel_hi:[1,1,1]
    v_pk_fma_f32 v[236:237], v[106:107], v[44:45], v[236:237] op_sel:[1,0,0] op_sel_hi:[1,1,1]
    v_pk_fma_f32 v[238:239], v[106:107], v[46:47], v[238:239] op_sel:[1,0,0] op_sel_hi:[1,1,1]
    v_pk_mul_f32 v[232:233], v[110:111], v[232:233] op_sel:[1,0] op_sel_hi:[1,1]
    v_pk_mul_f32 v[234:235], v[110:111], v[234:235] op_sel:[1,0] op_sel_hi:[1,1]
    v_pk_mul_f32 v[236:237], v[110:111], v[236:237] op_sel:[1,0] op_sel_hi:[1,1]
    v_pk_mul_f32 v[238:239], v[110:111], v[238:239] op_sel:[1,0] op_sel_hi:[1,1]
    v_cvt_pk_bf16_f32 v232, v232, v233
    v_cvt_pk_bf16_f32 v233, v234, v235
    v_cvt_pk_bf16_f32 v234, v236, v237
    v_cvt_pk_bf16_f32 v235, v238, v239
    v_accvgpr_write_b32 a52, v232
    v_accvgpr_write_b32 a53, v233
    v_accvgpr_write_b32 a54, v234
    v_accvgpr_write_b32 a55, v235
    v_pk_fma_f32 v[240:241], v[106:107], v[48:49], v[240:241] op_sel:[1,0,0] op_sel_hi:[1,1,1]
    v_pk_fma_f32 v[242:243], v[106:107], v[50:51], v[242:243] op_sel:[1,0,0] op_sel_hi:[1,1,1]
    v_pk_fma_f32 v[244:245], v[106:107], v[52:53], v[244:245] op_sel:[1,0,0] op_sel_hi:[1,1,1]
    v_pk_fma_f32 v[246:247], v[106:107], v[54:55], v[246:247] op_sel:[1,0,0] op_sel_hi:[1,1,1]
    v_pk_mul_f32 v[240:241], v[110:111], v[240:241] op_sel:[1,0] op_sel_hi:[1,1]
    v_pk_mul_f32 v[242:243], v[110:111], v[242:243] op_sel:[1,0] op_sel_hi:[1,1]
    v_pk_mul_f32 v[244:245], v[110:111], v[244:245] op_sel:[1,0] op_sel_hi:[1,1]
    v_pk_mul_f32 v[246:247], v[110:111], v[246:247] op_sel:[1,0] op_sel_hi:[1,1]
    v_cvt_pk_bf16_f32 v240, v240, v241
    v_cvt_pk_bf16_f32 v241, v242, v243
    v_cvt_pk_bf16_f32 v242, v244, v245
    v_cvt_pk_bf16_f32 v243, v246, v247
    v_accvgpr_write_b32 a56, v240
    v_accvgpr_write_b32 a57, v241
    v_accvgpr_write_b32 a58, v242
    v_accvgpr_write_b32 a59, v243
    v_pk_fma_f32 v[248:249], v[106:107], v[56:57], v[248:249] op_sel:[1,0,0] op_sel_hi:[1,1,1]
    v_pk_fma_f32 v[250:251], v[106:107], v[58:59], v[250:251] op_sel:[1,0,0] op_sel_hi:[1,1,1]
    v_pk_fma_f32 v[252:253], v[106:107], v[60:61], v[252:253] op_sel:[1,0,0] op_sel_hi:[1,1,1]
    v_pk_fma_f32 v[254:255], v[106:107], v[62:63], v[254:255] op_sel:[1,0,0] op_sel_hi:[1,1,1]
    v_pk_mul_f32 v[248:249], v[110:111], v[248:249] op_sel:[1,0] op_sel_hi:[1,1]
    v_pk_mul_f32 v[250:251], v[110:111], v[250:251] op_sel:[1,0] op_sel_hi:[1,1]
    v_pk_mul_f32 v[252:253], v[110:111], v[252:253] op_sel:[1,0] op_sel_hi:[1,1]
    v_pk_mul_f32 v[254:255], v[110:111], v[254:255] op_sel:[1,0] op_sel_hi:[1,1]
    v_cvt_pk_bf16_f32 v248, v248, v249
    v_cvt_pk_bf16_f32 v249, v250, v251
    v_cvt_pk_bf16_f32 v250, v252, v253
    v_cvt_pk_bf16_f32 v251, v254, v255
    v_accvgpr_write_b32 a60, v248
    v_accvgpr_write_b32 a61, v249
    v_accvgpr_write_b32 a62, v250
    v_accvgpr_write_b32 a63, v251
    v_accvgpr_read_b32 v128, a128
    v_accvgpr_read_b32 v129, a129
    v_accvgpr_read_b32 v130, a130
    v_accvgpr_read_b32 v131, a131
    v_accvgpr_read_b32 v132, a144
    v_accvgpr_read_b32 v133, a145
    v_accvgpr_read_b32 v134, a146
    v_accvgpr_read_b32 v135, a147
    v_pk_fma_f32 v[128:129], v[104:105], v[0:1], v[128:129] op_sel:[0,0,0] op_sel_hi:[0,1,1]
    v_pk_fma_f32 v[130:131], v[104:105], v[2:3], v[130:131] op_sel:[0,0,0] op_sel_hi:[0,1,1]
    v_pk_fma_f32 v[132:133], v[104:105], v[4:5], v[132:133] op_sel:[0,0,0] op_sel_hi:[0,1,1]
    v_pk_fma_f32 v[134:135], v[104:105], v[6:7], v[134:135] op_sel:[0,0,0] op_sel_hi:[0,1,1]
    v_pk_fma_f32 v[128:129], v[112:113], v[128:129], v[64:65] op_sel:[0,0,0] op_sel_hi:[0,1,1]
    v_pk_fma_f32 v[130:131], v[112:113], v[130:131], v[66:67] op_sel:[0,0,0] op_sel_hi:[0,1,1]
    v_pk_fma_f32 v[132:133], v[112:113], v[132:133], v[68:69] op_sel:[0,0,0] op_sel_hi:[0,1,1]
    v_pk_fma_f32 v[134:135], v[112:113], v[134:135], v[70:71] op_sel:[0,0,0] op_sel_hi:[0,1,1]
    v_pk_mul_f32 v[136:137], v[128:129], v[128:129] op_sel:[0,0] op_sel_hi:[1,1]
    v_pk_mul_f32 v[138:139], v[130:131], v[130:131] op_sel:[0,0] op_sel_hi:[1,1]
    v_pk_mul_f32 v[140:141], v[132:133], v[132:133] op_sel:[0,0] op_sel_hi:[1,1]
    v_pk_mul_f32 v[142:143], v[134:135], v[134:135] op_sel:[0,0] op_sel_hi:[1,1]
    v_pk_fma_f32 v[136:137], v[136:137], s[66:67], v[116:117] op_sel:[0,1,0] op_sel_hi:[1,1,0]
    v_pk_fma_f32 v[138:139], v[138:139], s[66:67], v[116:117] op_sel:[0,1,0] op_sel_hi:[1,1,0]
    v_pk_fma_f32 v[140:141], v[140:141], s[66:67], v[116:117] op_sel:[0,1,0] op_sel_hi:[1,1,0]
    v_pk_fma_f32 v[142:143], v[142:143], s[66:67], v[116:117] op_sel:[0,1,0] op_sel_hi:[1,1,0]
    v_pk_mul_f32 v[136:137], v[136:137], v[128:129] op_sel:[0,0] op_sel_hi:[1,1]
    v_pk_mul_f32 v[138:139], v[138:139], v[130:131] op_sel:[0,0] op_sel_hi:[1,1]
    v_pk_mul_f32 v[140:141], v[140:141], v[132:133] op_sel:[0,0] op_sel_hi:[1,1]
    v_pk_mul_f32 v[142:143], v[142:143], v[134:135] op_sel:[0,0] op_sel_hi:[1,1]
    v_exp_f32 v136, v136
    v_exp_f32 v137, v137
    v_exp_f32 v138, v138
    v_exp_f32 v139, v139
    v_exp_f32 v140, v140
    v_exp_f32 v141, v141
    v_exp_f32 v142, v142
    v_exp_f32 v143, v143
    v_pk_add_f32 v[136:137], v[136:137], 1.0 op_sel:[0,0] op_sel_hi:[1,0]
    v_pk_add_f32 v[138:139], v[138:139], 1.0 op_sel:[0,0] op_sel_hi:[1,0]
    v_pk_add_f32 v[140:141], v[140:141], 1.0 op_sel:[0,0] op_sel_hi:[1,0]
    v_pk_add_f32 v[142:143], v[142:143], 1.0 op_sel:[0,0] op_sel_hi:[1,0]
    v_rcp_f32 v136, v136
    v_rcp_f32 v137, v137
    v_rcp_f32 v138, v138
    v_rcp_f32 v139, v139
    v_rcp_f32 v140, v140
    v_rcp_f32 v141, v141
    v_rcp_f32 v142, v142
    v_rcp_f32 v143, v143
    v_pk_mul_f32 v[128:129], v[128:129], v[136:137] op_sel:[0,0] op_sel_hi:[1,1]
    v_pk_mul_f32 v[130:131], v[130:131], v[138:139] op_sel:[0,0] op_sel_hi:[1,1]
    v_pk_mul_f32 v[132:133], v[132:133], v[140:141] op_sel:[0,0] op_sel_hi:[1,1]
    v_pk_mul_f32 v[134:135], v[134:135], v[142:143] op_sel:[0,0] op_sel_hi:[1,1]
    v_cvt_pk_bf16_f32 v136, v128, v129
    v_cvt_pk_bf16_f32 v137, v130, v131
    v_cvt_pk_bf16_f32 v138, v132, v133
    v_cvt_pk_bf16_f32 v139, v134, v135
    buffer_store_dwordx4 v[136:139], v117, s[52:55], s68 offen offset:0 sc1
    v_accvgpr_read_b32 v144, a132
    v_accvgpr_read_b32 v145, a133
    v_accvgpr_read_b32 v146, a134
    v_accvgpr_read_b32 v147, a135
    v_accvgpr_read_b32 v148, a148
    v_accvgpr_read_b32 v149, a149
    v_accvgpr_read_b32 v150, a150
    v_accvgpr_read_b32 v151, a151
    v_pk_fma_f32 v[144:145], v[104:105], v[0:1], v[144:145] op_sel:[1,0,0] op_sel_hi:[1,1,1]
    v_pk_fma_f32 v[146:147], v[104:105], v[2:3], v[146:147] op_sel:[1,0,0] op_sel_hi:[1,1,1]
    v_pk_fma_f32 v[148:149], v[104:105], v[4:5], v[148:149] op_sel:[1,0,0] op_sel_hi:[1,1,1]
    v_pk_fma_f32 v[150:151], v[104:105], v[6:7], v[150:151] op_sel:[1,0,0] op_sel_hi:[1,1,1]
    v_pk_fma_f32 v[144:145], v[112:113], v[144:145], v[64:65] op_sel:[1,0,0] op_sel_hi:[1,1,1]
    v_pk_fma_f32 v[146:147], v[112:113], v[146:147], v[66:67] op_sel:[1,0,0] op_sel_hi:[1,1,1]
    v_pk_fma_f32 v[148:149], v[112:113], v[148:149], v[68:69] op_sel:[1,0,0] op_sel_hi:[1,1,1]
    v_pk_fma_f32 v[150:151], v[112:113], v[150:151], v[70:71] op_sel:[1,0,0] op_sel_hi:[1,1,1]
    v_pk_mul_f32 v[152:153], v[144:145], v[144:145] op_sel:[0,0] op_sel_hi:[1,1]
    v_pk_mul_f32 v[154:155], v[146:147], v[146:147] op_sel:[0,0] op_sel_hi:[1,1]
    v_pk_mul_f32 v[156:157], v[148:149], v[148:149] op_sel:[0,0] op_sel_hi:[1,1]
    v_pk_mul_f32 v[158:159], v[150:151], v[150:151] op_sel:[0,0] op_sel_hi:[1,1]
    v_pk_fma_f32 v[152:153], v[152:153], s[66:67], v[116:117] op_sel:[0,1,0] op_sel_hi:[1,1,0]
    v_pk_fma_f32 v[154:155], v[154:155], s[66:67], v[116:117] op_sel:[0,1,0] op_sel_hi:[1,1,0]
    v_pk_fma_f32 v[156:157], v[156:157], s[66:67], v[116:117] op_sel:[0,1,0] op_sel_hi:[1,1,0]
    v_pk_fma_f32 v[158:159], v[158:159], s[66:67], v[116:117] op_sel:[0,1,0] op_sel_hi:[1,1,0]
    v_pk_mul_f32 v[152:153], v[152:153], v[144:145] op_sel:[0,0] op_sel_hi:[1,1]
    v_pk_mul_f32 v[154:155], v[154:155], v[146:147] op_sel:[0,0] op_sel_hi:[1,1]
    v_pk_mul_f32 v[156:157], v[156:157], v[148:149] op_sel:[0,0] op_sel_hi:[1,1]
    v_pk_mul_f32 v[158:159], v[158:159], v[150:151] op_sel:[0,0] op_sel_hi:[1,1]
    v_exp_f32 v152, v152
    v_exp_f32 v153, v153
    v_exp_f32 v154, v154
    v_exp_f32 v155, v155
    v_exp_f32 v156, v156
    v_exp_f32 v157, v157
    v_exp_f32 v158, v158
    v_exp_f32 v159, v159
    v_pk_add_f32 v[152:153], v[152:153], 1.0 op_sel:[0,0] op_sel_hi:[1,0]
    v_pk_add_f32 v[154:155], v[154:155], 1.0 op_sel:[0,0] op_sel_hi:[1,0]
    v_pk_add_f32 v[156:157], v[156:157], 1.0 op_sel:[0,0] op_sel_hi:[1,0]
    v_pk_add_f32 v[158:159], v[158:159], 1.0 op_sel:[0,0] op_sel_hi:[1,0]
    v_rcp_f32 v152, v152
    v_rcp_f32 v153, v153
    v_rcp_f32 v154, v154
    v_rcp_f32 v155, v155
    v_rcp_f32 v156, v156
    v_rcp_f32 v157, v157
    v_rcp_f32 v158, v158
    v_rcp_f32 v159, v159
    v_pk_mul_f32 v[144:145], v[144:145], v[152:153] op_sel:[0,0] op_sel_hi:[1,1]
    v_pk_mul_f32 v[146:147], v[146:147], v[154:155] op_sel:[0,0] op_sel_hi:[1,1]
    v_pk_mul_f32 v[148:149], v[148:149], v[156:157] op_sel:[0,0] op_sel_hi:[1,1]
    v_pk_mul_f32 v[150:151], v[150:151], v[158:159] op_sel:[0,0] op_sel_hi:[1,1]
    v_cvt_pk_bf16_f32 v152, v144, v145
    v_cvt_pk_bf16_f32 v153, v146, v147
    v_cvt_pk_bf16_f32 v154, v148, v149
    v_cvt_pk_bf16_f32 v155, v150, v151
    buffer_store_dwordx4 v[152:155], v117, s[52:55], s68 offen offset:1024 sc1
    v_accvgpr_read_b32 v160, a136
    v_accvgpr_read_b32 v161, a137
    v_accvgpr_read_b32 v162, a138
    v_accvgpr_read_b32 v163, a139
    v_accvgpr_read_b32 v164, a152
    v_accvgpr_read_b32 v165, a153
    v_accvgpr_read_b32 v166, a154
    v_accvgpr_read_b32 v167, a155
    v_pk_fma_f32 v[160:161], v[106:107], v[0:1], v[160:161] op_sel:[0,0,0] op_sel_hi:[0,1,1]
    v_pk_fma_f32 v[162:163], v[106:107], v[2:3], v[162:163] op_sel:[0,0,0] op_sel_hi:[0,1,1]
    v_pk_fma_f32 v[164:165], v[106:107], v[4:5], v[164:165] op_sel:[0,0,0] op_sel_hi:[0,1,1]
    v_pk_fma_f32 v[166:167], v[106:107], v[6:7], v[166:167] op_sel:[0,0,0] op_sel_hi:[0,1,1]
    v_pk_fma_f32 v[160:161], v[114:115], v[160:161], v[64:65] op_sel:[0,0,0] op_sel_hi:[0,1,1]
    v_pk_fma_f32 v[162:163], v[114:115], v[162:163], v[66:67] op_sel:[0,0,0] op_sel_hi:[0,1,1]
    v_pk_fma_f32 v[164:165], v[114:115], v[164:165], v[68:69] op_sel:[0,0,0] op_sel_hi:[0,1,1]
    v_pk_fma_f32 v[166:167], v[114:115], v[166:167], v[70:71] op_sel:[0,0,0] op_sel_hi:[0,1,1]
    v_pk_mul_f32 v[168:169], v[160:161], v[160:161] op_sel:[0,0] op_sel_hi:[1,1]
    v_pk_mul_f32 v[170:171], v[162:163], v[162:163] op_sel:[0,0] op_sel_hi:[1,1]
    v_pk_mul_f32 v[172:173], v[164:165], v[164:165] op_sel:[0,0] op_sel_hi:[1,1]
    v_pk_mul_f32 v[174:175], v[166:167], v[166:167] op_sel:[0,0] op_sel_hi:[1,1]
    v_pk_fma_f32 v[168:169], v[168:169], s[66:67], v[116:117] op_sel:[0,1,0] op_sel_hi:[1,1,0]
    v_pk_fma_f32 v[170:171], v[170:171], s[66:67], v[116:117] op_sel:[0,1,0] op_sel_hi:[1,1,0]
    v_pk_fma_f32 v[172:173], v[172:173], s[66:67], v[116:117] op_sel:[0,1,0] op_sel_hi:[1,1,0]
    v_pk_fma_f32 v[174:175], v[174:175], s[66:67], v[116:117] op_sel:[0,1,0] op_sel_hi:[1,1,0]
    v_pk_mul_f32 v[168:169], v[168:169], v[160:161] op_sel:[0,0] op_sel_hi:[1,1]
    v_pk_mul_f32 v[170:171], v[170:171], v[162:163] op_sel:[0,0] op_sel_hi:[1,1]
    v_pk_mul_f32 v[172:173], v[172:173], v[164:165] op_sel:[0,0] op_sel_hi:[1,1]
    v_pk_mul_f32 v[174:175], v[174:175], v[166:167] op_sel:[0,0] op_sel_hi:[1,1]
    v_exp_f32 v168, v168
    v_exp_f32 v169, v169
    v_exp_f32 v170, v170
    v_exp_f32 v171, v171
    v_exp_f32 v172, v172
    v_exp_f32 v173, v173
    v_exp_f32 v174, v174
    v_exp_f32 v175, v175
    v_pk_add_f32 v[168:169], v[168:169], 1.0 op_sel:[0,0] op_sel_hi:[1,0]
    v_pk_add_f32 v[170:171], v[170:171], 1.0 op_sel:[0,0] op_sel_hi:[1,0]
    v_pk_add_f32 v[172:173], v[172:173], 1.0 op_sel:[0,0] op_sel_hi:[1,0]
    v_pk_add_f32 v[174:175], v[174:175], 1.0 op_sel:[0,0] op_sel_hi:[1,0]
    v_rcp_f32 v168, v168
    v_rcp_f32 v169, v169
    v_rcp_f32 v170, v170
    v_rcp_f32 v171, v171
    v_rcp_f32 v172, v172
    v_rcp_f32 v173, v173
    v_rcp_f32 v174, v174
    v_rcp_f32 v175, v175
    v_pk_mul_f32 v[160:161], v[160:161], v[168:169] op_sel:[0,0] op_sel_hi:[1,1]
    v_pk_mul_f32 v[162:163], v[162:163], v[170:171] op_sel:[0,0] op_sel_hi:[1,1]
    v_pk_mul_f32 v[164:165], v[164:165], v[172:173] op_sel:[0,0] op_sel_hi:[1,1]
    v_pk_mul_f32 v[166:167], v[166:167], v[174:175] op_sel:[0,0] op_sel_hi:[1,1]
    v_cvt_pk_bf16_f32 v168, v160, v161
    v_cvt_pk_bf16_f32 v169, v162, v163
    v_cvt_pk_bf16_f32 v170, v164, v165
    v_cvt_pk_bf16_f32 v171, v166, v167
    buffer_store_dwordx4 v[168:171], v117, s[52:55], s69 offen offset:0 sc1
    v_accvgpr_read_b32 v176, a140
    v_accvgpr_read_b32 v177, a141
    v_accvgpr_read_b32 v178, a142
    v_accvgpr_read_b32 v179, a143
    v_accvgpr_read_b32 v180, a156
    v_accvgpr_read_b32 v181, a157
    v_accvgpr_read_b32 v182, a158
    v_accvgpr_read_b32 v183, a159
    v_pk_fma_f32 v[176:177], v[106:107], v[0:1], v[176:177] op_sel:[1,0,0] op_sel_hi:[1,1,1]
    v_pk_fma_f32 v[178:179], v[106:107], v[2:3], v[178:179] op_sel:[1,0,0] op_sel_hi:[1,1,1]
    v_pk_fma_f32 v[180:181], v[106:107], v[4:5], v[180:181] op_sel:[1,0,0] op_sel_hi:[1,1,1]
    v_pk_fma_f32 v[182:183], v[106:107], v[6:7], v[182:183] op_sel:[1,0,0] op_sel_hi:[1,1,1]
    v_pk_fma_f32 v[176:177], v[114:115], v[176:177], v[64:65] op_sel:[1,0,0] op_sel_hi:[1,1,1]
    v_pk_fma_f32 v[178:179], v[114:115], v[178:179], v[66:67] op_sel:[1,0,0] op_sel_hi:[1,1,1]
    v_pk_fma_f32 v[180:181], v[114:115], v[180:181], v[68:69] op_sel:[1,0,0] op_sel_hi:[1,1,1]
    v_pk_fma_f32 v[182:183], v[114:115], v[182:183], v[70:71] op_sel:[1,0,0] op_sel_hi:[1,1,1]
    v_pk_mul_f32 v[184:185], v[176:177], v[176:177] op_sel:[0,0] op_sel_hi:[1,1]
    v_pk_mul_f32 v[186:187], v[178:179], v[178:179] op_sel:[0,0] op_sel_hi:[1,1]
    v_pk_mul_f32 v[188:189], v[180:181], v[180:181] op_sel:[0,0] op_sel_hi:[1,1]
    v_pk_mul_f32 v[190:191], v[182:183], v[182:183] op_sel:[0,0] op_sel_hi:[1,1]
    v_pk_fma_f32 v[184:185], v[184:185], s[66:67], v[116:117] op_sel:[0,1,0] op_sel_hi:[1,1,0]
    v_pk_fma_f32 v[186:187], v[186:187], s[66:67], v[116:117] op_sel:[0,1,0] op_sel_hi:[1,1,0]
    v_pk_fma_f32 v[188:189], v[188:189], s[66:67], v[116:117] op_sel:[0,1,0] op_sel_hi:[1,1,0]
    v_pk_fma_f32 v[190:191], v[190:191], s[66:67], v[116:117] op_sel:[0,1,0] op_sel_hi:[1,1,0]
    v_pk_mul_f32 v[184:185], v[184:185], v[176:177] op_sel:[0,0] op_sel_hi:[1,1]
    v_pk_mul_f32 v[186:187], v[186:187], v[178:179] op_sel:[0,0] op_sel_hi:[1,1]
    v_pk_mul_f32 v[188:189], v[188:189], v[180:181] op_sel:[0,0] op_sel_hi:[1,1]
    v_pk_mul_f32 v[190:191], v[190:191], v[182:183] op_sel:[0,0] op_sel_hi:[1,1]
    v_exp_f32 v184, v184
    v_exp_f32 v185, v185
    v_exp_f32 v186, v186
    v_exp_f32 v187, v187
    v_exp_f32 v188, v188
    v_exp_f32 v189, v189
    v_exp_f32 v190, v190
    v_exp_f32 v191, v191
    v_pk_add_f32 v[184:185], v[184:185], 1.0 op_sel:[0,0] op_sel_hi:[1,0]
    v_pk_add_f32 v[186:187], v[186:187], 1.0 op_sel:[0,0] op_sel_hi:[1,0]
    v_pk_add_f32 v[188:189], v[188:189], 1.0 op_sel:[0,0] op_sel_hi:[1,0]
    v_pk_add_f32 v[190:191], v[190:191], 1.0 op_sel:[0,0] op_sel_hi:[1,0]
    v_rcp_f32 v184, v184
    v_rcp_f32 v185, v185
    v_rcp_f32 v186, v186
    v_rcp_f32 v187, v187
    v_rcp_f32 v188, v188
    v_rcp_f32 v189, v189
    v_rcp_f32 v190, v190
    v_rcp_f32 v191, v191
    v_pk_mul_f32 v[176:177], v[176:177], v[184:185] op_sel:[0,0] op_sel_hi:[1,1]
    v_pk_mul_f32 v[178:179], v[178:179], v[186:187] op_sel:[0,0] op_sel_hi:[1,1]
    v_pk_mul_f32 v[180:181], v[180:181], v[188:189] op_sel:[0,0] op_sel_hi:[1,1]
    v_pk_mul_f32 v[182:183], v[182:183], v[190:191] op_sel:[0,0] op_sel_hi:[1,1]
    v_cvt_pk_bf16_f32 v184, v176, v177
    v_cvt_pk_bf16_f32 v185, v178, v179
    v_cvt_pk_bf16_f32 v186, v180, v181
    v_cvt_pk_bf16_f32 v187, v182, v183
    buffer_store_dwordx4 v[184:187], v117, s[52:55], s69 offen offset:1024 sc1
L_front_done:
    s_and_b32 s27, s2, 3
    s_lshl_b32 s27, s27, 2
    s_lshr_b32 s27, 8211, s27
    s_and_b32 s27, s27, 3
    s_mov_b32 s61, 0
    s_cmp_eq_u32 s27, 1
    s_cselect_b32 s61, 1441792, s61
    s_cmp_eq_u32 s27, 2
    s_cselect_b32 s61, 2883584, s61
    s_cmp_eq_u32 s27, 3
    s_cselect_b32 s26, 64, 32
    s_load_dwordx2 s[40:41], s[0:1], s26
    s_cselect_b32 s42, 1409024, s42
    s_lshr_b32 s26, s2, 3
    s_lshl_b32 s26, s26, 2
    s_add_u32 s26, s26, s20
    s_mul_i32 s26, s26, 11264
    s_add_u32 s61, s61, s26
    s_add_u32 s44, s12, 25165824
    s_addc_u32 s45, s13, 0
    s_mov_b32 s46, 12582912
    s_mul_i32 s62, s2, 49152
    s_mul_i32 s26, s20, 7168
    s_add_u32 s62, s62, s26
    v_lshlrev_b32 v127, 4, v102
    v_mov_b32 v116, -1
    v_mov_b32 v117, -1
    v_mov_b32 v118, -1
    v_mov_b32 v119, -1
    s_getpc_b64 s[56:57]
L_code1:
    s_add_u32 s56, s56, L_attn_finish-L_code1
    s_addc_u32 s57, s57, 0
    s_mov_b32 s58, L_attn_exact-L_attn_finish
    s_lshr_b32 s63, s2, 3
    s_lshl_b32 s63, s63, 2
    s_add_u32 s63, s63, s20
    s_lshl_b32 s63, s63, 8
    v_lshlrev_b32 v126, 2, v102
    s_mov_b32 s27, 1568669696
    s_mov_b64 s[78:79], -1
    s_mov_b32 s50, 524288
    s_load_dwordx2 s[16:17], s[0:1], 88
    s_movk_i32 s18, 256
    v_and_b32 v125, 7, v102
    v_lshlrev_b32 v125, 2, v125
    s_add_u32 s72, s12, 41943040
    s_addc_u32 s73, s13, 0
    s_movk_i32 s74, 16384
    s_mov_b32 s75, 0x20000
    s_lshl_b32 s30, s22, 11
    s_lshl_b32 s31, s21, 2
    s_add_u32 s30, s30, s31
    s_lshl_b32 s31, s20, 7
    s_add_u32 s30, s30, s31
    s_add_u32 s71, s30, 1536
    s_cmp_ge_u32 s21, 11
    s_cselect_b32 s31, 512, 0
    s_add_u32 s76, s30, s31
    s_cmp_ge_u32 s21, 22
    s_cselect_b32 s31, 512, 0
    s_add_u32 s76, s76, s31
    s_lshl_b32 s64, s22, 2
    s_and_b32 s31, s2, 3
    s_lshl_b32 s31, s31, 2
    s_lshr_b32 s31, 8211, s31
    s_and_b32 s31, s31, 3
    s_add_u32 s64, s64, s31
    s_lshl_b32 s64, s64, 2
    s_bfe_u32 s31, s2, 0x10002
    s_lshl_b32 s31, s31, 1
    s_add_u32 s64, s64, s31
    s_and_b32 s31, s20, 1
    s_add_u32 s64, s64, s31
    s_lshl_b32 s64, s64, 7
    s_mov_b64 exec, 1
    v_mov_b32 v124, 0
    buffer_store_dword v124, v125, s[72:75], s76 offen sc1
    buffer_store_dword v124, v125, s[72:75], s71 offen sc1
    s_mov_b64 exec, -1
    v_add_u32 v120, 139264, v80
    v_add_u32 v121, 139264, v81
    v_add_u32 v122, 139264, v82
    v_add_u32 v123, 139264, v83
    ds_read_b128 a[64:67], v120 offset:0
    ds_read_b128 a[68:71], v121 offset:0
    ds_read_b128 a[72:75], v122 offset:0
    ds_read_b128 a[76:79], v123 offset:0
    ds_read_b128 a[80:83], v120 offset:4096
    ds_read_b128 a[84:87], v121 offset:4096
    ds_read_b128 a[88:91], v122 offset:4096
    ds_read_b128 a[92:95], v123 offset:4096
    ds_read_b128 a[96:99], v120 offset:8192
    ds_read_b128 a[100:103], v121 offset:8192
    ds_read_b128 a[104:107], v122 offset:8192
    ds_read_b128 a[108:111], v123 offset:8192
    ds_read_b128 a[112:115], v120 offset:12288
    ds_read_b128 a[116:119], v121 offset:12288
    ds_read_b128 a[120:123], v122 offset:12288
    ds_read_b128 a[124:127], v123 offset:12288
    v_mov_b32 v124, 0x3f803f80
    v_accvgpr_write_b32 a211, v124
    v_accvgpr_write_b32 a210, v124
    v_accvgpr_write_b32 a209, v124
    v_accvgpr_write_b32 a208, v124
    v_accvgpr_write_b32 a207, 0
    v_accvgpr_write_b32 a206, 0
    v_accvgpr_write_b32 a205, 0
    v_accvgpr_write_b32 a204, 0
    v_accvgpr_write_b32 a203, 0
    v_accvgpr_write_b32 a202, 0
    v_accvgpr_write_b32 a201, 0
    v_accvgpr_write_b32 a200, 0
    v_mov_b32 v255, 0
    v_mov_b32 v254, 0
    v_mov_b32 v253, 0
    v_mov_b32 v252, 0
    v_mov_b32 v251, 0
    v_mov_b32 v250, 0
    v_mov_b32 v249, 0
    v_mov_b32 v248, 0
    s_waitcnt lgkmcnt(12)
    v_mfma_f32_16x16x32_bf16 v[0:3], a[64:67], a[0:3], 0
    v_mov_b32 v247, 0
    v_mov_b32 v246, 0
    v_mfma_f32_16x16x32_bf16 v[0:3], a[68:71], a[4:7], v[0:3]
    v_mov_b32 v245, 0
    v_mov_b32 v244, 0
    v_mfma_f32_16x16x32_bf16 v[0:3], a[72:75], a[8:11], v[0:3]
    v_mov_b32 v243, 0
    v_mov_b32 v242, 0
    v_mfma_f32_16x16x32_bf16 v[0:3], a[76:79], a[12:15], v[0:3]
    v_mov_b32 v241, 0
    v_mov_b32 v240, 0
    v_mfma_f32_16x16x32_bf16 v[16:19], a[64:67], a[16:19], 0
    v_mov_b32 v239, 0
    v_mov_b32 v238, 0
    v_mfma_f32_16x16x32_bf16 v[16:19], a[68:71], a[20:23], v[16:19]
    v_mov_b32 v237, 0
    v_mov_b32 v236, 0
    v_mfma_f32_16x16x32_bf16 v[16:19], a[72:75], a[24:27], v[16:19]
    v_mov_b32 v235, 0
    v_mov_b32 v234, 0
    v_mfma_f32_16x16x32_bf16 v[16:19], a[76:79], a[28:31], v[16:19]
    v_mov_b32 v233, 0
    v_mov_b32 v232, 0
    v_mfma_f32_16x16x32_bf16 v[32:35], a[64:67], a[32:35], 0
    v_mov_b32 v231, 0
    v_mov_b32 v230, 0
    v_mfma_f32_16x16x32_bf16 v[32:35], a[68:71], a[36:39], v[32:35]
    v_mov_b32 v229, 0
    v_mov_b32 v228, 0
    v_mfma_f32_16x16x32_bf16 v[32:35], a[72:75], a[40:43], v[32:35]
    v_mov_b32 v227, 0
    v_mov_b32 v226, 0
    v_mfma_f32_16x16x32_bf16 v[32:35], a[76:79], a[44:47], v[32:35]
    v_mov_b32 v225, 0
    v_mov_b32 v224, 0
    v_mfma_f32_16x16x32_bf16 v[48:51], a[64:67], a[48:51], 0
    v_mov_b32 v223, 0
    v_mov_b32 v222, 0
    v_mfma_f32_16x16x32_bf16 v[48:51], a[68:71], a[52:55], v[48:51]
    v_mov_b32 v221, 0
    v_mov_b32 v220, 0
    v_mfma_f32_16x16x32_bf16 v[48:51], a[72:75], a[56:59], v[48:51]
    v_mov_b32 v219, 0
    v_mov_b32 v218, 0
    v_mfma_f32_16x16x32_bf16 v[48:51], a[76:79], a[60:63], v[48:51]
    v_mov_b32 v217, 0
    v_mov_b32 v216, 0
    s_waitcnt vmcnt(12)
    s_barrier
    v_max3_f32 v104, v0, v1, v2
    v_max3_f32 v106, v16, v17, v18
    v_max3_f32 v108, v32, v33, v34
    s_nop 0
    v_max3_f32 v110, v48, v49, v50
    v_mov_b32 v215, 0
    v_max_f32 v104, v104, v3
    v_max_f32 v106, v106, v19
    v_max_f32 v108, v108, v35
    v_max_f32 v110, v110, v51
    v_mov_b32 v214, 0
    v_mov_b32 v105, v104
    v_mov_b32 v107, v106
    v_mov_b32 v109, v108
    v_mov_b32 v111, v110
    v_mov_b32 v213, 0
    v_permlane32_swap_b32 v104, v105
    v_permlane32_swap_b32 v106, v107
    v_permlane32_swap_b32 v108, v109
    v_permlane32_swap_b32 v110, v111
    v_mov_b32 v212, 0
    v_max_f32 v104, v104, v105
    v_max_f32 v106, v106, v107
    v_max_f32 v108, v108, v109
    v_max_f32 v110, v110, v111
    v_mov_b32 v211, 0
    v_mov_b32 v105, v104
    v_mov_b32 v107, v106
    v_mov_b32 v109, v108
    v_mov_b32 v111, v110
    v_mov_b32 v210, 0
    v_permlane16_swap_b32 v104, v105
    v_permlane16_swap_b32 v106, v107
    v_permlane16_swap_b32 v108, v109
    v_permlane16_swap_b32 v110, v111
    v_mov_b32 v209, 0
    v_max_f32 v104, v104, v105
    v_max_f32 v106, v106, v107
    v_max_f32 v108, v108, v109
    v_max_f32 v110, v110, v111
    v_mov_b32 v208, 0
    v_sub_f32 v64, 0, v104
    v_sub_f32 v65, 0, v104
    v_sub_f32 v66, 0, v104
    v_sub_f32 v67, 0, v104
    v_pk_add_f32 v[0:1], v[0:1], v[64:65] op_sel:[0,0] op_sel_hi:[1,0]
    v_pk_add_f32 v[2:3], v[2:3], v[64:65] op_sel:[0,0] op_sel_hi:[1,0]
    v_sub_f32 v68, 0, v106
    v_sub_f32 v69, 0, v106
    v_sub_f32 v70, 0, v106
    v_sub_f32 v71, 0, v106
    v_pk_add_f32 v[16:17], v[16:17], v[68:69] op_sel:[0,0] op_sel_hi:[1,0]
    v_pk_add_f32 v[18:19], v[18:19], v[68:69] op_sel:[0,0] op_sel_hi:[1,0]
    v_sub_f32 v72, 0, v108
    v_sub_f32 v73, 0, v108
    v_sub_f32 v74, 0, v108
    v_sub_f32 v75, 0, v108
    v_pk_add_f32 v[32:33], v[32:33], v[72:73] op_sel:[0,0] op_sel_hi:[1,0]
    v_pk_add_f32 v[34:35], v[34:35], v[72:73] op_sel:[0,0] op_sel_hi:[1,0]
    v_sub_f32 v76, 0, v110
    v_sub_f32 v77, 0, v110
    v_sub_f32 v78, 0, v110
    v_sub_f32 v79, 0, v110
    v_pk_add_f32 v[48:49], v[48:49], v[76:77] op_sel:[0,0] op_sel_hi:[1,0]
    v_pk_add_f32 v[50:51], v[50:51], v[76:77] op_sel:[0,0] op_sel_hi:[1,0]
    v_mov_b32 v192, 0
    v_mov_b32 v193, 0
    v_mov_b32 v194, 0
    v_mov_b32 v195, 0
    v_mov_b32 v196, 0
    v_mov_b32 v197, 0
    v_mov_b32 v198, 0
    v_mov_b32 v199, 0
    v_mov_b32 v200, 0
    v_mov_b32 v201, 0
    v_mov_b32 v202, 0
    v_mov_b32 v203, 0
    v_mov_b32 v204, 0
    v_mov_b32 v205, 0
    v_mov_b32 v206, 0
    v_mov_b32 v207, 0
    s_waitcnt lgkmcnt(0)
    v_mfma_f32_16x16x32_bf16 v[4:7], a[80:83], a[0:3], v[64:67]
    v_exp_f32 v0, v0
    v_mfma_f32_16x16x32_bf16 v[4:7], a[84:87], a[4:7], v[4:7]
    ds_read_b64_tr_b16 a[128:129], v84 offset:0
    v_mfma_f32_16x16x32_bf16 v[4:7], a[88:91], a[8:11], v[4:7]
    v_exp_f32 v1, v1
    v_mfma_f32_16x16x32_bf16 v[4:7], a[92:95], a[12:15], v[4:7]
    ds_read_b64_tr_b16 a[130:131], v84 offset:4096
    v_mfma_f32_16x16x32_bf16 v[20:23], a[80:83], a[16:19], v[68:71]
    s_add_u32 m0, s24, 32768
    s_nop 0
    buffer_load_dwordx4 v92, s[4:7], s23 offen offset:0 lds
    v_exp_f32 v2, v2
    v_mfma_f32_16x16x32_bf16 v[20:23], a[84:87], a[20:23], v[20:23]
    ds_read_b64_tr_b16 a[132:133], v84 offset:8192
    v_cvt_pk_bf16_f32 v0, v0, v1
    v_mfma_f32_16x16x32_bf16 v[20:23], a[88:91], a[24:27], v[20:23]
    v_exp_f32 v3, v3
    v_mfma_f32_16x16x32_bf16 v[20:23], a[92:95], a[28:31], v[20:23]
    ds_read_b64_tr_b16 a[134:135], v84 offset:12288
    v_mfma_f32_16x16x32_bf16 v[8:11], a[96:99], a[0:3], v[64:67]
    buffer_load_dwordx4 v93, s[4:7], s23 offen offset:1024 lds
    v_exp_f32 v16, v16
    v_mfma_f32_16x16x32_bf16 v[8:11], a[100:103], a[4:7], v[8:11]
    ds_read_b64_tr_b16 a[136:137], v85 offset:0
    v_cvt_pk_bf16_f32 v1, v2, v3
    v_mfma_f32_16x16x32_bf16 v[8:11], a[104:107], a[8:11], v[8:11]
    v_exp_f32 v17, v17
    v_mfma_f32_16x16x32_bf16 v[8:11], a[108:111], a[12:15], v[8:11]
    ds_read_b64_tr_b16 a[138:139], v85 offset:4096
    v_mfma_f32_16x16x32_bf16 v[24:27], a[96:99], a[16:19], v[68:71]
    buffer_load_dwordx4 v94, s[4:7], s23 offen offset:2048 lds
    v_exp_f32 v18, v18
    v_mfma_f32_16x16x32_bf16 v[24:27], a[100:103], a[20:23], v[24:27]
    ds_read_b64_tr_b16 a[140:141], v85 offset:8192
    v_cvt_pk_bf16_f32 v16, v16, v17
    v_mfma_f32_16x16x32_bf16 v[24:27], a[104:107], a[24:27], v[24:27]
    v_exp_f32 v19, v19
    v_mfma_f32_16x16x32_bf16 v[24:27], a[108:111], a[28:31], v[24:27]
    ds_read_b64_tr_b16 a[142:143], v85 offset:12288
    v_mfma_f32_16x16x32_bf16 v[12:15], a[112:115], a[0:3], v[64:67]
    buffer_load_dwordx4 v95, s[4:7], s23 offen offset:3072 lds
    v_exp_f32 v4, v4
    v_mfma_f32_16x16x32_bf16 v[12:15], a[116:119], a[4:7], v[12:15]
    ds_read_b64_tr_b16 a[144:145], v86 offset:0
    v_cvt_pk_bf16_f32 v17, v18, v19
    v_mfma_f32_16x16x32_bf16 v[12:15], a[120:123], a[8:11], v[12:15]
    v_exp_f32 v5, v5
    v_mfma_f32_16x16x32_bf16 v[12:15], a[124:127], a[12:15], v[12:15]
    ds_read_b64_tr_b16 a[146:147], v86 offset:4096
    v_mfma_f32_16x16x32_bf16 v[28:31], a[112:115], a[16:19], v[68:71]
    v_exp_f32 v6, v6
    v_mfma_f32_16x16x32_bf16 v[28:31], a[116:119], a[20:23], v[28:31]
    ds_read_b64_tr_b16 a[148:149], v86 offset:8192
    v_cvt_pk_bf16_f32 v2, v4, v5
    v_mfma_f32_16x16x32_bf16 v[28:31], a[120:123], a[24:27], v[28:31]
    s_add_u32 m0, s24, 98304
    s_nop 0
    buffer_load_dwordx4 v96, s[8:11], s23 offen offset:0 lds
    v_exp_f32 v7, v7
    v_mfma_f32_16x16x32_bf16 v[28:31], a[124:127], a[28:31], v[28:31]
    ds_read_b64_tr_b16 a[150:151], v86 offset:12288
    v_mfma_f32_16x16x32_bf16 v[36:39], a[80:83], a[32:35], v[72:75]
    v_exp_f32 v20, v20
    v_mfma_f32_16x16x32_bf16 v[36:39], a[84:87], a[36:39], v[36:39]
    ds_read_b64_tr_b16 a[152:153], v87 offset:0
    v_cvt_pk_bf16_f32 v3, v6, v7
    v_mfma_f32_16x16x32_bf16 v[36:39], a[88:91], a[40:43], v[36:39]
    buffer_load_dwordx4 v97, s[8:11], s23 offen offset:1024 lds
    v_exp_f32 v21, v21
    v_mfma_f32_16x16x32_bf16 v[36:39], a[92:95], a[44:47], v[36:39]
    ds_read_b64_tr_b16 a[154:155], v87 offset:4096
    v_mfma_f32_16x16x32_bf16 v[52:55], a[80:83], a[48:51], v[76:79]
    v_exp_f32 v22, v22
    v_mfma_f32_16x16x32_bf16 v[52:55], a[84:87], a[52:55], v[52:55]
    ds_read_b64_tr_b16 a[156:157], v87 offset:8192
    v_cvt_pk_bf16_f32 v18, v20, v21
    v_mfma_f32_16x16x32_bf16 v[52:55], a[88:91], a[56:59], v[52:55]
    buffer_load_dwordx4 v96, s[8:11], s23 offen offset:2048 lds
    v_exp_f32 v23, v23
    v_mfma_f32_16x16x32_bf16 v[52:55], a[92:95], a[60:63], v[52:55]
    ds_read_b64_tr_b16 a[158:159], v87 offset:12288
    v_mfma_f32_16x16x32_bf16 v[40:43], a[96:99], a[32:35], v[72:75]
    v_exp_f32 v8, v8
    v_mfma_f32_16x16x32_bf16 v[40:43], a[100:103], a[36:39], v[40:43]
    ds_read_b64_tr_b16 a[160:161], v88 offset:0
    v_cvt_pk_bf16_f32 v19, v22, v23
    v_mfma_f32_16x16x32_bf16 v[40:43], a[104:107], a[40:43], v[40:43]
    buffer_load_dwordx4 v97, s[8:11], s23 offen offset:3072 lds
    v_exp_f32 v9, v9
    v_mfma_f32_16x16x32_bf16 v[40:43], a[108:111], a[44:47], v[40:43]
    ds_read_b64_tr_b16 a[162:163], v88 offset:4096
    v_mfma_f32_16x16x32_bf16 v[56:59], a[96:99], a[48:51], v[76:79]
    v_exp_f32 v10, v10
    v_mfma_f32_16x16x32_bf16 v[56:59], a[100:103], a[52:55], v[56:59]
    ds_read_b64_tr_b16 a[164:165], v88 offset:8192
    v_cvt_pk_bf16_f32 v8, v8, v9
    v_mfma_f32_16x16x32_bf16 v[56:59], a[104:107], a[56:59], v[56:59]
    v_exp_f32 v11, v11
    v_mfma_f32_16x16x32_bf16 v[56:59], a[108:111], a[60:63], v[56:59]
    ds_read_b64_tr_b16 a[166:167], v88 offset:12288
    v_mfma_f32_16x16x32_bf16 v[44:47], a[112:115], a[32:35], v[72:75]
    s_add_u32 s23, s23, 16384
    v_exp_f32 v24, v24
    v_mfma_f32_16x16x32_bf16 v[44:47], a[116:119], a[36:39], v[44:47]
    ds_read_b64_tr_b16 a[168:169], v89 offset:0
    v_cvt_pk_bf16_f32 v9, v10, v11
    v_mfma_f32_16x16x32_bf16 v[44:47], a[120:123], a[40:43], v[44:47]
    v_exp_f32 v25, v25
    v_mfma_f32_16x16x32_bf16 v[44:47], a[124:127], a[44:47], v[44:47]
    ds_read_b64_tr_b16 a[170:171], v89 offset:4096
    v_mfma_f32_16x16x32_bf16 v[60:63], a[112:115], a[48:51], v[76:79]
    v_exp_f32 v26, v26
    v_mfma_f32_16x16x32_bf16 v[60:63], a[116:119], a[52:55], v[60:63]
    ds_read_b64_tr_b16 a[172:173], v89 offset:8192
    v_cvt_pk_bf16_f32 v24, v24, v25
    v_mfma_f32_16x16x32_bf16 v[60:63], a[120:123], a[56:59], v[60:63]
    v_exp_f32 v27, v27
    v_mfma_f32_16x16x32_bf16 v[60:63], a[124:127], a[60:63], v[60:63]
    ds_read_b64_tr_b16 a[174:175], v89 offset:12288
    v_exp_f32 v12, v12
    ds_read_b64_tr_b16 a[176:177], v90 offset:0
    v_cvt_pk_bf16_f32 v25, v26, v27
    v_exp_f32 v13, v13
    ds_read_b64_tr_b16 a[178:179], v90 offset:4096
    v_exp_f32 v14, v14
    ds_read_b64_tr_b16 a[180:181], v90 offset:8192
    v_cvt_pk_bf16_f32 v10, v12, v13
    v_exp_f32 v15, v15
    ds_read_b64_tr_b16 a[182:183], v90 offset:12288
    v_exp_f32 v28, v28
    ds_read_b64_tr_b16 a[184:185], v91 offset:0
    v_cvt_pk_bf16_f32 v11, v14, v15
    v_exp_f32 v29, v29
    ds_read_b64_tr_b16 a[186:187], v91 offset:4096
    v_exp_f32 v30, v30
    ds_read_b64_tr_b16 a[188:189], v91 offset:8192
    v_cvt_pk_bf16_f32 v26, v28, v29
    v_exp_f32 v31, v31
    ds_read_b64_tr_b16 a[190:191], v91 offset:12288
    v_cvt_pk_bf16_f32 v27, v30, v31
    v_exp_f32 v32, v32
    s_waitcnt lgkmcnt(0)
    v_mfma_f32_16x16x32_bf16 v[128:131], a[128:131], v[0:3], 0
    v_exp_f32 v33, v33
    v_mfma_f32_16x16x32_bf16 v[128:131], a[132:135], v[8:11], v[128:131]
    ds_read_b128 a[64:67], v80 offset:0
    v_mfma_f32_16x16x32_bf16 v[160:163], a[128:131], v[16:19], 0
    v_exp_f32 v34, v34
    v_mfma_f32_16x16x32_bf16 v[160:163], a[132:135], v[24:27], v[160:163]
    ds_read_b128 a[68:71], v81 offset:0
    v_cvt_pk_bf16_f32 v32, v32, v33
    v_mfma_f32_16x16x32_bf16 v[132:135], a[136:139], v[0:3], 0
    v_exp_f32 v35, v35
    v_mfma_f32_16x16x32_bf16 v[132:135], a[140:143], v[8:11], v[132:135]
    ds_read_b128 a[72:75], v82 offset:0
    v_mfma_f32_16x16x32_bf16 v[164:167], a[136:139], v[16:19], 0
    v_exp_f32 v48, v48
    v_mfma_f32_16x16x32_bf16 v[164:167], a[140:143], v[24:27], v[164:167]
    ds_read_b128 a[76:79], v83 offset:0
    v_cvt_pk_bf16_f32 v33, v34, v35
    v_mfma_f32_16x16x32_bf16 v[136:139], a[144:147], v[0:3], 0
    v_exp_f32 v49, v49
    v_mfma_f32_16x16x32_bf16 v[136:139], a[148:151], v[8:11], v[136:139]
    ds_read_b128 a[80:83], v80 offset:4096
    v_mfma_f32_16x16x32_bf16 v[168:171], a[144:147], v[16:19], 0
    v_exp_f32 v50, v50
    v_mfma_f32_16x16x32_bf16 v[168:171], a[148:151], v[24:27], v[168:171]
    ds_read_b128 a[84:87], v81 offset:4096
    v_cvt_pk_bf16_f32 v48, v48, v49
    v_mfma_f32_16x16x32_bf16 v[140:143], a[152:155], v[0:3], 0
    v_exp_f32 v51, v51
    v_mfma_f32_16x16x32_bf16 v[140:143], a[156:159], v[8:11], v[140:143]
    ds_read_b128 a[88:91], v82 offset:4096
    v_mfma_f32_16x16x32_bf16 v[172:175], a[152:155], v[16:19], 0
    v_exp_f32 v36, v36
    v_mfma_f32_16x16x32_bf16 v[172:175], a[156:159], v[24:27], v[172:175]
    ds_read_b128 a[92:95], v83 offset:4096
    v_cvt_pk_bf16_f32 v49, v50, v51
    v_mfma_f32_16x16x32_bf16 v[144:147], a[160:163], v[0:3], 0
    v_exp_f32 v37, v37
    v_mfma_f32_16x16x32_bf16 v[144:147], a[164:167], v[8:11], v[144:147]
    ds_read_b128 a[96:99], v80 offset:8192
    v_mfma_f32_16x16x32_bf16 v[176:179], a[160:163], v[16:19], 0
    v_exp_f32 v38, v38
    v_mfma_f32_16x16x32_bf16 v[176:179], a[164:167], v[24:27], v[176:179]
    ds_read_b128 a[100:103], v81 offset:8192
    v_cvt_pk_bf16_f32 v34, v36, v37
    v_mfma_f32_16x16x32_bf16 v[148:151], a[168:171], v[0:3], 0
    v_exp_f32 v39, v39
    v_mfma_f32_16x16x32_bf16 v[148:151], a[172:175], v[8:11], v[148:151]
    ds_read_b128 a[104:107], v82 offset:8192
    v_mfma_f32_16x16x32_bf16 v[180:183], a[168:171], v[16:19], 0
    v_exp_f32 v52, v52
    v_mfma_f32_16x16x32_bf16 v[180:183], a[172:175], v[24:27], v[180:183]
    ds_read_b128 a[108:111], v83 offset:8192
    v_cvt_pk_bf16_f32 v35, v38, v39
    v_mfma_f32_16x16x32_bf16 v[152:155], a[176:179], v[0:3], 0
    v_exp_f32 v53, v53
    v_mfma_f32_16x16x32_bf16 v[152:155], a[180:183], v[8:11], v[152:155]
    ds_read_b128 a[112:115], v80 offset:12288
    v_mfma_f32_16x16x32_bf16 v[184:187], a[176:179], v[16:19], 0
    v_exp_f32 v54, v54
    v_mfma_f32_16x16x32_bf16 v[184:187], a[180:183], v[24:27], v[184:187]
    ds_read_b128 a[116:119], v81 offset:12288
    v_cvt_pk_bf16_f32 v50, v52, v53
    v_mfma_f32_16x16x32_bf16 v[156:159], a[184:187], v[0:3], 0
    v_exp_f32 v55, v55
    v_mfma_f32_16x16x32_bf16 v[156:159], a[188:191], v[8:11], v[156:159]
    ds_read_b128 a[120:123], v82 offset:12288
    v_mfma_f32_16x16x32_bf16 v[188:191], a[184:187], v[16:19], 0
    v_exp_f32 v40, v40
    v_mfma_f32_16x16x32_bf16 v[188:191], a[188:191], v[24:27], v[188:191]
    ds_read_b128 a[124:127], v83 offset:12288
    v_cvt_pk_bf16_f32 v51, v54, v55
    v_mfma_f32_16x16x32_bf16 a[192:195], a[208:211], v[0:3], 0
    v_exp_f32 v41, v41
    v_mfma_f32_16x16x32_bf16 a[192:195], a[208:211], v[8:11], a[192:195]
    v_mfma_f32_16x16x32_bf16 a[196:199], a[208:211], v[16:19], 0
    v_exp_f32 v42, v42
    v_mfma_f32_16x16x32_bf16 a[196:199], a[208:211], v[24:27], a[196:199]
    v_cvt_pk_bf16_f32 v40, v40, v41
    v_exp_f32 v43, v43
    v_exp_f32 v56, v56
    v_cvt_pk_bf16_f32 v41, v42, v43
    v_exp_f32 v57, v57
    v_exp_f32 v58, v58
    v_cvt_pk_bf16_f32 v56, v56, v57
    v_exp_f32 v59, v59
    v_exp_f32 v44, v44
    v_cvt_pk_bf16_f32 v57, v58, v59
    v_exp_f32 v45, v45
    v_exp_f32 v46, v46
    v_cvt_pk_bf16_f32 v42, v44, v45
    v_exp_f32 v47, v47
    s_waitcnt vmcnt(8)
    s_barrier
    s_cmp_lg_u32 s20, 0
    s_cbranch_scc1 L_sig_h
    s_lshl_b32 s31, s22, 5
    s_add_u32 s31, s31, s21
    s_mov_b64 exec, 1
    v_mov_b32 v124, 3
    buffer_store_byte v124, v125, s[16:19], s31 offen sc1
    s_mov_b64 exec, -1
L_sig_h:
    s_mov_b32 s25, 7
L_attn_loop:
    s_waitcnt lgkmcnt(4)
    v_mfma_f32_16x16x32_bf16 v[0:3], a[64:67], a[0:3], v[64:67]
    v_exp_f32 v60, v60
    v_mfma_f32_16x16x32_bf16 v[0:3], a[68:71], a[4:7], v[0:3]
    s_waitcnt vmcnt(8)
    v_cvt_pk_bf16_f32 v43, v46, v47
    v_mfma_f32_16x16x32_bf16 v[0:3], a[72:75], a[8:11], v[0:3]
    s_barrier
    v_exp_f32 v61, v61
    v_mfma_f32_16x16x32_bf16 v[0:3], a[76:79], a[12:15], v[0:3]
    v_mfma_f32_16x16x32_bf16 v[16:19], a[64:67], a[16:19], v[68:71]
    v_exp_f32 v62, v62
    v_mfma_f32_16x16x32_bf16 v[16:19], a[68:71], a[20:23], v[16:19]
    v_cvt_pk_bf16_f32 v58, v60, v61
    v_mfma_f32_16x16x32_bf16 v[16:19], a[72:75], a[24:27], v[16:19]
    s_add_u32 m0, s24, 49152
    v_exp_f32 v63, v63
    v_mfma_f32_16x16x32_bf16 v[16:19], a[76:79], a[28:31], v[16:19]
    buffer_load_dwordx4 v92, s[4:7], s23 offen offset:0 lds
    v_mfma_f32_16x16x32_bf16 v[4:7], a[80:83], a[0:3], v[64:67]
    v_mfma_f32_16x16x32_bf16 v[4:7], a[84:87], a[4:7], v[4:7]
    v_cvt_pk_bf16_f32 v59, v62, v63
    v_mfma_f32_16x16x32_bf16 v[4:7], a[88:91], a[8:11], v[4:7]
    v_mfma_f32_16x16x32_bf16 v[4:7], a[92:95], a[12:15], v[4:7]
    v_mfma_f32_16x16x32_bf16 v[20:23], a[80:83], a[16:19], v[68:71]
    v_exp_f32 v0, v0
    v_mfma_f32_16x16x32_bf16 v[20:23], a[84:87], a[20:23], v[20:23]
    buffer_load_dwordx4 v93, s[4:7], s23 offen offset:1024 lds
    v_mfma_f32_16x16x32_bf16 v[20:23], a[88:91], a[24:27], v[20:23]
    v_exp_f32 v1, v1
    v_mfma_f32_16x16x32_bf16 v[20:23], a[92:95], a[28:31], v[20:23]
    v_mfma_f32_16x16x32_bf16 v[8:11], a[96:99], a[0:3], v[64:67]
    v_exp_f32 v2, v2
    v_mfma_f32_16x16x32_bf16 v[8:11], a[100:103], a[4:7], v[8:11]
    v_cvt_pk_bf16_f32 v0, v0, v1
    v_mfma_f32_16x16x32_bf16 v[8:11], a[104:107], a[8:11], v[8:11]
    v_exp_f32 v3, v3
    v_mfma_f32_16x16x32_bf16 v[8:11], a[108:111], a[12:15], v[8:11]
    buffer_load_dwordx4 v94, s[4:7], s23 offen offset:2048 lds
    v_mfma_f32_16x16x32_bf16 v[24:27], a[96:99], a[16:19], v[68:71]
    v_exp_f32 v16, v16
    v_mfma_f32_16x16x32_bf16 v[24:27], a[100:103], a[20:23], v[24:27]
    v_cvt_pk_bf16_f32 v1, v2, v3
    v_mfma_f32_16x16x32_bf16 v[24:27], a[104:107], a[24:27], v[24:27]
    v_exp_f32 v17, v17
    v_mfma_f32_16x16x32_bf16 v[24:27], a[108:111], a[28:31], v[24:27]
    s_waitcnt lgkmcnt(0)
    v_mfma_f32_16x16x32_bf16 v[12:15], a[112:115], a[0:3], v[64:67]
    v_exp_f32 v18, v18
    v_mfma_f32_16x16x32_bf16 v[12:15], a[116:119], a[4:7], v[12:15]
    buffer_load_dwordx4 v95, s[4:7], s23 offen offset:3072 lds
    v_cvt_pk_bf16_f32 v16, v16, v17
    v_mfma_f32_16x16x32_bf16 v[12:15], a[120:123], a[8:11], v[12:15]
    v_exp_f32 v19, v19
    v_mfma_f32_16x16x32_bf16 v[12:15], a[124:127], a[12:15], v[12:15]
    v_mfma_f32_16x16x32_bf16 v[28:31], a[112:115], a[16:19], v[68:71]
    v_exp_f32 v4, v4
    v_mfma_f32_16x16x32_bf16 v[28:31], a[116:119], a[20:23], v[28:31]
    v_cvt_pk_bf16_f32 v17, v18, v19
    v_mfma_f32_16x16x32_bf16 v[28:31], a[120:123], a[24:27], v[28:31]
    s_add_u32 m0, s24, 114688
    v_exp_f32 v5, v5
    v_mfma_f32_16x16x32_bf16 v[28:31], a[124:127], a[28:31], v[28:31]
    buffer_load_dwordx4 v96, s[8:11], s23 offen offset:0 lds
    v_mfma_f32_16x16x32_bf16 v[192:195], a[128:131], v[32:35], v[192:195]
    v_exp_f32 v6, v6
    v_mfma_f32_16x16x32_bf16 v[192:195], a[132:135], v[40:43], v[192:195]
    v_cvt_pk_bf16_f32 v2, v4, v5
    v_mfma_f32_16x16x32_bf16 v[224:227], a[128:131], v[48:51], v[224:227]
    v_exp_f32 v7, v7
    v_mfma_f32_16x16x32_bf16 v[224:227], a[132:135], v[56:59], v[224:227]
    v_mfma_f32_16x16x32_bf16 v[196:199], a[136:139], v[32:35], v[196:199]
    v_exp_f32 v20, v20
    v_mfma_f32_16x16x32_bf16 v[196:199], a[140:143], v[40:43], v[196:199]
    buffer_load_dwordx4 v97, s[8:11], s23 offen offset:1024 lds
    v_cvt_pk_bf16_f32 v3, v6, v7
    v_mfma_f32_16x16x32_bf16 v[228:231], a[136:139], v[48:51], v[228:231]
    v_exp_f32 v21, v21
    v_mfma_f32_16x16x32_bf16 v[228:231], a[140:143], v[56:59], v[228:231]
    ds_read_b64_tr_b16 a[128:129], v84 offset:16384
    v_mfma_f32_16x16x32_bf16 v[200:203], a[144:147], v[32:35], v[200:203]
    v_exp_f32 v22, v22
    v_mfma_f32_16x16x32_bf16 v[200:203], a[148:151], v[40:43], v[200:203]
    ds_read_b64_tr_b16 a[130:131], v84 offset:20480
    v_cvt_pk_bf16_f32 v18, v20, v21
    v_mfma_f32_16x16x32_bf16 v[232:235], a[144:147], v[48:51], v[232:235]
    v_exp_f32 v23, v23
    v_mfma_f32_16x16x32_bf16 v[232:235], a[148:151], v[56:59], v[232:235]
    buffer_load_dwordx4 v96, s[8:11], s23 offen offset:2048 lds
    v_mfma_f32_16x16x32_bf16 v[204:207], a[152:155], v[32:35], v[204:207]
    v_exp_f32 v8, v8
    v_mfma_f32_16x16x32_bf16 v[204:207], a[156:159], v[40:43], v[204:207]
    ds_read_b64_tr_b16 a[132:133], v84 offset:24576
    v_cvt_pk_bf16_f32 v19, v22, v23
    v_mfma_f32_16x16x32_bf16 v[236:239], a[152:155], v[48:51], v[236:239]
    v_exp_f32 v9, v9
    v_mfma_f32_16x16x32_bf16 v[236:239], a[156:159], v[56:59], v[236:239]
    ds_read_b64_tr_b16 a[134:135], v84 offset:28672
    v_mfma_f32_16x16x32_bf16 v[208:211], a[160:163], v[32:35], v[208:211]
    v_exp_f32 v10, v10
    v_mfma_f32_16x16x32_bf16 v[208:211], a[164:167], v[40:43], v[208:211]
    buffer_load_dwordx4 v97, s[8:11], s23 offen offset:3072 lds
    v_cvt_pk_bf16_f32 v8, v8, v9
    v_mfma_f32_16x16x32_bf16 v[240:243], a[160:163], v[48:51], v[240:243]
    v_exp_f32 v11, v11
    v_mfma_f32_16x16x32_bf16 v[240:243], a[164:167], v[56:59], v[240:243]
    ds_read_b64_tr_b16 a[136:137], v85 offset:16384
    v_mfma_f32_16x16x32_bf16 v[212:215], a[168:171], v[32:35], v[212:215]
    v_exp_f32 v24, v24
    v_mfma_f32_16x16x32_bf16 v[212:215], a[172:175], v[40:43], v[212:215]
    ds_read_b64_tr_b16 a[138:139], v85 offset:20480
    v_cvt_pk_bf16_f32 v9, v10, v11
    v_mfma_f32_16x16x32_bf16 v[244:247], a[168:171], v[48:51], v[244:247]
    v_exp_f32 v25, v25
    v_mfma_f32_16x16x32_bf16 v[244:247], a[172:175], v[56:59], v[244:247]
    ds_read_b64_tr_b16 a[140:141], v85 offset:24576
    v_mfma_f32_16x16x32_bf16 v[216:219], a[176:179], v[32:35], v[216:219]
    v_exp_f32 v26, v26
    v_mfma_f32_16x16x32_bf16 v[216:219], a[180:183], v[40:43], v[216:219]
    ds_read_b64_tr_b16 a[142:143], v85 offset:28672
    v_cvt_pk_bf16_f32 v24, v24, v25
    v_mfma_f32_16x16x32_bf16 v[248:251], a[176:179], v[48:51], v[248:251]
    v_exp_f32 v27, v27
    v_mfma_f32_16x16x32_bf16 v[248:251], a[180:183], v[56:59], v[248:251]
    ds_read_b64_tr_b16 a[144:145], v86 offset:16384
    v_mfma_f32_16x16x32_bf16 v[220:223], a[184:187], v[32:35], v[220:223]
    v_exp_f32 v12, v12
    v_mfma_f32_16x16x32_bf16 v[220:223], a[188:191], v[40:43], v[220:223]
    ds_read_b64_tr_b16 a[146:147], v86 offset:20480
    v_cvt_pk_bf16_f32 v25, v26, v27
    v_mfma_f32_16x16x32_bf16 v[252:255], a[184:187], v[48:51], v[252:255]
    v_exp_f32 v13, v13
    v_mfma_f32_16x16x32_bf16 v[252:255], a[188:191], v[56:59], v[252:255]
    ds_read_b64_tr_b16 a[148:149], v86 offset:24576
    v_mfma_f32_16x16x32_bf16 a[200:203], a[208:211], v[32:35], a[200:203]
    v_exp_f32 v14, v14
    v_mfma_f32_16x16x32_bf16 a[200:203], a[208:211], v[40:43], a[200:203]
    ds_read_b64_tr_b16 a[150:151], v86 offset:28672
    v_cvt_pk_bf16_f32 v10, v12, v13
    v_mfma_f32_16x16x32_bf16 a[204:207], a[208:211], v[48:51], a[204:207]
    v_exp_f32 v15, v15
    v_mfma_f32_16x16x32_bf16 a[204:207], a[208:211], v[56:59], a[204:207]
    ds_read_b64_tr_b16 a[152:153], v87 offset:16384
    v_mfma_f32_16x16x32_bf16 v[32:35], a[64:67], a[32:35], v[72:75]
    v_exp_f32 v28, v28
    v_mfma_f32_16x16x32_bf16 v[32:35], a[68:71], a[36:39], v[32:35]
    ds_read_b64_tr_b16 a[154:155], v87 offset:20480
    v_cvt_pk_bf16_f32 v11, v14, v15
    v_mfma_f32_16x16x32_bf16 v[32:35], a[72:75], a[40:43], v[32:35]
    v_exp_f32 v29, v29
    v_mfma_f32_16x16x32_bf16 v[32:35], a[76:79], a[44:47], v[32:35]
    ds_read_b64_tr_b16 a[156:157], v87 offset:24576
    v_mfma_f32_16x16x32_bf16 v[48:51], a[64:67], a[48:51], v[76:79]
    v_exp_f32 v30, v30
    v_mfma_f32_16x16x32_bf16 v[48:51], a[68:71], a[52:55], v[48:51]
    ds_read_b64_tr_b16 a[158:159], v87 offset:28672
    v_cvt_pk_bf16_f32 v26, v28, v29
    v_mfma_f32_16x16x32_bf16 v[48:51], a[72:75], a[56:59], v[48:51]
    v_exp_f32 v31, v31
    v_mfma_f32_16x16x32_bf16 v[48:51], a[76:79], a[60:63], v[48:51]
    ds_read_b64_tr_b16 a[160:161], v88 offset:16384
    v_mfma_f32_16x16x32_bf16 v[36:39], a[80:83], a[32:35], v[72:75]
    ds_read_b64_tr_b16 a[162:163], v88 offset:20480
    v_mfma_f32_16x16x32_bf16 v[36:39], a[84:87], a[36:39], v[36:39]
    ds_read_b64_tr_b16 a[164:165], v88 offset:24576
    v_cvt_pk_bf16_f32 v27, v30, v31
    v_mfma_f32_16x16x32_bf16 v[36:39], a[88:91], a[40:43], v[36:39]
    ds_read_b64_tr_b16 a[166:167], v88 offset:28672
    v_mfma_f32_16x16x32_bf16 v[36:39], a[92:95], a[44:47], v[36:39]
    ds_read_b64_tr_b16 a[168:169], v89 offset:16384
    v_mfma_f32_16x16x32_bf16 v[52:55], a[80:83], a[48:51], v[76:79]
    v_exp_f32 v32, v32
    v_mfma_f32_16x16x32_bf16 v[52:55], a[84:87], a[52:55], v[52:55]
    ds_read_b64_tr_b16 a[170:171], v89 offset:20480
    v_mfma_f32_16x16x32_bf16 v[52:55], a[88:91], a[56:59], v[52:55]
    v_exp_f32 v33, v33
    v_mfma_f32_16x16x32_bf16 v[52:55], a[92:95], a[60:63], v[52:55]
    ds_read_b64_tr_b16 a[172:173], v89 offset:24576
    v_mfma_f32_16x16x32_bf16 v[40:43], a[96:99], a[32:35], v[72:75]
    v_exp_f32 v34, v34
    v_mfma_f32_16x16x32_bf16 v[40:43], a[100:103], a[36:39], v[40:43]
    ds_read_b64_tr_b16 a[174:175], v89 offset:28672
    v_cvt_pk_bf16_f32 v32, v32, v33
    v_mfma_f32_16x16x32_bf16 v[40:43], a[104:107], a[40:43], v[40:43]
    v_exp_f32 v35, v35
    v_mfma_f32_16x16x32_bf16 v[40:43], a[108:111], a[44:47], v[40:43]
    ds_read_b64_tr_b16 a[176:177], v90 offset:16384
    v_mfma_f32_16x16x32_bf16 v[56:59], a[96:99], a[48:51], v[76:79]
    v_exp_f32 v48, v48
    v_mfma_f32_16x16x32_bf16 v[56:59], a[100:103], a[52:55], v[56:59]
    ds_read_b64_tr_b16 a[178:179], v90 offset:20480
    v_cvt_pk_bf16_f32 v33, v34, v35
    v_mfma_f32_16x16x32_bf16 v[56:59], a[104:107], a[56:59], v[56:59]
    v_exp_f32 v49, v49
    v_mfma_f32_16x16x32_bf16 v[56:59], a[108:111], a[60:63], v[56:59]
    ds_read_b64_tr_b16 a[180:181], v90 offset:24576
    v_mfma_f32_16x16x32_bf16 v[44:47], a[112:115], a[32:35], v[72:75]
    v_exp_f32 v50, v50
    v_mfma_f32_16x16x32_bf16 v[44:47], a[116:119], a[36:39], v[44:47]
    ds_read_b64_tr_b16 a[182:183], v90 offset:28672
    v_cvt_pk_bf16_f32 v48, v48, v49
    v_mfma_f32_16x16x32_bf16 v[44:47], a[120:123], a[40:43], v[44:47]
    v_exp_f32 v51, v51
    v_mfma_f32_16x16x32_bf16 v[44:47], a[124:127], a[44:47], v[44:47]
    ds_read_b64_tr_b16 a[184:185], v91 offset:16384
    v_mfma_f32_16x16x32_bf16 v[60:63], a[112:115], a[48:51], v[76:79]
    v_exp_f32 v36, v36
    v_mfma_f32_16x16x32_bf16 v[60:63], a[116:119], a[52:55], v[60:63]
    ds_read_b64_tr_b16 a[186:187], v91 offset:20480
    v_cvt_pk_bf16_f32 v49, v50, v51
    v_mfma_f32_16x16x32_bf16 v[60:63], a[120:123], a[56:59], v[60:63]
    v_exp_f32 v37, v37
    v_mfma_f32_16x16x32_bf16 v[60:63], a[124:127], a[60:63], v[60:63]
    ds_read_b64_tr_b16 a[188:189], v91 offset:24576
    s_waitcnt lgkmcnt(5)
    v_mfma_f32_16x16x32_bf16 v[128:131], a[128:131], v[0:3], v[128:131]
    v_exp_f32 v38, v38
    v_mfma_f32_16x16x32_bf16 v[128:131], a[132:135], v[8:11], v[128:131]
    ds_read_b64_tr_b16 a[190:191], v91 offset:28672
    v_cvt_pk_bf16_f32 v34, v36, v37
    v_mfma_f32_16x16x32_bf16 v[160:163], a[128:131], v[16:19], v[160:163]
    v_exp_f32 v39, v39
    v_mfma_f32_16x16x32_bf16 v[160:163], a[132:135], v[24:27], v[160:163]
    ds_read_b128 a[64:67], v80 offset:16384
    v_mfma_f32_16x16x32_bf16 v[132:135], a[136:139], v[0:3], v[132:135]
    v_exp_f32 v52, v52
    v_mfma_f32_16x16x32_bf16 v[132:135], a[140:143], v[8:11], v[132:135]
    ds_read_b128 a[68:71], v81 offset:16384
    v_cvt_pk_bf16_f32 v35, v38, v39
    v_mfma_f32_16x16x32_bf16 v[164:167], a[136:139], v[16:19], v[164:167]
    v_exp_f32 v53, v53
    v_mfma_f32_16x16x32_bf16 v[164:167], a[140:143], v[24:27], v[164:167]
    ds_read_b128 a[72:75], v82 offset:16384
    v_mfma_f32_16x16x32_bf16 v[136:139], a[144:147], v[0:3], v[136:139]
    v_exp_f32 v54, v54
    v_mfma_f32_16x16x32_bf16 v[136:139], a[148:151], v[8:11], v[136:139]
    ds_read_b128 a[76:79], v83 offset:16384
    v_cvt_pk_bf16_f32 v50, v52, v53
    v_mfma_f32_16x16x32_bf16 v[168:171], a[144:147], v[16:19], v[168:171]
    v_exp_f32 v55, v55
    v_mfma_f32_16x16x32_bf16 v[168:171], a[148:151], v[24:27], v[168:171]
    ds_read_b128 a[80:83], v80 offset:20480
    v_mfma_f32_16x16x32_bf16 v[140:143], a[152:155], v[0:3], v[140:143]
    v_exp_f32 v40, v40
    v_mfma_f32_16x16x32_bf16 v[140:143], a[156:159], v[8:11], v[140:143]
    ds_read_b128 a[84:87], v81 offset:20480
    v_cvt_pk_bf16_f32 v51, v54, v55
    v_mfma_f32_16x16x32_bf16 v[172:175], a[152:155], v[16:19], v[172:175]
    v_exp_f32 v41, v41
    v_mfma_f32_16x16x32_bf16 v[172:175], a[156:159], v[24:27], v[172:175]
    ds_read_b128 a[88:91], v82 offset:20480
    v_mfma_f32_16x16x32_bf16 v[144:147], a[160:163], v[0:3], v[144:147]
    v_exp_f32 v42, v42
    v_mfma_f32_16x16x32_bf16 v[144:147], a[164:167], v[8:11], v[144:147]
    ds_read_b128 a[92:95], v83 offset:20480
    v_cvt_pk_bf16_f32 v40, v40, v41
    v_mfma_f32_16x16x32_bf16 v[176:179], a[160:163], v[16:19], v[176:179]
    v_exp_f32 v43, v43
    v_mfma_f32_16x16x32_bf16 v[176:179], a[164:167], v[24:27], v[176:179]
    ds_read_b128 a[96:99], v80 offset:24576
    v_mfma_f32_16x16x32_bf16 v[148:151], a[168:171], v[0:3], v[148:151]
    v_exp_f32 v56, v56
    v_mfma_f32_16x16x32_bf16 v[148:151], a[172:175], v[8:11], v[148:151]
    ds_read_b128 a[100:103], v81 offset:24576
    v_cvt_pk_bf16_f32 v41, v42, v43
    v_mfma_f32_16x16x32_bf16 v[180:183], a[168:171], v[16:19], v[180:183]
    v_exp_f32 v57, v57
    v_mfma_f32_16x16x32_bf16 v[180:183], a[172:175], v[24:27], v[180:183]
    ds_read_b128 a[104:107], v82 offset:24576
    v_mfma_f32_16x16x32_bf16 v[152:155], a[176:179], v[0:3], v[152:155]
    s_waitcnt lgkmcnt(4)
    v_exp_f32 v58, v58
    v_mfma_f32_16x16x32_bf16 v[152:155], a[180:183], v[8:11], v[152:155]
    ds_read_b128 a[108:111], v83 offset:24576
    v_cvt_pk_bf16_f32 v56, v56, v57
    v_mfma_f32_16x16x32_bf16 v[184:187], a[176:179], v[16:19], v[184:187]
    v_exp_f32 v59, v59
    v_mfma_f32_16x16x32_bf16 v[184:187], a[180:183], v[24:27], v[184:187]
    ds_read_b128 a[112:115], v80 offset:28672
    v_mfma_f32_16x16x32_bf16 v[156:159], a[184:187], v[0:3], v[156:159]
    v_exp_f32 v44, v44
    v_mfma_f32_16x16x32_bf16 v[156:159], a[188:191], v[8:11], v[156:159]
    ds_read_b128 a[116:119], v81 offset:28672
    v_cvt_pk_bf16_f32 v57, v58, v59
    v_mfma_f32_16x16x32_bf16 v[188:191], a[184:187], v[16:19], v[188:191]
    v_exp_f32 v45, v45
    v_mfma_f32_16x16x32_bf16 v[188:191], a[188:191], v[24:27], v[188:191]
    ds_read_b128 a[120:123], v82 offset:28672
    v_mfma_f32_16x16x32_bf16 a[192:195], a[208:211], v[0:3], a[192:195]
    v_exp_f32 v46, v46
    v_mfma_f32_16x16x32_bf16 a[192:195], a[208:211], v[8:11], a[192:195]
    ds_read_b128 a[124:127], v83 offset:28672
    v_cvt_pk_bf16_f32 v42, v44, v45
    v_mfma_f32_16x16x32_bf16 a[196:199], a[208:211], v[16:19], a[196:199]
    v_exp_f32 v47, v47
    v_mfma_f32_16x16x32_bf16 a[196:199], a[208:211], v[24:27], a[196:199]
    s_add_u32 s23, s23, 16384
    s_waitcnt lgkmcnt(4)
    v_mfma_f32_16x16x32_bf16 v[0:3], a[64:67], a[0:3], v[64:67]
    v_exp_f32 v60, v60
    v_mfma_f32_16x16x32_bf16 v[0:3], a[68:71], a[4:7], v[0:3]
    s_waitcnt vmcnt(8)
    v_cvt_pk_bf16_f32 v43, v46, v47
    v_mfma_f32_16x16x32_bf16 v[0:3], a[72:75], a[8:11], v[0:3]
    s_barrier
    v_exp_f32 v61, v61
    v_mfma_f32_16x16x32_bf16 v[0:3], a[76:79], a[12:15], v[0:3]
    v_mfma_f32_16x16x32_bf16 v[16:19], a[64:67], a[16:19], v[68:71]
    v_exp_f32 v62, v62
    v_mfma_f32_16x16x32_bf16 v[16:19], a[68:71], a[20:23], v[16:19]
    v_cvt_pk_bf16_f32 v58, v60, v61
    v_mfma_f32_16x16x32_bf16 v[16:19], a[72:75], a[24:27], v[16:19]
    s_add_u32 m0, s24, 0
    v_exp_f32 v63, v63
    v_mfma_f32_16x16x32_bf16 v[16:19], a[76:79], a[28:31], v[16:19]
    buffer_load_dwordx4 v92, s[4:7], s23 offen offset:0 lds
    v_mfma_f32_16x16x32_bf16 v[4:7], a[80:83], a[0:3], v[64:67]
    v_mfma_f32_16x16x32_bf16 v[4:7], a[84:87], a[4:7], v[4:7]
    v_cvt_pk_bf16_f32 v59, v62, v63
    v_mfma_f32_16x16x32_bf16 v[4:7], a[88:91], a[8:11], v[4:7]
    v_mfma_f32_16x16x32_bf16 v[4:7], a[92:95], a[12:15], v[4:7]
    v_mfma_f32_16x16x32_bf16 v[20:23], a[80:83], a[16:19], v[68:71]
    v_exp_f32 v0, v0
    v_mfma_f32_16x16x32_bf16 v[20:23], a[84:87], a[20:23], v[20:23]
    buffer_load_dwordx4 v93, s[4:7], s23 offen offset:1024 lds
    v_mfma_f32_16x16x32_bf16 v[20:23], a[88:91], a[24:27], v[20:23]
    v_exp_f32 v1, v1
    v_mfma_f32_16x16x32_bf16 v[20:23], a[92:95], a[28:31], v[20:23]
    v_mfma_f32_16x16x32_bf16 v[8:11], a[96:99], a[0:3], v[64:67]
    v_exp_f32 v2, v2
    v_mfma_f32_16x16x32_bf16 v[8:11], a[100:103], a[4:7], v[8:11]
    v_cvt_pk_bf16_f32 v0, v0, v1
    v_mfma_f32_16x16x32_bf16 v[8:11], a[104:107], a[8:11], v[8:11]
    v_exp_f32 v3, v3
    v_mfma_f32_16x16x32_bf16 v[8:11], a[108:111], a[12:15], v[8:11]
    buffer_load_dwordx4 v94, s[4:7], s23 offen offset:2048 lds
    v_mfma_f32_16x16x32_bf16 v[24:27], a[96:99], a[16:19], v[68:71]
    v_exp_f32 v16, v16
    v_mfma_f32_16x16x32_bf16 v[24:27], a[100:103], a[20:23], v[24:27]
    v_cvt_pk_bf16_f32 v1, v2, v3
    v_mfma_f32_16x16x32_bf16 v[24:27], a[104:107], a[24:27], v[24:27]
    v_exp_f32 v17, v17
    v_mfma_f32_16x16x32_bf16 v[24:27], a[108:111], a[28:31], v[24:27]
    s_waitcnt lgkmcnt(0)
    v_mfma_f32_16x16x32_bf16 v[12:15], a[112:115], a[0:3], v[64:67]
    v_exp_f32 v18, v18
    v_mfma_f32_16x16x32_bf16 v[12:15], a[116:119], a[4:7], v[12:15]
    buffer_load_dwordx4 v95, s[4:7], s23 offen offset:3072 lds
    v_cvt_pk_bf16_f32 v16, v16, v17
    v_mfma_f32_16x16x32_bf16 v[12:15], a[120:123], a[8:11], v[12:15]
    v_exp_f32 v19, v19
    v_mfma_f32_16x16x32_bf16 v[12:15], a[124:127], a[12:15], v[12:15]
    v_mfma_f32_16x16x32_bf16 v[28:31], a[112:115], a[16:19], v[68:71]
    v_exp_f32 v4, v4
    v_mfma_f32_16x16x32_bf16 v[28:31], a[116:119], a[20:23], v[28:31]
    v_cvt_pk_bf16_f32 v17, v18, v19
    v_mfma_f32_16x16x32_bf16 v[28:31], a[120:123], a[24:27], v[28:31]
    s_add_u32 m0, s24, 65536
    v_exp_f32 v5, v5
    v_mfma_f32_16x16x32_bf16 v[28:31], a[124:127], a[28:31], v[28:31]
    buffer_load_dwordx4 v96, s[8:11], s23 offen offset:0 lds
    v_mfma_f32_16x16x32_bf16 v[192:195], a[128:131], v[32:35], v[192:195]
    v_exp_f32 v6, v6
    v_mfma_f32_16x16x32_bf16 v[192:195], a[132:135], v[40:43], v[192:195]
    v_cvt_pk_bf16_f32 v2, v4, v5
    v_mfma_f32_16x16x32_bf16 v[224:227], a[128:131], v[48:51], v[224:227]
    v_exp_f32 v7, v7
    v_mfma_f32_16x16x32_bf16 v[224:227], a[132:135], v[56:59], v[224:227]
    v_mfma_f32_16x16x32_bf16 v[196:199], a[136:139], v[32:35], v[196:199]
    v_exp_f32 v20, v20
    v_mfma_f32_16x16x32_bf16 v[196:199], a[140:143], v[40:43], v[196:199]
    buffer_load_dwordx4 v97, s[8:11], s23 offen offset:1024 lds
    v_cvt_pk_bf16_f32 v3, v6, v7
    v_mfma_f32_16x16x32_bf16 v[228:231], a[136:139], v[48:51], v[228:231]
    v_exp_f32 v21, v21
    v_mfma_f32_16x16x32_bf16 v[228:231], a[140:143], v[56:59], v[228:231]
    ds_read_b64_tr_b16 a[128:129], v84 offset:32768
    v_mfma_f32_16x16x32_bf16 v[200:203], a[144:147], v[32:35], v[200:203]
    v_exp_f32 v22, v22
    v_mfma_f32_16x16x32_bf16 v[200:203], a[148:151], v[40:43], v[200:203]
    ds_read_b64_tr_b16 a[130:131], v84 offset:36864
    v_cvt_pk_bf16_f32 v18, v20, v21
    v_mfma_f32_16x16x32_bf16 v[232:235], a[144:147], v[48:51], v[232:235]
    v_exp_f32 v23, v23
    v_mfma_f32_16x16x32_bf16 v[232:235], a[148:151], v[56:59], v[232:235]
    buffer_load_dwordx4 v96, s[8:11], s23 offen offset:2048 lds
    v_mfma_f32_16x16x32_bf16 v[204:207], a[152:155], v[32:35], v[204:207]
    v_exp_f32 v8, v8
    v_mfma_f32_16x16x32_bf16 v[204:207], a[156:159], v[40:43], v[204:207]
    ds_read_b64_tr_b16 a[132:133], v84 offset:40960
    v_cvt_pk_bf16_f32 v19, v22, v23
    v_mfma_f32_16x16x32_bf16 v[236:239], a[152:155], v[48:51], v[236:239]
    v_exp_f32 v9, v9
    v_mfma_f32_16x16x32_bf16 v[236:239], a[156:159], v[56:59], v[236:239]
    ds_read_b64_tr_b16 a[134:135], v84 offset:45056
    v_mfma_f32_16x16x32_bf16 v[208:211], a[160:163], v[32:35], v[208:211]
    v_exp_f32 v10, v10
    v_mfma_f32_16x16x32_bf16 v[208:211], a[164:167], v[40:43], v[208:211]
    buffer_load_dwordx4 v97, s[8:11], s23 offen offset:3072 lds
    v_cvt_pk_bf16_f32 v8, v8, v9
    v_mfma_f32_16x16x32_bf16 v[240:243], a[160:163], v[48:51], v[240:243]
    v_exp_f32 v11, v11
    v_mfma_f32_16x16x32_bf16 v[240:243], a[164:167], v[56:59], v[240:243]
    ds_read_b64_tr_b16 a[136:137], v85 offset:32768
    v_mfma_f32_16x16x32_bf16 v[212:215], a[168:171], v[32:35], v[212:215]
    v_exp_f32 v24, v24
    v_mfma_f32_16x16x32_bf16 v[212:215], a[172:175], v[40:43], v[212:215]
    ds_read_b64_tr_b16 a[138:139], v85 offset:36864
    v_cvt_pk_bf16_f32 v9, v10, v11
    v_mfma_f32_16x16x32_bf16 v[244:247], a[168:171], v[48:51], v[244:247]
    v_exp_f32 v25, v25
    v_mfma_f32_16x16x32_bf16 v[244:247], a[172:175], v[56:59], v[244:247]
    ds_read_b64_tr_b16 a[140:141], v85 offset:40960
    v_mfma_f32_16x16x32_bf16 v[216:219], a[176:179], v[32:35], v[216:219]
    v_exp_f32 v26, v26
    v_mfma_f32_16x16x32_bf16 v[216:219], a[180:183], v[40:43], v[216:219]
    ds_read_b64_tr_b16 a[142:143], v85 offset:45056
    v_cvt_pk_bf16_f32 v24, v24, v25
    v_mfma_f32_16x16x32_bf16 v[248:251], a[176:179], v[48:51], v[248:251]
    v_exp_f32 v27, v27
    v_mfma_f32_16x16x32_bf16 v[248:251], a[180:183], v[56:59], v[248:251]
    ds_read_b64_tr_b16 a[144:145], v86 offset:32768
    v_mfma_f32_16x16x32_bf16 v[220:223], a[184:187], v[32:35], v[220:223]
    v_exp_f32 v12, v12
    v_mfma_f32_16x16x32_bf16 v[220:223], a[188:191], v[40:43], v[220:223]
    ds_read_b64_tr_b16 a[146:147], v86 offset:36864
    v_cvt_pk_bf16_f32 v25, v26, v27
    v_mfma_f32_16x16x32_bf16 v[252:255], a[184:187], v[48:51], v[252:255]
    v_exp_f32 v13, v13
    v_mfma_f32_16x16x32_bf16 v[252:255], a[188:191], v[56:59], v[252:255]
    ds_read_b64_tr_b16 a[148:149], v86 offset:40960
    v_mfma_f32_16x16x32_bf16 a[200:203], a[208:211], v[32:35], a[200:203]
    v_exp_f32 v14, v14
    v_mfma_f32_16x16x32_bf16 a[200:203], a[208:211], v[40:43], a[200:203]
    ds_read_b64_tr_b16 a[150:151], v86 offset:45056
    v_cvt_pk_bf16_f32 v10, v12, v13
    v_mfma_f32_16x16x32_bf16 a[204:207], a[208:211], v[48:51], a[204:207]
    v_exp_f32 v15, v15
    v_mfma_f32_16x16x32_bf16 a[204:207], a[208:211], v[56:59], a[204:207]
    ds_read_b64_tr_b16 a[152:153], v87 offset:32768
    v_mfma_f32_16x16x32_bf16 v[32:35], a[64:67], a[32:35], v[72:75]
    v_exp_f32 v28, v28
    v_mfma_f32_16x16x32_bf16 v[32:35], a[68:71], a[36:39], v[32:35]
    ds_read_b64_tr_b16 a[154:155], v87 offset:36864
    v_cvt_pk_bf16_f32 v11, v14, v15
    v_mfma_f32_16x16x32_bf16 v[32:35], a[72:75], a[40:43], v[32:35]
    v_exp_f32 v29, v29
    v_mfma_f32_16x16x32_bf16 v[32:35], a[76:79], a[44:47], v[32:35]
    ds_read_b64_tr_b16 a[156:157], v87 offset:40960
    v_mfma_f32_16x16x32_bf16 v[48:51], a[64:67], a[48:51], v[76:79]
    v_exp_f32 v30, v30
    v_mfma_f32_16x16x32_bf16 v[48:51], a[68:71], a[52:55], v[48:51]
    ds_read_b64_tr_b16 a[158:159], v87 offset:45056
    v_cvt_pk_bf16_f32 v26, v28, v29
    v_mfma_f32_16x16x32_bf16 v[48:51], a[72:75], a[56:59], v[48:51]
    v_exp_f32 v31, v31
    v_mfma_f32_16x16x32_bf16 v[48:51], a[76:79], a[60:63], v[48:51]
    ds_read_b64_tr_b16 a[160:161], v88 offset:32768
    v_mfma_f32_16x16x32_bf16 v[36:39], a[80:83], a[32:35], v[72:75]
    ds_read_b64_tr_b16 a[162:163], v88 offset:36864
    v_mfma_f32_16x16x32_bf16 v[36:39], a[84:87], a[36:39], v[36:39]
    ds_read_b64_tr_b16 a[164:165], v88 offset:40960
    v_cvt_pk_bf16_f32 v27, v30, v31
    v_mfma_f32_16x16x32_bf16 v[36:39], a[88:91], a[40:43], v[36:39]
    ds_read_b64_tr_b16 a[166:167], v88 offset:45056
    v_mfma_f32_16x16x32_bf16 v[36:39], a[92:95], a[44:47], v[36:39]
    ds_read_b64_tr_b16 a[168:169], v89 offset:32768
    v_mfma_f32_16x16x32_bf16 v[52:55], a[80:83], a[48:51], v[76:79]
    v_exp_f32 v32, v32
    v_mfma_f32_16x16x32_bf16 v[52:55], a[84:87], a[52:55], v[52:55]
    ds_read_b64_tr_b16 a[170:171], v89 offset:36864
    v_mfma_f32_16x16x32_bf16 v[52:55], a[88:91], a[56:59], v[52:55]
    v_exp_f32 v33, v33
    v_mfma_f32_16x16x32_bf16 v[52:55], a[92:95], a[60:63], v[52:55]
    ds_read_b64_tr_b16 a[172:173], v89 offset:40960
    v_mfma_f32_16x16x32_bf16 v[40:43], a[96:99], a[32:35], v[72:75]
    v_exp_f32 v34, v34
    v_mfma_f32_16x16x32_bf16 v[40:43], a[100:103], a[36:39], v[40:43]
    ds_read_b64_tr_b16 a[174:175], v89 offset:45056
    v_cvt_pk_bf16_f32 v32, v32, v33
    v_mfma_f32_16x16x32_bf16 v[40:43], a[104:107], a[40:43], v[40:43]
    v_exp_f32 v35, v35
    v_mfma_f32_16x16x32_bf16 v[40:43], a[108:111], a[44:47], v[40:43]
    ds_read_b64_tr_b16 a[176:177], v90 offset:32768
    v_mfma_f32_16x16x32_bf16 v[56:59], a[96:99], a[48:51], v[76:79]
    v_exp_f32 v48, v48
    v_mfma_f32_16x16x32_bf16 v[56:59], a[100:103], a[52:55], v[56:59]
    ds_read_b64_tr_b16 a[178:179], v90 offset:36864
    v_cvt_pk_bf16_f32 v33, v34, v35
    v_mfma_f32_16x16x32_bf16 v[56:59], a[104:107], a[56:59], v[56:59]
    v_exp_f32 v49, v49
    v_mfma_f32_16x16x32_bf16 v[56:59], a[108:111], a[60:63], v[56:59]
    ds_read_b64_tr_b16 a[180:181], v90 offset:40960
    v_mfma_f32_16x16x32_bf16 v[44:47], a[112:115], a[32:35], v[72:75]
    v_exp_f32 v50, v50
    v_mfma_f32_16x16x32_bf16 v[44:47], a[116:119], a[36:39], v[44:47]
    ds_read_b64_tr_b16 a[182:183], v90 offset:45056
    v_cvt_pk_bf16_f32 v48, v48, v49
    v_mfma_f32_16x16x32_bf16 v[44:47], a[120:123], a[40:43], v[44:47]
    v_exp_f32 v51, v51
    v_mfma_f32_16x16x32_bf16 v[44:47], a[124:127], a[44:47], v[44:47]
    ds_read_b64_tr_b16 a[184:185], v91 offset:32768
    v_mfma_f32_16x16x32_bf16 v[60:63], a[112:115], a[48:51], v[76:79]
    v_exp_f32 v36, v36
    v_mfma_f32_16x16x32_bf16 v[60:63], a[116:119], a[52:55], v[60:63]
    ds_read_b64_tr_b16 a[186:187], v91 offset:36864
    v_cvt_pk_bf16_f32 v49, v50, v51
    v_mfma_f32_16x16x32_bf16 v[60:63], a[120:123], a[56:59], v[60:63]
    v_exp_f32 v37, v37
    v_mfma_f32_16x16x32_bf16 v[60:63], a[124:127], a[60:63], v[60:63]
    ds_read_b64_tr_b16 a[188:189], v91 offset:40960
    s_waitcnt lgkmcnt(5)
    v_mfma_f32_16x16x32_bf16 v[128:131], a[128:131], v[0:3], v[128:131]
    v_exp_f32 v38, v38
    v_mfma_f32_16x16x32_bf16 v[128:131], a[132:135], v[8:11], v[128:131]
    ds_read_b64_tr_b16 a[190:191], v91 offset:45056
    v_cvt_pk_bf16_f32 v34, v36, v37
    v_mfma_f32_16x16x32_bf16 v[160:163], a[128:131], v[16:19], v[160:163]
    v_exp_f32 v39, v39
    v_mfma_f32_16x16x32_bf16 v[160:163], a[132:135], v[24:27], v[160:163]
    ds_read_b128 a[64:67], v80 offset:32768
    v_mfma_f32_16x16x32_bf16 v[132:135], a[136:139], v[0:3], v[132:135]
    v_exp_f32 v52, v52
    v_mfma_f32_16x16x32_bf16 v[132:135], a[140:143], v[8:11], v[132:135]
    ds_read_b128 a[68:71], v81 offset:32768
    v_cvt_pk_bf16_f32 v35, v38, v39
    v_mfma_f32_16x16x32_bf16 v[164:167], a[136:139], v[16:19], v[164:167]
    v_exp_f32 v53, v53
    v_mfma_f32_16x16x32_bf16 v[164:167], a[140:143], v[24:27], v[164:167]
    ds_read_b128 a[72:75], v82 offset:32768
    v_mfma_f32_16x16x32_bf16 v[136:139], a[144:147], v[0:3], v[136:139]
    v_exp_f32 v54, v54
    v_mfma_f32_16x16x32_bf16 v[136:139], a[148:151], v[8:11], v[136:139]
    ds_read_b128 a[76:79], v83 offset:32768
    v_cvt_pk_bf16_f32 v50, v52, v53
    v_mfma_f32_16x16x32_bf16 v[168:171], a[144:147], v[16:19], v[168:171]
    v_exp_f32 v55, v55
    v_mfma_f32_16x16x32_bf16 v[168:171], a[148:151], v[24:27], v[168:171]
    ds_read_b128 a[80:83], v80 offset:36864
    v_mfma_f32_16x16x32_bf16 v[140:143], a[152:155], v[0:3], v[140:143]
    v_exp_f32 v40, v40
    v_mfma_f32_16x16x32_bf16 v[140:143], a[156:159], v[8:11], v[140:143]
    ds_read_b128 a[84:87], v81 offset:36864
    v_cvt_pk_bf16_f32 v51, v54, v55
    v_mfma_f32_16x16x32_bf16 v[172:175], a[152:155], v[16:19], v[172:175]
    v_exp_f32 v41, v41
    v_mfma_f32_16x16x32_bf16 v[172:175], a[156:159], v[24:27], v[172:175]
    ds_read_b128 a[88:91], v82 offset:36864
    v_mfma_f32_16x16x32_bf16 v[144:147], a[160:163], v[0:3], v[144:147]
    v_exp_f32 v42, v42
    v_mfma_f32_16x16x32_bf16 v[144:147], a[164:167], v[8:11], v[144:147]
    ds_read_b128 a[92:95], v83 offset:36864
    v_cvt_pk_bf16_f32 v40, v40, v41
    v_mfma_f32_16x16x32_bf16 v[176:179], a[160:163], v[16:19], v[176:179]
    v_exp_f32 v43, v43
    v_mfma_f32_16x16x32_bf16 v[176:179], a[164:167], v[24:27], v[176:179]
    ds_read_b128 a[96:99], v80 offset:40960
    v_mfma_f32_16x16x32_bf16 v[148:151], a[168:171], v[0:3], v[148:151]
    v_exp_f32 v56, v56
    v_mfma_f32_16x16x32_bf16 v[148:151], a[172:175], v[8:11], v[148:151]
    ds_read_b128 a[100:103], v81 offset:40960
    v_cvt_pk_bf16_f32 v41, v42, v43
    v_mfma_f32_16x16x32_bf16 v[180:183], a[168:171], v[16:19], v[180:183]
    v_exp_f32 v57, v57
    v_mfma_f32_16x16x32_bf16 v[180:183], a[172:175], v[24:27], v[180:183]
    ds_read_b128 a[104:107], v82 offset:40960
    v_mfma_f32_16x16x32_bf16 v[152:155], a[176:179], v[0:3], v[152:155]
    s_waitcnt lgkmcnt(4)
    v_exp_f32 v58, v58
    v_mfma_f32_16x16x32_bf16 v[152:155], a[180:183], v[8:11], v[152:155]
    ds_read_b128 a[108:111], v83 offset:40960
    v_cvt_pk_bf16_f32 v56, v56, v57
    v_mfma_f32_16x16x32_bf16 v[184:187], a[176:179], v[16:19], v[184:187]
    v_exp_f32 v59, v59
    v_mfma_f32_16x16x32_bf16 v[184:187], a[180:183], v[24:27], v[184:187]
    ds_read_b128 a[112:115], v80 offset:45056
    v_mfma_f32_16x16x32_bf16 v[156:159], a[184:187], v[0:3], v[156:159]
    v_exp_f32 v44, v44
    v_mfma_f32_16x16x32_bf16 v[156:159], a[188:191], v[8:11], v[156:159]
    ds_read_b128 a[116:119], v81 offset:45056
    v_cvt_pk_bf16_f32 v57, v58, v59
    v_mfma_f32_16x16x32_bf16 v[188:191], a[184:187], v[16:19], v[188:191]
    v_exp_f32 v45, v45
    v_mfma_f32_16x16x32_bf16 v[188:191], a[188:191], v[24:27], v[188:191]
    ds_read_b128 a[120:123], v82 offset:45056
    v_mfma_f32_16x16x32_bf16 a[192:195], a[208:211], v[0:3], a[192:195]
    v_exp_f32 v46, v46
    v_mfma_f32_16x16x32_bf16 a[192:195], a[208:211], v[8:11], a[192:195]
    ds_read_b128 a[124:127], v83 offset:45056
    v_cvt_pk_bf16_f32 v42, v44, v45
    v_mfma_f32_16x16x32_bf16 a[196:199], a[208:211], v[16:19], a[196:199]
    v_exp_f32 v47, v47
    v_mfma_f32_16x16x32_bf16 a[196:199], a[208:211], v[24:27], a[196:199]
    s_add_u32 s23, s23, 16384
    s_waitcnt lgkmcnt(4)
    v_mfma_f32_16x16x32_bf16 v[0:3], a[64:67], a[0:3], v[64:67]
    v_exp_f32 v60, v60
    v_mfma_f32_16x16x32_bf16 v[0:3], a[68:71], a[4:7], v[0:3]
    s_waitcnt vmcnt(8)
    v_cvt_pk_bf16_f32 v43, v46, v47
    v_mfma_f32_16x16x32_bf16 v[0:3], a[72:75], a[8:11], v[0:3]
    s_barrier
    v_exp_f32 v61, v61
    v_mfma_f32_16x16x32_bf16 v[0:3], a[76:79], a[12:15], v[0:3]
    v_mfma_f32_16x16x32_bf16 v[16:19], a[64:67], a[16:19], v[68:71]
    v_exp_f32 v62, v62
    v_mfma_f32_16x16x32_bf16 v[16:19], a[68:71], a[20:23], v[16:19]
    v_cvt_pk_bf16_f32 v58, v60, v61
    v_mfma_f32_16x16x32_bf16 v[16:19], a[72:75], a[24:27], v[16:19]
    s_add_u32 m0, s24, 16384
    v_exp_f32 v63, v63
    v_mfma_f32_16x16x32_bf16 v[16:19], a[76:79], a[28:31], v[16:19]
    buffer_load_dwordx4 v92, s[4:7], s23 offen offset:0 lds
    v_mfma_f32_16x16x32_bf16 v[4:7], a[80:83], a[0:3], v[64:67]
    v_mfma_f32_16x16x32_bf16 v[4:7], a[84:87], a[4:7], v[4:7]
    v_cvt_pk_bf16_f32 v59, v62, v63
    v_mfma_f32_16x16x32_bf16 v[4:7], a[88:91], a[8:11], v[4:7]
    v_mfma_f32_16x16x32_bf16 v[4:7], a[92:95], a[12:15], v[4:7]
    v_mfma_f32_16x16x32_bf16 v[20:23], a[80:83], a[16:19], v[68:71]
    v_exp_f32 v0, v0
    v_mfma_f32_16x16x32_bf16 v[20:23], a[84:87], a[20:23], v[20:23]
    buffer_load_dwordx4 v93, s[4:7], s23 offen offset:1024 lds
    v_mfma_f32_16x16x32_bf16 v[20:23], a[88:91], a[24:27], v[20:23]
    v_exp_f32 v1, v1
    v_mfma_f32_16x16x32_bf16 v[20:23], a[92:95], a[28:31], v[20:23]
    v_mfma_f32_16x16x32_bf16 v[8:11], a[96:99], a[0:3], v[64:67]
    v_exp_f32 v2, v2
    v_mfma_f32_16x16x32_bf16 v[8:11], a[100:103], a[4:7], v[8:11]
    v_cvt_pk_bf16_f32 v0, v0, v1
    v_mfma_f32_16x16x32_bf16 v[8:11], a[104:107], a[8:11], v[8:11]
    v_exp_f32 v3, v3
    v_mfma_f32_16x16x32_bf16 v[8:11], a[108:111], a[12:15], v[8:11]
    buffer_load_dwordx4 v94, s[4:7], s23 offen offset:2048 lds
    v_mfma_f32_16x16x32_bf16 v[24:27], a[96:99], a[16:19], v[68:71]
    v_exp_f32 v16, v16
    v_mfma_f32_16x16x32_bf16 v[24:27], a[100:103], a[20:23], v[24:27]
    v_cvt_pk_bf16_f32 v1, v2, v3
    v_mfma_f32_16x16x32_bf16 v[24:27], a[104:107], a[24:27], v[24:27]
    v_exp_f32 v17, v17
    v_mfma_f32_16x16x32_bf16 v[24:27], a[108:111], a[28:31], v[24:27]
    s_waitcnt lgkmcnt(0)
    v_mfma_f32_16x16x32_bf16 v[12:15], a[112:115], a[0:3], v[64:67]
    v_exp_f32 v18, v18
    v_mfma_f32_16x16x32_bf16 v[12:15], a[116:119], a[4:7], v[12:15]
    buffer_load_dwordx4 v95, s[4:7], s23 offen offset:3072 lds
    v_cvt_pk_bf16_f32 v16, v16, v17
    v_mfma_f32_16x16x32_bf16 v[12:15], a[120:123], a[8:11], v[12:15]
    v_exp_f32 v19, v19
    v_mfma_f32_16x16x32_bf16 v[12:15], a[124:127], a[12:15], v[12:15]
    v_mfma_f32_16x16x32_bf16 v[28:31], a[112:115], a[16:19], v[68:71]
    v_exp_f32 v4, v4
    v_mfma_f32_16x16x32_bf16 v[28:31], a[116:119], a[20:23], v[28:31]
    v_cvt_pk_bf16_f32 v17, v18, v19
    v_mfma_f32_16x16x32_bf16 v[28:31], a[120:123], a[24:27], v[28:31]
    s_add_u32 m0, s24, 81920
    v_exp_f32 v5, v5
    v_mfma_f32_16x16x32_bf16 v[28:31], a[124:127], a[28:31], v[28:31]
    buffer_load_dwordx4 v96, s[8:11], s23 offen offset:0 lds
    v_mfma_f32_16x16x32_bf16 v[192:195], a[128:131], v[32:35], v[192:195]
    v_exp_f32 v6, v6
    v_mfma_f32_16x16x32_bf16 v[192:195], a[132:135], v[40:43], v[192:195]
    v_cvt_pk_bf16_f32 v2, v4, v5
    v_mfma_f32_16x16x32_bf16 v[224:227], a[128:131], v[48:51], v[224:227]
    v_exp_f32 v7, v7
    v_mfma_f32_16x16x32_bf16 v[224:227], a[132:135], v[56:59], v[224:227]
    v_mfma_f32_16x16x32_bf16 v[196:199], a[136:139], v[32:35], v[196:199]
    v_exp_f32 v20, v20
    v_mfma_f32_16x16x32_bf16 v[196:199], a[140:143], v[40:43], v[196:199]
    buffer_load_dwordx4 v97, s[8:11], s23 offen offset:1024 lds
    v_cvt_pk_bf16_f32 v3, v6, v7
    v_mfma_f32_16x16x32_bf16 v[228:231], a[136:139], v[48:51], v[228:231]
    v_exp_f32 v21, v21
    v_mfma_f32_16x16x32_bf16 v[228:231], a[140:143], v[56:59], v[228:231]
    ds_read_b64_tr_b16 a[128:129], v84 offset:49152
    v_mfma_f32_16x16x32_bf16 v[200:203], a[144:147], v[32:35], v[200:203]
    v_exp_f32 v22, v22
    v_mfma_f32_16x16x32_bf16 v[200:203], a[148:151], v[40:43], v[200:203]
    ds_read_b64_tr_b16 a[130:131], v84 offset:53248
    v_cvt_pk_bf16_f32 v18, v20, v21
    v_mfma_f32_16x16x32_bf16 v[232:235], a[144:147], v[48:51], v[232:235]
    v_exp_f32 v23, v23
    v_mfma_f32_16x16x32_bf16 v[232:235], a[148:151], v[56:59], v[232:235]
    buffer_load_dwordx4 v96, s[8:11], s23 offen offset:2048 lds
    v_mfma_f32_16x16x32_bf16 v[204:207], a[152:155], v[32:35], v[204:207]
    v_exp_f32 v8, v8
    v_mfma_f32_16x16x32_bf16 v[204:207], a[156:159], v[40:43], v[204:207]
    ds_read_b64_tr_b16 a[132:133], v84 offset:57344
    v_cvt_pk_bf16_f32 v19, v22, v23
    v_mfma_f32_16x16x32_bf16 v[236:239], a[152:155], v[48:51], v[236:239]
    v_exp_f32 v9, v9
    v_mfma_f32_16x16x32_bf16 v[236:239], a[156:159], v[56:59], v[236:239]
    ds_read_b64_tr_b16 a[134:135], v84 offset:61440
    v_mfma_f32_16x16x32_bf16 v[208:211], a[160:163], v[32:35], v[208:211]
    v_exp_f32 v10, v10
    v_mfma_f32_16x16x32_bf16 v[208:211], a[164:167], v[40:43], v[208:211]
    buffer_load_dwordx4 v97, s[8:11], s23 offen offset:3072 lds
    v_cvt_pk_bf16_f32 v8, v8, v9
    v_mfma_f32_16x16x32_bf16 v[240:243], a[160:163], v[48:51], v[240:243]
    v_exp_f32 v11, v11
    v_mfma_f32_16x16x32_bf16 v[240:243], a[164:167], v[56:59], v[240:243]
    ds_read_b64_tr_b16 a[136:137], v85 offset:49152
    v_mfma_f32_16x16x32_bf16 v[212:215], a[168:171], v[32:35], v[212:215]
    v_exp_f32 v24, v24
    v_mfma_f32_16x16x32_bf16 v[212:215], a[172:175], v[40:43], v[212:215]
    ds_read_b64_tr_b16 a[138:139], v85 offset:53248
    v_cvt_pk_bf16_f32 v9, v10, v11
    v_mfma_f32_16x16x32_bf16 v[244:247], a[168:171], v[48:51], v[244:247]
    v_exp_f32 v25, v25
    v_mfma_f32_16x16x32_bf16 v[244:247], a[172:175], v[56:59], v[244:247]
    ds_read_b64_tr_b16 a[140:141], v85 offset:57344
    v_mfma_f32_16x16x32_bf16 v[216:219], a[176:179], v[32:35], v[216:219]
    v_exp_f32 v26, v26
    v_mfma_f32_16x16x32_bf16 v[216:219], a[180:183], v[40:43], v[216:219]
    ds_read_b64_tr_b16 a[142:143], v85 offset:61440
    v_cvt_pk_bf16_f32 v24, v24, v25
    v_mfma_f32_16x16x32_bf16 v[248:251], a[176:179], v[48:51], v[248:251]
    v_exp_f32 v27, v27
    v_mfma_f32_16x16x32_bf16 v[248:251], a[180:183], v[56:59], v[248:251]
    ds_read_b64_tr_b16 a[144:145], v86 offset:49152
    v_mfma_f32_16x16x32_bf16 v[220:223], a[184:187], v[32:35], v[220:223]
    v_exp_f32 v12, v12
    v_mfma_f32_16x16x32_bf16 v[220:223], a[188:191], v[40:43], v[220:223]
    ds_read_b64_tr_b16 a[146:147], v86 offset:53248
    v_cvt_pk_bf16_f32 v25, v26, v27
    v_mfma_f32_16x16x32_bf16 v[252:255], a[184:187], v[48:51], v[252:255]
    v_exp_f32 v13, v13
    v_mfma_f32_16x16x32_bf16 v[252:255], a[188:191], v[56:59], v[252:255]
    ds_read_b64_tr_b16 a[148:149], v86 offset:57344
    v_mfma_f32_16x16x32_bf16 a[200:203], a[208:211], v[32:35], a[200:203]
    v_exp_f32 v14, v14
    v_mfma_f32_16x16x32_bf16 a[200:203], a[208:211], v[40:43], a[200:203]
    ds_read_b64_tr_b16 a[150:151], v86 offset:61440
    v_cvt_pk_bf16_f32 v10, v12, v13
    v_mfma_f32_16x16x32_bf16 a[204:207], a[208:211], v[48:51], a[204:207]
    v_exp_f32 v15, v15
    v_mfma_f32_16x16x32_bf16 a[204:207], a[208:211], v[56:59], a[204:207]
    ds_read_b64_tr_b16 a[152:153], v87 offset:49152
    v_mfma_f32_16x16x32_bf16 v[32:35], a[64:67], a[32:35], v[72:75]
    v_exp_f32 v28, v28
    v_mfma_f32_16x16x32_bf16 v[32:35], a[68:71], a[36:39], v[32:35]
    ds_read_b64_tr_b16 a[154:155], v87 offset:53248
    v_cvt_pk_bf16_f32 v11, v14, v15
    v_mfma_f32_16x16x32_bf16 v[32:35], a[72:75], a[40:43], v[32:35]
    v_exp_f32 v29, v29
    v_mfma_f32_16x16x32_bf16 v[32:35], a[76:79], a[44:47], v[32:35]
    ds_read_b64_tr_b16 a[156:157], v87 offset:57344
    v_mfma_f32_16x16x32_bf16 v[48:51], a[64:67], a[48:51], v[76:79]
    v_exp_f32 v30, v30
    v_mfma_f32_16x16x32_bf16 v[48:51], a[68:71], a[52:55], v[48:51]
    ds_read_b64_tr_b16 a[158:159], v87 offset:61440
    v_cvt_pk_bf16_f32 v26, v28, v29
    v_mfma_f32_16x16x32_bf16 v[48:51], a[72:75], a[56:59], v[48:51]
    v_exp_f32 v31, v31
    v_mfma_f32_16x16x32_bf16 v[48:51], a[76:79], a[60:63], v[48:51]
    ds_read_b64_tr_b16 a[160:161], v88 offset:49152
    v_mfma_f32_16x16x32_bf16 v[36:39], a[80:83], a[32:35], v[72:75]
    ds_read_b64_tr_b16 a[162:163], v88 offset:53248
    v_mfma_f32_16x16x32_bf16 v[36:39], a[84:87], a[36:39], v[36:39]
    ds_read_b64_tr_b16 a[164:165], v88 offset:57344
    v_cvt_pk_bf16_f32 v27, v30, v31
    v_mfma_f32_16x16x32_bf16 v[36:39], a[88:91], a[40:43], v[36:39]
    ds_read_b64_tr_b16 a[166:167], v88 offset:61440
    v_mfma_f32_16x16x32_bf16 v[36:39], a[92:95], a[44:47], v[36:39]
    ds_read_b64_tr_b16 a[168:169], v89 offset:49152
    v_mfma_f32_16x16x32_bf16 v[52:55], a[80:83], a[48:51], v[76:79]
    v_exp_f32 v32, v32
    v_mfma_f32_16x16x32_bf16 v[52:55], a[84:87], a[52:55], v[52:55]
    ds_read_b64_tr_b16 a[170:171], v89 offset:53248
    v_mfma_f32_16x16x32_bf16 v[52:55], a[88:91], a[56:59], v[52:55]
    v_exp_f32 v33, v33
    v_mfma_f32_16x16x32_bf16 v[52:55], a[92:95], a[60:63], v[52:55]
    ds_read_b64_tr_b16 a[172:173], v89 offset:57344
    v_mfma_f32_16x16x32_bf16 v[40:43], a[96:99], a[32:35], v[72:75]
    v_exp_f32 v34, v34
    v_mfma_f32_16x16x32_bf16 v[40:43], a[100:103], a[36:39], v[40:43]
    ds_read_b64_tr_b16 a[174:175], v89 offset:61440
    v_cvt_pk_bf16_f32 v32, v32, v33
    v_mfma_f32_16x16x32_bf16 v[40:43], a[104:107], a[40:43], v[40:43]
    v_exp_f32 v35, v35
    v_mfma_f32_16x16x32_bf16 v[40:43], a[108:111], a[44:47], v[40:43]
    ds_read_b64_tr_b16 a[176:177], v90 offset:49152
    v_mfma_f32_16x16x32_bf16 v[56:59], a[96:99], a[48:51], v[76:79]
    v_exp_f32 v48, v48
    v_mfma_f32_16x16x32_bf16 v[56:59], a[100:103], a[52:55], v[56:59]
    ds_read_b64_tr_b16 a[178:179], v90 offset:53248
    v_cvt_pk_bf16_f32 v33, v34, v35
    v_mfma_f32_16x16x32_bf16 v[56:59], a[104:107], a[56:59], v[56:59]
    v_exp_f32 v49, v49
    v_mfma_f32_16x16x32_bf16 v[56:59], a[108:111], a[60:63], v[56:59]
    ds_read_b64_tr_b16 a[180:181], v90 offset:57344
    v_mfma_f32_16x16x32_bf16 v[44:47], a[112:115], a[32:35], v[72:75]
    v_exp_f32 v50, v50
    v_mfma_f32_16x16x32_bf16 v[44:47], a[116:119], a[36:39], v[44:47]
    ds_read_b64_tr_b16 a[182:183], v90 offset:61440
    v_cvt_pk_bf16_f32 v48, v48, v49
    v_mfma_f32_16x16x32_bf16 v[44:47], a[120:123], a[40:43], v[44:47]
    v_exp_f32 v51, v51
    v_mfma_f32_16x16x32_bf16 v[44:47], a[124:127], a[44:47], v[44:47]
    ds_read_b64_tr_b16 a[184:185], v91 offset:49152
    v_mfma_f32_16x16x32_bf16 v[60:63], a[112:115], a[48:51], v[76:79]
    v_exp_f32 v36, v36
    v_mfma_f32_16x16x32_bf16 v[60:63], a[116:119], a[52:55], v[60:63]
    ds_read_b64_tr_b16 a[186:187], v91 offset:53248
    v_cvt_pk_bf16_f32 v49, v50, v51
    v_mfma_f32_16x16x32_bf16 v[60:63], a[120:123], a[56:59], v[60:63]
    v_exp_f32 v37, v37
    v_mfma_f32_16x16x32_bf16 v[60:63], a[124:127], a[60:63], v[60:63]
    ds_read_b64_tr_b16 a[188:189], v91 offset:57344
    s_waitcnt lgkmcnt(5)
    v_mfma_f32_16x16x32_bf16 v[128:131], a[128:131], v[0:3], v[128:131]
    v_exp_f32 v38, v38
    v_mfma_f32_16x16x32_bf16 v[128:131], a[132:135], v[8:11], v[128:131]
    ds_read_b64_tr_b16 a[190:191], v91 offset:61440
    v_cvt_pk_bf16_f32 v34, v36, v37
    v_mfma_f32_16x16x32_bf16 v[160:163], a[128:131], v[16:19], v[160:163]
    v_exp_f32 v39, v39
    v_mfma_f32_16x16x32_bf16 v[160:163], a[132:135], v[24:27], v[160:163]
    ds_read_b128 a[64:67], v80 offset:49152
    v_mfma_f32_16x16x32_bf16 v[132:135], a[136:139], v[0:3], v[132:135]
    v_exp_f32 v52, v52
    v_mfma_f32_16x16x32_bf16 v[132:135], a[140:143], v[8:11], v[132:135]
    ds_read_b128 a[68:71], v81 offset:49152
    v_cvt_pk_bf16_f32 v35, v38, v39
    v_mfma_f32_16x16x32_bf16 v[164:167], a[136:139], v[16:19], v[164:167]
    v_exp_f32 v53, v53
    v_mfma_f32_16x16x32_bf16 v[164:167], a[140:143], v[24:27], v[164:167]
    ds_read_b128 a[72:75], v82 offset:49152
    v_mfma_f32_16x16x32_bf16 v[136:139], a[144:147], v[0:3], v[136:139]
    v_exp_f32 v54, v54
    v_mfma_f32_16x16x32_bf16 v[136:139], a[148:151], v[8:11], v[136:139]
    ds_read_b128 a[76:79], v83 offset:49152
    v_cvt_pk_bf16_f32 v50, v52, v53
    v_mfma_f32_16x16x32_bf16 v[168:171], a[144:147], v[16:19], v[168:171]
    v_exp_f32 v55, v55
    v_mfma_f32_16x16x32_bf16 v[168:171], a[148:151], v[24:27], v[168:171]
    ds_read_b128 a[80:83], v80 offset:53248
    v_mfma_f32_16x16x32_bf16 v[140:143], a[152:155], v[0:3], v[140:143]
    v_exp_f32 v40, v40
    v_mfma_f32_16x16x32_bf16 v[140:143], a[156:159], v[8:11], v[140:143]
    ds_read_b128 a[84:87], v81 offset:53248
    v_cvt_pk_bf16_f32 v51, v54, v55
    v_mfma_f32_16x16x32_bf16 v[172:175], a[152:155], v[16:19], v[172:175]
    v_exp_f32 v41, v41
    v_mfma_f32_16x16x32_bf16 v[172:175], a[156:159], v[24:27], v[172:175]
    ds_read_b128 a[88:91], v82 offset:53248
    v_mfma_f32_16x16x32_bf16 v[144:147], a[160:163], v[0:3], v[144:147]
    v_exp_f32 v42, v42
    v_mfma_f32_16x16x32_bf16 v[144:147], a[164:167], v[8:11], v[144:147]
    ds_read_b128 a[92:95], v83 offset:53248
    v_cvt_pk_bf16_f32 v40, v40, v41
    v_mfma_f32_16x16x32_bf16 v[176:179], a[160:163], v[16:19], v[176:179]
    v_exp_f32 v43, v43
    v_mfma_f32_16x16x32_bf16 v[176:179], a[164:167], v[24:27], v[176:179]
    ds_read_b128 a[96:99], v80 offset:57344
    v_mfma_f32_16x16x32_bf16 v[148:151], a[168:171], v[0:3], v[148:151]
    v_exp_f32 v56, v56
    v_mfma_f32_16x16x32_bf16 v[148:151], a[172:175], v[8:11], v[148:151]
    ds_read_b128 a[100:103], v81 offset:57344
    v_cvt_pk_bf16_f32 v41, v42, v43
    v_mfma_f32_16x16x32_bf16 v[180:183], a[168:171], v[16:19], v[180:183]
    v_exp_f32 v57, v57
    v_mfma_f32_16x16x32_bf16 v[180:183], a[172:175], v[24:27], v[180:183]
    ds_read_b128 a[104:107], v82 offset:57344
    v_mfma_f32_16x16x32_bf16 v[152:155], a[176:179], v[0:3], v[152:155]
    s_waitcnt lgkmcnt(4)
    v_exp_f32 v58, v58
    v_mfma_f32_16x16x32_bf16 v[152:155], a[180:183], v[8:11], v[152:155]
    ds_read_b128 a[108:111], v83 offset:57344
    v_cvt_pk_bf16_f32 v56, v56, v57
    v_mfma_f32_16x16x32_bf16 v[184:187], a[176:179], v[16:19], v[184:187]
    v_exp_f32 v59, v59
    v_mfma_f32_16x16x32_bf16 v[184:187], a[180:183], v[24:27], v[184:187]
    ds_read_b128 a[112:115], v80 offset:61440
    v_mfma_f32_16x16x32_bf16 v[156:159], a[184:187], v[0:3], v[156:159]
    v_exp_f32 v44, v44
    v_mfma_f32_16x16x32_bf16 v[156:159], a[188:191], v[8:11], v[156:159]
    ds_read_b128 a[116:119], v81 offset:61440
    v_cvt_pk_bf16_f32 v57, v58, v59
    v_mfma_f32_16x16x32_bf16 v[188:191], a[184:187], v[16:19], v[188:191]
    v_exp_f32 v45, v45
    v_mfma_f32_16x16x32_bf16 v[188:191], a[188:191], v[24:27], v[188:191]
    ds_read_b128 a[120:123], v82 offset:61440
    v_mfma_f32_16x16x32_bf16 a[192:195], a[208:211], v[0:3], a[192:195]
    v_exp_f32 v46, v46
    v_mfma_f32_16x16x32_bf16 a[192:195], a[208:211], v[8:11], a[192:195]
    ds_read_b128 a[124:127], v83 offset:61440
    v_cvt_pk_bf16_f32 v42, v44, v45
    v_mfma_f32_16x16x32_bf16 a[196:199], a[208:211], v[16:19], a[196:199]
    v_exp_f32 v47, v47
    v_mfma_f32_16x16x32_bf16 a[196:199], a[208:211], v[24:27], a[196:199]
    s_add_u32 s23, s23, 16384
    s_waitcnt lgkmcnt(4)
    v_mfma_f32_16x16x32_bf16 v[0:3], a[64:67], a[0:3], v[64:67]
    v_exp_f32 v60, v60
    v_mfma_f32_16x16x32_bf16 v[0:3], a[68:71], a[4:7], v[0:3]
    s_waitcnt vmcnt(8)
    v_cvt_pk_bf16_f32 v43, v46, v47
    v_mfma_f32_16x16x32_bf16 v[0:3], a[72:75], a[8:11], v[0:3]
    s_barrier
    v_exp_f32 v61, v61
    v_mfma_f32_16x16x32_bf16 v[0:3], a[76:79], a[12:15], v[0:3]
    v_mfma_f32_16x16x32_bf16 v[16:19], a[64:67], a[16:19], v[68:71]
    v_exp_f32 v62, v62
    v_mfma_f32_16x16x32_bf16 v[16:19], a[68:71], a[20:23], v[16:19]
    v_cvt_pk_bf16_f32 v58, v60, v61
    v_mfma_f32_16x16x32_bf16 v[16:19], a[72:75], a[24:27], v[16:19]
    s_add_u32 m0, s24, 32768
    v_exp_f32 v63, v63
    v_mfma_f32_16x16x32_bf16 v[16:19], a[76:79], a[28:31], v[16:19]
    buffer_load_dwordx4 v92, s[4:7], s23 offen offset:0 lds
    v_mfma_f32_16x16x32_bf16 v[4:7], a[80:83], a[0:3], v[64:67]
    v_mfma_f32_16x16x32_bf16 v[4:7], a[84:87], a[4:7], v[4:7]
    v_cvt_pk_bf16_f32 v59, v62, v63
    v_mfma_f32_16x16x32_bf16 v[4:7], a[88:91], a[8:11], v[4:7]
    v_mfma_f32_16x16x32_bf16 v[4:7], a[92:95], a[12:15], v[4:7]
    v_mfma_f32_16x16x32_bf16 v[20:23], a[80:83], a[16:19], v[68:71]
    v_exp_f32 v0, v0
    v_mfma_f32_16x16x32_bf16 v[20:23], a[84:87], a[20:23], v[20:23]
    buffer_load_dwordx4 v93, s[4:7], s23 offen offset:1024 lds
    v_mfma_f32_16x16x32_bf16 v[20:23], a[88:91], a[24:27], v[20:23]
    v_exp_f32 v1, v1
    v_mfma_f32_16x16x32_bf16 v[20:23], a[92:95], a[28:31], v[20:23]
    v_mfma_f32_16x16x32_bf16 v[8:11], a[96:99], a[0:3], v[64:67]
    v_exp_f32 v2, v2
    v_mfma_f32_16x16x32_bf16 v[8:11], a[100:103], a[4:7], v[8:11]
    v_cvt_pk_bf16_f32 v0, v0, v1
    v_mfma_f32_16x16x32_bf16 v[8:11], a[104:107], a[8:11], v[8:11]
    v_exp_f32 v3, v3
    v_mfma_f32_16x16x32_bf16 v[8:11], a[108:111], a[12:15], v[8:11]
    buffer_load_dwordx4 v94, s[4:7], s23 offen offset:2048 lds
    v_mfma_f32_16x16x32_bf16 v[24:27], a[96:99], a[16:19], v[68:71]
    v_exp_f32 v16, v16
    v_mfma_f32_16x16x32_bf16 v[24:27], a[100:103], a[20:23], v[24:27]
    v_cvt_pk_bf16_f32 v1, v2, v3
    v_mfma_f32_16x16x32_bf16 v[24:27], a[104:107], a[24:27], v[24:27]
    v_exp_f32 v17, v17
    v_mfma_f32_16x16x32_bf16 v[24:27], a[108:111], a[28:31], v[24:27]
    s_waitcnt lgkmcnt(0)
    v_mfma_f32_16x16x32_bf16 v[12:15], a[112:115], a[0:3], v[64:67]
    v_exp_f32 v18, v18
    v_mfma_f32_16x16x32_bf16 v[12:15], a[116:119], a[4:7], v[12:15]
    buffer_load_dwordx4 v95, s[4:7], s23 offen offset:3072 lds
    v_cvt_pk_bf16_f32 v16, v16, v17
    v_mfma_f32_16x16x32_bf16 v[12:15], a[120:123], a[8:11], v[12:15]
    v_exp_f32 v19, v19
    v_mfma_f32_16x16x32_bf16 v[12:15], a[124:127], a[12:15], v[12:15]
    v_mfma_f32_16x16x32_bf16 v[28:31], a[112:115], a[16:19], v[68:71]
    v_exp_f32 v4, v4
    v_mfma_f32_16x16x32_bf16 v[28:31], a[116:119], a[20:23], v[28:31]
    v_cvt_pk_bf16_f32 v17, v18, v19
    v_mfma_f32_16x16x32_bf16 v[28:31], a[120:123], a[24:27], v[28:31]
    s_add_u32 m0, s24, 98304
    v_exp_f32 v5, v5
    v_mfma_f32_16x16x32_bf16 v[28:31], a[124:127], a[28:31], v[28:31]
    buffer_load_dwordx4 v96, s[8:11], s23 offen offset:0 lds
    v_mfma_f32_16x16x32_bf16 v[192:195], a[128:131], v[32:35], v[192:195]
    v_exp_f32 v6, v6
    v_mfma_f32_16x16x32_bf16 v[192:195], a[132:135], v[40:43], v[192:195]
    v_cvt_pk_bf16_f32 v2, v4, v5
    v_mfma_f32_16x16x32_bf16 v[224:227], a[128:131], v[48:51], v[224:227]
    v_exp_f32 v7, v7
    v_mfma_f32_16x16x32_bf16 v[224:227], a[132:135], v[56:59], v[224:227]
    v_mfma_f32_16x16x32_bf16 v[196:199], a[136:139], v[32:35], v[196:199]
    v_exp_f32 v20, v20
    v_mfma_f32_16x16x32_bf16 v[196:199], a[140:143], v[40:43], v[196:199]
    buffer_load_dwordx4 v97, s[8:11], s23 offen offset:1024 lds
    v_cvt_pk_bf16_f32 v3, v6, v7
    v_mfma_f32_16x16x32_bf16 v[228:231], a[136:139], v[48:51], v[228:231]
    v_exp_f32 v21, v21
    v_mfma_f32_16x16x32_bf16 v[228:231], a[140:143], v[56:59], v[228:231]
    ds_read_b64_tr_b16 a[128:129], v84 offset:0
    v_mfma_f32_16x16x32_bf16 v[200:203], a[144:147], v[32:35], v[200:203]
    v_exp_f32 v22, v22
    v_mfma_f32_16x16x32_bf16 v[200:203], a[148:151], v[40:43], v[200:203]
    ds_read_b64_tr_b16 a[130:131], v84 offset:4096
    v_cvt_pk_bf16_f32 v18, v20, v21
    v_mfma_f32_16x16x32_bf16 v[232:235], a[144:147], v[48:51], v[232:235]
    v_exp_f32 v23, v23
    v_mfma_f32_16x16x32_bf16 v[232:235], a[148:151], v[56:59], v[232:235]
    buffer_load_dwordx4 v96, s[8:11], s23 offen offset:2048 lds
    v_mfma_f32_16x16x32_bf16 v[204:207], a[152:155], v[32:35], v[204:207]
    v_exp_f32 v8, v8
    v_mfma_f32_16x16x32_bf16 v[204:207], a[156:159], v[40:43], v[204:207]
    ds_read_b64_tr_b16 a[132:133], v84 offset:8192
    v_cvt_pk_bf16_f32 v19, v22, v23
    v_mfma_f32_16x16x32_bf16 v[236:239], a[152:155], v[48:51], v[236:239]
    v_exp_f32 v9, v9
    v_mfma_f32_16x16x32_bf16 v[236:239], a[156:159], v[56:59], v[236:239]
    ds_read_b64_tr_b16 a[134:135], v84 offset:12288
    v_mfma_f32_16x16x32_bf16 v[208:211], a[160:163], v[32:35], v[208:211]
    v_exp_f32 v10, v10
    v_mfma_f32_16x16x32_bf16 v[208:211], a[164:167], v[40:43], v[208:211]
    buffer_load_dwordx4 v97, s[8:11], s23 offen offset:3072 lds
    v_cvt_pk_bf16_f32 v8, v8, v9
    v_mfma_f32_16x16x32_bf16 v[240:243], a[160:163], v[48:51], v[240:243]
    v_exp_f32 v11, v11
    v_mfma_f32_16x16x32_bf16 v[240:243], a[164:167], v[56:59], v[240:243]
    ds_read_b64_tr_b16 a[136:137], v85 offset:0
    v_mfma_f32_16x16x32_bf16 v[212:215], a[168:171], v[32:35], v[212:215]
    v_exp_f32 v24, v24
    v_mfma_f32_16x16x32_bf16 v[212:215], a[172:175], v[40:43], v[212:215]
    ds_read_b64_tr_b16 a[138:139], v85 offset:4096
    v_cvt_pk_bf16_f32 v9, v10, v11
    v_mfma_f32_16x16x32_bf16 v[244:247], a[168:171], v[48:51], v[244:247]
    v_exp_f32 v25, v25
    v_mfma_f32_16x16x32_bf16 v[244:247], a[172:175], v[56:59], v[244:247]
    ds_read_b64_tr_b16 a[140:141], v85 offset:8192
    v_mfma_f32_16x16x32_bf16 v[216:219], a[176:179], v[32:35], v[216:219]
    v_exp_f32 v26, v26
    v_mfma_f32_16x16x32_bf16 v[216:219], a[180:183], v[40:43], v[216:219]
    ds_read_b64_tr_b16 a[142:143], v85 offset:12288
    v_cvt_pk_bf16_f32 v24, v24, v25
    v_mfma_f32_16x16x32_bf16 v[248:251], a[176:179], v[48:51], v[248:251]
    v_exp_f32 v27, v27
    v_mfma_f32_16x16x32_bf16 v[248:251], a[180:183], v[56:59], v[248:251]
    ds_read_b64_tr_b16 a[144:145], v86 offset:0
    v_mfma_f32_16x16x32_bf16 v[220:223], a[184:187], v[32:35], v[220:223]
    v_exp_f32 v12, v12
    v_mfma_f32_16x16x32_bf16 v[220:223], a[188:191], v[40:43], v[220:223]
    ds_read_b64_tr_b16 a[146:147], v86 offset:4096
    v_cvt_pk_bf16_f32 v25, v26, v27
    v_mfma_f32_16x16x32_bf16 v[252:255], a[184:187], v[48:51], v[252:255]
    v_exp_f32 v13, v13
    v_mfma_f32_16x16x32_bf16 v[252:255], a[188:191], v[56:59], v[252:255]
    ds_read_b64_tr_b16 a[148:149], v86 offset:8192
    v_mfma_f32_16x16x32_bf16 a[200:203], a[208:211], v[32:35], a[200:203]
    v_exp_f32 v14, v14
    v_mfma_f32_16x16x32_bf16 a[200:203], a[208:211], v[40:43], a[200:203]
    ds_read_b64_tr_b16 a[150:151], v86 offset:12288
    v_cvt_pk_bf16_f32 v10, v12, v13
    v_mfma_f32_16x16x32_bf16 a[204:207], a[208:211], v[48:51], a[204:207]
    v_exp_f32 v15, v15
    v_mfma_f32_16x16x32_bf16 a[204:207], a[208:211], v[56:59], a[204:207]
    ds_read_b64_tr_b16 a[152:153], v87 offset:0
    v_mfma_f32_16x16x32_bf16 v[32:35], a[64:67], a[32:35], v[72:75]
    v_exp_f32 v28, v28
    v_mfma_f32_16x16x32_bf16 v[32:35], a[68:71], a[36:39], v[32:35]
    ds_read_b64_tr_b16 a[154:155], v87 offset:4096
    v_cvt_pk_bf16_f32 v11, v14, v15
    v_mfma_f32_16x16x32_bf16 v[32:35], a[72:75], a[40:43], v[32:35]
    v_exp_f32 v29, v29
    v_mfma_f32_16x16x32_bf16 v[32:35], a[76:79], a[44:47], v[32:35]
    ds_read_b64_tr_b16 a[156:157], v87 offset:8192
    v_mfma_f32_16x16x32_bf16 v[48:51], a[64:67], a[48:51], v[76:79]
    v_exp_f32 v30, v30
    v_mfma_f32_16x16x32_bf16 v[48:51], a[68:71], a[52:55], v[48:51]
    ds_read_b64_tr_b16 a[158:159], v87 offset:12288
    v_cvt_pk_bf16_f32 v26, v28, v29
    v_mfma_f32_16x16x32_bf16 v[48:51], a[72:75], a[56:59], v[48:51]
    v_exp_f32 v31, v31
    v_mfma_f32_16x16x32_bf16 v[48:51], a[76:79], a[60:63], v[48:51]
    ds_read_b64_tr_b16 a[160:161], v88 offset:0
    v_mfma_f32_16x16x32_bf16 v[36:39], a[80:83], a[32:35], v[72:75]
    ds_read_b64_tr_b16 a[162:163], v88 offset:4096
    v_mfma_f32_16x16x32_bf16 v[36:39], a[84:87], a[36:39], v[36:39]
    ds_read_b64_tr_b16 a[164:165], v88 offset:8192
    v_cvt_pk_bf16_f32 v27, v30, v31
    v_mfma_f32_16x16x32_bf16 v[36:39], a[88:91], a[40:43], v[36:39]
    ds_read_b64_tr_b16 a[166:167], v88 offset:12288
    v_mfma_f32_16x16x32_bf16 v[36:39], a[92:95], a[44:47], v[36:39]
    ds_read_b64_tr_b16 a[168:169], v89 offset:0
    v_mfma_f32_16x16x32_bf16 v[52:55], a[80:83], a[48:51], v[76:79]
    v_exp_f32 v32, v32
    v_mfma_f32_16x16x32_bf16 v[52:55], a[84:87], a[52:55], v[52:55]
    ds_read_b64_tr_b16 a[170:171], v89 offset:4096
    v_mfma_f32_16x16x32_bf16 v[52:55], a[88:91], a[56:59], v[52:55]
    v_exp_f32 v33, v33
    v_mfma_f32_16x16x32_bf16 v[52:55], a[92:95], a[60:63], v[52:55]
    ds_read_b64_tr_b16 a[172:173], v89 offset:8192
    v_mfma_f32_16x16x32_bf16 v[40:43], a[96:99], a[32:35], v[72:75]
    v_exp_f32 v34, v34
    v_mfma_f32_16x16x32_bf16 v[40:43], a[100:103], a[36:39], v[40:43]
    ds_read_b64_tr_b16 a[174:175], v89 offset:12288
    v_cvt_pk_bf16_f32 v32, v32, v33
    v_mfma_f32_16x16x32_bf16 v[40:43], a[104:107], a[40:43], v[40:43]
    v_exp_f32 v35, v35
    v_mfma_f32_16x16x32_bf16 v[40:43], a[108:111], a[44:47], v[40:43]
    ds_read_b64_tr_b16 a[176:177], v90 offset:0
    v_mfma_f32_16x16x32_bf16 v[56:59], a[96:99], a[48:51], v[76:79]
    v_exp_f32 v48, v48
    v_mfma_f32_16x16x32_bf16 v[56:59], a[100:103], a[52:55], v[56:59]
    ds_read_b64_tr_b16 a[178:179], v90 offset:4096
    v_cvt_pk_bf16_f32 v33, v34, v35
    v_mfma_f32_16x16x32_bf16 v[56:59], a[104:107], a[56:59], v[56:59]
    v_exp_f32 v49, v49
    v_mfma_f32_16x16x32_bf16 v[56:59], a[108:111], a[60:63], v[56:59]
    ds_read_b64_tr_b16 a[180:181], v90 offset:8192
    v_mfma_f32_16x16x32_bf16 v[44:47], a[112:115], a[32:35], v[72:75]
    v_exp_f32 v50, v50
    v_mfma_f32_16x16x32_bf16 v[44:47], a[116:119], a[36:39], v[44:47]
    ds_read_b64_tr_b16 a[182:183], v90 offset:12288
    v_cvt_pk_bf16_f32 v48, v48, v49
    v_mfma_f32_16x16x32_bf16 v[44:47], a[120:123], a[40:43], v[44:47]
    v_exp_f32 v51, v51
    v_mfma_f32_16x16x32_bf16 v[44:47], a[124:127], a[44:47], v[44:47]
    ds_read_b64_tr_b16 a[184:185], v91 offset:0
    v_mfma_f32_16x16x32_bf16 v[60:63], a[112:115], a[48:51], v[76:79]
    v_exp_f32 v36, v36
    v_mfma_f32_16x16x32_bf16 v[60:63], a[116:119], a[52:55], v[60:63]
    ds_read_b64_tr_b16 a[186:187], v91 offset:4096
    v_cvt_pk_bf16_f32 v49, v50, v51
    v_mfma_f32_16x16x32_bf16 v[60:63], a[120:123], a[56:59], v[60:63]
    v_exp_f32 v37, v37
    v_mfma_f32_16x16x32_bf16 v[60:63], a[124:127], a[60:63], v[60:63]
    ds_read_b64_tr_b16 a[188:189], v91 offset:8192
    s_waitcnt lgkmcnt(5)
    v_mfma_f32_16x16x32_bf16 v[128:131], a[128:131], v[0:3], v[128:131]
    v_exp_f32 v38, v38
    v_mfma_f32_16x16x32_bf16 v[128:131], a[132:135], v[8:11], v[128:131]
    ds_read_b64_tr_b16 a[190:191], v91 offset:12288
    v_cvt_pk_bf16_f32 v34, v36, v37
    v_mfma_f32_16x16x32_bf16 v[160:163], a[128:131], v[16:19], v[160:163]
    v_exp_f32 v39, v39
    v_mfma_f32_16x16x32_bf16 v[160:163], a[132:135], v[24:27], v[160:163]
    ds_read_b128 a[64:67], v80 offset:0
    v_mfma_f32_16x16x32_bf16 v[132:135], a[136:139], v[0:3], v[132:135]
    v_exp_f32 v52, v52
    v_mfma_f32_16x16x32_bf16 v[132:135], a[140:143], v[8:11], v[132:135]
    ds_read_b128 a[68:71], v81 offset:0
    v_cvt_pk_bf16_f32 v35, v38, v39
    v_mfma_f32_16x16x32_bf16 v[164:167], a[136:139], v[16:19], v[164:167]
    v_exp_f32 v53, v53
    v_mfma_f32_16x16x32_bf16 v[164:167], a[140:143], v[24:27], v[164:167]
    ds_read_b128 a[72:75], v82 offset:0
    v_mfma_f32_16x16x32_bf16 v[136:139], a[144:147], v[0:3], v[136:139]
    v_exp_f32 v54, v54
    v_mfma_f32_16x16x32_bf16 v[136:139], a[148:151], v[8:11], v[136:139]
    ds_read_b128 a[76:79], v83 offset:0
    v_cvt_pk_bf16_f32 v50, v52, v53
    v_mfma_f32_16x16x32_bf16 v[168:171], a[144:147], v[16:19], v[168:171]
    v_exp_f32 v55, v55
    v_mfma_f32_16x16x32_bf16 v[168:171], a[148:151], v[24:27], v[168:171]
    ds_read_b128 a[80:83], v80 offset:4096
    v_mfma_f32_16x16x32_bf16 v[140:143], a[152:155], v[0:3], v[140:143]
    v_exp_f32 v40, v40
    v_mfma_f32_16x16x32_bf16 v[140:143], a[156:159], v[8:11], v[140:143]
    ds_read_b128 a[84:87], v81 offset:4096
    v_cvt_pk_bf16_f32 v51, v54, v55
    v_mfma_f32_16x16x32_bf16 v[172:175], a[152:155], v[16:19], v[172:175]
    v_exp_f32 v41, v41
    v_mfma_f32_16x16x32_bf16 v[172:175], a[156:159], v[24:27], v[172:175]
    ds_read_b128 a[88:91], v82 offset:4096
    v_mfma_f32_16x16x32_bf16 v[144:147], a[160:163], v[0:3], v[144:147]
    v_exp_f32 v42, v42
    v_mfma_f32_16x16x32_bf16 v[144:147], a[164:167], v[8:11], v[144:147]
    ds_read_b128 a[92:95], v83 offset:4096
    v_cvt_pk_bf16_f32 v40, v40, v41
    v_mfma_f32_16x16x32_bf16 v[176:179], a[160:163], v[16:19], v[176:179]
    v_exp_f32 v43, v43
    v_mfma_f32_16x16x32_bf16 v[176:179], a[164:167], v[24:27], v[176:179]
    ds_read_b128 a[96:99], v80 offset:8192
    v_mfma_f32_16x16x32_bf16 v[148:151], a[168:171], v[0:3], v[148:151]
    v_exp_f32 v56, v56
    v_mfma_f32_16x16x32_bf16 v[148:151], a[172:175], v[8:11], v[148:151]
    ds_read_b128 a[100:103], v81 offset:8192
    v_cvt_pk_bf16_f32 v41, v42, v43
    v_mfma_f32_16x16x32_bf16 v[180:183], a[168:171], v[16:19], v[180:183]
    v_exp_f32 v57, v57
    v_mfma_f32_16x16x32_bf16 v[180:183], a[172:175], v[24:27], v[180:183]
    ds_read_b128 a[104:107], v82 offset:8192
    v_mfma_f32_16x16x32_bf16 v[152:155], a[176:179], v[0:3], v[152:155]
    s_waitcnt lgkmcnt(4)
    v_exp_f32 v58, v58
    v_mfma_f32_16x16x32_bf16 v[152:155], a[180:183], v[8:11], v[152:155]
    ds_read_b128 a[108:111], v83 offset:8192
    v_cvt_pk_bf16_f32 v56, v56, v57
    v_mfma_f32_16x16x32_bf16 v[184:187], a[176:179], v[16:19], v[184:187]
    v_exp_f32 v59, v59
    v_mfma_f32_16x16x32_bf16 v[184:187], a[180:183], v[24:27], v[184:187]
    ds_read_b128 a[112:115], v80 offset:12288
    v_mfma_f32_16x16x32_bf16 v[156:159], a[184:187], v[0:3], v[156:159]
    v_exp_f32 v44, v44
    v_mfma_f32_16x16x32_bf16 v[156:159], a[188:191], v[8:11], v[156:159]
    ds_read_b128 a[116:119], v81 offset:12288
    v_cvt_pk_bf16_f32 v57, v58, v59
    v_mfma_f32_16x16x32_bf16 v[188:191], a[184:187], v[16:19], v[188:191]
    v_exp_f32 v45, v45
    v_mfma_f32_16x16x32_bf16 v[188:191], a[188:191], v[24:27], v[188:191]
    ds_read_b128 a[120:123], v82 offset:12288
    v_mfma_f32_16x16x32_bf16 a[192:195], a[208:211], v[0:3], a[192:195]
    v_exp_f32 v46, v46
    v_mfma_f32_16x16x32_bf16 a[192:195], a[208:211], v[8:11], a[192:195]
    ds_read_b128 a[124:127], v83 offset:12288
    v_cvt_pk_bf16_f32 v42, v44, v45
    v_mfma_f32_16x16x32_bf16 a[196:199], a[208:211], v[16:19], a[196:199]
    v_exp_f32 v47, v47
    v_mfma_f32_16x16x32_bf16 a[196:199], a[208:211], v[24:27], a[196:199]
    s_add_u32 s23, s23, 16384
    s_sub_u32 s25, s25, 1
    s_cmp_lg_u32 s25, 0
    s_cbranch_scc1 L_attn_loop
    s_waitcnt lgkmcnt(4)
    v_mfma_f32_16x16x32_bf16 v[0:3], a[64:67], a[0:3], v[64:67]
    v_exp_f32 v60, v60
    v_mfma_f32_16x16x32_bf16 v[0:3], a[68:71], a[4:7], v[0:3]
    s_waitcnt vmcnt(8)
    v_cvt_pk_bf16_f32 v43, v46, v47
    v_mfma_f32_16x16x32_bf16 v[0:3], a[72:75], a[8:11], v[0:3]
    s_barrier
    v_exp_f32 v61, v61
    v_mfma_f32_16x16x32_bf16 v[0:3], a[76:79], a[12:15], v[0:3]
    v_mfma_f32_16x16x32_bf16 v[16:19], a[64:67], a[16:19], v[68:71]
    s_lshl_b32 s31, s22, 5
    buffer_load_dword v124, v125, s[16:19], s31 offen sc1
    v_exp_f32 v62, v62
    v_mfma_f32_16x16x32_bf16 v[16:19], a[68:71], a[20:23], v[16:19]
    v_cvt_pk_bf16_f32 v58, v60, v61
    v_mfma_f32_16x16x32_bf16 v[16:19], a[72:75], a[24:27], v[16:19]
    v_exp_f32 v63, v63
    v_mfma_f32_16x16x32_bf16 v[16:19], a[76:79], a[28:31], v[16:19]
    v_mfma_f32_16x16x32_bf16 v[4:7], a[80:83], a[0:3], v[64:67]
    v_mfma_f32_16x16x32_bf16 v[4:7], a[84:87], a[4:7], v[4:7]
    v_cvt_pk_bf16_f32 v59, v62, v63
    v_mfma_f32_16x16x32_bf16 v[4:7], a[88:91], a[8:11], v[4:7]
    v_mfma_f32_16x16x32_bf16 v[4:7], a[92:95], a[12:15], v[4:7]
    v_mfma_f32_16x16x32_bf16 v[20:23], a[80:83], a[16:19], v[68:71]
    v_exp_f32 v0, v0
    v_mfma_f32_16x16x32_bf16 v[20:23], a[84:87], a[20:23], v[20:23]
    v_mfma_f32_16x16x32_bf16 v[20:23], a[88:91], a[24:27], v[20:23]
    v_exp_f32 v1, v1
    v_mfma_f32_16x16x32_bf16 v[20:23], a[92:95], a[28:31], v[20:23]
    v_mfma_f32_16x16x32_bf16 v[8:11], a[96:99], a[0:3], v[64:67]
    v_exp_f32 v2, v2
    v_mfma_f32_16x16x32_bf16 v[8:11], a[100:103], a[4:7], v[8:11]
    v_cvt_pk_bf16_f32 v0, v0, v1
    v_mfma_f32_16x16x32_bf16 v[8:11], a[104:107], a[8:11], v[8:11]
    v_exp_f32 v3, v3
    v_mfma_f32_16x16x32_bf16 v[8:11], a[108:111], a[12:15], v[8:11]
    v_mfma_f32_16x16x32_bf16 v[24:27], a[96:99], a[16:19], v[68:71]
    v_exp_f32 v16, v16
    v_mfma_f32_16x16x32_bf16 v[24:27], a[100:103], a[20:23], v[24:27]
    v_cvt_pk_bf16_f32 v1, v2, v3
    v_mfma_f32_16x16x32_bf16 v[24:27], a[104:107], a[24:27], v[24:27]
    v_exp_f32 v17, v17
    v_mfma_f32_16x16x32_bf16 v[24:27], a[108:111], a[28:31], v[24:27]
    s_waitcnt lgkmcnt(0)
    v_mfma_f32_16x16x32_bf16 v[12:15], a[112:115], a[0:3], v[64:67]
    v_exp_f32 v18, v18
    v_mfma_f32_16x16x32_bf16 v[12:15], a[116:119], a[4:7], v[12:15]
    v_cvt_pk_bf16_f32 v16, v16, v17
    v_mfma_f32_16x16x32_bf16 v[12:15], a[120:123], a[8:11], v[12:15]
    v_exp_f32 v19, v19
    v_mfma_f32_16x16x32_bf16 v[12:15], a[124:127], a[12:15], v[12:15]
    v_mfma_f32_16x16x32_bf16 v[28:31], a[112:115], a[16:19], v[68:71]
    v_exp_f32 v4, v4
    v_mfma_f32_16x16x32_bf16 v[28:31], a[116:119], a[20:23], v[28:31]
    v_cvt_pk_bf16_f32 v17, v18, v19
    v_mfma_f32_16x16x32_bf16 v[28:31], a[120:123], a[24:27], v[28:31]
    s_add_u32 m0, s24, 114688
    v_exp_f32 v5, v5
    v_mfma_f32_16x16x32_bf16 v[28:31], a[124:127], a[28:31], v[28:31]
    buffer_load_dwordx4 v96, s[8:11], s23 offen offset:0 lds
    v_mfma_f32_16x16x32_bf16 v[192:195], a[128:131], v[32:35], v[192:195]
    v_exp_f32 v6, v6
    v_mfma_f32_16x16x32_bf16 v[192:195], a[132:135], v[40:43], v[192:195]
    v_cvt_pk_bf16_f32 v2, v4, v5
    v_mfma_f32_16x16x32_bf16 v[224:227], a[128:131], v[48:51], v[224:227]
    v_exp_f32 v7, v7
    v_mfma_f32_16x16x32_bf16 v[224:227], a[132:135], v[56:59], v[224:227]
    v_mfma_f32_16x16x32_bf16 v[196:199], a[136:139], v[32:35], v[196:199]
    v_exp_f32 v20, v20
    v_mfma_f32_16x16x32_bf16 v[196:199], a[140:143], v[40:43], v[196:199]
    buffer_load_dwordx4 v97, s[8:11], s23 offen offset:1024 lds
    v_cvt_pk_bf16_f32 v3, v6, v7
    v_mfma_f32_16x16x32_bf16 v[228:231], a[136:139], v[48:51], v[228:231]
    v_exp_f32 v21, v21
    v_mfma_f32_16x16x32_bf16 v[228:231], a[140:143], v[56:59], v[228:231]
    ds_read_b64_tr_b16 a[128:129], v84 offset:16384
    v_mfma_f32_16x16x32_bf16 v[200:203], a[144:147], v[32:35], v[200:203]
    v_exp_f32 v22, v22
    v_mfma_f32_16x16x32_bf16 v[200:203], a[148:151], v[40:43], v[200:203]
    ds_read_b64_tr_b16 a[130:131], v84 offset:20480
    v_cvt_pk_bf16_f32 v18, v20, v21
    v_mfma_f32_16x16x32_bf16 v[232:235], a[144:147], v[48:51], v[232:235]
    v_exp_f32 v23, v23
    v_mfma_f32_16x16x32_bf16 v[232:235], a[148:151], v[56:59], v[232:235]
    buffer_load_dwordx4 v96, s[8:11], s23 offen offset:2048 lds
    v_mfma_f32_16x16x32_bf16 v[204:207], a[152:155], v[32:35], v[204:207]
    v_exp_f32 v8, v8
    v_mfma_f32_16x16x32_bf16 v[204:207], a[156:159], v[40:43], v[204:207]
    ds_read_b64_tr_b16 a[132:133], v84 offset:24576
    v_cvt_pk_bf16_f32 v19, v22, v23
    v_mfma_f32_16x16x32_bf16 v[236:239], a[152:155], v[48:51], v[236:239]
    v_exp_f32 v9, v9
    v_mfma_f32_16x16x32_bf16 v[236:239], a[156:159], v[56:59], v[236:239]
    ds_read_b64_tr_b16 a[134:135], v84 offset:28672
    v_mfma_f32_16x16x32_bf16 v[208:211], a[160:163], v[32:35], v[208:211]
    v_exp_f32 v10, v10
    v_mfma_f32_16x16x32_bf16 v[208:211], a[164:167], v[40:43], v[208:211]
    buffer_load_dwordx4 v97, s[8:11], s23 offen offset:3072 lds
    v_cvt_pk_bf16_f32 v8, v8, v9
    v_mfma_f32_16x16x32_bf16 v[240:243], a[160:163], v[48:51], v[240:243]
    v_exp_f32 v11, v11
    v_mfma_f32_16x16x32_bf16 v[240:243], a[164:167], v[56:59], v[240:243]
    ds_read_b64_tr_b16 a[136:137], v85 offset:16384
    v_mfma_f32_16x16x32_bf16 v[212:215], a[168:171], v[32:35], v[212:215]
    v_exp_f32 v24, v24
    v_mfma_f32_16x16x32_bf16 v[212:215], a[172:175], v[40:43], v[212:215]
    buffer_load_dwordx4 v[120:123], v127, s[40:43], s61 offen offset:0
    ds_read_b64_tr_b16 a[138:139], v85 offset:20480
    v_cvt_pk_bf16_f32 v9, v10, v11
    v_mfma_f32_16x16x32_bf16 v[244:247], a[168:171], v[48:51], v[244:247]
    v_exp_f32 v25, v25
    v_mfma_f32_16x16x32_bf16 v[244:247], a[172:175], v[56:59], v[244:247]
    ds_read_b64_tr_b16 a[140:141], v85 offset:24576
    v_mfma_f32_16x16x32_bf16 v[216:219], a[176:179], v[32:35], v[216:219]
    v_exp_f32 v26, v26
    v_mfma_f32_16x16x32_bf16 v[216:219], a[180:183], v[40:43], v[216:219]
    ds_read_b64_tr_b16 a[142:143], v85 offset:28672
    v_cvt_pk_bf16_f32 v24, v24, v25
    v_mfma_f32_16x16x32_bf16 v[248:251], a[176:179], v[48:51], v[248:251]
    v_exp_f32 v27, v27
    v_mfma_f32_16x16x32_bf16 v[248:251], a[180:183], v[56:59], v[248:251]
    buffer_load_dwordx4 v[120:123], v127, s[40:43], s61 offen offset:1024
    ds_read_b64_tr_b16 a[144:145], v86 offset:16384
    v_mfma_f32_16x16x32_bf16 v[220:223], a[184:187], v[32:35], v[220:223]
    v_exp_f32 v12, v12
    v_mfma_f32_16x16x32_bf16 v[220:223], a[188:191], v[40:43], v[220:223]
    ds_read_b64_tr_b16 a[146:147], v86 offset:20480
    v_cvt_pk_bf16_f32 v25, v26, v27
    v_mfma_f32_16x16x32_bf16 v[252:255], a[184:187], v[48:51], v[252:255]
    v_exp_f32 v13, v13
    v_mfma_f32_16x16x32_bf16 v[252:255], a[188:191], v[56:59], v[252:255]
    ds_read_b64_tr_b16 a[148:149], v86 offset:24576
    v_mfma_f32_16x16x32_bf16 a[200:203], a[208:211], v[32:35], a[200:203]
    v_exp_f32 v14, v14
    v_mfma_f32_16x16x32_bf16 a[200:203], a[208:211], v[40:43], a[200:203]
    buffer_load_dwordx4 v[120:123], v127, s[40:43], s61 offen offset:2048
    ds_read_b64_tr_b16 a[150:151], v86 offset:28672
    v_cvt_pk_bf16_f32 v10, v12, v13
    v_mfma_f32_16x16x32_bf16 a[204:207], a[208:211], v[48:51], a[204:207]
    v_exp_f32 v15, v15
    v_mfma_f32_16x16x32_bf16 a[204:207], a[208:211], v[56:59], a[204:207]
    ds_read_b64_tr_b16 a[152:153], v87 offset:16384
    v_mfma_f32_16x16x32_bf16 v[32:35], a[64:67], a[32:35], v[72:75]
    v_exp_f32 v28, v28
    v_mfma_f32_16x16x32_bf16 v[32:35], a[68:71], a[36:39], v[32:35]
    ds_read_b64_tr_b16 a[154:155], v87 offset:20480
    v_cvt_pk_bf16_f32 v11, v14, v15
    v_mfma_f32_16x16x32_bf16 v[32:35], a[72:75], a[40:43], v[32:35]
    v_exp_f32 v29, v29
    v_mfma_f32_16x16x32_bf16 v[32:35], a[76:79], a[44:47], v[32:35]
    buffer_load_dwordx4 v[120:123], v127, s[40:43], s61 offen offset:3072
    s_add_u32 s61, s61, 4096
    ds_read_b64_tr_b16 a[156:157], v87 offset:24576
    v_mfma_f32_16x16x32_bf16 v[48:51], a[64:67], a[48:51], v[76:79]
    v_exp_f32 v30, v30
    v_mfma_f32_16x16x32_bf16 v[48:51], a[68:71], a[52:55], v[48:51]
    ds_read_b64_tr_b16 a[158:159], v87 offset:28672
    v_cvt_pk_bf16_f32 v26, v28, v29
    v_mfma_f32_16x16x32_bf16 v[48:51], a[72:75], a[56:59], v[48:51]
    v_exp_f32 v31, v31
    v_mfma_f32_16x16x32_bf16 v[48:51], a[76:79], a[60:63], v[48:51]
    ds_read_b64_tr_b16 a[160:161], v88 offset:16384
    v_mfma_f32_16x16x32_bf16 v[36:39], a[80:83], a[32:35], v[72:75]
    ds_read_b64_tr_b16 a[162:163], v88 offset:20480
    v_mfma_f32_16x16x32_bf16 v[36:39], a[84:87], a[36:39], v[36:39]
    buffer_load_dwordx4 v[120:123], v127, s[40:43], s61 offen offset:0
    ds_read_b64_tr_b16 a[164:165], v88 offset:24576
    v_cvt_pk_bf16_f32 v27, v30, v31
    v_mfma_f32_16x16x32_bf16 v[36:39], a[88:91], a[40:43], v[36:39]
    ds_read_b64_tr_b16 a[166:167], v88 offset:28672
    v_mfma_f32_16x16x32_bf16 v[36:39], a[92:95], a[44:47], v[36:39]
    ds_read_b64_tr_b16 a[168:169], v89 offset:16384
    v_mfma_f32_16x16x32_bf16 v[52:55], a[80:83], a[48:51], v[76:79]
    v_exp_f32 v32, v32
    v_mfma_f32_16x16x32_bf16 v[52:55], a[84:87], a[52:55], v[52:55]
    ds_read_b64_tr_b16 a[170:171], v89 offset:20480
    v_mfma_f32_16x16x32_bf16 v[52:55], a[88:91], a[56:59], v[52:55]
    v_exp_f32 v33, v33
    v_mfma_f32_16x16x32_bf16 v[52:55], a[92:95], a[60:63], v[52:55]
    buffer_load_dwordx4 v[120:123], v127, s[40:43], s61 offen offset:1024
    ds_read_b64_tr_b16 a[172:173], v89 offset:24576
    v_mfma_f32_16x16x32_bf16 v[40:43], a[96:99], a[32:35], v[72:75]
    v_exp_f32 v34, v34
    v_mfma_f32_16x16x32_bf16 v[40:43], a[100:103], a[36:39], v[40:43]
    ds_read_b64_tr_b16 a[174:175], v89 offset:28672
    v_cvt_pk_bf16_f32 v32, v32, v33
    v_mfma_f32_16x16x32_bf16 v[40:43], a[104:107], a[40:43], v[40:43]
    v_exp_f32 v35, v35
    v_mfma_f32_16x16x32_bf16 v[40:43], a[108:111], a[44:47], v[40:43]
    ds_read_b64_tr_b16 a[176:177], v90 offset:16384
    v_mfma_f32_16x16x32_bf16 v[56:59], a[96:99], a[48:51], v[76:79]
    v_exp_f32 v48, v48
    v_mfma_f32_16x16x32_bf16 v[56:59], a[100:103], a[52:55], v[56:59]
    buffer_load_dwordx4 v[120:123], v127, s[40:43], s61 offen offset:2048
    ds_read_b64_tr_b16 a[178:179], v90 offset:20480
    v_cvt_pk_bf16_f32 v33, v34, v35
    v_mfma_f32_16x16x32_bf16 v[56:59], a[104:107], a[56:59], v[56:59]
    v_exp_f32 v49, v49
    v_mfma_f32_16x16x32_bf16 v[56:59], a[108:111], a[60:63], v[56:59]
    ds_read_b64_tr_b16 a[180:181], v90 offset:24576
    v_mfma_f32_16x16x32_bf16 v[44:47], a[112:115], a[32:35], v[72:75]
    v_exp_f32 v50, v50
    v_mfma_f32_16x16x32_bf16 v[44:47], a[116:119], a[36:39], v[44:47]
    ds_read_b64_tr_b16 a[182:183], v90 offset:28672
    v_cvt_pk_bf16_f32 v48, v48, v49
    v_mfma_f32_16x16x32_bf16 v[44:47], a[120:123], a[40:43], v[44:47]
    v_exp_f32 v51, v51
    v_mfma_f32_16x16x32_bf16 v[44:47], a[124:127], a[44:47], v[44:47]
    buffer_load_dwordx4 v[120:123], v127, s[40:43], s61 offen offset:3072
    s_add_u32 s61, s61, 4096
    ds_read_b64_tr_b16 a[184:185], v91 offset:16384
    v_mfma_f32_16x16x32_bf16 v[60:63], a[112:115], a[48:51], v[76:79]
    v_exp_f32 v36, v36
    v_mfma_f32_16x16x32_bf16 v[60:63], a[116:119], a[52:55], v[60:63]
    ds_read_b64_tr_b16 a[186:187], v91 offset:20480
    v_cvt_pk_bf16_f32 v49, v50, v51
    v_mfma_f32_16x16x32_bf16 v[60:63], a[120:123], a[56:59], v[60:63]
    v_exp_f32 v37, v37
    v_mfma_f32_16x16x32_bf16 v[60:63], a[124:127], a[60:63], v[60:63]
    ds_read_b64_tr_b16 a[188:189], v91 offset:24576
    s_waitcnt lgkmcnt(5)
    v_mfma_f32_16x16x32_bf16 v[128:131], a[128:131], v[0:3], v[128:131]
    v_exp_f32 v38, v38
    v_mfma_f32_16x16x32_bf16 v[128:131], a[132:135], v[8:11], v[128:131]
    buffer_load_dwordx4 v[120:123], v127, s[40:43], s61 offen offset:0
    ds_read_b64_tr_b16 a[190:191], v91 offset:28672
    v_cvt_pk_bf16_f32 v34, v36, v37
    v_mfma_f32_16x16x32_bf16 v[160:163], a[128:131], v[16:19], v[160:163]
    v_exp_f32 v39, v39
    v_mfma_f32_16x16x32_bf16 v[160:163], a[132:135], v[24:27], v[160:163]
    ds_read_b128 a[64:67], v80 offset:16384
    v_mfma_f32_16x16x32_bf16 v[132:135], a[136:139], v[0:3], v[132:135]
    v_exp_f32 v52, v52
    v_mfma_f32_16x16x32_bf16 v[132:135], a[140:143], v[8:11], v[132:135]
    ds_read_b128 a[68:71], v81 offset:16384
    v_cvt_pk_bf16_f32 v35, v38, v39
    v_mfma_f32_16x16x32_bf16 v[164:167], a[136:139], v[16:19], v[164:167]
    v_exp_f32 v53, v53
    v_mfma_f32_16x16x32_bf16 v[164:167], a[140:143], v[24:27], v[164:167]
    buffer_load_dwordx4 v[120:123], v127, s[40:43], s61 offen offset:1024
    ds_read_b128 a[72:75], v82 offset:16384
    v_mfma_f32_16x16x32_bf16 v[136:139], a[144:147], v[0:3], v[136:139]
    v_exp_f32 v54, v54
    v_mfma_f32_16x16x32_bf16 v[136:139], a[148:151], v[8:11], v[136:139]
    ds_read_b128 a[76:79], v83 offset:16384
    v_cvt_pk_bf16_f32 v50, v52, v53
    v_mfma_f32_16x16x32_bf16 v[168:171], a[144:147], v[16:19], v[168:171]
    v_exp_f32 v55, v55
    v_mfma_f32_16x16x32_bf16 v[168:171], a[148:151], v[24:27], v[168:171]
    ds_read_b128 a[80:83], v80 offset:20480
    v_mfma_f32_16x16x32_bf16 v[140:143], a[152:155], v[0:3], v[140:143]
    v_exp_f32 v40, v40
    v_mfma_f32_16x16x32_bf16 v[140:143], a[156:159], v[8:11], v[140:143]
    ds_read_b128 a[84:87], v81 offset:20480
    v_cvt_pk_bf16_f32 v51, v54, v55
    v_mfma_f32_16x16x32_bf16 v[172:175], a[152:155], v[16:19], v[172:175]
    v_exp_f32 v41, v41
    v_mfma_f32_16x16x32_bf16 v[172:175], a[156:159], v[24:27], v[172:175]
    ds_read_b128 a[88:91], v82 offset:20480
    v_mfma_f32_16x16x32_bf16 v[144:147], a[160:163], v[0:3], v[144:147]
    v_exp_f32 v42, v42
    v_mfma_f32_16x16x32_bf16 v[144:147], a[164:167], v[8:11], v[144:147]
    ds_read_b128 a[92:95], v83 offset:20480
    v_cvt_pk_bf16_f32 v40, v40, v41
    v_mfma_f32_16x16x32_bf16 v[176:179], a[160:163], v[16:19], v[176:179]
    v_exp_f32 v43, v43
    v_mfma_f32_16x16x32_bf16 v[176:179], a[164:167], v[24:27], v[176:179]
    ds_read_b128 a[96:99], v80 offset:24576
    v_mfma_f32_16x16x32_bf16 v[148:151], a[168:171], v[0:3], v[148:151]
    v_exp_f32 v56, v56
    v_mfma_f32_16x16x32_bf16 v[148:151], a[172:175], v[8:11], v[148:151]
    ds_read_b128 a[100:103], v81 offset:24576
    v_cvt_pk_bf16_f32 v41, v42, v43
    v_mfma_f32_16x16x32_bf16 v[180:183], a[168:171], v[16:19], v[180:183]
    v_exp_f32 v57, v57
    v_mfma_f32_16x16x32_bf16 v[180:183], a[172:175], v[24:27], v[180:183]
    ds_read_b128 a[104:107], v82 offset:24576
    v_mfma_f32_16x16x32_bf16 v[152:155], a[176:179], v[0:3], v[152:155]
    s_waitcnt lgkmcnt(4)
    v_exp_f32 v58, v58
    v_mfma_f32_16x16x32_bf16 v[152:155], a[180:183], v[8:11], v[152:155]
    ds_read_b128 a[108:111], v83 offset:24576
    v_cvt_pk_bf16_f32 v56, v56, v57
    v_mfma_f32_16x16x32_bf16 v[184:187], a[176:179], v[16:19], v[184:187]
    v_exp_f32 v59, v59
    v_mfma_f32_16x16x32_bf16 v[184:187], a[180:183], v[24:27], v[184:187]
    ds_read_b128 a[112:115], v80 offset:28672
    v_mfma_f32_16x16x32_bf16 v[156:159], a[184:187], v[0:3], v[156:159]
    v_exp_f32 v44, v44
    v_mfma_f32_16x16x32_bf16 v[156:159], a[188:191], v[8:11], v[156:159]
    ds_read_b128 a[116:119], v81 offset:28672
    v_cvt_pk_bf16_f32 v57, v58, v59
    v_mfma_f32_16x16x32_bf16 v[188:191], a[184:187], v[16:19], v[188:191]
    v_exp_f32 v45, v45
    v_mfma_f32_16x16x32_bf16 v[188:191], a[188:191], v[24:27], v[188:191]
    ds_read_b128 a[120:123], v82 offset:28672
    v_mfma_f32_16x16x32_bf16 a[192:195], a[208:211], v[0:3], a[192:195]
    v_exp_f32 v46, v46
    v_mfma_f32_16x16x32_bf16 a[192:195], a[208:211], v[8:11], a[192:195]
    ds_read_b128 a[124:127], v83 offset:28672
    v_cvt_pk_bf16_f32 v42, v44, v45
    v_mfma_f32_16x16x32_bf16 a[196:199], a[208:211], v[16:19], a[196:199]
    v_exp_f32 v47, v47
    v_mfma_f32_16x16x32_bf16 a[196:199], a[208:211], v[24:27], a[196:199]
    s_add_u32 s23, s23, 16384
    s_waitcnt lgkmcnt(4)
    v_mfma_f32_16x16x32_bf16 v[0:3], a[64:67], a[0:3], v[64:67]
    v_exp_f32 v60, v60
    v_mfma_f32_16x16x32_bf16 v[0:3], a[68:71], a[4:7], v[0:3]
    s_waitcnt vmcnt(14)
    v_cvt_pk_bf16_f32 v43, v46, v47
    v_mfma_f32_16x16x32_bf16 v[0:3], a[72:75], a[8:11], v[0:3]
    s_barrier
    v_exp_f32 v61, v61
    v_mfma_f32_16x16x32_bf16 v[0:3], a[76:79], a[12:15], v[0:3]
    v_mfma_f32_16x16x32_bf16 v[16:19], a[64:67], a[16:19], v[68:71]
    v_exp_f32 v62, v62
    v_mfma_f32_16x16x32_bf16 v[16:19], a[68:71], a[20:23], v[16:19]
    v_cvt_pk_bf16_f32 v58, v60, v61
    v_mfma_f32_16x16x32_bf16 v[16:19], a[72:75], a[24:27], v[16:19]
    v_exp_f32 v63, v63
    v_mfma_f32_16x16x32_bf16 v[16:19], a[76:79], a[28:31], v[16:19]
    buffer_load_dwordx4 v[120:123], v127, s[40:43], s61 offen offset:2048
    v_mfma_f32_16x16x32_bf16 v[4:7], a[80:83], a[0:3], v[64:67]
    v_mfma_f32_16x16x32_bf16 v[4:7], a[84:87], a[4:7], v[4:7]
    v_cvt_pk_bf16_f32 v59, v62, v63
    v_mfma_f32_16x16x32_bf16 v[4:7], a[88:91], a[8:11], v[4:7]
    v_mfma_f32_16x16x32_bf16 v[4:7], a[92:95], a[12:15], v[4:7]
    v_mfma_f32_16x16x32_bf16 v[20:23], a[80:83], a[16:19], v[68:71]
    v_exp_f32 v0, v0
    v_mfma_f32_16x16x32_bf16 v[20:23], a[84:87], a[20:23], v[20:23]
    v_mfma_f32_16x16x32_bf16 v[20:23], a[88:91], a[24:27], v[20:23]
    v_exp_f32 v1, v1
    v_mfma_f32_16x16x32_bf16 v[20:23], a[92:95], a[28:31], v[20:23]
    v_mfma_f32_16x16x32_bf16 v[8:11], a[96:99], a[0:3], v[64:67]
    v_exp_f32 v2, v2
    v_mfma_f32_16x16x32_bf16 v[8:11], a[100:103], a[4:7], v[8:11]
    buffer_load_dword v120, v126, s[56:59], s63 offen
    v_cvt_pk_bf16_f32 v0, v0, v1
    v_mfma_f32_16x16x32_bf16 v[8:11], a[104:107], a[8:11], v[8:11]
    v_exp_f32 v3, v3
    v_mfma_f32_16x16x32_bf16 v[8:11], a[108:111], a[12:15], v[8:11]
    v_mfma_f32_16x16x32_bf16 v[24:27], a[96:99], a[16:19], v[68:71]
    v_exp_f32 v16, v16
    v_mfma_f32_16x16x32_bf16 v[24:27], a[100:103], a[20:23], v[24:27]
    v_cvt_pk_bf16_f32 v1, v2, v3
    v_mfma_f32_16x16x32_bf16 v[24:27], a[104:107], a[24:27], v[24:27]
    v_exp_f32 v17, v17
    v_mfma_f32_16x16x32_bf16 v[24:27], a[108:111], a[28:31], v[24:27]
    s_waitcnt lgkmcnt(0)
    v_mfma_f32_16x16x32_bf16 v[12:15], a[112:115], a[0:3], v[64:67]
    v_exp_f32 v18, v18
    v_mfma_f32_16x16x32_bf16 v[12:15], a[116:119], a[4:7], v[12:15]
    v_cvt_pk_bf16_f32 v16, v16, v17
    v_mfma_f32_16x16x32_bf16 v[12:15], a[120:123], a[8:11], v[12:15]
    v_exp_f32 v19, v19
    v_mfma_f32_16x16x32_bf16 v[12:15], a[124:127], a[12:15], v[12:15]
    buffer_store_dwordx4 v[116:119], v127, s[44:47], s62 offen offset:0 sc1
    v_mfma_f32_16x16x32_bf16 v[28:31], a[112:115], a[16:19], v[68:71]
    v_exp_f32 v4, v4
    v_mfma_f32_16x16x32_bf16 v[28:31], a[116:119], a[20:23], v[28:31]
    v_cvt_pk_bf16_f32 v17, v18, v19
    v_mfma_f32_16x16x32_bf16 v[28:31], a[120:123], a[24:27], v[28:31]
    v_exp_f32 v5, v5
    v_mfma_f32_16x16x32_bf16 v[28:31], a[124:127], a[28:31], v[28:31]
    v_mfma_f32_16x16x32_bf16 v[192:195], a[128:131], v[32:35], v[192:195]
    v_exp_f32 v6, v6
    v_mfma_f32_16x16x32_bf16 v[192:195], a[132:135], v[40:43], v[192:195]
    v_cvt_pk_bf16_f32 v2, v4, v5
    v_mfma_f32_16x16x32_bf16 v[224:227], a[128:131], v[48:51], v[224:227]
    v_exp_f32 v7, v7
    v_mfma_f32_16x16x32_bf16 v[224:227], a[132:135], v[56:59], v[224:227]
    v_mfma_f32_16x16x32_bf16 v[196:199], a[136:139], v[32:35], v[196:199]
    v_exp_f32 v20, v20
    v_mfma_f32_16x16x32_bf16 v[196:199], a[140:143], v[40:43], v[196:199]
    buffer_store_dwordx4 v[116:119], v127, s[44:47], s62 offen offset:1024 sc1
    v_cvt_pk_bf16_f32 v3, v6, v7
    v_mfma_f32_16x16x32_bf16 v[228:231], a[136:139], v[48:51], v[228:231]
    v_exp_f32 v21, v21
    v_mfma_f32_16x16x32_bf16 v[228:231], a[140:143], v[56:59], v[228:231]
    ds_read_b64_tr_b16 a[128:129], v84 offset:32768
    v_mfma_f32_16x16x32_bf16 v[200:203], a[144:147], v[32:35], v[200:203]
    v_exp_f32 v22, v22
    v_mfma_f32_16x16x32_bf16 v[200:203], a[148:151], v[40:43], v[200:203]
    ds_read_b64_tr_b16 a[130:131], v84 offset:36864
    v_cvt_pk_bf16_f32 v18, v20, v21
    v_mfma_f32_16x16x32_bf16 v[232:235], a[144:147], v[48:51], v[232:235]
    v_exp_f32 v23, v23
    v_mfma_f32_16x16x32_bf16 v[232:235], a[148:151], v[56:59], v[232:235]
    v_mfma_f32_16x16x32_bf16 v[204:207], a[152:155], v[32:35], v[204:207]
    v_exp_f32 v8, v8
    v_mfma_f32_16x16x32_bf16 v[204:207], a[156:159], v[40:43], v[204:207]
    ds_read_b64_tr_b16 a[132:133], v84 offset:40960
    v_cvt_pk_bf16_f32 v19, v22, v23
    v_mfma_f32_16x16x32_bf16 v[236:239], a[152:155], v[48:51], v[236:239]
    v_exp_f32 v9, v9
    v_mfma_f32_16x16x32_bf16 v[236:239], a[156:159], v[56:59], v[236:239]
    buffer_store_dwordx4 v[116:119], v127, s[44:47], s62 offen offset:2048 sc1
    ds_read_b64_tr_b16 a[134:135], v84 offset:45056
    v_mfma_f32_16x16x32_bf16 v[208:211], a[160:163], v[32:35], v[208:211]
    v_exp_f32 v10, v10
    v_mfma_f32_16x16x32_bf16 v[208:211], a[164:167], v[40:43], v[208:211]
    v_cvt_pk_bf16_f32 v8, v8, v9
    v_mfma_f32_16x16x32_bf16 v[240:243], a[160:163], v[48:51], v[240:243]
    v_exp_f32 v11, v11
    v_mfma_f32_16x16x32_bf16 v[240:243], a[164:167], v[56:59], v[240:243]
    ds_read_b64_tr_b16 a[136:137], v85 offset:32768
    v_mfma_f32_16x16x32_bf16 v[212:215], a[168:171], v[32:35], v[212:215]
    v_exp_f32 v24, v24
    v_mfma_f32_16x16x32_bf16 v[212:215], a[172:175], v[40:43], v[212:215]
    ds_read_b64_tr_b16 a[138:139], v85 offset:36864
    v_cvt_pk_bf16_f32 v9, v10, v11
    v_mfma_f32_16x16x32_bf16 v[244:247], a[168:171], v[48:51], v[244:247]
    v_exp_f32 v25, v25
    v_mfma_f32_16x16x32_bf16 v[244:247], a[172:175], v[56:59], v[244:247]
    ds_read_b64_tr_b16 a[140:141], v85 offset:40960
    v_mfma_f32_16x16x32_bf16 v[216:219], a[176:179], v[32:35], v[216:219]
    v_exp_f32 v26, v26
    v_mfma_f32_16x16x32_bf16 v[216:219], a[180:183], v[40:43], v[216:219]
    buffer_store_dwordx4 v[116:119], v127, s[44:47], s62 offen offset:3072 sc1
    s_add_u32 s62, s62, 4096
    ds_read_b64_tr_b16 a[142:143], v85 offset:45056
    v_cvt_pk_bf16_f32 v24, v24, v25
    v_mfma_f32_16x16x32_bf16 v[248:251], a[176:179], v[48:51], v[248:251]
    v_exp_f32 v27, v27
    v_mfma_f32_16x16x32_bf16 v[248:251], a[180:183], v[56:59], v[248:251]
    ds_read_b64_tr_b16 a[144:145], v86 offset:32768
    v_mfma_f32_16x16x32_bf16 v[220:223], a[184:187], v[32:35], v[220:223]
    v_exp_f32 v12, v12
    v_mfma_f32_16x16x32_bf16 v[220:223], a[188:191], v[40:43], v[220:223]
    ds_read_b64_tr_b16 a[146:147], v86 offset:36864
    v_cvt_pk_bf16_f32 v25, v26, v27
    v_mfma_f32_16x16x32_bf16 v[252:255], a[184:187], v[48:51], v[252:255]
    v_exp_f32 v13, v13
    v_mfma_f32_16x16x32_bf16 v[252:255], a[188:191], v[56:59], v[252:255]
    ds_read_b64_tr_b16 a[148:149], v86 offset:40960
    v_mfma_f32_16x16x32_bf16 a[200:203], a[208:211], v[32:35], a[200:203]
    v_exp_f32 v14, v14
    v_mfma_f32_16x16x32_bf16 a[200:203], a[208:211], v[40:43], a[200:203]
    ds_read_b64_tr_b16 a[150:151], v86 offset:45056
    v_cvt_pk_bf16_f32 v10, v12, v13
    v_mfma_f32_16x16x32_bf16 a[204:207], a[208:211], v[48:51], a[204:207]
    v_exp_f32 v15, v15
    v_mfma_f32_16x16x32_bf16 a[204:207], a[208:211], v[56:59], a[204:207]
    buffer_store_dwordx4 v[116:119], v127, s[44:47], s62 offen offset:0 sc1
    ds_read_b64_tr_b16 a[152:153], v87 offset:32768
    v_mfma_f32_16x16x32_bf16 v[32:35], a[64:67], a[32:35], v[72:75]
    v_exp_f32 v28, v28
    v_mfma_f32_16x16x32_bf16 v[32:35], a[68:71], a[36:39], v[32:35]
    ds_read_b64_tr_b16 a[154:155], v87 offset:36864
    v_cvt_pk_bf16_f32 v11, v14, v15
    v_mfma_f32_16x16x32_bf16 v[32:35], a[72:75], a[40:43], v[32:35]
    v_exp_f32 v29, v29
    v_mfma_f32_16x16x32_bf16 v[32:35], a[76:79], a[44:47], v[32:35]
    ds_read_b64_tr_b16 a[156:157], v87 offset:40960
    v_mfma_f32_16x16x32_bf16 v[48:51], a[64:67], a[48:51], v[76:79]
    v_exp_f32 v30, v30
    v_mfma_f32_16x16x32_bf16 v[48:51], a[68:71], a[52:55], v[48:51]
    ds_read_b64_tr_b16 a[158:159], v87 offset:45056
    v_cvt_pk_bf16_f32 v26, v28, v29
    v_mfma_f32_16x16x32_bf16 v[48:51], a[72:75], a[56:59], v[48:51]
    v_exp_f32 v31, v31
    v_mfma_f32_16x16x32_bf16 v[48:51], a[76:79], a[60:63], v[48:51]
    ds_read_b64_tr_b16 a[160:161], v88 offset:32768
    v_mfma_f32_16x16x32_bf16 v[36:39], a[80:83], a[32:35], v[72:75]
    ds_read_b64_tr_b16 a[162:163], v88 offset:36864
    v_mfma_f32_16x16x32_bf16 v[36:39], a[84:87], a[36:39], v[36:39]
    buffer_store_dwordx4 v[116:119], v127, s[44:47], s62 offen offset:1024 sc1
    ds_read_b64_tr_b16 a[164:165], v88 offset:40960
    v_cvt_pk_bf16_f32 v27, v30, v31
    v_mfma_f32_16x16x32_bf16 v[36:39], a[88:91], a[40:43], v[36:39]
    ds_read_b64_tr_b16 a[166:167], v88 offset:45056
    v_mfma_f32_16x16x32_bf16 v[36:39], a[92:95], a[44:47], v[36:39]
    ds_read_b64_tr_b16 a[168:169], v89 offset:32768
    v_mfma_f32_16x16x32_bf16 v[52:55], a[80:83], a[48:51], v[76:79]
    v_exp_f32 v32, v32
    v_mfma_f32_16x16x32_bf16 v[52:55], a[84:87], a[52:55], v[52:55]
    ds_read_b64_tr_b16 a[170:171], v89 offset:36864
    v_mfma_f32_16x16x32_bf16 v[52:55], a[88:91], a[56:59], v[52:55]
    v_exp_f32 v33, v33
    v_mfma_f32_16x16x32_bf16 v[52:55], a[92:95], a[60:63], v[52:55]
    ds_read_b64_tr_b16 a[172:173], v89 offset:40960
    v_mfma_f32_16x16x32_bf16 v[40:43], a[96:99], a[32:35], v[72:75]
    v_exp_f32 v34, v34
    v_mfma_f32_16x16x32_bf16 v[40:43], a[100:103], a[36:39], v[40:43]
    ds_read_b64_tr_b16 a[174:175], v89 offset:45056
    v_cvt_pk_bf16_f32 v32, v32, v33
    v_mfma_f32_16x16x32_bf16 v[40:43], a[104:107], a[40:43], v[40:43]
    v_exp_f32 v35, v35
    v_mfma_f32_16x16x32_bf16 v[40:43], a[108:111], a[44:47], v[40:43]
    buffer_store_dwordx4 v[116:119], v127, s[44:47], s62 offen offset:2048 sc1
    ds_read_b64_tr_b16 a[176:177], v90 offset:32768
    v_mfma_f32_16x16x32_bf16 v[56:59], a[96:99], a[48:51], v[76:79]
    v_exp_f32 v48, v48
    v_mfma_f32_16x16x32_bf16 v[56:59], a[100:103], a[52:55], v[56:59]
    ds_read_b64_tr_b16 a[178:179], v90 offset:36864
    v_cvt_pk_bf16_f32 v33, v34, v35
    v_mfma_f32_16x16x32_bf16 v[56:59], a[104:107], a[56:59], v[56:59]
    v_exp_f32 v49, v49
    v_mfma_f32_16x16x32_bf16 v[56:59], a[108:111], a[60:63], v[56:59]
    ds_read_b64_tr_b16 a[180:181], v90 offset:40960
    v_mfma_f32_16x16x32_bf16 v[44:47], a[112:115], a[32:35], v[72:75]
    v_exp_f32 v50, v50
    v_mfma_f32_16x16x32_bf16 v[44:47], a[116:119], a[36:39], v[44:47]
    ds_read_b64_tr_b16 a[182:183], v90 offset:45056
    v_cvt_pk_bf16_f32 v48, v48, v49
    v_mfma_f32_16x16x32_bf16 v[44:47], a[120:123], a[40:43], v[44:47]
    v_exp_f32 v51, v51
    v_mfma_f32_16x16x32_bf16 v[44:47], a[124:127], a[44:47], v[44:47]
    ds_read_b64_tr_b16 a[184:185], v91 offset:32768
    v_mfma_f32_16x16x32_bf16 v[60:63], a[112:115], a[48:51], v[76:79]
    v_exp_f32 v36, v36
    v_mfma_f32_16x16x32_bf16 v[60:63], a[116:119], a[52:55], v[60:63]
    ds_read_b64_tr_b16 a[186:187], v91 offset:36864
    v_cvt_pk_bf16_f32 v49, v50, v51
    v_mfma_f32_16x16x32_bf16 v[60:63], a[120:123], a[56:59], v[60:63]
    v_exp_f32 v37, v37
    v_mfma_f32_16x16x32_bf16 v[60:63], a[124:127], a[60:63], v[60:63]
    ds_read_b64_tr_b16 a[188:189], v91 offset:40960
    s_waitcnt lgkmcnt(5)
    v_mfma_f32_16x16x32_bf16 v[128:131], a[128:131], v[0:3], v[128:131]
    v_exp_f32 v38, v38
    v_mfma_f32_16x16x32_bf16 v[128:131], a[132:135], v[8:11], v[128:131]
    ds_read_b64_tr_b16 a[190:191], v91 offset:45056
    v_cvt_pk_bf16_f32 v34, v36, v37
    v_mfma_f32_16x16x32_bf16 v[160:163], a[128:131], v[16:19], v[160:163]
    v_exp_f32 v39, v39
    v_mfma_f32_16x16x32_bf16 v[160:163], a[132:135], v[24:27], v[160:163]
    ds_read_b128 a[64:67], v80 offset:32768
    v_mfma_f32_16x16x32_bf16 v[132:135], a[136:139], v[0:3], v[132:135]
    v_exp_f32 v52, v52
    v_mfma_f32_16x16x32_bf16 v[132:135], a[140:143], v[8:11], v[132:135]
    ds_read_b128 a[68:71], v81 offset:32768
    v_cvt_pk_bf16_f32 v35, v38, v39
    v_mfma_f32_16x16x32_bf16 v[164:167], a[136:139], v[16:19], v[164:167]
    v_exp_f32 v53, v53
    v_mfma_f32_16x16x32_bf16 v[164:167], a[140:143], v[24:27], v[164:167]
    ds_read_b128 a[72:75], v82 offset:32768
    v_mfma_f32_16x16x32_bf16 v[136:139], a[144:147], v[0:3], v[136:139]
    v_exp_f32 v54, v54
    v_mfma_f32_16x16x32_bf16 v[136:139], a[148:151], v[8:11], v[136:139]
    ds_read_b128 a[76:79], v83 offset:32768
    v_cvt_pk_bf16_f32 v50, v52, v53
    v_mfma_f32_16x16x32_bf16 v[168:171], a[144:147], v[16:19], v[168:171]
    v_exp_f32 v55, v55
    v_mfma_f32_16x16x32_bf16 v[168:171], a[148:151], v[24:27], v[168:171]
    ds_read_b128 a[80:83], v80 offset:36864
    v_mfma_f32_16x16x32_bf16 v[140:143], a[152:155], v[0:3], v[140:143]
    v_exp_f32 v40, v40
    v_mfma_f32_16x16x32_bf16 v[140:143], a[156:159], v[8:11], v[140:143]
    ds_read_b128 a[84:87], v81 offset:36864
    v_cvt_pk_bf16_f32 v51, v54, v55
    v_mfma_f32_16x16x32_bf16 v[172:175], a[152:155], v[16:19], v[172:175]
    v_exp_f32 v41, v41
    v_mfma_f32_16x16x32_bf16 v[172:175], a[156:159], v[24:27], v[172:175]
    ds_read_b128 a[88:91], v82 offset:36864
    v_mfma_f32_16x16x32_bf16 v[144:147], a[160:163], v[0:3], v[144:147]
    v_exp_f32 v42, v42
    v_mfma_f32_16x16x32_bf16 v[144:147], a[164:167], v[8:11], v[144:147]
    ds_read_b128 a[92:95], v83 offset:36864
    v_cvt_pk_bf16_f32 v40, v40, v41
    v_mfma_f32_16x16x32_bf16 v[176:179], a[160:163], v[16:19], v[176:179]
    v_exp_f32 v43, v43
    v_mfma_f32_16x16x32_bf16 v[176:179], a[164:167], v[24:27], v[176:179]
    ds_read_b128 a[96:99], v80 offset:40960
    v_mfma_f32_16x16x32_bf16 v[148:151], a[168:171], v[0:3], v[148:151]
    v_exp_f32 v56, v56
    v_mfma_f32_16x16x32_bf16 v[148:151], a[172:175], v[8:11], v[148:151]
    ds_read_b128 a[100:103], v81 offset:40960
    v_cvt_pk_bf16_f32 v41, v42, v43
    v_mfma_f32_16x16x32_bf16 v[180:183], a[168:171], v[16:19], v[180:183]
    v_exp_f32 v57, v57
    v_mfma_f32_16x16x32_bf16 v[180:183], a[172:175], v[24:27], v[180:183]
    ds_read_b128 a[104:107], v82 offset:40960
    v_mfma_f32_16x16x32_bf16 v[152:155], a[176:179], v[0:3], v[152:155]
    s_waitcnt lgkmcnt(4)
    v_exp_f32 v58, v58
    v_mfma_f32_16x16x32_bf16 v[152:155], a[180:183], v[8:11], v[152:155]
    ds_read_b128 a[108:111], v83 offset:40960
    v_cvt_pk_bf16_f32 v56, v56, v57
    v_mfma_f32_16x16x32_bf16 v[184:187], a[176:179], v[16:19], v[184:187]
    v_exp_f32 v59, v59
    v_mfma_f32_16x16x32_bf16 v[184:187], a[180:183], v[24:27], v[184:187]
    ds_read_b128 a[112:115], v80 offset:45056
    v_mfma_f32_16x16x32_bf16 v[156:159], a[184:187], v[0:3], v[156:159]
    v_exp_f32 v44, v44
    v_mfma_f32_16x16x32_bf16 v[156:159], a[188:191], v[8:11], v[156:159]
    ds_read_b128 a[116:119], v81 offset:45056
    v_cvt_pk_bf16_f32 v57, v58, v59
    v_mfma_f32_16x16x32_bf16 v[188:191], a[184:187], v[16:19], v[188:191]
    v_exp_f32 v45, v45
    v_mfma_f32_16x16x32_bf16 v[188:191], a[188:191], v[24:27], v[188:191]
    ds_read_b128 a[120:123], v82 offset:45056
    v_mfma_f32_16x16x32_bf16 a[192:195], a[208:211], v[0:3], a[192:195]
    v_exp_f32 v46, v46
    v_mfma_f32_16x16x32_bf16 a[192:195], a[208:211], v[8:11], a[192:195]
    ds_read_b128 a[124:127], v83 offset:45056
    v_cvt_pk_bf16_f32 v42, v44, v45
    v_mfma_f32_16x16x32_bf16 a[196:199], a[208:211], v[16:19], a[196:199]
    v_exp_f32 v47, v47
    v_mfma_f32_16x16x32_bf16 a[196:199], a[208:211], v[24:27], a[196:199]
    s_waitcnt lgkmcnt(4)
    v_mfma_f32_16x16x32_bf16 v[0:3], a[64:67], a[0:3], v[64:67]
    v_exp_f32 v60, v60
    v_mfma_f32_16x16x32_bf16 v[0:3], a[68:71], a[4:7], v[0:3]
    s_waitcnt vmcnt(19) lgkmcnt(0)
    v_cvt_pk_bf16_f32 v43, v46, v47
    v_mfma_f32_16x16x32_bf16 v[0:3], a[72:75], a[8:11], v[0:3]
    s_barrier
    v_exp_f32 v61, v61
    v_mfma_f32_16x16x32_bf16 v[0:3], a[76:79], a[12:15], v[0:3]
    v_mfma_f32_16x16x32_bf16 v[16:19], a[64:67], a[16:19], v[68:71]
    v_exp_f32 v62, v62
    v_mfma_f32_16x16x32_bf16 v[16:19], a[68:71], a[20:23], v[16:19]
    s_and_b32 s26, s2, 3
    v_cvt_pk_bf16_f32 v58, v60, v61
    v_mfma_f32_16x16x32_bf16 v[16:19], a[72:75], a[24:27], v[16:19]
    v_exp_f32 v63, v63
    v_mfma_f32_16x16x32_bf16 v[16:19], a[76:79], a[28:31], v[16:19]
    s_and_b32 s57, s2, 3
    v_mfma_f32_16x16x32_bf16 v[4:7], a[80:83], a[0:3], v[64:67]
    v_mfma_f32_16x16x32_bf16 v[4:7], a[84:87], a[4:7], v[4:7]
    s_lshl_b32 s57, s57, 2
    v_cvt_pk_bf16_f32 v59, v62, v63
    v_mfma_f32_16x16x32_bf16 v[4:7], a[88:91], a[8:11], v[4:7]
    v_mfma_f32_16x16x32_bf16 v[4:7], a[92:95], a[12:15], v[4:7]
    s_lshr_b32 s57, 8211, s57
    v_mfma_f32_16x16x32_bf16 v[20:23], a[80:83], a[16:19], v[68:71]
    v_exp_f32 v0, v0
    v_mfma_f32_16x16x32_bf16 v[20:23], a[84:87], a[20:23], v[20:23]
    s_and_b32 s57, s57, 3
    v_mfma_f32_16x16x32_bf16 v[20:23], a[88:91], a[24:27], v[20:23]
    v_exp_f32 v1, v1
    v_mfma_f32_16x16x32_bf16 v[20:23], a[92:95], a[28:31], v[20:23]
    s_mov_b32 s77, 2047
    v_mfma_f32_16x16x32_bf16 v[8:11], a[96:99], a[0:3], v[64:67]
    v_exp_f32 v2, v2
    v_mfma_f32_16x16x32_bf16 v[8:11], a[100:103], a[4:7], v[8:11]
    s_cmp_eq_u32 s57, 1
    s_cselect_b32 s77, 4192256, s77
    v_cvt_pk_bf16_f32 v0, v0, v1
    v_mfma_f32_16x16x32_bf16 v[8:11], a[104:107], a[8:11], v[8:11]
    v_exp_f32 v3, v3
    v_mfma_f32_16x16x32_bf16 v[8:11], a[108:111], a[12:15], v[8:11]
    s_cmp_eq_u32 s57, 2
    s_cselect_b32 s77, 4290772992, s77
    v_mfma_f32_16x16x32_bf16 v[24:27], a[96:99], a[16:19], v[68:71]
    v_exp_f32 v16, v16
    v_mfma_f32_16x16x32_bf16 v[24:27], a[100:103], a[20:23], v[24:27]
    s_cmp_eq_u32 s57, 3
    s_cselect_b32 s77, 0x7ff, s77
    s_cselect_b32 s23, 0, s77
    s_cselect_b32 s56, 0, 0
    v_cvt_pk_bf16_f32 v1, v2, v3
    v_mfma_f32_16x16x32_bf16 v[24:27], a[104:107], a[24:27], v[24:27]
    v_exp_f32 v17, v17
    v_mfma_f32_16x16x32_bf16 v[24:27], a[108:111], a[28:31], v[24:27]
    s_andn2_b32 s59, s71, 0x7f
    s_waitcnt lgkmcnt(0)
    v_mfma_f32_16x16x32_bf16 v[12:15], a[112:115], a[0:3], v[64:67]
    v_exp_f32 v18, v18
    v_mfma_f32_16x16x32_bf16 v[12:15], a[116:119], a[4:7], v[12:15]
    s_lshl_b32 s58, s20, 14
    v_cvt_pk_bf16_f32 v16, v16, v17
    v_mfma_f32_16x16x32_bf16 v[12:15], a[120:123], a[8:11], v[12:15]
    v_exp_f32 v19, v19
    v_mfma_f32_16x16x32_bf16 v[12:15], a[124:127], a[12:15], v[12:15]
    s_bfe_u32 s28, s2, 0x20003
    v_mfma_f32_16x16x32_bf16 v[28:31], a[112:115], a[16:19], v[68:71]
    v_exp_f32 v4, v4
    v_mfma_f32_16x16x32_bf16 v[28:31], a[116:119], a[20:23], v[28:31]
    s_lshl_b32 s67, s28, 8
    v_cvt_pk_bf16_f32 v17, v18, v19
    v_mfma_f32_16x16x32_bf16 v[28:31], a[120:123], a[24:27], v[28:31]
    v_exp_f32 v5, v5
    v_mfma_f32_16x16x32_bf16 v[28:31], a[124:127], a[28:31], v[28:31]
    s_add_u32 s58, s58, s67
    v_mfma_f32_16x16x32_bf16 v[192:195], a[128:131], v[32:35], v[192:195]
    v_exp_f32 v6, v6
    v_mfma_f32_16x16x32_bf16 v[192:195], a[132:135], v[40:43], v[192:195]
    s_lshr_b32 s30, s20, 1
    v_cvt_pk_bf16_f32 v2, v4, v5
    v_mfma_f32_16x16x32_bf16 v[224:227], a[128:131], v[48:51], v[224:227]
    v_exp_f32 v7, v7
    v_mfma_f32_16x16x32_bf16 v[224:227], a[132:135], v[56:59], v[224:227]
    s_lshl_b32 s31, s30, 7
    v_mfma_f32_16x16x32_bf16 v[196:199], a[136:139], v[32:35], v[196:199]
    v_exp_f32 v20, v20
    v_mfma_f32_16x16x32_bf16 v[196:199], a[140:143], v[40:43], v[196:199]
    s_add_u32 s67, s67, s31
    v_cvt_pk_bf16_f32 v3, v6, v7
    v_mfma_f32_16x16x32_bf16 v[228:231], a[136:139], v[48:51], v[228:231]
    v_exp_f32 v21, v21
    v_mfma_f32_16x16x32_bf16 v[228:231], a[140:143], v[56:59], v[228:231]
    s_lshl_b32 s63, s30, 17
    ds_read_b64_tr_b16 a[128:129], v84 offset:49152
    v_mfma_f32_16x16x32_bf16 v[200:203], a[144:147], v[32:35], v[200:203]
    v_exp_f32 v22, v22
    v_mfma_f32_16x16x32_bf16 v[200:203], a[148:151], v[40:43], v[200:203]
    s_lshl_b32 s29, s22, 4
    ds_read_b64_tr_b16 a[130:131], v84 offset:53248
    v_cvt_pk_bf16_f32 v18, v20, v21
    v_mfma_f32_16x16x32_bf16 v[232:235], a[144:147], v[48:51], v[232:235]
    v_exp_f32 v23, v23
    v_mfma_f32_16x16x32_bf16 v[232:235], a[148:151], v[56:59], v[232:235]
    s_bfe_u32 s30, s2, 0x10002
    v_mfma_f32_16x16x32_bf16 v[204:207], a[152:155], v[32:35], v[204:207]
    v_exp_f32 v8, v8
    v_mfma_f32_16x16x32_bf16 v[204:207], a[156:159], v[40:43], v[204:207]
    s_lshl_b32 s30, s30, 3
    ds_read_b64_tr_b16 a[132:133], v84 offset:57344
    v_cvt_pk_bf16_f32 v19, v22, v23
    v_mfma_f32_16x16x32_bf16 v[236:239], a[152:155], v[48:51], v[236:239]
    v_exp_f32 v9, v9
    v_mfma_f32_16x16x32_bf16 v[236:239], a[156:159], v[56:59], v[236:239]
    s_add_u32 s29, s29, s30
    ds_read_b64_tr_b16 a[134:135], v84 offset:61440
    v_mfma_f32_16x16x32_bf16 v[208:211], a[160:163], v[32:35], v[208:211]
    v_exp_f32 v10, v10
    v_mfma_f32_16x16x32_bf16 v[208:211], a[164:167], v[40:43], v[208:211]
    s_and_b32 s68, s20, 1
    v_cvt_pk_bf16_f32 v8, v8, v9
    v_mfma_f32_16x16x32_bf16 v[240:243], a[160:163], v[48:51], v[240:243]
    v_exp_f32 v11, v11
    v_mfma_f32_16x16x32_bf16 v[240:243], a[164:167], v[56:59], v[240:243]
    s_lshl_b32 s68, s68, 2
    ds_read_b64_tr_b16 a[136:137], v85 offset:49152
    v_mfma_f32_16x16x32_bf16 v[212:215], a[168:171], v[32:35], v[212:215]
    v_exp_f32 v24, v24
    v_mfma_f32_16x16x32_bf16 v[212:215], a[172:175], v[40:43], v[212:215]
    s_add_u32 s29, s29, s68
    ds_read_b64_tr_b16 a[138:139], v85 offset:53248
    v_cvt_pk_bf16_f32 v9, v10, v11
    v_mfma_f32_16x16x32_bf16 v[244:247], a[168:171], v[48:51], v[244:247]
    v_exp_f32 v25, v25
    v_mfma_f32_16x16x32_bf16 v[244:247], a[172:175], v[56:59], v[244:247]
    s_lshl_b32 s30, s29, 10
    ds_read_b64_tr_b16 a[140:141], v85 offset:57344
    v_mfma_f32_16x16x32_bf16 v[216:219], a[176:179], v[32:35], v[216:219]
    v_exp_f32 v26, v26
    v_mfma_f32_16x16x32_bf16 v[216:219], a[180:183], v[40:43], v[216:219]
    s_add_u32 s63, s63, s30
    ds_read_b64_tr_b16 a[142:143], v85 offset:61440
    v_cvt_pk_bf16_f32 v24, v24, v25
    v_mfma_f32_16x16x32_bf16 v[248:251], a[176:179], v[48:51], v[248:251]
    v_exp_f32 v27, v27
    v_mfma_f32_16x16x32_bf16 v[248:251], a[180:183], v[56:59], v[248:251]
    s_add_u32 s29, s29, s26
    ds_read_b64_tr_b16 a[144:145], v86 offset:49152
    v_mfma_f32_16x16x32_bf16 v[220:223], a[184:187], v[32:35], v[220:223]
    v_exp_f32 v12, v12
    v_mfma_f32_16x16x32_bf16 v[220:223], a[188:191], v[40:43], v[220:223]
    s_lshl_b32 s66, s29, 14
    ds_read_b64_tr_b16 a[146:147], v86 offset:53248
    v_cvt_pk_bf16_f32 v25, v26, v27
    v_mfma_f32_16x16x32_bf16 v[252:255], a[184:187], v[48:51], v[252:255]
    v_exp_f32 v13, v13
    v_mfma_f32_16x16x32_bf16 v[252:255], a[188:191], v[56:59], v[252:255]
    s_add_u32 s66, s66, s67
    ds_read_b64_tr_b16 a[148:149], v86 offset:57344
    v_mfma_f32_16x16x32_bf16 a[200:203], a[208:211], v[32:35], a[200:203]
    v_exp_f32 v14, v14
    v_mfma_f32_16x16x32_bf16 a[200:203], a[208:211], v[40:43], a[200:203]
    s_mov_b32 s70, 0
    ds_read_b64_tr_b16 a[150:151], v86 offset:61440
    v_cvt_pk_bf16_f32 v10, v12, v13
    v_mfma_f32_16x16x32_bf16 a[204:207], a[208:211], v[48:51], a[204:207]
    v_exp_f32 v15, v15
    v_mfma_f32_16x16x32_bf16 a[204:207], a[208:211], v[56:59], a[204:207]
    s_mov_b32 s25, 0x40000
    ds_read_b64_tr_b16 a[152:153], v87 offset:49152
    v_mfma_f32_16x16x32_bf16 v[32:35], a[64:67], a[32:35], v[72:75]
    v_exp_f32 v28, v28
    v_mfma_f32_16x16x32_bf16 v[32:35], a[68:71], a[36:39], v[32:35]
    v_lshrrev_b32 v82, 4, v102
    ds_read_b64_tr_b16 a[154:155], v87 offset:53248
    v_cvt_pk_bf16_f32 v11, v14, v15
    v_mfma_f32_16x16x32_bf16 v[32:35], a[72:75], a[40:43], v[32:35]
    v_exp_f32 v29, v29
    v_mfma_f32_16x16x32_bf16 v[32:35], a[76:79], a[44:47], v[32:35]
    v_mul_u32_u24 v82, 0x300, v82
    ds_read_b64_tr_b16 a[156:157], v87 offset:57344
    v_mfma_f32_16x16x32_bf16 v[48:51], a[64:67], a[48:51], v[76:79]
    v_exp_f32 v30, v30
    v_mfma_f32_16x16x32_bf16 v[48:51], a[68:71], a[52:55], v[48:51]
    v_add_u32 v92, v96, v82
    ds_read_b64_tr_b16 a[158:159], v87 offset:61440
    v_cvt_pk_bf16_f32 v26, v28, v29
    v_mfma_f32_16x16x32_bf16 v[48:51], a[72:75], a[56:59], v[48:51]
    v_exp_f32 v31, v31
    v_mfma_f32_16x16x32_bf16 v[48:51], a[76:79], a[60:63], v[48:51]
    v_add_u32 v93, v97, v82
    ds_read_b64_tr_b16 a[160:161], v88 offset:49152
    v_mfma_f32_16x16x32_bf16 v[36:39], a[80:83], a[32:35], v[72:75]
    ds_read_b64_tr_b16 a[162:163], v88 offset:53248
    v_mfma_f32_16x16x32_bf16 v[36:39], a[84:87], a[36:39], v[36:39]
    v_add_u32 v93, 3072, v93
    ds_read_b64_tr_b16 a[164:165], v88 offset:57344
    v_cvt_pk_bf16_f32 v27, v30, v31
    v_mfma_f32_16x16x32_bf16 v[36:39], a[88:91], a[40:43], v[36:39]
    ds_read_b64_tr_b16 a[166:167], v88 offset:61440
    v_mfma_f32_16x16x32_bf16 v[36:39], a[92:95], a[44:47], v[36:39]
    v_add_u32 v94, 6144, v92
    ds_read_b64_tr_b16 a[168:169], v89 offset:49152
    v_mfma_f32_16x16x32_bf16 v[52:55], a[80:83], a[48:51], v[76:79]
    v_exp_f32 v32, v32
    v_mfma_f32_16x16x32_bf16 v[52:55], a[84:87], a[52:55], v[52:55]
    v_add_u32 v95, 6144, v93
    ds_read_b64_tr_b16 a[170:171], v89 offset:53248
    v_mfma_f32_16x16x32_bf16 v[52:55], a[88:91], a[56:59], v[52:55]
    v_exp_f32 v33, v33
    v_mfma_f32_16x16x32_bf16 v[52:55], a[92:95], a[60:63], v[52:55]
    s_and_b32 s30, s77, s56
    s_cselect_b32 s30, s30, s77
    s_ff1_i32_b32 s96, s30
    ds_read_b64_tr_b16 a[172:173], v89 offset:57344
    v_mfma_f32_16x16x32_bf16 v[40:43], a[96:99], a[32:35], v[72:75]
    s_bitset0_b32 s77, s96
    s_lshl_b32 s30, s96, 17
    v_exp_f32 v34, v34
    v_mfma_f32_16x16x32_bf16 v[40:43], a[100:103], a[36:39], v[40:43]
    s_add_u32 s60, s30, s58
    s_add_u32 m0, s24, 0
    ds_read_b64_tr_b16 a[174:175], v89 offset:61440
    v_cvt_pk_bf16_f32 v32, v32, v33
    v_mfma_f32_16x16x32_bf16 v[40:43], a[104:107], a[40:43], v[40:43]
    v_exp_f32 v35, v35
    v_mfma_f32_16x16x32_bf16 v[40:43], a[108:111], a[44:47], v[40:43]
    buffer_load_dwordx4 v92, s[40:43], s60 offen offset:0 lds
    ds_read_b64_tr_b16 a[176:177], v90 offset:49152
    v_mfma_f32_16x16x32_bf16 v[56:59], a[96:99], a[48:51], v[76:79]
    v_exp_f32 v48, v48
    v_mfma_f32_16x16x32_bf16 v[56:59], a[100:103], a[52:55], v[56:59]
    buffer_load_dwordx4 v93, s[40:43], s60 offen offset:1024 lds
    ds_read_b64_tr_b16 a[178:179], v90 offset:53248
    v_cvt_pk_bf16_f32 v33, v34, v35
    v_mfma_f32_16x16x32_bf16 v[56:59], a[104:107], a[56:59], v[56:59]
    v_exp_f32 v49, v49
    v_mfma_f32_16x16x32_bf16 v[56:59], a[108:111], a[60:63], v[56:59]
    buffer_load_dwordx4 v94, s[40:43], s60 offen offset:2048 lds
    ds_read_b64_tr_b16 a[180:181], v90 offset:57344
    v_mfma_f32_16x16x32_bf16 v[44:47], a[112:115], a[32:35], v[72:75]
    v_exp_f32 v50, v50
    v_mfma_f32_16x16x32_bf16 v[44:47], a[116:119], a[36:39], v[44:47]
    buffer_load_dwordx4 v95, s[40:43], s60 offen offset:3072 lds
    ds_read_b64_tr_b16 a[182:183], v90 offset:61440
    v_cvt_pk_bf16_f32 v48, v48, v49
    v_mfma_f32_16x16x32_bf16 v[44:47], a[120:123], a[40:43], v[44:47]
    v_exp_f32 v51, v51
    v_mfma_f32_16x16x32_bf16 v[44:47], a[124:127], a[44:47], v[44:47]
    s_add_u32 s60, s60, 0x10000
    s_add_u32 m0, s24, 16384
    ds_read_b64_tr_b16 a[184:185], v91 offset:49152
    v_mfma_f32_16x16x32_bf16 v[60:63], a[112:115], a[48:51], v[76:79]
    v_exp_f32 v36, v36
    v_mfma_f32_16x16x32_bf16 v[60:63], a[116:119], a[52:55], v[60:63]
    buffer_load_dwordx4 v92, s[40:43], s60 offen offset:0 lds
    ds_read_b64_tr_b16 a[186:187], v91 offset:53248
    v_cvt_pk_bf16_f32 v49, v50, v51
    v_mfma_f32_16x16x32_bf16 v[60:63], a[120:123], a[56:59], v[60:63]
    v_exp_f32 v37, v37
    v_mfma_f32_16x16x32_bf16 v[60:63], a[124:127], a[60:63], v[60:63]
    buffer_load_dwordx4 v93, s[40:43], s60 offen offset:1024 lds
    ds_read_b64_tr_b16 a[188:189], v91 offset:57344
    s_waitcnt lgkmcnt(5)
    v_mfma_f32_16x16x32_bf16 v[128:131], a[128:131], v[0:3], v[128:131]
    v_exp_f32 v38, v38
    v_mfma_f32_16x16x32_bf16 v[128:131], a[132:135], v[8:11], v[128:131]
    buffer_load_dwordx4 v94, s[40:43], s60 offen offset:2048 lds
    ds_read_b64_tr_b16 a[190:191], v91 offset:61440
    v_cvt_pk_bf16_f32 v34, v36, v37
    v_mfma_f32_16x16x32_bf16 v[160:163], a[128:131], v[16:19], v[160:163]
    v_exp_f32 v39, v39
    v_mfma_f32_16x16x32_bf16 v[160:163], a[132:135], v[24:27], v[160:163]
    buffer_load_dwordx4 v95, s[40:43], s60 offen offset:3072 lds
    v_mfma_f32_16x16x32_bf16 v[132:135], a[136:139], v[0:3], v[132:135]
    v_exp_f32 v52, v52
    v_mfma_f32_16x16x32_bf16 v[132:135], a[140:143], v[8:11], v[132:135]
    s_and_b32 s30, s77, s56
    s_cselect_b32 s30, s30, s77
    s_ff1_i32_b32 s97, s30
    v_cvt_pk_bf16_f32 v35, v38, v39
    v_mfma_f32_16x16x32_bf16 v[164:167], a[136:139], v[16:19], v[164:167]
    s_bitset0_b32 s77, s97
    s_lshl_b32 s30, s97, 17
    v_exp_f32 v53, v53
    v_mfma_f32_16x16x32_bf16 v[164:167], a[140:143], v[24:27], v[164:167]
    s_add_u32 s60, s30, s58
    s_add_u32 m0, s24, 32768
    v_mfma_f32_16x16x32_bf16 v[136:139], a[144:147], v[0:3], v[136:139]
    v_exp_f32 v54, v54
    v_mfma_f32_16x16x32_bf16 v[136:139], a[148:151], v[8:11], v[136:139]
    buffer_load_dwordx4 v92, s[40:43], s60 offen offset:0 lds
    v_cvt_pk_bf16_f32 v50, v52, v53
    v_mfma_f32_16x16x32_bf16 v[168:171], a[144:147], v[16:19], v[168:171]
    v_exp_f32 v55, v55
    v_mfma_f32_16x16x32_bf16 v[168:171], a[148:151], v[24:27], v[168:171]
    buffer_load_dwordx4 v93, s[40:43], s60 offen offset:1024 lds
    v_mfma_f32_16x16x32_bf16 v[140:143], a[152:155], v[0:3], v[140:143]
    v_exp_f32 v40, v40
    v_mfma_f32_16x16x32_bf16 v[140:143], a[156:159], v[8:11], v[140:143]
    buffer_load_dwordx4 v94, s[40:43], s60 offen offset:2048 lds
    v_cvt_pk_bf16_f32 v51, v54, v55
    v_mfma_f32_16x16x32_bf16 v[172:175], a[152:155], v[16:19], v[172:175]
    v_exp_f32 v41, v41
    v_mfma_f32_16x16x32_bf16 v[172:175], a[156:159], v[24:27], v[172:175]
    buffer_load_dwordx4 v95, s[40:43], s60 offen offset:3072 lds
    v_mfma_f32_16x16x32_bf16 v[144:147], a[160:163], v[0:3], v[144:147]
    v_exp_f32 v42, v42
    v_mfma_f32_16x16x32_bf16 v[144:147], a[164:167], v[8:11], v[144:147]
    v_cvt_pk_bf16_f32 v40, v40, v41
    v_mfma_f32_16x16x32_bf16 v[176:179], a[160:163], v[16:19], v[176:179]
    v_exp_f32 v43, v43
    v_mfma_f32_16x16x32_bf16 v[176:179], a[164:167], v[24:27], v[176:179]
    v_mfma_f32_16x16x32_bf16 v[148:151], a[168:171], v[0:3], v[148:151]
    v_exp_f32 v56, v56
    v_mfma_f32_16x16x32_bf16 v[148:151], a[172:175], v[8:11], v[148:151]
    v_cvt_pk_bf16_f32 v41, v42, v43
    v_mfma_f32_16x16x32_bf16 v[180:183], a[168:171], v[16:19], v[180:183]
    v_exp_f32 v57, v57
    v_mfma_f32_16x16x32_bf16 v[180:183], a[172:175], v[24:27], v[180:183]
    v_mfma_f32_16x16x32_bf16 v[152:155], a[176:179], v[0:3], v[152:155]
    s_waitcnt lgkmcnt(0)
    v_exp_f32 v58, v58
    v_mfma_f32_16x16x32_bf16 v[152:155], a[180:183], v[8:11], v[152:155]
    v_cvt_pk_bf16_f32 v56, v56, v57
    v_mfma_f32_16x16x32_bf16 v[184:187], a[176:179], v[16:19], v[184:187]
    v_exp_f32 v59, v59
    v_mfma_f32_16x16x32_bf16 v[184:187], a[180:183], v[24:27], v[184:187]
    v_mfma_f32_16x16x32_bf16 v[156:159], a[184:187], v[0:3], v[156:159]
    v_exp_f32 v44, v44
    v_mfma_f32_16x16x32_bf16 v[156:159], a[188:191], v[8:11], v[156:159]
    v_cvt_pk_bf16_f32 v57, v58, v59
    v_mfma_f32_16x16x32_bf16 v[188:191], a[184:187], v[16:19], v[188:191]
    v_exp_f32 v45, v45
    v_mfma_f32_16x16x32_bf16 v[188:191], a[188:191], v[24:27], v[188:191]
    v_mfma_f32_16x16x32_bf16 a[192:195], a[208:211], v[0:3], a[192:195]
    v_exp_f32 v46, v46
    v_mfma_f32_16x16x32_bf16 a[192:195], a[208:211], v[8:11], a[192:195]
    v_cvt_pk_bf16_f32 v42, v44, v45
    v_mfma_f32_16x16x32_bf16 a[196:199], a[208:211], v[16:19], a[196:199]
    v_exp_f32 v47, v47
    v_mfma_f32_16x16x32_bf16 a[196:199], a[208:211], v[24:27], a[196:199]
    v_exp_f32 v60, v60
    v_cvt_pk_bf16_f32 v43, v46, v47
    v_exp_f32 v61, v61
    v_exp_f32 v62, v62
    v_cvt_pk_bf16_f32 v58, v60, v61
    v_exp_f32 v63, v63
    s_nop 0
    v_cvt_pk_bf16_f32 v59, v62, v63
    s_andn2_b32 s31, s64, 0x80
    buffer_load_dword v103, v126, s[72:75], s31 offen sc1
    v_lshlrev_b32 v112, 4, v102
    s_lshl_b32 s28, s22, 4
    s_lshl_b32 s29, s20, 2
    s_add_u32 s28, s28, s29
    s_lshl_b32 s28, s28, 10
    s_lshl_b32 s29, s21, 19
    s_add_u32 s28, s28, s29
    s_lshl_b32 s29, s65, 6
    s_add_u32 s28, s28, s29
    s_xor_b32 s29, s28, 2048
    v_mfma_f32_16x16x32_bf16 v[192:195], a[128:131], v[32:35], v[192:195]
    v_accvgpr_read_b32 v98, a192
    v_accvgpr_read_b32 v99, a196
    v_mfma_f32_16x16x32_bf16 v[192:195], a[132:135], v[40:43], v[192:195]
    v_rcp_f32 v108, v98
    v_rcp_f32 v109, v99
    v_mfma_f32_16x16x32_bf16 v[224:227], a[128:131], v[48:51], v[224:227]
    v_mul_f32 v128, v128, v108
    v_mul_f32 v129, v129, v108
    v_mfma_f32_16x16x32_bf16 v[224:227], a[132:135], v[56:59], v[224:227]
    v_mul_f32 v130, v130, v108
    v_mul_f32 v131, v131, v108
    v_mfma_f32_16x16x32_bf16 v[196:199], a[136:139], v[32:35], v[196:199]
    v_mul_f32 v132, v132, v108
    v_mul_f32 v133, v133, v108
    v_mfma_f32_16x16x32_bf16 v[196:199], a[140:143], v[40:43], v[196:199]
    v_mul_f32 v134, v134, v108
    v_mul_f32 v135, v135, v108
    v_mfma_f32_16x16x32_bf16 v[228:231], a[136:139], v[48:51], v[228:231]
    v_cvt_pk_bf16_f32 v0, v128, v129
    v_cvt_pk_bf16_f32 v1, v130, v131
    v_mfma_f32_16x16x32_bf16 v[228:231], a[140:143], v[56:59], v[228:231]
    v_cvt_pk_bf16_f32 v2, v132, v133
    v_cvt_pk_bf16_f32 v3, v134, v135
    v_mfma_f32_16x16x32_bf16 v[200:203], a[144:147], v[32:35], v[200:203]
    buffer_store_dwordx4 v[0:3], v112, s[12:15], s28 offen offset:0 sc1
    v_mul_f32 v160, v160, v109
    v_mfma_f32_16x16x32_bf16 v[200:203], a[148:151], v[40:43], v[200:203]
    v_mul_f32 v161, v161, v109
    v_mul_f32 v162, v162, v109
    v_mfma_f32_16x16x32_bf16 v[232:235], a[144:147], v[48:51], v[232:235]
    v_mul_f32 v163, v163, v109
    v_mul_f32 v164, v164, v109
    v_mfma_f32_16x16x32_bf16 v[232:235], a[148:151], v[56:59], v[232:235]
    v_mul_f32 v165, v165, v109
    v_mul_f32 v166, v166, v109
    v_mfma_f32_16x16x32_bf16 v[204:207], a[152:155], v[32:35], v[204:207]
    v_mul_f32 v167, v167, v109
    v_cvt_pk_bf16_f32 v4, v160, v161
    v_mfma_f32_16x16x32_bf16 v[204:207], a[156:159], v[40:43], v[204:207]
    v_cvt_pk_bf16_f32 v5, v162, v163
    v_cvt_pk_bf16_f32 v6, v164, v165
    v_mfma_f32_16x16x32_bf16 v[236:239], a[152:155], v[48:51], v[236:239]
    v_cvt_pk_bf16_f32 v7, v166, v167
    buffer_store_dwordx4 v[4:7], v112, s[12:15], s28 offen offset:1024 sc1
    s_add_u32 s28, s28, 0x20000
    v_mfma_f32_16x16x32_bf16 v[236:239], a[156:159], v[56:59], v[236:239]
    v_mul_f32 v136, v136, v108
    v_mul_f32 v137, v137, v108
    v_mfma_f32_16x16x32_bf16 v[208:211], a[160:163], v[32:35], v[208:211]
    v_mul_f32 v138, v138, v108
    v_mul_f32 v139, v139, v108
    v_mfma_f32_16x16x32_bf16 v[208:211], a[164:167], v[40:43], v[208:211]
    v_mul_f32 v140, v140, v108
    v_mul_f32 v141, v141, v108
    v_mfma_f32_16x16x32_bf16 v[240:243], a[160:163], v[48:51], v[240:243]
    v_mul_f32 v142, v142, v108
    v_mul_f32 v143, v143, v108
    v_mfma_f32_16x16x32_bf16 v[240:243], a[164:167], v[56:59], v[240:243]
    v_cvt_pk_bf16_f32 v8, v136, v137
    v_cvt_pk_bf16_f32 v9, v138, v139
    v_mfma_f32_16x16x32_bf16 v[212:215], a[168:171], v[32:35], v[212:215]
    v_cvt_pk_bf16_f32 v10, v140, v141
    v_cvt_pk_bf16_f32 v11, v142, v143
    v_mfma_f32_16x16x32_bf16 v[212:215], a[172:175], v[40:43], v[212:215]
    buffer_store_dwordx4 v[8:11], v112, s[12:15], s28 offen offset:0 sc1
    v_mul_f32 v168, v168, v109
    v_mfma_f32_16x16x32_bf16 v[244:247], a[168:171], v[48:51], v[244:247]
    v_mul_f32 v169, v169, v109
    v_mul_f32 v170, v170, v109
    v_mfma_f32_16x16x32_bf16 v[244:247], a[172:175], v[56:59], v[244:247]
    v_mul_f32 v171, v171, v109
    v_mul_f32 v172, v172, v109
    v_mfma_f32_16x16x32_bf16 v[216:219], a[176:179], v[32:35], v[216:219]
    v_mul_f32 v173, v173, v109
    v_mul_f32 v174, v174, v109
    v_mfma_f32_16x16x32_bf16 v[216:219], a[180:183], v[40:43], v[216:219]
    v_mul_f32 v175, v175, v109
    v_cvt_pk_bf16_f32 v12, v168, v169
    v_mfma_f32_16x16x32_bf16 v[248:251], a[176:179], v[48:51], v[248:251]
    v_cvt_pk_bf16_f32 v13, v170, v171
    v_cvt_pk_bf16_f32 v14, v172, v173
    v_mfma_f32_16x16x32_bf16 v[248:251], a[180:183], v[56:59], v[248:251]
    v_cvt_pk_bf16_f32 v15, v174, v175
    buffer_store_dwordx4 v[12:15], v112, s[12:15], s28 offen offset:1024 sc1
    s_add_u32 s28, s28, 0x20000
    v_mfma_f32_16x16x32_bf16 v[220:223], a[184:187], v[32:35], v[220:223]
    v_mul_f32 v144, v144, v108
    v_mul_f32 v145, v145, v108
    v_mfma_f32_16x16x32_bf16 v[220:223], a[188:191], v[40:43], v[220:223]
    v_mul_f32 v146, v146, v108
    v_mul_f32 v147, v147, v108
    v_mfma_f32_16x16x32_bf16 v[252:255], a[184:187], v[48:51], v[252:255]
    v_mul_f32 v148, v148, v108
    v_mul_f32 v149, v149, v108
    v_mfma_f32_16x16x32_bf16 v[252:255], a[188:191], v[56:59], v[252:255]
    v_mul_f32 v150, v150, v108
    v_mul_f32 v151, v151, v108
    v_mfma_f32_16x16x32_bf16 a[200:203], a[208:211], v[32:35], a[200:203]
    v_cvt_pk_bf16_f32 v0, v144, v145
    v_cvt_pk_bf16_f32 v1, v146, v147
    v_mfma_f32_16x16x32_bf16 a[200:203], a[208:211], v[40:43], a[200:203]
    v_cvt_pk_bf16_f32 v2, v148, v149
    v_cvt_pk_bf16_f32 v3, v150, v151
    v_mfma_f32_16x16x32_bf16 a[204:207], a[208:211], v[48:51], a[204:207]
    buffer_store_dwordx4 v[0:3], v112, s[12:15], s28 offen offset:0 sc1
    v_mul_f32 v176, v176, v109
    v_mfma_f32_16x16x32_bf16 a[204:207], a[208:211], v[56:59], a[204:207]
    v_mul_f32 v177, v177, v109
    v_mul_f32 v178, v178, v109
    v_mul_f32 v179, v179, v109
    v_mul_f32 v180, v180, v109
    v_mul_f32 v181, v181, v109
    v_mul_f32 v182, v182, v109
    v_mul_f32 v183, v183, v109
    v_cvt_pk_bf16_f32 v4, v176, v177
    v_cvt_pk_bf16_f32 v5, v178, v179
    v_cvt_pk_bf16_f32 v6, v180, v181
    v_cvt_pk_bf16_f32 v7, v182, v183
    buffer_store_dwordx4 v[4:7], v112, s[12:15], s28 offen offset:1024 sc1
    s_add_u32 s28, s28, 0x20000
    v_mul_f32 v152, v152, v108
    v_mul_f32 v153, v153, v108
    v_mul_f32 v154, v154, v108
    v_mul_f32 v155, v155, v108
    v_mul_f32 v156, v156, v108
    v_mul_f32 v157, v157, v108
    v_mul_f32 v158, v158, v108
    v_mul_f32 v159, v159, v108
    v_cvt_pk_bf16_f32 v8, v152, v153
    v_cvt_pk_bf16_f32 v9, v154, v155
    v_cvt_pk_bf16_f32 v10, v156, v157
    v_cvt_pk_bf16_f32 v11, v158, v159
    buffer_store_dwordx4 v[8:11], v112, s[12:15], s28 offen offset:0 sc1
    v_mul_f32 v184, v184, v109
    v_mul_f32 v185, v185, v109
    v_mul_f32 v186, v186, v109
    v_mul_f32 v187, v187, v109
    v_mul_f32 v188, v188, v109
    v_mul_f32 v189, v189, v109
    v_mul_f32 v190, v190, v109
    v_mul_f32 v191, v191, v109
    v_cvt_pk_bf16_f32 v12, v184, v185
    v_cvt_pk_bf16_f32 v13, v186, v187
    v_cvt_pk_bf16_f32 v14, v188, v189
    v_cvt_pk_bf16_f32 v15, v190, v191
    buffer_store_dwordx4 v[12:15], v112, s[12:15], s28 offen offset:1024 sc1
    v_accvgpr_read_b32 v100, a200
    v_accvgpr_read_b32 v101, a204
L_attn_finish:
    v_cmp_ngt_f32 s[32:33], s27, v98
    v_cmp_ngt_f32 s[34:35], s27, v99
    v_cmp_ngt_f32 s[36:37], s27, v100
    v_cmp_ngt_f32 s[38:39], s27, v101
    v_rcp_f32 v110, v100
    v_rcp_f32 v111, v101
    s_or_b64 s[32:33], s[32:33], s[34:35]
    s_or_b64 s[36:37], s[36:37], s[38:39]
    s_or_b64 s[32:33], s[32:33], s[36:37]
    s_and_b64 s[32:33], s[32:33], s[78:79]
    s_cbranch_scc1 L_attn_exact
    s_waitcnt vmcnt(8)
    v_cmp_eq_u32 vcc, 1, v103
    s_and_b32 s30, s20, 1
    s_cselect_b32 s62, vcc_hi, vcc_lo
    s_barrier
    s_load_dwordx2 s[32:33], s[0:1], 0
    s_load_dwordx4 s[36:39], s[0:1], 72
    v_pk_mul_f32 v[192:193], v[192:193], v[110:111] op_sel:[0,0] op_sel_hi:[1,0]
    v_pk_mul_f32 v[194:195], v[194:195], v[110:111] op_sel:[0,0] op_sel_hi:[1,0]
    v_pk_mul_f32 v[196:197], v[196:197], v[110:111] op_sel:[0,0] op_sel_hi:[1,0]
    v_pk_mul_f32 v[198:199], v[198:199], v[110:111] op_sel:[0,0] op_sel_hi:[1,0]
    v_cvt_pk_bf16_f32 v16, v192, v193
    v_cvt_pk_bf16_f32 v17, v194, v195
    v_cvt_pk_bf16_f32 v18, v196, v197
    v_cvt_pk_bf16_f32 v19, v198, v199
    buffer_store_dwordx4 v[16:19], v112, s[12:15], s29 offen offset:0 sc1
    v_pk_mul_f32 v[224:225], v[224:225], v[110:111] op_sel:[0,1] op_sel_hi:[1,1]
    v_pk_mul_f32 v[226:227], v[226:227], v[110:111] op_sel:[0,1] op_sel_hi:[1,1]
    v_pk_mul_f32 v[228:229], v[228:229], v[110:111] op_sel:[0,1] op_sel_hi:[1,1]
    v_pk_mul_f32 v[230:231], v[230:231], v[110:111] op_sel:[0,1] op_sel_hi:[1,1]
    v_cvt_pk_bf16_f32 v20, v224, v225
    v_cvt_pk_bf16_f32 v21, v226, v227
    v_cvt_pk_bf16_f32 v22, v228, v229
    v_cvt_pk_bf16_f32 v23, v230, v231
    buffer_store_dwordx4 v[20:23], v112, s[12:15], s29 offen offset:1024 sc1
    s_add_u32 s29, s29, 0x20000
    v_pk_mul_f32 v[200:201], v[200:201], v[110:111] op_sel:[0,0] op_sel_hi:[1,0]
    v_pk_mul_f32 v[202:203], v[202:203], v[110:111] op_sel:[0,0] op_sel_hi:[1,0]
    v_pk_mul_f32 v[204:205], v[204:205], v[110:111] op_sel:[0,0] op_sel_hi:[1,0]
    v_pk_mul_f32 v[206:207], v[206:207], v[110:111] op_sel:[0,0] op_sel_hi:[1,0]
    v_cvt_pk_bf16_f32 v24, v200, v201
    v_cvt_pk_bf16_f32 v25, v202, v203
    v_cvt_pk_bf16_f32 v26, v204, v205
    v_cvt_pk_bf16_f32 v27, v206, v207
    buffer_store_dwordx4 v[24:27], v112, s[12:15], s29 offen offset:0 sc1
    v_pk_mul_f32 v[232:233], v[232:233], v[110:111] op_sel:[0,1] op_sel_hi:[1,1]
    v_pk_mul_f32 v[234:235], v[234:235], v[110:111] op_sel:[0,1] op_sel_hi:[1,1]
    v_pk_mul_f32 v[236:237], v[236:237], v[110:111] op_sel:[0,1] op_sel_hi:[1,1]
    v_pk_mul_f32 v[238:239], v[238:239], v[110:111] op_sel:[0,1] op_sel_hi:[1,1]
    v_cvt_pk_bf16_f32 v28, v232, v233
    v_cvt_pk_bf16_f32 v29, v234, v235
    v_cvt_pk_bf16_f32 v30, v236, v237
    v_cvt_pk_bf16_f32 v31, v238, v239
    buffer_store_dwordx4 v[28:31], v112, s[12:15], s29 offen offset:1024 sc1
    s_add_u32 s29, s29, 0x20000
    v_pk_mul_f32 v[208:209], v[208:209], v[110:111] op_sel:[0,0] op_sel_hi:[1,0]
    v_pk_mul_f32 v[210:211], v[210:211], v[110:111] op_sel:[0,0] op_sel_hi:[1,0]
    v_pk_mul_f32 v[212:213], v[212:213], v[110:111] op_sel:[0,0] op_sel_hi:[1,0]
    v_pk_mul_f32 v[214:215], v[214:215], v[110:111] op_sel:[0,0] op_sel_hi:[1,0]
    v_cvt_pk_bf16_f32 v16, v208, v209
    v_cvt_pk_bf16_f32 v17, v210, v211
    v_cvt_pk_bf16_f32 v18, v212, v213
    v_cvt_pk_bf16_f32 v19, v214, v215
    buffer_store_dwordx4 v[16:19], v112, s[12:15], s29 offen offset:0 sc1
    v_pk_mul_f32 v[240:241], v[240:241], v[110:111] op_sel:[0,1] op_sel_hi:[1,1]
    v_pk_mul_f32 v[242:243], v[242:243], v[110:111] op_sel:[0,1] op_sel_hi:[1,1]
    v_pk_mul_f32 v[244:245], v[244:245], v[110:111] op_sel:[0,1] op_sel_hi:[1,1]
    v_pk_mul_f32 v[246:247], v[246:247], v[110:111] op_sel:[0,1] op_sel_hi:[1,1]
    v_cvt_pk_bf16_f32 v20, v240, v241
    v_cvt_pk_bf16_f32 v21, v242, v243
    v_cvt_pk_bf16_f32 v22, v244, v245
    v_cvt_pk_bf16_f32 v23, v246, v247
    buffer_store_dwordx4 v[20:23], v112, s[12:15], s29 offen offset:1024 sc1
    s_add_u32 s29, s29, 0x20000
    v_pk_mul_f32 v[216:217], v[216:217], v[110:111] op_sel:[0,0] op_sel_hi:[1,0]
    v_pk_mul_f32 v[218:219], v[218:219], v[110:111] op_sel:[0,0] op_sel_hi:[1,0]
    v_pk_mul_f32 v[220:221], v[220:221], v[110:111] op_sel:[0,0] op_sel_hi:[1,0]
    v_pk_mul_f32 v[222:223], v[222:223], v[110:111] op_sel:[0,0] op_sel_hi:[1,0]
    v_cvt_pk_bf16_f32 v24, v216, v217
    v_cvt_pk_bf16_f32 v25, v218, v219
    v_cvt_pk_bf16_f32 v26, v220, v221
    v_cvt_pk_bf16_f32 v27, v222, v223
    buffer_store_dwordx4 v[24:27], v112, s[12:15], s29 offen offset:0 sc1
    v_pk_mul_f32 v[248:249], v[248:249], v[110:111] op_sel:[0,1] op_sel_hi:[1,1]
    v_pk_mul_f32 v[250:251], v[250:251], v[110:111] op_sel:[0,1] op_sel_hi:[1,1]
    v_pk_mul_f32 v[252:253], v[252:253], v[110:111] op_sel:[0,1] op_sel_hi:[1,1]
    v_pk_mul_f32 v[254:255], v[254:255], v[110:111] op_sel:[0,1] op_sel_hi:[1,1]
    v_cvt_pk_bf16_f32 v28, v248, v249
    v_cvt_pk_bf16_f32 v29, v250, v251
    v_cvt_pk_bf16_f32 v30, v252, v253
    v_cvt_pk_bf16_f32 v31, v254, v255
    buffer_store_dwordx4 v[28:31], v112, s[12:15], s29 offen offset:1024 sc1
    v_and_b32 v124, 0x02020202, v124
    v_lshlrev_b32 v89, 2, v102
    v_mov_b32 v90, 0
    s_mov_b32 s27, s58
    s_mov_b32 s69, s59
    s_mov_b32 s65, s56
    s_cmp_eq_u32 s57, 3
    s_cselect_b32 s8, s52, s12
    s_cselect_b32 s9, s53, s13
    s_cselect_b32 s10, s54, s14
    v_cmp_ne_u32 vcc, 0x02020202, v124
    s_nop 0
    s_cbranch_vccnz L_rdy
L_rdy_ok:
    s_mov_b32 s29, s96
    s_lshl_b32 s28, 1, s29
    s_and_b32 s28, s28, s23
    s_lshl_b32 s30, s29, 19
    s_add_u32 s61, s30, s63
    s_andn2_b32 s31, s28, s62
    s_cbranch_scc1 L_pb0
L_qb0:
    s_add_u32 m0, s24, 65536
    s_nop 0
    buffer_load_dwordx4 v127, s[8:11], s61 offen offset:0 sc1 lds
    buffer_load_dwordx4 v127, s[8:11], s61 offen offset:1024 sc1 lds
    buffer_load_dwordx4 v127, s[8:11], s61 offen offset:2048 sc1 lds
    buffer_load_dwordx4 v127, s[8:11], s61 offen offset:3072 sc1 lds
    s_add_u32 s61, s61, 0x40000
    s_add_u32 m0, s24, 81920
    s_nop 0
    buffer_load_dwordx4 v127, s[8:11], s61 offen offset:0 sc1 lds
    buffer_load_dwordx4 v127, s[8:11], s61 offen offset:1024 sc1 lds
    buffer_load_dwordx4 v127, s[8:11], s61 offen offset:2048 sc1 lds
    buffer_load_dwordx4 v127, s[8:11], s61 offen offset:3072 sc1 lds
    s_mov_b32 s29, s97
    s_lshl_b32 s28, 1, s29
    s_and_b32 s28, s28, s23
    s_lshl_b32 s30, s29, 19
    s_add_u32 s61, s30, s63
    s_andn2_b32 s31, s28, s62
    s_cbranch_scc1 L_pb2
L_qb2:
    s_add_u32 m0, s24, 98304
    s_nop 0
    buffer_load_dwordx4 v127, s[8:11], s61 offen offset:0 sc1 lds
    buffer_load_dwordx4 v127, s[8:11], s61 offen offset:1024 sc1 lds
    buffer_load_dwordx4 v127, s[8:11], s61 offen offset:2048 sc1 lds
    buffer_load_dwordx4 v127, s[8:11], s61 offen offset:3072 sc1 lds
    v_lshrrev_b32 v82, 2, v102
    v_and_b32 v83, 7, v82
    v_and_b32 v84, 3, v102
    v_lshlrev_b32 v84, 3, v84
    v_lshl_add_u32 v84, v82, 8, v84
    s_and_b32 s30, s20, 2
    s_lshl_b32 s30, s30, 1
    s_add_u32 s31, s30, 0
    v_xor_b32 v80, s31, v83
    v_lshl_add_u32 v64, v80, 5, v84
    s_add_u32 s31, s30, 1
    v_xor_b32 v80, s31, v83
    v_lshl_add_u32 v65, v80, 5, v84
    s_add_u32 s31, s30, 2
    v_xor_b32 v80, s31, v83
    v_lshl_add_u32 v66, v80, 5, v84
    s_add_u32 s31, s30, 3
    v_xor_b32 v80, s31, v83
    v_lshl_add_u32 v67, v80, 5, v84
    s_xor_b32 s31, s26, 0
    s_add_u32 s31, s31, s68
    s_lshl_b32 s31, s31, 10
    s_add_u32 s31, s31, 65536
    v_add_u32 v72, s31, v127
    s_xor_b32 s31, s26, 1
    s_add_u32 s31, s31, s68
    s_lshl_b32 s31, s31, 10
    s_add_u32 s31, s31, 65536
    v_add_u32 v73, s31, v127
    s_xor_b32 s31, s26, 2
    s_add_u32 s31, s31, s68
    s_lshl_b32 s31, s31, 10
    s_add_u32 s31, s31, 65536
    v_add_u32 v74, s31, v127
    s_xor_b32 s31, s26, 3
    s_add_u32 s31, s31, s68
    s_lshl_b32 s31, s31, 10
    s_add_u32 s31, s31, 65536
    v_add_u32 v75, s31, v127
    v_and_b32 v80, 15, v102
    v_lshrrev_b32 v81, 4, v102
    v_lshlrev_b32 v81, 3, v81
    v_lshl_add_u32 v85, v80, 10, v81
    s_waitcnt lgkmcnt(0)
    s_mov_b32 s4, s32
    s_mov_b32 s5, s33
    s_mov_b32 s6, 0x200000
    s_mov_b32 s56, s36
    s_mov_b32 s57, s37
    s_mov_b32 s58, 1024
    s_mov_b32 s59, 0x20000
    v_mov_b32 v0, 0
    v_mov_b32 v1, 0
    v_mov_b32 v2, 0
    v_mov_b32 v3, 0
    v_mov_b32 v4, 0
    v_mov_b32 v5, 0
    v_mov_b32 v6, 0
    v_mov_b32 v7, 0
    v_mov_b32 v8, 0
    v_mov_b32 v9, 0
    v_mov_b32 v10, 0
    v_mov_b32 v11, 0
    v_mov_b32 v12, 0
    v_mov_b32 v13, 0
    v_mov_b32 v14, 0
    v_mov_b32 v15, 0
    v_mov_b32 v16, 0
    v_mov_b32 v17, 0
    v_mov_b32 v18, 0
    v_mov_b32 v19, 0
    v_mov_b32 v20, 0
    v_mov_b32 v21, 0
    v_mov_b32 v22, 0
    v_mov_b32 v23, 0
    v_mov_b32 v24, 0
    v_mov_b32 v25, 0
    v_mov_b32 v26, 0
    v_mov_b32 v27, 0
    v_mov_b32 v28, 0
    v_mov_b32 v29, 0
    v_mov_b32 v30, 0
    v_mov_b32 v31, 0
    v_mov_b32 v32, 0
    v_mov_b32 v33, 0
    v_mov_b32 v34, 0
    v_mov_b32 v35, 0
    v_mov_b32 v36, 0
    v_mov_b32 v37, 0
    v_mov_b32 v38, 0
    v_mov_b32 v39, 0
    v_mov_b32 v40, 0
    v_mov_b32 v41, 0
    v_mov_b32 v42, 0
    v_mov_b32 v43, 0
    v_mov_b32 v44, 0
    v_mov_b32 v45, 0
    v_mov_b32 v46, 0
    v_mov_b32 v47, 0
    v_mov_b32 v48, 0
    v_mov_b32 v49, 0
    v_mov_b32 v50, 0
    v_mov_b32 v51, 0
    v_mov_b32 v52, 0
    v_mov_b32 v53, 0
    v_mov_b32 v54, 0
    v_mov_b32 v55, 0
    v_mov_b32 v56, 0
    v_mov_b32 v57, 0
    v_mov_b32 v58, 0
    v_mov_b32 v59, 0
    v_mov_b32 v60, 0
    v_mov_b32 v61, 0
    v_mov_b32 v62, 0
    v_mov_b32 v63, 0
    s_bcnt1_i32_b32 s34, s23
    s_cselect_b32 s34, s34, 11
    s_lshr_b32 s35, s34, 1
    s_waitcnt vmcnt(4)
    s_cmp_lg_u32 s70, 0
    s_cbranch_scc1 L_pub
    s_mov_b64 exec, 1
    v_mov_b32 v87, 1
    buffer_store_dword v87, v90, s[72:75], s76 offen sc1
    buffer_store_dword v87, v90, s[72:75], s71 offen sc1
    s_mov_b64 exec, -1
    s_mov_b32 s70, 1
L_pub:
    s_barrier
    ds_read_b128 v[192:195], v72 offset:0
    ds_read_b128 v[196:199], v73 offset:0
    ds_read_b128 v[200:203], v74 offset:0
    ds_read_b128 v[204:207], v75 offset:0
    ds_read_b128 v[208:211], v72 offset:8192
    ds_read_b128 v[212:215], v73 offset:8192
    ds_read_b128 v[216:219], v74 offset:8192
    ds_read_b128 v[220:223], v75 offset:8192
    ds_read_b64_tr_b16 v[128:129], v64 offset:0
    ds_read_b64_tr_b16 v[130:131], v64 offset:4096
    ds_read_b64_tr_b16 v[144:145], v64 offset:8192
    ds_read_b64_tr_b16 v[146:147], v64 offset:12288
    ds_read_b64_tr_b16 v[132:133], v65 offset:0
    ds_read_b64_tr_b16 v[134:135], v65 offset:4096
    ds_read_b64_tr_b16 v[148:149], v65 offset:8192
    ds_read_b64_tr_b16 v[150:151], v65 offset:12288
    ds_read_b64_tr_b16 v[136:137], v66 offset:0
    ds_read_b64_tr_b16 v[138:139], v66 offset:4096
    ds_read_b64_tr_b16 v[152:153], v66 offset:8192
    ds_read_b64_tr_b16 v[154:155], v66 offset:12288
    ds_read_b64_tr_b16 v[140:141], v67 offset:0
    ds_read_b64_tr_b16 v[142:143], v67 offset:4096
    ds_read_b64_tr_b16 v[156:157], v67 offset:8192
    ds_read_b64_tr_b16 v[158:159], v67 offset:12288
L_t_loop:
    s_waitcnt lgkmcnt(12)
    v_mfma_f32_16x16x32_bf16 v[0:3], v[128:131], v[192:195], v[0:3]
    s_waitcnt vmcnt(8)
    s_barrier
    v_mfma_f32_16x16x32_bf16 v[0:3], v[144:147], v[208:211], v[0:3]
    ds_read_b128 v[224:227], v72 offset:16384
    v_mfma_f32_16x16x32_bf16 v[4:7], v[128:131], v[196:199], v[4:7]
    ds_read_b128 v[228:231], v73 offset:16384
    v_mfma_f32_16x16x32_bf16 v[4:7], v[144:147], v[212:215], v[4:7]
    ds_read_b128 v[232:235], v74 offset:16384
    s_add_u32 s60, s60, 0x10000
    s_add_u32 m0, s24, 49152
    v_mfma_f32_16x16x32_bf16 v[8:11], v[128:131], v[200:203], v[8:11]
    buffer_load_dwordx4 v92, s[40:43], s60 offen offset:0 lds
    v_mfma_f32_16x16x32_bf16 v[8:11], v[144:147], v[216:219], v[8:11]
    ds_read_b128 v[236:239], v75 offset:16384
    v_mfma_f32_16x16x32_bf16 v[12:15], v[128:131], v[204:207], v[12:15]
    ds_read_b128 v[240:243], v72 offset:24576
    v_mfma_f32_16x16x32_bf16 v[12:15], v[144:147], v[220:223], v[12:15]
    ds_read_b128 v[244:247], v73 offset:24576
    s_waitcnt lgkmcnt(14)
    v_mfma_f32_16x16x32_bf16 v[16:19], v[132:135], v[192:195], v[16:19]
    buffer_load_dwordx4 v93, s[40:43], s60 offen offset:1024 lds
    v_mfma_f32_16x16x32_bf16 v[16:19], v[148:151], v[208:211], v[16:19]
    ds_read_b128 v[248:251], v74 offset:24576
    v_mfma_f32_16x16x32_bf16 v[20:23], v[132:135], v[196:199], v[20:23]
    ds_read_b128 v[252:255], v75 offset:24576
    v_mfma_f32_16x16x32_bf16 v[20:23], v[148:151], v[212:215], v[20:23]
    ds_read_b64_tr_b16 v[160:161], v64 offset:16384
    v_mfma_f32_16x16x32_bf16 v[24:27], v[132:135], v[200:203], v[24:27]
    buffer_load_dwordx4 v94, s[40:43], s60 offen offset:2048 lds
    v_mfma_f32_16x16x32_bf16 v[24:27], v[148:151], v[216:219], v[24:27]
    ds_read_b64_tr_b16 v[162:163], v64 offset:20480
    v_mfma_f32_16x16x32_bf16 v[28:31], v[132:135], v[204:207], v[28:31]
    ds_read_b64_tr_b16 v[176:177], v64 offset:24576
    v_mfma_f32_16x16x32_bf16 v[28:31], v[148:151], v[220:223], v[28:31]
    ds_read_b64_tr_b16 v[178:179], v64 offset:28672
    s_waitcnt lgkmcnt(15)
    v_mfma_f32_16x16x32_bf16 v[32:35], v[136:139], v[192:195], v[32:35]
    buffer_load_dwordx4 v95, s[40:43], s60 offen offset:3072 lds
    v_mfma_f32_16x16x32_bf16 v[32:35], v[152:155], v[208:211], v[32:35]
    ds_read_b64_tr_b16 v[164:165], v65 offset:16384
    v_mfma_f32_16x16x32_bf16 v[36:39], v[136:139], v[196:199], v[36:39]
    ds_read_b64_tr_b16 v[166:167], v65 offset:20480
    v_mfma_f32_16x16x32_bf16 v[36:39], v[152:155], v[212:215], v[36:39]
    ds_read_b64_tr_b16 v[180:181], v65 offset:24576
    s_add_u32 s61, s61, 0x40000
    s_add_u32 m0, s24, 114688
    v_mfma_f32_16x16x32_bf16 v[40:43], v[136:139], v[200:203], v[40:43]
    buffer_load_dwordx4 v127, s[8:11], s61 offen offset:0 sc1 lds
    v_mfma_f32_16x16x32_bf16 v[40:43], v[152:155], v[216:219], v[40:43]
    ds_read_b64_tr_b16 v[182:183], v65 offset:28672
    v_mfma_f32_16x16x32_bf16 v[44:47], v[136:139], v[204:207], v[44:47]
    ds_read_b64_tr_b16 v[168:169], v66 offset:16384
    v_mfma_f32_16x16x32_bf16 v[44:47], v[152:155], v[220:223], v[44:47]
    ds_read_b64_tr_b16 v[170:171], v66 offset:20480
    s_waitcnt lgkmcnt(15)
    v_mfma_f32_16x16x32_bf16 v[48:51], v[140:143], v[192:195], v[48:51]
    buffer_load_dwordx4 v127, s[8:11], s61 offen offset:1024 sc1 lds
    v_mfma_f32_16x16x32_bf16 v[48:51], v[156:159], v[208:211], v[48:51]
    ds_read_b64_tr_b16 v[184:185], v66 offset:24576
    v_mfma_f32_16x16x32_bf16 v[52:55], v[140:143], v[196:199], v[52:55]
    ds_read_b64_tr_b16 v[186:187], v66 offset:28672
    v_mfma_f32_16x16x32_bf16 v[52:55], v[156:159], v[212:215], v[52:55]
    ds_read_b64_tr_b16 v[172:173], v67 offset:16384
    v_mfma_f32_16x16x32_bf16 v[56:59], v[140:143], v[200:203], v[56:59]
    buffer_load_dwordx4 v127, s[8:11], s61 offen offset:2048 sc1 lds
    v_mfma_f32_16x16x32_bf16 v[56:59], v[156:159], v[216:219], v[56:59]
    ds_read_b64_tr_b16 v[174:175], v67 offset:20480
    v_mfma_f32_16x16x32_bf16 v[60:63], v[140:143], v[204:207], v[60:63]
    ds_read_b64_tr_b16 v[188:189], v67 offset:24576
    ds_read_b64_tr_b16 v[190:191], v67 offset:28672
    v_mfma_f32_16x16x32_bf16 v[60:63], v[156:159], v[220:223], v[60:63]
    buffer_load_dwordx4 v127, s[8:11], s61 offen offset:3072 sc1 lds
    s_waitcnt lgkmcnt(12)
    v_mfma_f32_16x16x32_bf16 v[0:3], v[160:163], v[224:227], v[0:3]
    s_waitcnt vmcnt(8)
    s_barrier
    v_mfma_f32_16x16x32_bf16 v[0:3], v[176:179], v[240:243], v[0:3]
    ds_read_b128 v[192:195], v72 offset:32768
    s_and_b32 s30, s77, s65
    s_cselect_b32 s30, s30, s77
    s_ff1_i32_b32 s29, s30
    v_mfma_f32_16x16x32_bf16 v[4:7], v[160:163], v[228:231], v[4:7]
    ds_read_b128 v[196:199], v73 offset:32768
    s_bitset0_b32 s77, s29
    s_lshl_b32 s30, s29, 17
    v_mfma_f32_16x16x32_bf16 v[4:7], v[176:179], v[244:247], v[4:7]
    ds_read_b128 v[200:203], v74 offset:32768
    s_add_u32 s60, s30, s27
    s_add_u32 m0, s24, 0
    v_mfma_f32_16x16x32_bf16 v[8:11], v[160:163], v[232:235], v[8:11]
    buffer_load_dwordx4 v92, s[40:43], s60 offen offset:0 lds
    v_mfma_f32_16x16x32_bf16 v[8:11], v[176:179], v[248:251], v[8:11]
    ds_read_b128 v[204:207], v75 offset:32768
    v_mfma_f32_16x16x32_bf16 v[12:15], v[160:163], v[236:239], v[12:15]
    ds_read_b128 v[208:211], v72 offset:40960
    v_mfma_f32_16x16x32_bf16 v[12:15], v[176:179], v[252:255], v[12:15]
    ds_read_b128 v[212:215], v73 offset:40960
    s_waitcnt lgkmcnt(14)
    v_mfma_f32_16x16x32_bf16 v[16:19], v[164:167], v[224:227], v[16:19]
    buffer_load_dwordx4 v93, s[40:43], s60 offen offset:1024 lds
    v_mfma_f32_16x16x32_bf16 v[16:19], v[180:183], v[240:243], v[16:19]
    ds_read_b128 v[216:219], v74 offset:40960
    v_mfma_f32_16x16x32_bf16 v[20:23], v[164:167], v[228:231], v[20:23]
    ds_read_b128 v[220:223], v75 offset:40960
    v_mfma_f32_16x16x32_bf16 v[20:23], v[180:183], v[244:247], v[20:23]
    ds_read_b64_tr_b16 v[128:129], v64 offset:32768
    v_mfma_f32_16x16x32_bf16 v[24:27], v[164:167], v[232:235], v[24:27]
    buffer_load_dwordx4 v94, s[40:43], s60 offen offset:2048 lds
    v_mfma_f32_16x16x32_bf16 v[24:27], v[180:183], v[248:251], v[24:27]
    ds_read_b64_tr_b16 v[130:131], v64 offset:36864
    v_mfma_f32_16x16x32_bf16 v[28:31], v[164:167], v[236:239], v[28:31]
    ds_read_b64_tr_b16 v[144:145], v64 offset:40960
    v_mfma_f32_16x16x32_bf16 v[28:31], v[180:183], v[252:255], v[28:31]
    ds_read_b64_tr_b16 v[146:147], v64 offset:45056
    s_waitcnt lgkmcnt(15)
    v_mfma_f32_16x16x32_bf16 v[32:35], v[168:171], v[224:227], v[32:35]
    buffer_load_dwordx4 v95, s[40:43], s60 offen offset:3072 lds
    v_mfma_f32_16x16x32_bf16 v[32:35], v[184:187], v[240:243], v[32:35]
    ds_read_b64_tr_b16 v[132:133], v65 offset:32768
    s_lshl_b32 s28, 1, s29
    s_and_b32 s28, s28, s23
    s_lshl_b32 s30, s29, 19
    s_add_u32 s61, s30, s63
    v_mfma_f32_16x16x32_bf16 v[36:39], v[168:171], v[228:231], v[36:39]
    ds_read_b64_tr_b16 v[134:135], v65 offset:36864
    s_andn2_b32 s31, s28, s62
    s_cbranch_scc1 L_pb8
L_qb8:
    v_mfma_f32_16x16x32_bf16 v[36:39], v[184:187], v[244:247], v[36:39]
    ds_read_b64_tr_b16 v[148:149], v65 offset:40960
    s_add_u32 m0, s24, 65536
    v_mfma_f32_16x16x32_bf16 v[40:43], v[168:171], v[232:235], v[40:43]
    buffer_load_dwordx4 v127, s[8:11], s61 offen offset:0 sc1 lds
    v_mfma_f32_16x16x32_bf16 v[40:43], v[184:187], v[248:251], v[40:43]
    ds_read_b64_tr_b16 v[150:151], v65 offset:45056
    v_mfma_f32_16x16x32_bf16 v[44:47], v[168:171], v[236:239], v[44:47]
    ds_read_b64_tr_b16 v[136:137], v66 offset:32768
    v_mfma_f32_16x16x32_bf16 v[44:47], v[184:187], v[252:255], v[44:47]
    ds_read_b64_tr_b16 v[138:139], v66 offset:36864
    s_waitcnt lgkmcnt(15)
    v_mfma_f32_16x16x32_bf16 v[48:51], v[172:175], v[224:227], v[48:51]
    buffer_load_dwordx4 v127, s[8:11], s61 offen offset:1024 sc1 lds
    v_mfma_f32_16x16x32_bf16 v[48:51], v[188:191], v[240:243], v[48:51]
    ds_read_b64_tr_b16 v[152:153], v66 offset:40960
    v_mfma_f32_16x16x32_bf16 v[52:55], v[172:175], v[228:231], v[52:55]
    ds_read_b64_tr_b16 v[154:155], v66 offset:45056
    v_mfma_f32_16x16x32_bf16 v[52:55], v[188:191], v[244:247], v[52:55]
    ds_read_b64_tr_b16 v[140:141], v67 offset:32768
    v_mfma_f32_16x16x32_bf16 v[56:59], v[172:175], v[232:235], v[56:59]
    buffer_load_dwordx4 v127, s[8:11], s61 offen offset:2048 sc1 lds
    v_mfma_f32_16x16x32_bf16 v[56:59], v[188:191], v[248:251], v[56:59]
    ds_read_b64_tr_b16 v[142:143], v67 offset:36864
    v_mfma_f32_16x16x32_bf16 v[60:63], v[172:175], v[236:239], v[60:63]
    ds_read_b64_tr_b16 v[156:157], v67 offset:40960
    ds_read_b64_tr_b16 v[158:159], v67 offset:45056
    v_mfma_f32_16x16x32_bf16 v[60:63], v[188:191], v[252:255], v[60:63]
    buffer_load_dwordx4 v127, s[8:11], s61 offen offset:3072 sc1 lds
    s_waitcnt lgkmcnt(12)
    v_mfma_f32_16x16x32_bf16 v[0:3], v[128:131], v[192:195], v[0:3]
    s_waitcnt vmcnt(8)
    s_barrier
    v_mfma_f32_16x16x32_bf16 v[0:3], v[144:147], v[208:211], v[0:3]
    ds_read_b128 v[224:227], v72 offset:49152
    v_mfma_f32_16x16x32_bf16 v[4:7], v[128:131], v[196:199], v[4:7]
    ds_read_b128 v[228:231], v73 offset:49152
    v_mfma_f32_16x16x32_bf16 v[4:7], v[144:147], v[212:215], v[4:7]
    ds_read_b128 v[232:235], v74 offset:49152
    s_add_u32 s60, s60, 0x10000
    s_add_u32 m0, s24, 16384
    v_mfma_f32_16x16x32_bf16 v[8:11], v[128:131], v[200:203], v[8:11]
    buffer_load_dwordx4 v92, s[40:43], s60 offen offset:0 lds
    v_mfma_f32_16x16x32_bf16 v[8:11], v[144:147], v[216:219], v[8:11]
    ds_read_b128 v[236:239], v75 offset:49152
    v_mfma_f32_16x16x32_bf16 v[12:15], v[128:131], v[204:207], v[12:15]
    ds_read_b128 v[240:243], v72 offset:57344
    v_mfma_f32_16x16x32_bf16 v[12:15], v[144:147], v[220:223], v[12:15]
    ds_read_b128 v[244:247], v73 offset:57344
    s_waitcnt lgkmcnt(14)
    v_mfma_f32_16x16x32_bf16 v[16:19], v[132:135], v[192:195], v[16:19]
    buffer_load_dwordx4 v93, s[40:43], s60 offen offset:1024 lds
    v_mfma_f32_16x16x32_bf16 v[16:19], v[148:151], v[208:211], v[16:19]
    ds_read_b128 v[248:251], v74 offset:57344
    v_mfma_f32_16x16x32_bf16 v[20:23], v[132:135], v[196:199], v[20:23]
    ds_read_b128 v[252:255], v75 offset:57344
    v_mfma_f32_16x16x32_bf16 v[20:23], v[148:151], v[212:215], v[20:23]
    ds_read_b64_tr_b16 v[160:161], v64 offset:49152
    v_mfma_f32_16x16x32_bf16 v[24:27], v[132:135], v[200:203], v[24:27]
    buffer_load_dwordx4 v94, s[40:43], s60 offen offset:2048 lds
    v_mfma_f32_16x16x32_bf16 v[24:27], v[148:151], v[216:219], v[24:27]
    ds_read_b64_tr_b16 v[162:163], v64 offset:53248
    v_mfma_f32_16x16x32_bf16 v[28:31], v[132:135], v[204:207], v[28:31]
    ds_read_b64_tr_b16 v[176:177], v64 offset:57344
    v_mfma_f32_16x16x32_bf16 v[28:31], v[148:151], v[220:223], v[28:31]
    ds_read_b64_tr_b16 v[178:179], v64 offset:61440
    s_waitcnt lgkmcnt(15)
    v_mfma_f32_16x16x32_bf16 v[32:35], v[136:139], v[192:195], v[32:35]
    buffer_load_dwordx4 v95, s[40:43], s60 offen offset:3072 lds
    v_mfma_f32_16x16x32_bf16 v[32:35], v[152:155], v[208:211], v[32:35]
    ds_read_b64_tr_b16 v[164:165], v65 offset:49152
    v_mfma_f32_16x16x32_bf16 v[36:39], v[136:139], v[196:199], v[36:39]
    ds_read_b64_tr_b16 v[166:167], v65 offset:53248
    v_mfma_f32_16x16x32_bf16 v[36:39], v[152:155], v[212:215], v[36:39]
    ds_read_b64_tr_b16 v[180:181], v65 offset:57344
    s_add_u32 s61, s61, 0x40000
    s_add_u32 m0, s24, 81920
    v_mfma_f32_16x16x32_bf16 v[40:43], v[136:139], v[200:203], v[40:43]
    buffer_load_dwordx4 v127, s[8:11], s61 offen offset:0 sc1 lds
    v_mfma_f32_16x16x32_bf16 v[40:43], v[152:155], v[216:219], v[40:43]
    ds_read_b64_tr_b16 v[182:183], v65 offset:61440
    v_mfma_f32_16x16x32_bf16 v[44:47], v[136:139], v[204:207], v[44:47]
    ds_read_b64_tr_b16 v[168:169], v66 offset:49152
    v_mfma_f32_16x16x32_bf16 v[44:47], v[152:155], v[220:223], v[44:47]
    ds_read_b64_tr_b16 v[170:171], v66 offset:53248
    s_waitcnt lgkmcnt(15)
    v_mfma_f32_16x16x32_bf16 v[48:51], v[140:143], v[192:195], v[48:51]
    buffer_load_dwordx4 v127, s[8:11], s61 offen offset:1024 sc1 lds
    v_mfma_f32_16x16x32_bf16 v[48:51], v[156:159], v[208:211], v[48:51]
    ds_read_b64_tr_b16 v[184:185], v66 offset:57344
    v_mfma_f32_16x16x32_bf16 v[52:55], v[140:143], v[196:199], v[52:55]
    ds_read_b64_tr_b16 v[186:187], v66 offset:61440
    v_mfma_f32_16x16x32_bf16 v[52:55], v[156:159], v[212:215], v[52:55]
    ds_read_b64_tr_b16 v[172:173], v67 offset:49152
    v_mfma_f32_16x16x32_bf16 v[56:59], v[140:143], v[200:203], v[56:59]
    buffer_load_dwordx4 v127, s[8:11], s61 offen offset:2048 sc1 lds
    v_mfma_f32_16x16x32_bf16 v[56:59], v[156:159], v[216:219], v[56:59]
    ds_read_b64_tr_b16 v[174:175], v67 offset:53248
    v_mfma_f32_16x16x32_bf16 v[60:63], v[140:143], v[204:207], v[60:63]
    ds_read_b64_tr_b16 v[188:189], v67 offset:57344
    ds_read_b64_tr_b16 v[190:191], v67 offset:61440
    v_mfma_f32_16x16x32_bf16 v[60:63], v[156:159], v[220:223], v[60:63]
    buffer_load_dwordx4 v127, s[8:11], s61 offen offset:3072 sc1 lds
    s_waitcnt lgkmcnt(12)
    v_mfma_f32_16x16x32_bf16 v[0:3], v[160:163], v[224:227], v[0:3]
    s_waitcnt vmcnt(8)
    s_barrier
    v_mfma_f32_16x16x32_bf16 v[0:3], v[176:179], v[240:243], v[0:3]
    ds_read_b128 v[192:195], v72 offset:0
    s_and_b32 s30, s77, s65
    s_cselect_b32 s30, s30, s77
    s_ff1_i32_b32 s29, s30
    v_mfma_f32_16x16x32_bf16 v[4:7], v[160:163], v[228:231], v[4:7]
    ds_read_b128 v[196:199], v73 offset:0
    s_bitset0_b32 s77, s29
    s_lshl_b32 s30, s29, 17
    v_mfma_f32_16x16x32_bf16 v[4:7], v[176:179], v[244:247], v[4:7]
    ds_read_b128 v[200:203], v74 offset:0
    s_add_u32 s60, s30, s27
    s_add_u32 m0, s24, 32768
    v_mfma_f32_16x16x32_bf16 v[8:11], v[160:163], v[232:235], v[8:11]
    buffer_load_dwordx4 v92, s[40:43], s60 offen offset:0 lds
    v_mfma_f32_16x16x32_bf16 v[8:11], v[176:179], v[248:251], v[8:11]
    ds_read_b128 v[204:207], v75 offset:0
    v_mfma_f32_16x16x32_bf16 v[12:15], v[160:163], v[236:239], v[12:15]
    ds_read_b128 v[208:211], v72 offset:8192
    v_mfma_f32_16x16x32_bf16 v[12:15], v[176:179], v[252:255], v[12:15]
    ds_read_b128 v[212:215], v73 offset:8192
    s_waitcnt lgkmcnt(14)
    v_mfma_f32_16x16x32_bf16 v[16:19], v[164:167], v[224:227], v[16:19]
    buffer_load_dwordx4 v93, s[40:43], s60 offen offset:1024 lds
    v_mfma_f32_16x16x32_bf16 v[16:19], v[180:183], v[240:243], v[16:19]
    ds_read_b128 v[216:219], v74 offset:8192
    v_mfma_f32_16x16x32_bf16 v[20:23], v[164:167], v[228:231], v[20:23]
    ds_read_b128 v[220:223], v75 offset:8192
    v_mfma_f32_16x16x32_bf16 v[20:23], v[180:183], v[244:247], v[20:23]
    ds_read_b64_tr_b16 v[128:129], v64 offset:0
    v_mfma_f32_16x16x32_bf16 v[24:27], v[164:167], v[232:235], v[24:27]
    buffer_load_dwordx4 v94, s[40:43], s60 offen offset:2048 lds
    v_mfma_f32_16x16x32_bf16 v[24:27], v[180:183], v[248:251], v[24:27]
    ds_read_b64_tr_b16 v[130:131], v64 offset:4096
    v_mfma_f32_16x16x32_bf16 v[28:31], v[164:167], v[236:239], v[28:31]
    ds_read_b64_tr_b16 v[144:145], v64 offset:8192
    v_mfma_f32_16x16x32_bf16 v[28:31], v[180:183], v[252:255], v[28:31]
    ds_read_b64_tr_b16 v[146:147], v64 offset:12288
    s_waitcnt lgkmcnt(15)
    v_mfma_f32_16x16x32_bf16 v[32:35], v[168:171], v[224:227], v[32:35]
    buffer_load_dwordx4 v95, s[40:43], s60 offen offset:3072 lds
    v_mfma_f32_16x16x32_bf16 v[32:35], v[184:187], v[240:243], v[32:35]
    ds_read_b64_tr_b16 v[132:133], v65 offset:0
    s_lshl_b32 s28, 1, s29
    s_and_b32 s28, s28, s23
    s_lshl_b32 s30, s29, 19
    s_add_u32 s61, s30, s63
    v_mfma_f32_16x16x32_bf16 v[36:39], v[168:171], v[228:231], v[36:39]
    ds_read_b64_tr_b16 v[134:135], v65 offset:4096
    s_andn2_b32 s31, s28, s62
    s_cbranch_scc1 L_pb10
L_qb10:
    v_mfma_f32_16x16x32_bf16 v[36:39], v[184:187], v[244:247], v[36:39]
    ds_read_b64_tr_b16 v[148:149], v65 offset:8192
    s_add_u32 m0, s24, 98304
    v_mfma_f32_16x16x32_bf16 v[40:43], v[168:171], v[232:235], v[40:43]
    buffer_load_dwordx4 v127, s[8:11], s61 offen offset:0 sc1 lds
    v_mfma_f32_16x16x32_bf16 v[40:43], v[184:187], v[248:251], v[40:43]
    ds_read_b64_tr_b16 v[150:151], v65 offset:12288
    v_mfma_f32_16x16x32_bf16 v[44:47], v[168:171], v[236:239], v[44:47]
    ds_read_b64_tr_b16 v[136:137], v66 offset:0
    v_mfma_f32_16x16x32_bf16 v[44:47], v[184:187], v[252:255], v[44:47]
    ds_read_b64_tr_b16 v[138:139], v66 offset:4096
    s_waitcnt lgkmcnt(15)
    v_mfma_f32_16x16x32_bf16 v[48:51], v[172:175], v[224:227], v[48:51]
    buffer_load_dwordx4 v127, s[8:11], s61 offen offset:1024 sc1 lds
    v_mfma_f32_16x16x32_bf16 v[48:51], v[188:191], v[240:243], v[48:51]
    ds_read_b64_tr_b16 v[152:153], v66 offset:8192
    v_mfma_f32_16x16x32_bf16 v[52:55], v[172:175], v[228:231], v[52:55]
    ds_read_b64_tr_b16 v[154:155], v66 offset:12288
    v_mfma_f32_16x16x32_bf16 v[52:55], v[188:191], v[244:247], v[52:55]
    ds_read_b64_tr_b16 v[140:141], v67 offset:0
    v_mfma_f32_16x16x32_bf16 v[56:59], v[172:175], v[232:235], v[56:59]
    buffer_load_dwordx4 v127, s[8:11], s61 offen offset:2048 sc1 lds
    v_mfma_f32_16x16x32_bf16 v[56:59], v[188:191], v[248:251], v[56:59]
    ds_read_b64_tr_b16 v[142:143], v67 offset:4096
    v_mfma_f32_16x16x32_bf16 v[60:63], v[172:175], v[236:239], v[60:63]
    ds_read_b64_tr_b16 v[156:157], v67 offset:8192
    ds_read_b64_tr_b16 v[158:159], v67 offset:12288
    v_mfma_f32_16x16x32_bf16 v[60:63], v[188:191], v[252:255], v[60:63]
    buffer_load_dwordx4 v127, s[8:11], s61 offen offset:3072 sc1 lds
    s_sub_u32 s35, s35, 1
    s_cmp_lg_u32 s35, 0
    s_cbranch_scc1 L_t_loop
    buffer_load_dword v86, v89, s[72:75], s69 offen sc1
    buffer_load_dwordx2 v[104:105], v85, s[4:7], s66 offen offset:0
    buffer_load_dwordx2 v[112:113], v81, s[56:59], s67 offen offset:0
    buffer_load_dwordx2 v[106:107], v85, s[4:7], s66 offen offset:32
    buffer_load_dwordx2 v[114:115], v81, s[56:59], s67 offen offset:32
    buffer_load_dwordx2 v[108:109], v85, s[4:7], s66 offen offset:64
    buffer_load_dwordx2 v[116:117], v81, s[56:59], s67 offen offset:64
    buffer_load_dwordx2 v[110:111], v85, s[4:7], s66 offen offset:96
    buffer_load_dwordx2 v[118:119], v81, s[56:59], s67 offen offset:96
    s_bitcmp1_b32 s34, 0
    s_cbranch_scc0 L_t_done
    s_waitcnt lgkmcnt(12)
    v_mfma_f32_16x16x32_bf16 v[0:3], v[128:131], v[192:195], v[0:3]
    s_waitcnt vmcnt(17)
    s_barrier
    v_mfma_f32_16x16x32_bf16 v[0:3], v[144:147], v[208:211], v[0:3]
    ds_read_b128 v[224:227], v72 offset:16384
    v_mfma_f32_16x16x32_bf16 v[4:7], v[128:131], v[196:199], v[4:7]
    ds_read_b128 v[228:231], v73 offset:16384
    v_mfma_f32_16x16x32_bf16 v[4:7], v[144:147], v[212:215], v[4:7]
    ds_read_b128 v[232:235], v74 offset:16384
    v_mfma_f32_16x16x32_bf16 v[8:11], v[128:131], v[200:203], v[8:11]
    v_mfma_f32_16x16x32_bf16 v[8:11], v[144:147], v[216:219], v[8:11]
    ds_read_b128 v[236:239], v75 offset:16384
    v_mfma_f32_16x16x32_bf16 v[12:15], v[128:131], v[204:207], v[12:15]
    ds_read_b128 v[240:243], v72 offset:24576
    v_mfma_f32_16x16x32_bf16 v[12:15], v[144:147], v[220:223], v[12:15]
    ds_read_b128 v[244:247], v73 offset:24576
    s_waitcnt lgkmcnt(14)
    v_mfma_f32_16x16x32_bf16 v[16:19], v[132:135], v[192:195], v[16:19]
    v_mfma_f32_16x16x32_bf16 v[16:19], v[148:151], v[208:211], v[16:19]
    ds_read_b128 v[248:251], v74 offset:24576
    v_mfma_f32_16x16x32_bf16 v[20:23], v[132:135], v[196:199], v[20:23]
    ds_read_b128 v[252:255], v75 offset:24576
    v_mfma_f32_16x16x32_bf16 v[20:23], v[148:151], v[212:215], v[20:23]
    ds_read_b64_tr_b16 v[160:161], v64 offset:16384
    v_mfma_f32_16x16x32_bf16 v[24:27], v[132:135], v[200:203], v[24:27]
    v_mfma_f32_16x16x32_bf16 v[24:27], v[148:151], v[216:219], v[24:27]
    ds_read_b64_tr_b16 v[162:163], v64 offset:20480
    v_mfma_f32_16x16x32_bf16 v[28:31], v[132:135], v[204:207], v[28:31]
    ds_read_b64_tr_b16 v[176:177], v64 offset:24576
    v_mfma_f32_16x16x32_bf16 v[28:31], v[148:151], v[220:223], v[28:31]
    ds_read_b64_tr_b16 v[178:179], v64 offset:28672
    s_waitcnt lgkmcnt(15)
    v_mfma_f32_16x16x32_bf16 v[32:35], v[136:139], v[192:195], v[32:35]
    v_mfma_f32_16x16x32_bf16 v[32:35], v[152:155], v[208:211], v[32:35]
    ds_read_b64_tr_b16 v[164:165], v65 offset:16384
    v_mfma_f32_16x16x32_bf16 v[36:39], v[136:139], v[196:199], v[36:39]
    ds_read_b64_tr_b16 v[166:167], v65 offset:20480
    v_mfma_f32_16x16x32_bf16 v[36:39], v[152:155], v[212:215], v[36:39]
    ds_read_b64_tr_b16 v[180:181], v65 offset:24576
    v_mfma_f32_16x16x32_bf16 v[40:43], v[136:139], v[200:203], v[40:43]
    v_mfma_f32_16x16x32_bf16 v[40:43], v[152:155], v[216:219], v[40:43]
    ds_read_b64_tr_b16 v[182:183], v65 offset:28672
    v_mfma_f32_16x16x32_bf16 v[44:47], v[136:139], v[204:207], v[44:47]
    ds_read_b64_tr_b16 v[168:169], v66 offset:16384
    v_mfma_f32_16x16x32_bf16 v[44:47], v[152:155], v[220:223], v[44:47]
    ds_read_b64_tr_b16 v[170:171], v66 offset:20480
    s_waitcnt lgkmcnt(15)
    v_mfma_f32_16x16x32_bf16 v[48:51], v[140:143], v[192:195], v[48:51]
    v_mfma_f32_16x16x32_bf16 v[48:51], v[156:159], v[208:211], v[48:51]
    ds_read_b64_tr_b16 v[184:185], v66 offset:24576
    v_mfma_f32_16x16x32_bf16 v[52:55], v[140:143], v[196:199], v[52:55]
    ds_read_b64_tr_b16 v[186:187], v66 offset:28672
    v_mfma_f32_16x16x32_bf16 v[52:55], v[156:159], v[212:215], v[52:55]
    ds_read_b64_tr_b16 v[172:173], v67 offset:16384
    v_mfma_f32_16x16x32_bf16 v[56:59], v[140:143], v[200:203], v[56:59]
    v_mfma_f32_16x16x32_bf16 v[56:59], v[156:159], v[216:219], v[56:59]
    ds_read_b64_tr_b16 v[174:175], v67 offset:20480
    v_mfma_f32_16x16x32_bf16 v[60:63], v[140:143], v[204:207], v[60:63]
    ds_read_b64_tr_b16 v[188:189], v67 offset:24576
    ds_read_b64_tr_b16 v[190:191], v67 offset:28672
    v_mfma_f32_16x16x32_bf16 v[60:63], v[156:159], v[220:223], v[60:63]
    s_waitcnt lgkmcnt(12)
    v_mfma_f32_16x16x32_bf16 v[0:3], v[160:163], v[224:227], v[0:3]
    v_mfma_f32_16x16x32_bf16 v[0:3], v[176:179], v[240:243], v[0:3]
    v_mfma_f32_16x16x32_bf16 v[4:7], v[160:163], v[228:231], v[4:7]
    v_mfma_f32_16x16x32_bf16 v[4:7], v[176:179], v[244:247], v[4:7]
    v_mfma_f32_16x16x32_bf16 v[8:11], v[160:163], v[232:235], v[8:11]
    v_mfma_f32_16x16x32_bf16 v[8:11], v[176:179], v[248:251], v[8:11]
    v_mfma_f32_16x16x32_bf16 v[12:15], v[160:163], v[236:239], v[12:15]
    v_mfma_f32_16x16x32_bf16 v[12:15], v[176:179], v[252:255], v[12:15]
    s_waitcnt lgkmcnt(8)
    v_mfma_f32_16x16x32_bf16 v[16:19], v[164:167], v[224:227], v[16:19]
    v_mfma_f32_16x16x32_bf16 v[16:19], v[180:183], v[240:243], v[16:19]
    v_mfma_f32_16x16x32_bf16 v[20:23], v[164:167], v[228:231], v[20:23]
    v_mfma_f32_16x16x32_bf16 v[20:23], v[180:183], v[244:247], v[20:23]
    v_mfma_f32_16x16x32_bf16 v[24:27], v[164:167], v[232:235], v[24:27]
    v_mfma_f32_16x16x32_bf16 v[24:27], v[180:183], v[248:251], v[24:27]
    v_mfma_f32_16x16x32_bf16 v[28:31], v[164:167], v[236:239], v[28:31]
    v_mfma_f32_16x16x32_bf16 v[28:31], v[180:183], v[252:255], v[28:31]
    s_waitcnt lgkmcnt(4)
    v_mfma_f32_16x16x32_bf16 v[32:35], v[168:171], v[224:227], v[32:35]
    v_mfma_f32_16x16x32_bf16 v[32:35], v[184:187], v[240:243], v[32:35]
    v_mfma_f32_16x16x32_bf16 v[36:39], v[168:171], v[228:231], v[36:39]
    v_mfma_f32_16x16x32_bf16 v[36:39], v[184:187], v[244:247], v[36:39]
    v_mfma_f32_16x16x32_bf16 v[40:43], v[168:171], v[232:235], v[40:43]
    v_mfma_f32_16x16x32_bf16 v[40:43], v[184:187], v[248:251], v[40:43]
    v_mfma_f32_16x16x32_bf16 v[44:47], v[168:171], v[236:239], v[44:47]
    v_mfma_f32_16x16x32_bf16 v[44:47], v[184:187], v[252:255], v[44:47]
    s_waitcnt lgkmcnt(0)
    v_mfma_f32_16x16x32_bf16 v[48:51], v[172:175], v[224:227], v[48:51]
    v_mfma_f32_16x16x32_bf16 v[48:51], v[188:191], v[240:243], v[48:51]
    v_mfma_f32_16x16x32_bf16 v[52:55], v[172:175], v[228:231], v[52:55]
    v_mfma_f32_16x16x32_bf16 v[52:55], v[188:191], v[244:247], v[52:55]
    v_mfma_f32_16x16x32_bf16 v[56:59], v[172:175], v[232:235], v[56:59]
    v_mfma_f32_16x16x32_bf16 v[56:59], v[188:191], v[248:251], v[56:59]
    v_mfma_f32_16x16x32_bf16 v[60:63], v[172:175], v[236:239], v[60:63]
    v_mfma_f32_16x16x32_bf16 v[60:63], v[188:191], v[252:255], v[60:63]
L_t_done:
    s_waitcnt vmcnt(8)
    v_cmp_eq_u32 vcc, 1, v86
    s_mov_b32 s64, s69
    s_and_b32 s29, s21, 0x13
    s_lshl_b32 s30, 0x1111, s29
    s_mov_b32 s62, vcc_lo
    s_andn2_b32 s31, s30, s62
    s_cbranch_scc1 L_px
L_qx:
    v_lshlrev_b32 v84, 2, v102
    s_mul_i32 s28, s20, 7168
    s_mov_b32 s72, 0x07060302
    s_mov_b32 s73, 0x05010c0c
    s_mov_b32 s74, 0x07060302
    s_mov_b32 s75, 0xf0f0f0f0
    s_mov_b32 s75, 0xc0c0c0c0
    s_mov_b32 s76, 0xf0f0f0f0
    s_xor_b32 s31, s2, 1
    s_mul_i32 s31, s31, 49152
    s_add_u32 s31, s31, s28
    s_add_u32 s31, s31, 0
    v_min_u32 v4, 0xfffe0000, v4
    v_min_u32 v6, 0xfffe0000, v6
    v_add_u32 v4, 8192, v4
    v_add_u32 v5, 8192, v5
    v_add_u32 v6, 8192, v6
    v_add_u32 v7, 8192, v7
    v_perm_b32 v192, v4, v5, s72
    v_perm_b32 v193, v6, v7, s72
    v_perm_b32 v4, v4, v5, s73
    v_perm_b32 v6, v6, v7, s73
    v_perm_b32 v204, v4, v6, s74
    v_min_u32 v20, 0xfffe0000, v20
    v_min_u32 v22, 0xfffe0000, v22
    v_add_u32 v20, 8192, v20
    v_add_u32 v21, 8192, v21
    v_add_u32 v22, 8192, v22
    v_add_u32 v23, 8192, v23
    v_perm_b32 v194, v20, v21, s72
    v_perm_b32 v195, v22, v23, s72
    v_perm_b32 v20, v20, v21, s73
    v_perm_b32 v22, v22, v23, s73
    v_perm_b32 v205, v20, v22, s74
    v_min_u32 v36, 0xfffe0000, v36
    v_min_u32 v38, 0xfffe0000, v38
    v_add_u32 v36, 8192, v36
    v_add_u32 v37, 8192, v37
    v_add_u32 v38, 8192, v38
    v_add_u32 v39, 8192, v39
    v_perm_b32 v196, v36, v37, s72
    v_perm_b32 v197, v38, v39, s72
    v_perm_b32 v36, v36, v37, s73
    v_perm_b32 v38, v38, v39, s73
    v_perm_b32 v206, v36, v38, s74
    v_min_u32 v52, 0xfffe0000, v52
    v_min_u32 v54, 0xfffe0000, v54
    v_add_u32 v52, 8192, v52
    v_add_u32 v53, 8192, v53
    v_add_u32 v54, 8192, v54
    v_add_u32 v55, 8192, v55
    v_perm_b32 v198, v52, v53, s72
    v_perm_b32 v199, v54, v55, s72
    v_perm_b32 v52, v52, v53, s73
    v_perm_b32 v54, v54, v55, s73
    v_perm_b32 v207, v52, v54, s74
    buffer_store_dwordx4 v[192:195], v127, s[44:47], s31 offen sc1
    buffer_store_dwordx4 v[196:199], v127, s[44:47], s31 offen offset:1024 sc1
    v_lshrrev_b32 v205, 2, v205
    v_bfi_b32 v204, s75, v204, v205
    v_lshrrev_b32 v207, 2, v207
    v_bfi_b32 v206, s75, v206, v207
    v_lshrrev_b32 v206, 4, v206
    v_bfi_b32 v200, s76, v204, v206
    v_min_u32 v200, -2, v200
    buffer_store_dword v200, v84, s[44:47], s31 offen offset:2048 sc1
    s_xor_b32 s31, s2, 2
    s_mul_i32 s31, s31, 49152
    s_add_u32 s31, s31, s28
    s_add_u32 s31, s31, 2304
    v_min_u32 v8, 0xfffe0000, v8
    v_min_u32 v10, 0xfffe0000, v10
    v_add_u32 v8, 8192, v8
    v_add_u32 v9, 8192, v9
    v_add_u32 v10, 8192, v10
    v_add_u32 v11, 8192, v11
    v_perm_b32 v208, v8, v9, s72
    v_perm_b32 v209, v10, v11, s72
    v_perm_b32 v8, v8, v9, s73
    v_perm_b32 v10, v10, v11, s73
    v_perm_b32 v220, v8, v10, s74
    v_min_u32 v24, 0xfffe0000, v24
    v_min_u32 v26, 0xfffe0000, v26
    v_add_u32 v24, 8192, v24
    v_add_u32 v25, 8192, v25
    v_add_u32 v26, 8192, v26
    v_add_u32 v27, 8192, v27
    v_perm_b32 v210, v24, v25, s72
    v_perm_b32 v211, v26, v27, s72
    v_perm_b32 v24, v24, v25, s73
    v_perm_b32 v26, v26, v27, s73
    v_perm_b32 v221, v24, v26, s74
    v_min_u32 v40, 0xfffe0000, v40
    v_min_u32 v42, 0xfffe0000, v42
    v_add_u32 v40, 8192, v40
    v_add_u32 v41, 8192, v41
    v_add_u32 v42, 8192, v42
    v_add_u32 v43, 8192, v43
    v_perm_b32 v212, v40, v41, s72
    v_perm_b32 v213, v42, v43, s72
    v_perm_b32 v40, v40, v41, s73
    v_perm_b32 v42, v42, v43, s73
    v_perm_b32 v222, v40, v42, s74
    v_min_u32 v56, 0xfffe0000, v56
    v_min_u32 v58, 0xfffe0000, v58
    v_add_u32 v56, 8192, v56
    v_add_u32 v57, 8192, v57
    v_add_u32 v58, 8192, v58
    v_add_u32 v59, 8192, v59
    v_perm_b32 v214, v56, v57, s72
    v_perm_b32 v215, v58, v59, s72
    v_perm_b32 v56, v56, v57, s73
    v_perm_b32 v58, v58, v59, s73
    v_perm_b32 v223, v56, v58, s74
    buffer_store_dwordx4 v[208:211], v127, s[44:47], s31 offen sc1
    buffer_store_dwordx4 v[212:215], v127, s[44:47], s31 offen offset:1024 sc1
    v_lshrrev_b32 v221, 2, v221
    v_bfi_b32 v220, s75, v220, v221
    v_lshrrev_b32 v223, 2, v223
    v_bfi_b32 v222, s75, v222, v223
    v_lshrrev_b32 v222, 4, v222
    v_bfi_b32 v216, s76, v220, v222
    v_min_u32 v216, -2, v216
    buffer_store_dword v216, v84, s[44:47], s31 offen offset:2048 sc1
    s_xor_b32 s31, s2, 3
    s_mul_i32 s31, s31, 49152
    s_add_u32 s31, s31, s28
    s_add_u32 s31, s31, 4608
    v_min_u32 v12, 0xfffe0000, v12
    v_min_u32 v14, 0xfffe0000, v14
    v_add_u32 v12, 8192, v12
    v_add_u32 v13, 8192, v13
    v_add_u32 v14, 8192, v14
    v_add_u32 v15, 8192, v15
    v_perm_b32 v224, v12, v13, s72
    v_perm_b32 v225, v14, v15, s72
    v_perm_b32 v12, v12, v13, s73
    v_perm_b32 v14, v14, v15, s73
    v_perm_b32 v236, v12, v14, s74
    v_min_u32 v28, 0xfffe0000, v28
    v_min_u32 v30, 0xfffe0000, v30
    v_add_u32 v28, 8192, v28
    v_add_u32 v29, 8192, v29
    v_add_u32 v30, 8192, v30
    v_add_u32 v31, 8192, v31
    v_perm_b32 v226, v28, v29, s72
    v_perm_b32 v227, v30, v31, s72
    v_perm_b32 v28, v28, v29, s73
    v_perm_b32 v30, v30, v31, s73
    v_perm_b32 v237, v28, v30, s74
    v_min_u32 v44, 0xfffe0000, v44
    v_min_u32 v46, 0xfffe0000, v46
    v_add_u32 v44, 8192, v44
    v_add_u32 v45, 8192, v45
    v_add_u32 v46, 8192, v46
    v_add_u32 v47, 8192, v47
    v_perm_b32 v228, v44, v45, s72
    v_perm_b32 v229, v46, v47, s72
    v_perm_b32 v44, v44, v45, s73
    v_perm_b32 v46, v46, v47, s73
    v_perm_b32 v238, v44, v46, s74
    v_min_u32 v60, 0xfffe0000, v60
    v_min_u32 v62, 0xfffe0000, v62
    v_add_u32 v60, 8192, v60
    v_add_u32 v61, 8192, v61
    v_add_u32 v62, 8192, v62
    v_add_u32 v63, 8192, v63
    v_perm_b32 v230, v60, v61, s72
    v_perm_b32 v231, v62, v63, s72
    v_perm_b32 v60, v60, v61, s73
    v_perm_b32 v62, v62, v63, s73
    v_perm_b32 v239, v60, v62, s74
    buffer_store_dwordx4 v[224:227], v127, s[44:47], s31 offen sc1
    buffer_store_dwordx4 v[228:231], v127, s[44:47], s31 offen offset:1024 sc1
    v_lshrrev_b32 v237, 2, v237
    v_bfi_b32 v236, s75, v236, v237
    v_lshrrev_b32 v239, 2, v239
    v_bfi_b32 v238, s75, v238, v239
    v_lshrrev_b32 v238, 4, v238
    v_bfi_b32 v232, s76, v236, v238
    v_min_u32 v232, -2, v232
    buffer_store_dword v232, v84, s[44:47], s31 offen offset:2048 sc1
    s_mul_i32 s49, s2, 49152
    s_add_u32 s49, s49, s28
    s_add_u32 s50, s49, 2304
    s_add_u32 s51, s49, 4608
    s_mov_b32 s40, 117834508
    s_mov_b32 s41, 84148748
    s_mov_b32 s42, 117833996
    s_mov_b32 s43, 84148236
    s_mov_b32 s4, s38
    s_mov_b32 s5, s39
    s_mov_b32 s67, 0xbfb8aa3b
    s_cmp_eq_u32 s26, 1
    s_cselect_b64 s[32:33], -1, 0
    s_cmp_eq_u32 s26, 2
    s_cselect_b64 s[34:35], -1, 0
    s_cmp_eq_u32 s26, 3
    s_cselect_b64 s[36:37], -1, 0
    s_waitcnt vmcnt(9)
    v_lshlrev_b32 v176, 16, v104
    v_lshlrev_b32 v240, 16, v112
    v_and_b32 v177, 0xffff0000, v104
    v_and_b32 v241, 0xffff0000, v112
    v_lshlrev_b32 v178, 16, v105
    v_lshlrev_b32 v242, 16, v113
    v_and_b32 v179, 0xffff0000, v105
    v_and_b32 v243, 0xffff0000, v113
    v_lshlrev_b32 v180, 16, v106
    v_lshlrev_b32 v244, 16, v114
    v_and_b32 v181, 0xffff0000, v106
    v_and_b32 v245, 0xffff0000, v114
    v_lshlrev_b32 v182, 16, v107
    v_lshlrev_b32 v246, 16, v115
    v_and_b32 v183, 0xffff0000, v107
    v_and_b32 v247, 0xffff0000, v115
    v_lshlrev_b32 v184, 16, v108
    v_lshlrev_b32 v248, 16, v116
    v_and_b32 v185, 0xffff0000, v108
    v_and_b32 v249, 0xffff0000, v116
    v_lshlrev_b32 v186, 16, v109
    v_lshlrev_b32 v250, 16, v117
    v_and_b32 v187, 0xffff0000, v109
    v_and_b32 v251, 0xffff0000, v117
    v_lshlrev_b32 v188, 16, v110
    v_lshlrev_b32 v252, 16, v118
    v_and_b32 v189, 0xffff0000, v110
    v_and_b32 v253, 0xffff0000, v118
    v_lshlrev_b32 v190, 16, v111
    v_lshlrev_b32 v254, 16, v119
    v_and_b32 v191, 0xffff0000, v111
    v_and_b32 v255, 0xffff0000, v119
L_x_poll:
    buffer_load_dwordx4 v[192:195], v127, s[44:47], s49 offen sc1
    buffer_load_dwordx4 v[196:199], v127, s[44:47], s49 offen offset:1024 sc1
    buffer_load_dword v200, v84, s[44:47], s49 offen offset:2048 sc1
    buffer_load_dwordx4 v[208:211], v127, s[44:47], s50 offen sc1
    buffer_load_dwordx4 v[212:215], v127, s[44:47], s50 offen offset:1024 sc1
    buffer_load_dword v216, v84, s[44:47], s50 offen offset:2048 sc1
    buffer_load_dwordx4 v[224:227], v127, s[44:47], s51 offen sc1
    buffer_load_dwordx4 v[228:231], v127, s[44:47], s51 offen offset:1024 sc1
    buffer_load_dword v232, v84, s[44:47], s51 offen offset:2048 sc1
    s_waitcnt vmcnt(6)
    v_max3_u32 v86, v192, v193, v192
    v_max3_u32 v86, v194, v195, v86
    v_max3_u32 v86, v196, v197, v86
    v_max3_u32 v86, v198, v199, v86
    v_max3_u32 v86, v200, v200, v86
    v_and_b32 v204, s75, v200
    v_lshlrev_b32 v205, 2, v200
    v_and_b32 v205, s75, v205
    v_lshlrev_b32 v206, 4, v200
    v_and_b32 v206, s75, v206
    v_lshlrev_b32 v207, 6, v200
    v_and_b32 v207, s75, v207
    v_perm_b32 v128, v192, v204, s40
    v_perm_b32 v129, v192, v204, s41
    v_perm_b32 v130, v193, v204, s42
    v_perm_b32 v131, v193, v204, s43
    v_perm_b32 v132, v194, v205, s40
    v_perm_b32 v133, v194, v205, s41
    v_perm_b32 v134, v195, v205, s42
    v_perm_b32 v135, v195, v205, s43
    v_perm_b32 v136, v196, v206, s40
    v_perm_b32 v137, v196, v206, s41
    v_perm_b32 v138, v197, v206, s42
    v_perm_b32 v139, v197, v206, s43
    v_perm_b32 v140, v198, v207, s40
    v_perm_b32 v141, v198, v207, s41
    v_perm_b32 v142, v199, v207, s42
    v_perm_b32 v143, v199, v207, s43
    s_waitcnt vmcnt(3)
    v_max3_u32 v86, v208, v209, v86
    v_max3_u32 v86, v210, v211, v86
    v_max3_u32 v86, v212, v213, v86
    v_max3_u32 v86, v214, v215, v86
    v_max3_u32 v86, v216, v216, v86
    v_and_b32 v220, s75, v216
    v_lshlrev_b32 v221, 2, v216
    v_and_b32 v221, s75, v221
    v_lshlrev_b32 v222, 4, v216
    v_and_b32 v222, s75, v222
    v_lshlrev_b32 v223, 6, v216
    v_and_b32 v223, s75, v223
    v_perm_b32 v144, v208, v220, s40
    v_perm_b32 v145, v208, v220, s41
    v_perm_b32 v146, v209, v220, s42
    v_perm_b32 v147, v209, v220, s43
    v_perm_b32 v148, v210, v221, s40
    v_perm_b32 v149, v210, v221, s41
    v_perm_b32 v150, v211, v221, s42
    v_perm_b32 v151, v211, v221, s43
    v_perm_b32 v152, v212, v222, s40
    v_perm_b32 v153, v212, v222, s41
    v_perm_b32 v154, v213, v222, s42
    v_perm_b32 v155, v213, v222, s43
    v_perm_b32 v156, v214, v223, s40
    v_perm_b32 v157, v214, v223, s41
    v_perm_b32 v158, v215, v223, s42
    v_perm_b32 v159, v215, v223, s43
    s_waitcnt vmcnt(0)
    v_max3_u32 v86, v224, v225, v86
    v_max3_u32 v86, v226, v227, v86
    v_max3_u32 v86, v228, v229, v86
    v_max3_u32 v86, v230, v231, v86
    v_max3_u32 v86, v232, v232, v86
    v_and_b32 v236, s75, v232
    v_lshlrev_b32 v237, 2, v232
    v_and_b32 v237, s75, v237
    v_lshlrev_b32 v238, 4, v232
    v_and_b32 v238, s75, v238
    v_lshlrev_b32 v239, 6, v232
    v_and_b32 v239, s75, v239
    v_perm_b32 v160, v224, v236, s40
    v_perm_b32 v161, v224, v236, s41
    v_perm_b32 v162, v225, v236, s42
    v_perm_b32 v163, v225, v236, s43
    v_perm_b32 v164, v226, v237, s40
    v_perm_b32 v165, v226, v237, s41
    v_perm_b32 v166, v227, v237, s42
    v_perm_b32 v167, v227, v237, s43
    v_perm_b32 v168, v228, v238, s40
    v_perm_b32 v169, v228, v238, s41
    v_perm_b32 v170, v229, v238, s42
    v_perm_b32 v171, v229, v238, s43
    v_perm_b32 v172, v230, v239, s40
    v_perm_b32 v173, v230, v239, s41
    v_perm_b32 v174, v231, v239, s42
    v_perm_b32 v175, v231, v239, s43
    v_cmp_eq_u32 vcc, -1, v86
    s_sub_u32 s25, s25, 16
    s_cbranch_scc1 L_x_go
    s_cbranch_vccnz L_x_poll
L_x_go:
    v_cndmask_b32 v192, v0, v128, s[32:33]
    v_cndmask_b32 v193, v1, v129, s[32:33]
    v_cndmask_b32 v194, v2, v130, s[32:33]
    v_cndmask_b32 v195, v3, v131, s[32:33]
    v_cndmask_b32 v196, v16, v132, s[32:33]
    v_cndmask_b32 v197, v17, v133, s[32:33]
    v_cndmask_b32 v198, v18, v134, s[32:33]
    v_cndmask_b32 v199, v19, v135, s[32:33]
    v_cndmask_b32 v200, v32, v136, s[32:33]
    v_cndmask_b32 v201, v33, v137, s[32:33]
    v_cndmask_b32 v202, v34, v138, s[32:33]
    v_cndmask_b32 v203, v35, v139, s[32:33]
    v_cndmask_b32 v204, v48, v140, s[32:33]
    v_cndmask_b32 v205, v49, v141, s[32:33]
    v_cndmask_b32 v206, v50, v142, s[32:33]
    v_cndmask_b32 v207, v51, v143, s[32:33]
    v_cndmask_b32 v192, v192, v144, s[34:35]
    v_cndmask_b32 v193, v193, v145, s[34:35]
    v_cndmask_b32 v194, v194, v146, s[34:35]
    v_cndmask_b32 v195, v195, v147, s[34:35]
    v_cndmask_b32 v196, v196, v148, s[34:35]
    v_cndmask_b32 v197, v197, v149, s[34:35]
    v_cndmask_b32 v198, v198, v150, s[34:35]
    v_cndmask_b32 v199, v199, v151, s[34:35]
    v_cndmask_b32 v200, v200, v152, s[34:35]
    v_cndmask_b32 v201, v201, v153, s[34:35]
    v_cndmask_b32 v202, v202, v154, s[34:35]
    v_cndmask_b32 v203, v203, v155, s[34:35]
    v_cndmask_b32 v204, v204, v156, s[34:35]
    v_cndmask_b32 v205, v205, v157, s[34:35]
    v_cndmask_b32 v206, v206, v158, s[34:35]
    v_cndmask_b32 v207, v207, v159, s[34:35]
    v_cndmask_b32 v192, v192, v160, s[36:37]
    v_cndmask_b32 v193, v193, v161, s[36:37]
    v_cndmask_b32 v194, v194, v162, s[36:37]
    v_cndmask_b32 v195, v195, v163, s[36:37]
    v_cndmask_b32 v196, v196, v164, s[36:37]
    v_cndmask_b32 v197, v197, v165, s[36:37]
    v_cndmask_b32 v198, v198, v166, s[36:37]
    v_cndmask_b32 v199, v199, v167, s[36:37]
    v_cndmask_b32 v200, v200, v168, s[36:37]
    v_cndmask_b32 v201, v201, v169, s[36:37]
    v_cndmask_b32 v202, v202, v170, s[36:37]
    v_cndmask_b32 v203, v203, v171, s[36:37]
    v_cndmask_b32 v204, v204, v172, s[36:37]
    v_cndmask_b32 v205, v205, v173, s[36:37]
    v_cndmask_b32 v206, v206, v174, s[36:37]
    v_cndmask_b32 v207, v207, v175, s[36:37]
    v_pk_add_f32 v[128:129], v[128:129], v[0:1] op_sel:[0,0] op_sel_hi:[1,1]
    v_pk_add_f32 v[144:145], v[144:145], v[160:161] op_sel:[0,0] op_sel_hi:[1,1]
    v_pk_add_f32 v[130:131], v[130:131], v[2:3] op_sel:[0,0] op_sel_hi:[1,1]
    v_pk_add_f32 v[146:147], v[146:147], v[162:163] op_sel:[0,0] op_sel_hi:[1,1]
    v_pk_add_f32 v[132:133], v[132:133], v[16:17] op_sel:[0,0] op_sel_hi:[1,1]
    v_pk_add_f32 v[148:149], v[148:149], v[164:165] op_sel:[0,0] op_sel_hi:[1,1]
    v_pk_add_f32 v[134:135], v[134:135], v[18:19] op_sel:[0,0] op_sel_hi:[1,1]
    v_pk_add_f32 v[150:151], v[150:151], v[166:167] op_sel:[0,0] op_sel_hi:[1,1]
    v_pk_add_f32 v[136:137], v[136:137], v[32:33] op_sel:[0,0] op_sel_hi:[1,1]
    v_pk_add_f32 v[152:153], v[152:153], v[168:169] op_sel:[0,0] op_sel_hi:[1,1]
    v_pk_add_f32 v[138:139], v[138:139], v[34:35] op_sel:[0,0] op_sel_hi:[1,1]
    v_pk_add_f32 v[154:155], v[154:155], v[170:171] op_sel:[0,0] op_sel_hi:[1,1]
    v_pk_add_f32 v[140:141], v[140:141], v[48:49] op_sel:[0,0] op_sel_hi:[1,1]
    v_pk_add_f32 v[156:157], v[156:157], v[172:173] op_sel:[0,0] op_sel_hi:[1,1]
    v_pk_add_f32 v[142:143], v[142:143], v[50:51] op_sel:[0,0] op_sel_hi:[1,1]
    v_pk_add_f32 v[158:159], v[158:159], v[174:175] op_sel:[0,0] op_sel_hi:[1,1]
    v_pk_add_f32 v[128:129], v[128:129], v[144:145] op_sel:[0,0] op_sel_hi:[1,1]
    v_pk_add_f32 v[240:241], v[240:241], v[192:193] op_sel:[0,0] op_sel_hi:[1,1]
    v_pk_add_f32 v[130:131], v[130:131], v[146:147] op_sel:[0,0] op_sel_hi:[1,1]
    v_pk_add_f32 v[242:243], v[242:243], v[194:195] op_sel:[0,0] op_sel_hi:[1,1]
    v_pk_add_f32 v[132:133], v[132:133], v[148:149] op_sel:[0,0] op_sel_hi:[1,1]
    v_pk_add_f32 v[244:245], v[244:245], v[196:197] op_sel:[0,0] op_sel_hi:[1,1]
    v_pk_add_f32 v[134:135], v[134:135], v[150:151] op_sel:[0,0] op_sel_hi:[1,1]
    v_pk_add_f32 v[246:247], v[246:247], v[198:199] op_sel:[0,0] op_sel_hi:[1,1]
    v_pk_add_f32 v[136:137], v[136:137], v[152:153] op_sel:[0,0] op_sel_hi:[1,1]
    v_pk_add_f32 v[248:249], v[248:249], v[200:201] op_sel:[0,0] op_sel_hi:[1,1]
    v_pk_add_f32 v[138:139], v[138:139], v[154:155] op_sel:[0,0] op_sel_hi:[1,1]
    v_pk_add_f32 v[250:251], v[250:251], v[202:203] op_sel:[0,0] op_sel_hi:[1,1]
    v_pk_add_f32 v[140:141], v[140:141], v[156:157] op_sel:[0,0] op_sel_hi:[1,1]
    v_pk_add_f32 v[252:253], v[252:253], v[204:205] op_sel:[0,0] op_sel_hi:[1,1]
    v_pk_add_f32 v[142:143], v[142:143], v[158:159] op_sel:[0,0] op_sel_hi:[1,1]
    v_pk_add_f32 v[254:255], v[254:255], v[206:207] op_sel:[0,0] op_sel_hi:[1,1]
    v_pk_add_f32 v[128:129], v[128:129], v[192:193] op_sel:[0,0] op_sel_hi:[1,1] neg_lo:[0,1] neg_hi:[0,1]
    v_pk_mul_f32 v[208:209], v[240:241], s[66:67] op_sel:[0,1] op_sel_hi:[1,1]
    v_pk_add_f32 v[130:131], v[130:131], v[194:195] op_sel:[0,0] op_sel_hi:[1,1] neg_lo:[0,1] neg_hi:[0,1]
    v_pk_mul_f32 v[210:211], v[242:243], s[66:67] op_sel:[0,1] op_sel_hi:[1,1]
    v_pk_add_f32 v[132:133], v[132:133], v[196:197] op_sel:[0,0] op_sel_hi:[1,1] neg_lo:[0,1] neg_hi:[0,1]
    v_pk_mul_f32 v[212:213], v[244:245], s[66:67] op_sel:[0,1] op_sel_hi:[1,1]
    v_pk_add_f32 v[134:135], v[134:135], v[198:199] op_sel:[0,0] op_sel_hi:[1,1] neg_lo:[0,1] neg_hi:[0,1]
    v_pk_mul_f32 v[214:215], v[246:247], s[66:67] op_sel:[0,1] op_sel_hi:[1,1]
    v_pk_add_f32 v[136:137], v[136:137], v[200:201] op_sel:[0,0] op_sel_hi:[1,1] neg_lo:[0,1] neg_hi:[0,1]
    v_pk_mul_f32 v[216:217], v[248:249], s[66:67] op_sel:[0,1] op_sel_hi:[1,1]
    v_pk_add_f32 v[138:139], v[138:139], v[202:203] op_sel:[0,0] op_sel_hi:[1,1] neg_lo:[0,1] neg_hi:[0,1]
    v_pk_mul_f32 v[218:219], v[250:251], s[66:67] op_sel:[0,1] op_sel_hi:[1,1]
    v_pk_add_f32 v[140:141], v[140:141], v[204:205] op_sel:[0,0] op_sel_hi:[1,1] neg_lo:[0,1] neg_hi:[0,1]
    v_pk_mul_f32 v[220:221], v[252:253], s[66:67] op_sel:[0,1] op_sel_hi:[1,1]
    v_pk_add_f32 v[142:143], v[142:143], v[206:207] op_sel:[0,0] op_sel_hi:[1,1] neg_lo:[0,1] neg_hi:[0,1]
    v_pk_mul_f32 v[222:223], v[254:255], s[66:67] op_sel:[0,1] op_sel_hi:[1,1]
    v_exp_f32 v208, v208
    v_exp_f32 v209, v209
    v_exp_f32 v210, v210
    v_exp_f32 v211, v211
    v_exp_f32 v212, v212
    v_exp_f32 v213, v213
    v_exp_f32 v214, v214
    v_exp_f32 v215, v215
    v_exp_f32 v216, v216
    v_exp_f32 v217, v217
    v_exp_f32 v218, v218
    v_exp_f32 v219, v219
    v_exp_f32 v220, v220
    v_exp_f32 v221, v221
    v_exp_f32 v222, v222
    v_exp_f32 v223, v223
    v_pk_add_f32 v[208:209], v[208:209], 1.0 op_sel:[0,0] op_sel_hi:[1,0]
    v_pk_mul_f32 v[128:129], v[128:129], v[240:241] op_sel:[0,0] op_sel_hi:[1,1]
    v_pk_add_f32 v[210:211], v[210:211], 1.0 op_sel:[0,0] op_sel_hi:[1,0]
    v_pk_mul_f32 v[130:131], v[130:131], v[242:243] op_sel:[0,0] op_sel_hi:[1,1]
    v_pk_add_f32 v[212:213], v[212:213], 1.0 op_sel:[0,0] op_sel_hi:[1,0]
    v_pk_mul_f32 v[132:133], v[132:133], v[244:245] op_sel:[0,0] op_sel_hi:[1,1]
    v_pk_add_f32 v[214:215], v[214:215], 1.0 op_sel:[0,0] op_sel_hi:[1,0]
    v_pk_mul_f32 v[134:135], v[134:135], v[246:247] op_sel:[0,0] op_sel_hi:[1,1]
    v_pk_add_f32 v[216:217], v[216:217], 1.0 op_sel:[0,0] op_sel_hi:[1,0]
    v_pk_mul_f32 v[136:137], v[136:137], v[248:249] op_sel:[0,0] op_sel_hi:[1,1]
    v_pk_add_f32 v[218:219], v[218:219], 1.0 op_sel:[0,0] op_sel_hi:[1,0]
    v_pk_mul_f32 v[138:139], v[138:139], v[250:251] op_sel:[0,0] op_sel_hi:[1,1]
    v_pk_add_f32 v[220:221], v[220:221], 1.0 op_sel:[0,0] op_sel_hi:[1,0]
    v_pk_mul_f32 v[140:141], v[140:141], v[252:253] op_sel:[0,0] op_sel_hi:[1,1]
    v_pk_add_f32 v[222:223], v[222:223], 1.0 op_sel:[0,0] op_sel_hi:[1,0]
    v_pk_mul_f32 v[142:143], v[142:143], v[254:255] op_sel:[0,0] op_sel_hi:[1,1]
    v_rcp_f32 v208, v208
    v_rcp_f32 v209, v209
    v_rcp_f32 v210, v210
    v_rcp_f32 v211, v211
    v_rcp_f32 v212, v212
    v_rcp_f32 v213, v213
    v_rcp_f32 v214, v214
    v_rcp_f32 v215, v215
    v_rcp_f32 v216, v216
    v_rcp_f32 v217, v217
    v_rcp_f32 v218, v218
    v_rcp_f32 v219, v219
    v_rcp_f32 v220, v220
    v_rcp_f32 v221, v221
    v_rcp_f32 v222, v222
    v_rcp_f32 v223, v223
    v_pk_fma_f32 v[128:129], v[128:129], v[208:209], v[176:177] op_sel:[0,0,0] op_sel_hi:[1,1,1]
    v_pk_fma_f32 v[130:131], v[130:131], v[210:211], v[178:179] op_sel:[0,0,0] op_sel_hi:[1,1,1]
    v_cvt_pk_bf16_f32 v192, v128, v129
    v_cvt_pk_bf16_f32 v193, v130, v131
    buffer_store_dwordx2 v[192:193], v85, s[4:7], s66 offen offset:0
    v_pk_fma_f32 v[132:133], v[132:133], v[212:213], v[180:181] op_sel:[0,0,0] op_sel_hi:[1,1,1]
    v_pk_fma_f32 v[134:135], v[134:135], v[214:215], v[182:183] op_sel:[0,0,0] op_sel_hi:[1,1,1]
    v_cvt_pk_bf16_f32 v194, v132, v133
    v_cvt_pk_bf16_f32 v195, v134, v135
    buffer_store_dwordx2 v[194:195], v85, s[4:7], s66 offen offset:32
    v_pk_fma_f32 v[136:137], v[136:137], v[216:217], v[184:185] op_sel:[0,0,0] op_sel_hi:[1,1,1]
    v_pk_fma_f32 v[138:139], v[138:139], v[218:219], v[186:187] op_sel:[0,0,0] op_sel_hi:[1,1,1]
    v_cvt_pk_bf16_f32 v196, v136, v137
    v_cvt_pk_bf16_f32 v197, v138, v139
    buffer_store_dwordx2 v[196:197], v85, s[4:7], s66 offen offset:64
    v_pk_fma_f32 v[140:141], v[140:141], v[220:221], v[188:189] op_sel:[0,0,0] op_sel_hi:[1,1,1]
    v_pk_fma_f32 v[142:143], v[142:143], v[222:223], v[190:191] op_sel:[0,0,0] op_sel_hi:[1,1,1]
    v_cvt_pk_bf16_f32 v198, v140, v141
    v_cvt_pk_bf16_f32 v199, v142, v143
    buffer_store_dwordx2 v[198:199], v85, s[4:7], s66 offen offset:96
L_k2_end:
    s_endpgm
L_rdy:
    s_mov_b32 s62, 0
    s_waitcnt vmcnt(0)
    s_cmp_lg_u32 s70, 0
    s_cbranch_scc1 L_rdy_s
    s_mov_b64 exec, 1
    v_mov_b32 v87, 1
    buffer_store_dword v87, v90, s[72:75], s76 offen sc1
    buffer_store_dword v87, v90, s[72:75], s71 offen sc1
    s_mov_b64 exec, -1
    s_mov_b32 s70, 1
L_rdy_s:
    s_lshl_b32 s31, s22, 5
    buffer_load_dword v124, v125, s[16:19], s31 offen sc1
    s_waitcnt vmcnt(0)
    v_and_b32 v124, 0x02020202, v124
    v_cmp_ne_u32 vcc, 0x02020202, v124
    s_sub_u32 s25, s25, 1
    s_cbranch_scc1 L_rdy_t
    s_cbranch_vccnz L_rdy
    s_branch L_rdy_ok
L_rdy_t:
    s_mov_b32 s25, 0
    s_branch L_rdy_ok
L_pb0:
    s_waitcnt vmcnt(0)
    s_cmp_lg_u32 s70, 0
    s_cbranch_scc1 L_sb0
    s_mov_b64 exec, 1
    v_mov_b32 v87, 1
    buffer_store_dword v87, v90, s[72:75], s76 offen sc1
    buffer_store_dword v87, v90, s[72:75], s71 offen sc1
    s_mov_b64 exec, -1
    s_mov_b32 s70, 1
L_sb0:
    buffer_load_dword v88, v89, s[72:75], s64 offen sc1
    s_waitcnt vmcnt(0)
    v_cmp_eq_u32 vcc, 1, v88
    s_sub_u32 s25, s25, 1
    s_mov_b32 s62, vcc_lo
    s_cbranch_scc1 L_rb0
    s_andn2_b32 s31, s28, s62
    s_cbranch_scc1 L_pb0
    s_branch L_qb0
L_rb0:
    s_mov_b32 s25, 0
    s_branch L_qb0
L_pb2:
    s_waitcnt vmcnt(0)
    s_cmp_lg_u32 s70, 0
    s_cbranch_scc1 L_sb2
    s_mov_b64 exec, 1
    v_mov_b32 v87, 1
    buffer_store_dword v87, v90, s[72:75], s76 offen sc1
    buffer_store_dword v87, v90, s[72:75], s71 offen sc1
    s_mov_b64 exec, -1
    s_mov_b32 s70, 1
L_sb2:
    buffer_load_dword v88, v89, s[72:75], s64 offen sc1
    s_waitcnt vmcnt(0)
    v_cmp_eq_u32 vcc, 1, v88
    s_sub_u32 s25, s25, 1
    s_mov_b32 s62, vcc_lo
    s_cbranch_scc1 L_rb2
    s_andn2_b32 s31, s28, s62
    s_cbranch_scc1 L_pb2
    s_branch L_qb2
L_rb2:
    s_mov_b32 s25, 0
    s_branch L_qb2
L_pb8:
    buffer_load_dword v88, v89, s[72:75], s64 offen sc1
    s_waitcnt vmcnt(0)
    v_cmp_eq_u32 vcc, 1, v88
    s_sub_u32 s25, s25, 1
    s_mov_b32 s62, vcc_lo
    s_cbranch_scc1 L_rb8
    s_andn2_b32 s31, s28, s62
    s_cbranch_scc1 L_pb8
    s_branch L_qb8
L_rb8:
    s_mov_b32 s25, 0
    s_branch L_qb8
L_pb10:
    buffer_load_dword v88, v89, s[72:75], s64 offen sc1
    s_waitcnt vmcnt(0)
    v_cmp_eq_u32 vcc, 1, v88
    s_sub_u32 s25, s25, 1
    s_mov_b32 s62, vcc_lo
    s_cbranch_scc1 L_rb10
    s_andn2_b32 s31, s28, s62
    s_cbranch_scc1 L_pb10
    s_branch L_qb10
L_rb10:
    s_mov_b32 s25, 0
    s_branch L_qb10
L_px:
    buffer_load_dword v88, v89, s[72:75], s64 offen sc1
    s_waitcnt vmcnt(0)
    v_cmp_eq_u32 vcc, 1, v88
    s_sub_u32 s25, s25, 1
    s_mov_b32 s62, vcc_lo
    s_cbranch_scc1 L_rx
    s_andn2_b32 s31, s30, s62
    s_cbranch_scc1 L_px
    s_branch L_qx
L_rx:
    s_mov_b32 s25, 0
    s_branch L_qx
L_attn_exact:
    s_mov_b64 s[78:79], 0
    s_waitcnt vmcnt(0)
    v_and_b32 v113, 15, v102
    v_lshrrev_b32 v104, 4, v102
    v_lshlrev_b32 v104, 4, v104
    v_lshl_add_u32 v113, v113, 8, v104
    s_xor_b32 s32, s20, 0
    s_lshl_b32 s32, s32, 6
    s_xor_b32 s33, s20, 1
    s_lshl_b32 s33, s33, 6
    s_xor_b32 s34, s20, 2
    s_lshl_b32 s34, s34, 6
    s_xor_b32 s35, s20, 3
    s_lshl_b32 s35, s35, 6
    s_lshl_b32 s36, s20, 13
    s_add_u32 s36, s36, 0x20000
    s_sub_u32 s37, s36, 0x10000
    v_add_u32 v84, s37, v84
    v_add_u32 v85, s37, v85
    v_add_u32 v86, s37, v86
    v_add_u32 v87, s37, v87
    v_add_u32 v88, s37, v88
    v_add_u32 v89, s37, v89
    v_add_u32 v90, s37, v90
    v_add_u32 v91, s37, v91
    v_mov_b32 v116, 0xff800000
    v_mov_b32 v98, 0
    v_mov_b32 v117, 0xff800000
    v_mov_b32 v99, 0
    v_mov_b32 v118, 0xff800000
    v_mov_b32 v100, 0
    v_mov_b32 v119, 0xff800000
    v_mov_b32 v101, 0
    v_mov_b32 v64, 0
    v_mov_b32 v65, 0
    v_mov_b32 v66, 0
    v_mov_b32 v67, 0
    v_mov_b32 v68, 0
    v_mov_b32 v69, 0
    v_mov_b32 v70, 0
    v_mov_b32 v71, 0
    v_mov_b32 v72, 0
    v_mov_b32 v73, 0
    v_mov_b32 v74, 0
    v_mov_b32 v75, 0
    v_mov_b32 v76, 0
    v_mov_b32 v77, 0
    v_mov_b32 v78, 0
    v_mov_b32 v79, 0
    v_mov_b32 v128, 0
    v_mov_b32 v129, 0
    v_mov_b32 v130, 0
    v_mov_b32 v131, 0
    v_mov_b32 v132, 0
    v_mov_b32 v133, 0
    v_mov_b32 v134, 0
    v_mov_b32 v135, 0
    v_mov_b32 v136, 0
    v_mov_b32 v137, 0
    v_mov_b32 v138, 0
    v_mov_b32 v139, 0
    v_mov_b32 v140, 0
    v_mov_b32 v141, 0
    v_mov_b32 v142, 0
    v_mov_b32 v143, 0
    v_mov_b32 v144, 0
    v_mov_b32 v145, 0
    v_mov_b32 v146, 0
    v_mov_b32 v147, 0
    v_mov_b32 v148, 0
    v_mov_b32 v149, 0
    v_mov_b32 v150, 0
    v_mov_b32 v151, 0
    v_mov_b32 v152, 0
    v_mov_b32 v153, 0
    v_mov_b32 v154, 0
    v_mov_b32 v155, 0
    v_mov_b32 v156, 0
    v_mov_b32 v157, 0
    v_mov_b32 v158, 0
    v_mov_b32 v159, 0
    v_mov_b32 v160, 0
    v_mov_b32 v161, 0
    v_mov_b32 v162, 0
    v_mov_b32 v163, 0
    v_mov_b32 v164, 0
    v_mov_b32 v165, 0
    v_mov_b32 v166, 0
    v_mov_b32 v167, 0
    v_mov_b32 v168, 0
    v_mov_b32 v169, 0
    v_mov_b32 v170, 0
    v_mov_b32 v171, 0
    v_mov_b32 v172, 0
    v_mov_b32 v173, 0
    v_mov_b32 v174, 0
    v_mov_b32 v175, 0
    v_mov_b32 v176, 0
    v_mov_b32 v177, 0
    v_mov_b32 v178, 0
    v_mov_b32 v179, 0
    v_mov_b32 v180, 0
    v_mov_b32 v181, 0
    v_mov_b32 v182, 0
    v_mov_b32 v183, 0
    v_mov_b32 v184, 0
    v_mov_b32 v185, 0
    v_mov_b32 v186, 0
    v_mov_b32 v187, 0
    v_mov_b32 v188, 0
    v_mov_b32 v189, 0
    v_mov_b32 v190, 0
    v_mov_b32 v191, 0
    v_mov_b32 v192, 0
    v_mov_b32 v193, 0
    v_mov_b32 v194, 0
    v_mov_b32 v195, 0
    v_mov_b32 v196, 0
    v_mov_b32 v197, 0
    v_mov_b32 v198, 0
    v_mov_b32 v199, 0
    v_mov_b32 v200, 0
    v_mov_b32 v201, 0
    v_mov_b32 v202, 0
    v_mov_b32 v203, 0
    v_mov_b32 v204, 0
    v_mov_b32 v205, 0
    v_mov_b32 v206, 0
    v_mov_b32 v207, 0
    v_mov_b32 v208, 0
    v_mov_b32 v209, 0
    v_mov_b32 v210, 0
    v_mov_b32 v211, 0
    v_mov_b32 v212, 0
    v_mov_b32 v213, 0
    v_mov_b32 v214, 0
    v_mov_b32 v215, 0
    v_mov_b32 v216, 0
    v_mov_b32 v217, 0
    v_mov_b32 v218, 0
    v_mov_b32 v219, 0
    v_mov_b32 v220, 0
    v_mov_b32 v221, 0
    v_mov_b32 v222, 0
    v_mov_b32 v223, 0
    v_mov_b32 v224, 0
    v_mov_b32 v225, 0
    v_mov_b32 v226, 0
    v_mov_b32 v227, 0
    v_mov_b32 v228, 0
    v_mov_b32 v229, 0
    v_mov_b32 v230, 0
    v_mov_b32 v231, 0
    v_mov_b32 v232, 0
    v_mov_b32 v233, 0
    v_mov_b32 v234, 0
    v_mov_b32 v235, 0
    v_mov_b32 v236, 0
    v_mov_b32 v237, 0
    v_mov_b32 v238, 0
    v_mov_b32 v239, 0
    v_mov_b32 v240, 0
    v_mov_b32 v241, 0
    v_mov_b32 v242, 0
    v_mov_b32 v243, 0
    v_mov_b32 v244, 0
    v_mov_b32 v245, 0
    v_mov_b32 v246, 0
    v_mov_b32 v247, 0
    v_mov_b32 v248, 0
    v_mov_b32 v249, 0
    v_mov_b32 v250, 0
    v_mov_b32 v251, 0
    v_mov_b32 v252, 0
    v_mov_b32 v253, 0
    v_mov_b32 v254, 0
    v_mov_b32 v255, 0
    s_mov_b32 s38, 0
L_ex_sweep:
    s_mov_b32 s39, 0
L_ex_tile:
    s_add_u32 s31, s39, s32
    s_add_u32 s31, s31, 0
    buffer_load_dwordx4 a[64:67], v113, s[48:51], s31 offen
    s_add_u32 s31, s39, s33
    s_add_u32 s31, s31, 0
    buffer_load_dwordx4 a[68:71], v113, s[48:51], s31 offen
    s_add_u32 s31, s39, s34
    s_add_u32 s31, s31, 0
    buffer_load_dwordx4 a[72:75], v113, s[48:51], s31 offen
    s_add_u32 s31, s39, s35
    s_add_u32 s31, s31, 0
    buffer_load_dwordx4 a[76:79], v113, s[48:51], s31 offen
    s_add_u32 s31, s39, s32
    s_add_u32 s31, s31, 4096
    buffer_load_dwordx4 a[80:83], v113, s[48:51], s31 offen
    s_add_u32 s31, s39, s33
    s_add_u32 s31, s31, 4096
    buffer_load_dwordx4 a[84:87], v113, s[48:51], s31 offen
    s_add_u32 s31, s39, s34
    s_add_u32 s31, s31, 4096
    buffer_load_dwordx4 a[88:91], v113, s[48:51], s31 offen
    s_add_u32 s31, s39, s35
    s_add_u32 s31, s31, 4096
    buffer_load_dwordx4 a[92:95], v113, s[48:51], s31 offen
    s_add_u32 s31, s39, s32
    s_add_u32 s31, s31, 8192
    buffer_load_dwordx4 a[96:99], v113, s[48:51], s31 offen
    s_add_u32 s31, s39, s33
    s_add_u32 s31, s31, 8192
    buffer_load_dwordx4 a[100:103], v113, s[48:51], s31 offen
    s_add_u32 s31, s39, s34
    s_add_u32 s31, s31, 8192
    buffer_load_dwordx4 a[104:107], v113, s[48:51], s31 offen
    s_add_u32 s31, s39, s35
    s_add_u32 s31, s31, 8192
    buffer_load_dwordx4 a[108:111], v113, s[48:51], s31 offen
    s_add_u32 s31, s39, s32
    s_add_u32 s31, s31, 12288
    buffer_load_dwordx4 a[112:115], v113, s[48:51], s31 offen
    s_add_u32 s31, s39, s33
    s_add_u32 s31, s31, 12288
    buffer_load_dwordx4 a[116:119], v113, s[48:51], s31 offen
    s_add_u32 s31, s39, s34
    s_add_u32 s31, s31, 12288
    buffer_load_dwordx4 a[120:123], v113, s[48:51], s31 offen
    s_add_u32 s31, s39, s35
    s_add_u32 s31, s31, 12288
    buffer_load_dwordx4 a[124:127], v113, s[48:51], s31 offen
    s_waitcnt vmcnt(0)
    v_mfma_f32_16x16x32_bf16 v[0:3], a[64:67], a[0:3], v[64:67]
    v_mfma_f32_16x16x32_bf16 v[0:3], a[68:71], a[4:7], v[0:3]
    v_mfma_f32_16x16x32_bf16 v[0:3], a[72:75], a[8:11], v[0:3]
    v_mfma_f32_16x16x32_bf16 v[0:3], a[76:79], a[12:15], v[0:3]
    v_mfma_f32_16x16x32_bf16 v[4:7], a[80:83], a[0:3], v[64:67]
    v_mfma_f32_16x16x32_bf16 v[4:7], a[84:87], a[4:7], v[4:7]
    v_mfma_f32_16x16x32_bf16 v[4:7], a[88:91], a[8:11], v[4:7]
    v_mfma_f32_16x16x32_bf16 v[4:7], a[92:95], a[12:15], v[4:7]
    v_mfma_f32_16x16x32_bf16 v[8:11], a[96:99], a[0:3], v[64:67]
    v_mfma_f32_16x16x32_bf16 v[8:11], a[100:103], a[4:7], v[8:11]
    v_mfma_f32_16x16x32_bf16 v[8:11], a[104:107], a[8:11], v[8:11]
    v_mfma_f32_16x16x32_bf16 v[8:11], a[108:111], a[12:15], v[8:11]
    v_mfma_f32_16x16x32_bf16 v[12:15], a[112:115], a[0:3], v[64:67]
    v_mfma_f32_16x16x32_bf16 v[12:15], a[116:119], a[4:7], v[12:15]
    v_mfma_f32_16x16x32_bf16 v[12:15], a[120:123], a[8:11], v[12:15]
    v_mfma_f32_16x16x32_bf16 v[12:15], a[124:127], a[12:15], v[12:15]
    v_mfma_f32_16x16x32_bf16 v[16:19], a[64:67], a[16:19], v[68:71]
    v_mfma_f32_16x16x32_bf16 v[16:19], a[68:71], a[20:23], v[16:19]
    v_mfma_f32_16x16x32_bf16 v[16:19], a[72:75], a[24:27], v[16:19]
    v_mfma_f32_16x16x32_bf16 v[16:19], a[76:79], a[28:31], v[16:19]
    v_mfma_f32_16x16x32_bf16 v[20:23], a[80:83], a[16:19], v[68:71]
    v_mfma_f32_16x16x32_bf16 v[20:23], a[84:87], a[20:23], v[20:23]
    v_mfma_f32_16x16x32_bf16 v[20:23], a[88:91], a[24:27], v[20:23]
    v_mfma_f32_16x16x32_bf16 v[20:23], a[92:95], a[28:31], v[20:23]
    v_mfma_f32_16x16x32_bf16 v[24:27], a[96:99], a[16:19], v[68:71]
    v_mfma_f32_16x16x32_bf16 v[24:27], a[100:103], a[20:23], v[24:27]
    v_mfma_f32_16x16x32_bf16 v[24:27], a[104:107], a[24:27], v[24:27]
    v_mfma_f32_16x16x32_bf16 v[24:27], a[108:111], a[28:31], v[24:27]
    v_mfma_f32_16x16x32_bf16 v[28:31], a[112:115], a[16:19], v[68:71]
    v_mfma_f32_16x16x32_bf16 v[28:31], a[116:119], a[20:23], v[28:31]
    v_mfma_f32_16x16x32_bf16 v[28:31], a[120:123], a[24:27], v[28:31]
    v_mfma_f32_16x16x32_bf16 v[28:31], a[124:127], a[28:31], v[28:31]
    v_mfma_f32_16x16x32_bf16 v[32:35], a[64:67], a[32:35], v[72:75]
    v_mfma_f32_16x16x32_bf16 v[32:35], a[68:71], a[36:39], v[32:35]
    v_mfma_f32_16x16x32_bf16 v[32:35], a[72:75], a[40:43], v[32:35]
    v_mfma_f32_16x16x32_bf16 v[32:35], a[76:79], a[44:47], v[32:35]
    v_mfma_f32_16x16x32_bf16 v[36:39], a[80:83], a[32:35], v[72:75]
    v_mfma_f32_16x16x32_bf16 v[36:39], a[84:87], a[36:39], v[36:39]
    v_mfma_f32_16x16x32_bf16 v[36:39], a[88:91], a[40:43], v[36:39]
    v_mfma_f32_16x16x32_bf16 v[36:39], a[92:95], a[44:47], v[36:39]
    v_mfma_f32_16x16x32_bf16 v[40:43], a[96:99], a[32:35], v[72:75]
    v_mfma_f32_16x16x32_bf16 v[40:43], a[100:103], a[36:39], v[40:43]
    v_mfma_f32_16x16x32_bf16 v[40:43], a[104:107], a[40:43], v[40:43]
    v_mfma_f32_16x16x32_bf16 v[40:43], a[108:111], a[44:47], v[40:43]
    v_mfma_f32_16x16x32_bf16 v[44:47], a[112:115], a[32:35], v[72:75]
    v_mfma_f32_16x16x32_bf16 v[44:47], a[116:119], a[36:39], v[44:47]
    v_mfma_f32_16x16x32_bf16 v[44:47], a[120:123], a[40:43], v[44:47]
    v_mfma_f32_16x16x32_bf16 v[44:47], a[124:127], a[44:47], v[44:47]
    v_mfma_f32_16x16x32_bf16 v[48:51], a[64:67], a[48:51], v[76:79]
    v_mfma_f32_16x16x32_bf16 v[48:51], a[68:71], a[52:55], v[48:51]
    v_mfma_f32_16x16x32_bf16 v[48:51], a[72:75], a[56:59], v[48:51]
    v_mfma_f32_16x16x32_bf16 v[48:51], a[76:79], a[60:63], v[48:51]
    v_mfma_f32_16x16x32_bf16 v[52:55], a[80:83], a[48:51], v[76:79]
    v_mfma_f32_16x16x32_bf16 v[52:55], a[84:87], a[52:55], v[52:55]
    v_mfma_f32_16x16x32_bf16 v[52:55], a[88:91], a[56:59], v[52:55]
    v_mfma_f32_16x16x32_bf16 v[52:55], a[92:95], a[60:63], v[52:55]
    v_mfma_f32_16x16x32_bf16 v[56:59], a[96:99], a[48:51], v[76:79]
    v_mfma_f32_16x16x32_bf16 v[56:59], a[100:103], a[52:55], v[56:59]
    v_mfma_f32_16x16x32_bf16 v[56:59], a[104:107], a[56:59], v[56:59]
    v_mfma_f32_16x16x32_bf16 v[56:59], a[108:111], a[60:63], v[56:59]
    v_mfma_f32_16x16x32_bf16 v[60:63], a[112:115], a[48:51], v[76:79]
    v_mfma_f32_16x16x32_bf16 v[60:63], a[116:119], a[52:55], v[60:63]
    v_mfma_f32_16x16x32_bf16 v[60:63], a[120:123], a[56:59], v[60:63]
    v_mfma_f32_16x16x32_bf16 v[60:63], a[124:127], a[60:63], v[60:63]
    s_cmp_eq_u32 s38, 0
    s_cbranch_scc0 L_ex_pv
    s_nop 7
    v_max3_f32 v116, v116, v0, v1
    v_max3_f32 v116, v116, v2, v3
    v_max3_f32 v116, v116, v4, v5
    v_max3_f32 v116, v116, v6, v7
    v_max3_f32 v116, v116, v8, v9
    v_max3_f32 v116, v116, v10, v11
    v_max3_f32 v116, v116, v12, v13
    v_max3_f32 v116, v116, v14, v15
    v_max3_f32 v117, v117, v16, v17
    v_max3_f32 v117, v117, v18, v19
    v_max3_f32 v117, v117, v20, v21
    v_max3_f32 v117, v117, v22, v23
    v_max3_f32 v117, v117, v24, v25
    v_max3_f32 v117, v117, v26, v27
    v_max3_f32 v117, v117, v28, v29
    v_max3_f32 v117, v117, v30, v31
    v_max3_f32 v118, v118, v32, v33
    v_max3_f32 v118, v118, v34, v35
    v_max3_f32 v118, v118, v36, v37
    v_max3_f32 v118, v118, v38, v39
    v_max3_f32 v118, v118, v40, v41
    v_max3_f32 v118, v118, v42, v43
    v_max3_f32 v118, v118, v44, v45
    v_max3_f32 v118, v118, v46, v47
    v_max3_f32 v119, v119, v48, v49
    v_max3_f32 v119, v119, v50, v51
    v_max3_f32 v119, v119, v52, v53
    v_max3_f32 v119, v119, v54, v55
    v_max3_f32 v119, v119, v56, v57
    v_max3_f32 v119, v119, v58, v59
    v_max3_f32 v119, v119, v60, v61
    v_max3_f32 v119, v119, v62, v63
    s_branch L_ex_next
L_ex_pv:
    s_add_u32 m0, s36, 0
    s_add_u32 s31, s39, 0
    buffer_load_dwordx4 v96, s[8:11], s31 offen offset:0 lds
    buffer_load_dwordx4 v97, s[8:11], s31 offen offset:1024 lds
    buffer_load_dwordx4 v96, s[8:11], s31 offen offset:2048 lds
    buffer_load_dwordx4 v97, s[8:11], s31 offen offset:3072 lds
    s_add_u32 m0, s36, 4096
    s_add_u32 s31, s39, 4096
    buffer_load_dwordx4 v96, s[8:11], s31 offen offset:0 lds
    buffer_load_dwordx4 v97, s[8:11], s31 offen offset:1024 lds
    buffer_load_dwordx4 v96, s[8:11], s31 offen offset:2048 lds
    buffer_load_dwordx4 v97, s[8:11], s31 offen offset:3072 lds
    s_waitcnt vmcnt(0)
    ds_read_b64_tr_b16 a[128:129], v84 offset:0
    ds_read_b64_tr_b16 a[130:131], v84 offset:4096
    ds_read_b64_tr_b16 a[136:137], v85 offset:0
    ds_read_b64_tr_b16 a[138:139], v85 offset:4096
    ds_read_b64_tr_b16 a[144:145], v86 offset:0
    ds_read_b64_tr_b16 a[146:147], v86 offset:4096
    ds_read_b64_tr_b16 a[152:153], v87 offset:0
    ds_read_b64_tr_b16 a[154:155], v87 offset:4096
    ds_read_b64_tr_b16 a[160:161], v88 offset:0
    ds_read_b64_tr_b16 a[162:163], v88 offset:4096
    ds_read_b64_tr_b16 a[168:169], v89 offset:0
    ds_read_b64_tr_b16 a[170:171], v89 offset:4096
    ds_read_b64_tr_b16 a[176:177], v90 offset:0
    ds_read_b64_tr_b16 a[178:179], v90 offset:4096
    ds_read_b64_tr_b16 a[184:185], v91 offset:0
    ds_read_b64_tr_b16 a[186:187], v91 offset:4096
    s_waitcnt lgkmcnt(0)
    s_add_u32 m0, s36, 0
    s_add_u32 s31, s39, 8192
    buffer_load_dwordx4 v96, s[8:11], s31 offen offset:0 lds
    buffer_load_dwordx4 v97, s[8:11], s31 offen offset:1024 lds
    buffer_load_dwordx4 v96, s[8:11], s31 offen offset:2048 lds
    buffer_load_dwordx4 v97, s[8:11], s31 offen offset:3072 lds
    s_add_u32 m0, s36, 4096
    s_add_u32 s31, s39, 12288
    buffer_load_dwordx4 v96, s[8:11], s31 offen offset:0 lds
    buffer_load_dwordx4 v97, s[8:11], s31 offen offset:1024 lds
    buffer_load_dwordx4 v96, s[8:11], s31 offen offset:2048 lds
    buffer_load_dwordx4 v97, s[8:11], s31 offen offset:3072 lds
    s_waitcnt vmcnt(0)
    ds_read_b64_tr_b16 a[132:133], v84 offset:0
    ds_read_b64_tr_b16 a[134:135], v84 offset:4096
    ds_read_b64_tr_b16 a[140:141], v85 offset:0
    ds_read_b64_tr_b16 a[142:143], v85 offset:4096
    ds_read_b64_tr_b16 a[148:149], v86 offset:0
    ds_read_b64_tr_b16 a[150:151], v86 offset:4096
    ds_read_b64_tr_b16 a[156:157], v87 offset:0
    ds_read_b64_tr_b16 a[158:159], v87 offset:4096
    ds_read_b64_tr_b16 a[164:165], v88 offset:0
    ds_read_b64_tr_b16 a[166:167], v88 offset:4096
    ds_read_b64_tr_b16 a[172:173], v89 offset:0
    ds_read_b64_tr_b16 a[174:175], v89 offset:4096
    ds_read_b64_tr_b16 a[180:181], v90 offset:0
    ds_read_b64_tr_b16 a[182:183], v90 offset:4096
    ds_read_b64_tr_b16 a[188:189], v91 offset:0
    ds_read_b64_tr_b16 a[190:191], v91 offset:4096
    s_waitcnt lgkmcnt(0)
    v_exp_f32 v0, v0
    v_exp_f32 v1, v1
    v_exp_f32 v2, v2
    v_exp_f32 v3, v3
    v_exp_f32 v4, v4
    v_exp_f32 v5, v5
    v_exp_f32 v6, v6
    v_exp_f32 v7, v7
    v_exp_f32 v8, v8
    v_exp_f32 v9, v9
    v_exp_f32 v10, v10
    v_exp_f32 v11, v11
    v_exp_f32 v12, v12
    v_exp_f32 v13, v13
    v_exp_f32 v14, v14
    v_exp_f32 v15, v15
    v_exp_f32 v16, v16
    v_exp_f32 v17, v17
    v_exp_f32 v18, v18
    v_exp_f32 v19, v19
    v_exp_f32 v20, v20
    v_exp_f32 v21, v21
    v_exp_f32 v22, v22
    v_exp_f32 v23, v23
    v_exp_f32 v24, v24
    v_exp_f32 v25, v25
    v_exp_f32 v26, v26
    v_exp_f32 v27, v27
    v_exp_f32 v28, v28
    v_exp_f32 v29, v29
    v_exp_f32 v30, v30
    v_exp_f32 v31, v31
    v_exp_f32 v32, v32
    v_exp_f32 v33, v33
    v_exp_f32 v34, v34
    v_exp_f32 v35, v35
    v_exp_f32 v36, v36
    v_exp_f32 v37, v37
    v_exp_f32 v38, v38
    v_exp_f32 v39, v39
    v_exp_f32 v40, v40
    v_exp_f32 v41, v41
    v_exp_f32 v42, v42
    v_exp_f32 v43, v43
    v_exp_f32 v44, v44
    v_exp_f32 v45, v45
    v_exp_f32 v46, v46
    v_exp_f32 v47, v47
    v_exp_f32 v48, v48
    v_exp_f32 v49, v49
    v_exp_f32 v50, v50
    v_exp_f32 v51, v51
    v_exp_f32 v52, v52
    v_exp_f32 v53, v53
    v_exp_f32 v54, v54
    v_exp_f32 v55, v55
    v_exp_f32 v56, v56
    v_exp_f32 v57, v57
    v_exp_f32 v58, v58
    v_exp_f32 v59, v59
    v_exp_f32 v60, v60
    v_exp_f32 v61, v61
    v_exp_f32 v62, v62
    v_exp_f32 v63, v63
    v_add_f32 v98, v98, v0
    v_add_f32 v98, v98, v1
    v_add_f32 v98, v98, v2
    v_add_f32 v98, v98, v3
    v_add_f32 v98, v98, v4
    v_add_f32 v98, v98, v5
    v_add_f32 v98, v98, v6
    v_add_f32 v98, v98, v7
    v_add_f32 v98, v98, v8
    v_add_f32 v98, v98, v9
    v_add_f32 v98, v98, v10
    v_add_f32 v98, v98, v11
    v_add_f32 v98, v98, v12
    v_add_f32 v98, v98, v13
    v_add_f32 v98, v98, v14
    v_add_f32 v98, v98, v15
    v_add_f32 v99, v99, v16
    v_add_f32 v99, v99, v17
    v_add_f32 v99, v99, v18
    v_add_f32 v99, v99, v19
    v_add_f32 v99, v99, v20
    v_add_f32 v99, v99, v21
    v_add_f32 v99, v99, v22
    v_add_f32 v99, v99, v23
    v_add_f32 v99, v99, v24
    v_add_f32 v99, v99, v25
    v_add_f32 v99, v99, v26
    v_add_f32 v99, v99, v27
    v_add_f32 v99, v99, v28
    v_add_f32 v99, v99, v29
    v_add_f32 v99, v99, v30
    v_add_f32 v99, v99, v31
    v_add_f32 v100, v100, v32
    v_add_f32 v100, v100, v33
    v_add_f32 v100, v100, v34
    v_add_f32 v100, v100, v35
    v_add_f32 v100, v100, v36
    v_add_f32 v100, v100, v37
    v_add_f32 v100, v100, v38
    v_add_f32 v100, v100, v39
    v_add_f32 v100, v100, v40
    v_add_f32 v100, v100, v41
    v_add_f32 v100, v100, v42
    v_add_f32 v100, v100, v43
    v_add_f32 v100, v100, v44
    v_add_f32 v100, v100, v45
    v_add_f32 v100, v100, v46
    v_add_f32 v100, v100, v47
    v_add_f32 v101, v101, v48
    v_add_f32 v101, v101, v49
    v_add_f32 v101, v101, v50
    v_add_f32 v101, v101, v51
    v_add_f32 v101, v101, v52
    v_add_f32 v101, v101, v53
    v_add_f32 v101, v101, v54
    v_add_f32 v101, v101, v55
    v_add_f32 v101, v101, v56
    v_add_f32 v101, v101, v57
    v_add_f32 v101, v101, v58
    v_add_f32 v101, v101, v59
    v_add_f32 v101, v101, v60
    v_add_f32 v101, v101, v61
    v_add_f32 v101, v101, v62
    v_add_f32 v101, v101, v63
    v_cvt_pk_bf16_f32 v0, v0, v1
    v_cvt_pk_bf16_f32 v1, v2, v3
    v_cvt_pk_bf16_f32 v2, v4, v5
    v_cvt_pk_bf16_f32 v3, v6, v7
    v_cvt_pk_bf16_f32 v8, v8, v9
    v_cvt_pk_bf16_f32 v9, v10, v11
    v_cvt_pk_bf16_f32 v10, v12, v13
    v_cvt_pk_bf16_f32 v11, v14, v15
    v_cvt_pk_bf16_f32 v16, v16, v17
    v_cvt_pk_bf16_f32 v17, v18, v19
    v_cvt_pk_bf16_f32 v18, v20, v21
    v_cvt_pk_bf16_f32 v19, v22, v23
    v_cvt_pk_bf16_f32 v24, v24, v25
    v_cvt_pk_bf16_f32 v25, v26, v27
    v_cvt_pk_bf16_f32 v26, v28, v29
    v_cvt_pk_bf16_f32 v27, v30, v31
    v_cvt_pk_bf16_f32 v32, v32, v33
    v_cvt_pk_bf16_f32 v33, v34, v35
    v_cvt_pk_bf16_f32 v34, v36, v37
    v_cvt_pk_bf16_f32 v35, v38, v39
    v_cvt_pk_bf16_f32 v40, v40, v41
    v_cvt_pk_bf16_f32 v41, v42, v43
    v_cvt_pk_bf16_f32 v42, v44, v45
    v_cvt_pk_bf16_f32 v43, v46, v47
    v_cvt_pk_bf16_f32 v48, v48, v49
    v_cvt_pk_bf16_f32 v49, v50, v51
    v_cvt_pk_bf16_f32 v50, v52, v53
    v_cvt_pk_bf16_f32 v51, v54, v55
    v_cvt_pk_bf16_f32 v56, v56, v57
    v_cvt_pk_bf16_f32 v57, v58, v59
    v_cvt_pk_bf16_f32 v58, v60, v61
    v_cvt_pk_bf16_f32 v59, v62, v63
    s_waitcnt lgkmcnt(0)
    v_mfma_f32_16x16x32_bf16 v[128:131], a[128:131], v[0:3], v[128:131]
    v_mfma_f32_16x16x32_bf16 v[128:131], a[132:135], v[8:11], v[128:131]
    v_mfma_f32_16x16x32_bf16 v[132:135], a[136:139], v[0:3], v[132:135]
    v_mfma_f32_16x16x32_bf16 v[132:135], a[140:143], v[8:11], v[132:135]
    v_mfma_f32_16x16x32_bf16 v[136:139], a[144:147], v[0:3], v[136:139]
    v_mfma_f32_16x16x32_bf16 v[136:139], a[148:151], v[8:11], v[136:139]
    v_mfma_f32_16x16x32_bf16 v[140:143], a[152:155], v[0:3], v[140:143]
    v_mfma_f32_16x16x32_bf16 v[140:143], a[156:159], v[8:11], v[140:143]
    v_mfma_f32_16x16x32_bf16 v[144:147], a[160:163], v[0:3], v[144:147]
    v_mfma_f32_16x16x32_bf16 v[144:147], a[164:167], v[8:11], v[144:147]
    v_mfma_f32_16x16x32_bf16 v[148:151], a[168:171], v[0:3], v[148:151]
    v_mfma_f32_16x16x32_bf16 v[148:151], a[172:175], v[8:11], v[148:151]
    v_mfma_f32_16x16x32_bf16 v[152:155], a[176:179], v[0:3], v[152:155]
    v_mfma_f32_16x16x32_bf16 v[152:155], a[180:183], v[8:11], v[152:155]
    v_mfma_f32_16x16x32_bf16 v[156:159], a[184:187], v[0:3], v[156:159]
    v_mfma_f32_16x16x32_bf16 v[156:159], a[188:191], v[8:11], v[156:159]
    v_mfma_f32_16x16x32_bf16 v[160:163], a[128:131], v[16:19], v[160:163]
    v_mfma_f32_16x16x32_bf16 v[160:163], a[132:135], v[24:27], v[160:163]
    v_mfma_f32_16x16x32_bf16 v[164:167], a[136:139], v[16:19], v[164:167]
    v_mfma_f32_16x16x32_bf16 v[164:167], a[140:143], v[24:27], v[164:167]
    v_mfma_f32_16x16x32_bf16 v[168:171], a[144:147], v[16:19], v[168:171]
    v_mfma_f32_16x16x32_bf16 v[168:171], a[148:151], v[24:27], v[168:171]
    v_mfma_f32_16x16x32_bf16 v[172:175], a[152:155], v[16:19], v[172:175]
    v_mfma_f32_16x16x32_bf16 v[172:175], a[156:159], v[24:27], v[172:175]
    v_mfma_f32_16x16x32_bf16 v[176:179], a[160:163], v[16:19], v[176:179]
    v_mfma_f32_16x16x32_bf16 v[176:179], a[164:167], v[24:27], v[176:179]
    v_mfma_f32_16x16x32_bf16 v[180:183], a[168:171], v[16:19], v[180:183]
    v_mfma_f32_16x16x32_bf16 v[180:183], a[172:175], v[24:27], v[180:183]
    v_mfma_f32_16x16x32_bf16 v[184:187], a[176:179], v[16:19], v[184:187]
    v_mfma_f32_16x16x32_bf16 v[184:187], a[180:183], v[24:27], v[184:187]
    v_mfma_f32_16x16x32_bf16 v[188:191], a[184:187], v[16:19], v[188:191]
    v_mfma_f32_16x16x32_bf16 v[188:191], a[188:191], v[24:27], v[188:191]
    v_mfma_f32_16x16x32_bf16 v[192:195], a[128:131], v[32:35], v[192:195]
    v_mfma_f32_16x16x32_bf16 v[192:195], a[132:135], v[40:43], v[192:195]
    v_mfma_f32_16x16x32_bf16 v[196:199], a[136:139], v[32:35], v[196:199]
    v_mfma_f32_16x16x32_bf16 v[196:199], a[140:143], v[40:43], v[196:199]
    v_mfma_f32_16x16x32_bf16 v[200:203], a[144:147], v[32:35], v[200:203]
    v_mfma_f32_16x16x32_bf16 v[200:203], a[148:151], v[40:43], v[200:203]
    v_mfma_f32_16x16x32_bf16 v[204:207], a[152:155], v[32:35], v[204:207]
    v_mfma_f32_16x16x32_bf16 v[204:207], a[156:159], v[40:43], v[204:207]
    v_mfma_f32_16x16x32_bf16 v[208:211], a[160:163], v[32:35], v[208:211]
    v_mfma_f32_16x16x32_bf16 v[208:211], a[164:167], v[40:43], v[208:211]
    v_mfma_f32_16x16x32_bf16 v[212:215], a[168:171], v[32:35], v[212:215]
    v_mfma_f32_16x16x32_bf16 v[212:215], a[172:175], v[40:43], v[212:215]
    v_mfma_f32_16x16x32_bf16 v[216:219], a[176:179], v[32:35], v[216:219]
    v_mfma_f32_16x16x32_bf16 v[216:219], a[180:183], v[40:43], v[216:219]
    v_mfma_f32_16x16x32_bf16 v[220:223], a[184:187], v[32:35], v[220:223]
    v_mfma_f32_16x16x32_bf16 v[220:223], a[188:191], v[40:43], v[220:223]
    v_mfma_f32_16x16x32_bf16 v[224:227], a[128:131], v[48:51], v[224:227]
    v_mfma_f32_16x16x32_bf16 v[224:227], a[132:135], v[56:59], v[224:227]
    v_mfma_f32_16x16x32_bf16 v[228:231], a[136:139], v[48:51], v[228:231]
    v_mfma_f32_16x16x32_bf16 v[228:231], a[140:143], v[56:59], v[228:231]
    v_mfma_f32_16x16x32_bf16 v[232:235], a[144:147], v[48:51], v[232:235]
    v_mfma_f32_16x16x32_bf16 v[232:235], a[148:151], v[56:59], v[232:235]
    v_mfma_f32_16x16x32_bf16 v[236:239], a[152:155], v[48:51], v[236:239]
    v_mfma_f32_16x16x32_bf16 v[236:239], a[156:159], v[56:59], v[236:239]
    v_mfma_f32_16x16x32_bf16 v[240:243], a[160:163], v[48:51], v[240:243]
    v_mfma_f32_16x16x32_bf16 v[240:243], a[164:167], v[56:59], v[240:243]
    v_mfma_f32_16x16x32_bf16 v[244:247], a[168:171], v[48:51], v[244:247]
    v_mfma_f32_16x16x32_bf16 v[244:247], a[172:175], v[56:59], v[244:247]
    v_mfma_f32_16x16x32_bf16 v[248:251], a[176:179], v[48:51], v[248:251]
    v_mfma_f32_16x16x32_bf16 v[248:251], a[180:183], v[56:59], v[248:251]
    v_mfma_f32_16x16x32_bf16 v[252:255], a[184:187], v[48:51], v[252:255]
    v_mfma_f32_16x16x32_bf16 v[252:255], a[188:191], v[56:59], v[252:255]
L_ex_next:
    s_add_u32 s39, s39, 16384
    s_cmp_lt_u32 s39, 0x80000
    s_cbranch_scc1 L_ex_tile
    s_cmp_eq_u32 s38, 0
    s_cbranch_scc0 L_ex_done
    v_mov_b32 v104, v116
    s_nop 1
    v_permlane32_swap_b32 v116, v104
    v_max_f32 v116, v116, v104
    v_mov_b32 v104, v116
    s_nop 1
    v_permlane16_swap_b32 v116, v104
    v_max_f32 v116, v116, v104
    v_sub_f32 v64, 0, v116
    v_sub_f32 v65, 0, v116
    v_sub_f32 v66, 0, v116
    v_sub_f32 v67, 0, v116
    v_mov_b32 v104, v117
    s_nop 1
    v_permlane32_swap_b32 v117, v104
    v_max_f32 v117, v117, v104
    v_mov_b32 v104, v117
    s_nop 1
    v_permlane16_swap_b32 v117, v104
    v_max_f32 v117, v117, v104
    v_sub_f32 v68, 0, v117
    v_sub_f32 v69, 0, v117
    v_sub_f32 v70, 0, v117
    v_sub_f32 v71, 0, v117
    v_mov_b32 v104, v118
    s_nop 1
    v_permlane32_swap_b32 v118, v104
    v_max_f32 v118, v118, v104
    v_mov_b32 v104, v118
    s_nop 1
    v_permlane16_swap_b32 v118, v104
    v_max_f32 v118, v118, v104
    v_sub_f32 v72, 0, v118
    v_sub_f32 v73, 0, v118
    v_sub_f32 v74, 0, v118
    v_sub_f32 v75, 0, v118
    v_mov_b32 v104, v119
    s_nop 1
    v_permlane32_swap_b32 v119, v104
    v_max_f32 v119, v119, v104
    v_mov_b32 v104, v119
    s_nop 1
    v_permlane16_swap_b32 v119, v104
    v_max_f32 v119, v119, v104
    v_sub_f32 v76, 0, v119
    v_sub_f32 v77, 0, v119
    v_sub_f32 v78, 0, v119
    v_sub_f32 v79, 0, v119
    s_mov_b32 s38, 1
    s_branch L_ex_sweep
L_ex_done:
    v_mov_b32 v104, v98
    s_nop 1
    v_permlane32_swap_b32 v98, v104
    v_add_f32 v98, v98, v104
    v_mov_b32 v104, v98
    s_nop 1
    v_permlane16_swap_b32 v98, v104
    v_add_f32 v98, v98, v104
    v_mov_b32 v104, v99
    s_nop 1
    v_permlane32_swap_b32 v99, v104
    v_add_f32 v99, v99, v104
    v_mov_b32 v104, v99
    s_nop 1
    v_permlane16_swap_b32 v99, v104
    v_add_f32 v99, v99, v104
    v_mov_b32 v104, v100
    s_nop 1
    v_permlane32_swap_b32 v100, v104
    v_add_f32 v100, v100, v104
    v_mov_b32 v104, v100
    s_nop 1
    v_permlane16_swap_b32 v100, v104
    v_add_f32 v100, v100, v104
    v_mov_b32 v104, v101
    s_nop 1
    v_permlane32_swap_b32 v101, v104
    v_add_f32 v101, v101, v104
    v_mov_b32 v104, v101
    s_nop 1
    v_permlane16_swap_b32 v101, v104
    v_add_f32 v101, v101, v104
    v_rcp_f32 v108, v98
    v_rcp_f32 v109, v99
    v_lshlrev_b32 v112, 4, v102
    s_lshl_b32 s28, s22, 4
    s_lshl_b32 s29, s20, 2
    s_add_u32 s28, s28, s29
    s_lshl_b32 s28, s28, 10
    s_lshl_b32 s29, s21, 19
    s_add_u32 s28, s28, s29
    s_lshl_b32 s29, s65, 6
    s_add_u32 s28, s28, s29
    s_xor_b32 s29, s28, 2048
    v_pk_mul_f32 v[128:129], v[128:129], v[108:109] op_sel:[0,0] op_sel_hi:[1,0]
    v_pk_mul_f32 v[130:131], v[130:131], v[108:109] op_sel:[0,0] op_sel_hi:[1,0]
    v_pk_mul_f32 v[132:133], v[132:133], v[108:109] op_sel:[0,0] op_sel_hi:[1,0]
    v_pk_mul_f32 v[134:135], v[134:135], v[108:109] op_sel:[0,0] op_sel_hi:[1,0]
    v_cvt_pk_bf16_f32 v0, v128, v129
    v_cvt_pk_bf16_f32 v1, v130, v131
    v_cvt_pk_bf16_f32 v2, v132, v133
    v_cvt_pk_bf16_f32 v3, v134, v135
    buffer_store_dwordx4 v[0:3], v112, s[12:15], s28 offen offset:0 sc1
    v_pk_mul_f32 v[160:161], v[160:161], v[108:109] op_sel:[0,1] op_sel_hi:[1,1]
    v_pk_mul_f32 v[162:163], v[162:163], v[108:109] op_sel:[0,1] op_sel_hi:[1,1]
    v_pk_mul_f32 v[164:165], v[164:165], v[108:109] op_sel:[0,1] op_sel_hi:[1,1]
    v_pk_mul_f32 v[166:167], v[166:167], v[108:109] op_sel:[0,1] op_sel_hi:[1,1]
    v_cvt_pk_bf16_f32 v4, v160, v161
    v_cvt_pk_bf16_f32 v5, v162, v163
    v_cvt_pk_bf16_f32 v6, v164, v165
    v_cvt_pk_bf16_f32 v7, v166, v167
    buffer_store_dwordx4 v[4:7], v112, s[12:15], s28 offen offset:1024 sc1
    s_add_u32 s28, s28, 0x20000
    v_pk_mul_f32 v[136:137], v[136:137], v[108:109] op_sel:[0,0] op_sel_hi:[1,0]
    v_pk_mul_f32 v[138:139], v[138:139], v[108:109] op_sel:[0,0] op_sel_hi:[1,0]
    v_pk_mul_f32 v[140:141], v[140:141], v[108:109] op_sel:[0,0] op_sel_hi:[1,0]
    v_pk_mul_f32 v[142:143], v[142:143], v[108:109] op_sel:[0,0] op_sel_hi:[1,0]
    v_cvt_pk_bf16_f32 v8, v136, v137
    v_cvt_pk_bf16_f32 v9, v138, v139
    v_cvt_pk_bf16_f32 v10, v140, v141
    v_cvt_pk_bf16_f32 v11, v142, v143
    buffer_store_dwordx4 v[8:11], v112, s[12:15], s28 offen offset:0 sc1
    v_pk_mul_f32 v[168:169], v[168:169], v[108:109] op_sel:[0,1] op_sel_hi:[1,1]
    v_pk_mul_f32 v[170:171], v[170:171], v[108:109] op_sel:[0,1] op_sel_hi:[1,1]
    v_pk_mul_f32 v[172:173], v[172:173], v[108:109] op_sel:[0,1] op_sel_hi:[1,1]
    v_pk_mul_f32 v[174:175], v[174:175], v[108:109] op_sel:[0,1] op_sel_hi:[1,1]
    v_cvt_pk_bf16_f32 v12, v168, v169
    v_cvt_pk_bf16_f32 v13, v170, v171
    v_cvt_pk_bf16_f32 v14, v172, v173
    v_cvt_pk_bf16_f32 v15, v174, v175
    buffer_store_dwordx4 v[12:15], v112, s[12:15], s28 offen offset:1024 sc1
    s_add_u32 s28, s28, 0x20000
    v_pk_mul_f32 v[144:145], v[144:145], v[108:109] op_sel:[0,0] op_sel_hi:[1,0]
    v_pk_mul_f32 v[146:147], v[146:147], v[108:109] op_sel:[0,0] op_sel_hi:[1,0]
    v_pk_mul_f32 v[148:149], v[148:149], v[108:109] op_sel:[0,0] op_sel_hi:[1,0]
    v_pk_mul_f32 v[150:151], v[150:151], v[108:109] op_sel:[0,0] op_sel_hi:[1,0]
    v_cvt_pk_bf16_f32 v0, v144, v145
    v_cvt_pk_bf16_f32 v1, v146, v147
    v_cvt_pk_bf16_f32 v2, v148, v149
    v_cvt_pk_bf16_f32 v3, v150, v151
    buffer_store_dwordx4 v[0:3], v112, s[12:15], s28 offen offset:0 sc1
    v_pk_mul_f32 v[176:177], v[176:177], v[108:109] op_sel:[0,1] op_sel_hi:[1,1]
    v_pk_mul_f32 v[178:179], v[178:179], v[108:109] op_sel:[0,1] op_sel_hi:[1,1]
    v_pk_mul_f32 v[180:181], v[180:181], v[108:109] op_sel:[0,1] op_sel_hi:[1,1]
    v_pk_mul_f32 v[182:183], v[182:183], v[108:109] op_sel:[0,1] op_sel_hi:[1,1]
    v_cvt_pk_bf16_f32 v4, v176, v177
    v_cvt_pk_bf16_f32 v5, v178, v179
    v_cvt_pk_bf16_f32 v6, v180, v181
    v_cvt_pk_bf16_f32 v7, v182, v183
    buffer_store_dwordx4 v[4:7], v112, s[12:15], s28 offen offset:1024 sc1
    s_add_u32 s28, s28, 0x20000
    v_pk_mul_f32 v[152:153], v[152:153], v[108:109] op_sel:[0,0] op_sel_hi:[1,0]
    v_pk_mul_f32 v[154:155], v[154:155], v[108:109] op_sel:[0,0] op_sel_hi:[1,0]
    v_pk_mul_f32 v[156:157], v[156:157], v[108:109] op_sel:[0,0] op_sel_hi:[1,0]
    v_pk_mul_f32 v[158:159], v[158:159], v[108:109] op_sel:[0,0] op_sel_hi:[1,0]
    v_cvt_pk_bf16_f32 v8, v152, v153
    v_cvt_pk_bf16_f32 v9, v154, v155
    v_cvt_pk_bf16_f32 v10, v156, v157
    v_cvt_pk_bf16_f32 v11, v158, v159
    buffer_store_dwordx4 v[8:11], v112, s[12:15], s28 offen offset:0 sc1
    v_pk_mul_f32 v[184:185], v[184:185], v[108:109] op_sel:[0,1] op_sel_hi:[1,1]
    v_pk_mul_f32 v[186:187], v[186:187], v[108:109] op_sel:[0,1] op_sel_hi:[1,1]
    v_pk_mul_f32 v[188:189], v[188:189], v[108:109] op_sel:[0,1] op_sel_hi:[1,1]
    v_pk_mul_f32 v[190:191], v[190:191], v[108:109] op_sel:[0,1] op_sel_hi:[1,1]
    v_cvt_pk_bf16_f32 v12, v184, v185
    v_cvt_pk_bf16_f32 v13, v186, v187
    v_cvt_pk_bf16_f32 v14, v188, v189
    v_cvt_pk_bf16_f32 v15, v190, v191
    buffer_store_dwordx4 v[12:15], v112, s[12:15], s28 offen offset:1024 sc1
    s_branch L_attn_finish
L_code_end:
.section .rodata,"a"
.p2align 6
.amdhsa_kernel recurrent_scan__mha_block_cached__mixer_channel_mlp__prompt_kernel
.amdhsa_next_free_vgpr 512
.amdhsa_next_free_sgpr 102
.amdhsa_accum_offset 256
.amdhsa_group_segment_fixed_size 0
.amdhsa_kernarg_size 104
.amdhsa_user_sgpr_count 2
.amdhsa_user_sgpr_kernarg_segment_ptr 1
.amdhsa_system_sgpr_workgroup_id_x 1
.end_amdhsa_kernel
```
